```python
import torch

def _softmax(x, axis=-1):
    return torch.softmax(x, dim=axis)
def _gelu(x):
    return torch.nn.functional.gelu(x, approximate="tanh")
def _silu(x):
    return torch.nn.functional.silu(x)
def _sigmoid(x):
    return torch.sigmoid(x)
def _layernorm(x, axis=-1, eps=1e-5):
    m = x.mean(dim=axis, keepdim=True)
    v = x.var(dim=axis, keepdim=True, unbiased=False)
    return (x - m) / torch.sqrt(v + eps)
def _scatter_add(tgt, idx, src, axis=0):
    return tgt.clone().index_add_(axis, idx, src)
def _segment_sum(src, seg, n):
    out = torch.zeros((n,) + src.shape[1:], dtype=src.dtype)
    return out.index_add_(0, seg, src)
def _pad(x, pw):
    flat = tuple(v for pair in reversed(pw) for v in pair)
    return torch.nn.functional.pad(x, flat)

kernel_name = 'gated_mix__grouped_kv_mqa__dense_activation_squared_relu__prompt'

def setup_inputs():

    _w = (lambda a: (lambda t: t.to(torch.bfloat16) if t.is_floating_point() else t)(torch.as_tensor(a)))
    def _A_setup():
        B, S, D, H = 1, 2048, 1024, 32
        Dh = D // H
        return {
            "x": _w((lambda *s: torch.randn(*s, dtype=torch.bfloat16) * 0.05)(B, S, D)),
            "wq": _w((lambda *s: torch.randn(*s, dtype=torch.bfloat16) * 0.8)(D, H * Dh)),
            "wk": _w((lambda *s: torch.randn(*s, dtype=torch.bfloat16) * 0.8)(D, Dh)),
            "wv": _w((lambda *s: torch.randn(*s, dtype=torch.bfloat16) * 0.1)(D, Dh)),
            "wo": _w((lambda *s: torch.randn(*s, dtype=torch.bfloat16) * 0.1)(H * Dh, D)),
        }
    _A_in = _A_setup()

    def _B_setup():
        B, S, D, F = 1, 2048, 1024, 3584
        return {
            "x": _w((lambda *s: torch.randn(*s, dtype=torch.bfloat16) * 0.05)(B, S, D)),
            "w1": _w((lambda *s: torch.randn(*s, dtype=torch.bfloat16) * 0.05)(D, F)),
            "b1": _w((lambda *s: torch.randn(*s, dtype=torch.bfloat16) * 0.05)(F)),
            "w2": _w((lambda *s: torch.randn(*s, dtype=torch.bfloat16) * 0.05)(F, D)),
            "b2": _w((lambda *s: torch.randn(*s, dtype=torch.bfloat16) * 0.05)(D)),
        }
    _B_in = _B_setup()

    return {
        "A_x": _A_in["x"],
        "A_wq": _A_in["wq"],
        "A_wk": _A_in["wk"],
        "A_wv": _A_in["wv"],
        "A_wo": _A_in["wo"],
        "B_x": _B_in["x"],
        "B_w1": _B_in["w1"],
        "B_b1": _B_in["b1"],
        "B_w2": _B_in["w2"],
        "B_b2": _B_in["b2"],
        "gate_w": _w((lambda *s: torch.randn(*s, dtype=torch.bfloat16) * 0.05)(1024) * 16.0),
    }

def reference(A_x, A_wq, A_wk, A_wv, A_wo, B_x, B_w1, B_b1, B_w2, B_b2, gate_w):
    def _A_ref(x, wq, wk, wv, wo):
        B, S, D = x.shape
        H = 32
        Dh = D // H
        q = (lambda x, *d: x.permute(*d))((x @ wq).reshape(B, S, H, Dh), 0, 2, 1, 3)
        k = x @ wk
        v = x @ wv
        scores = torch.einsum("bhqd,bkd->bhqk", q, k) * (Dh ** -0.5)
        p = _softmax(scores, axis=-1)
        o = torch.einsum("bhqk,bkd->bhqd", p, v)
        return (lambda x, *d: x.permute(*d))(o, 0, 2, 1, 3).reshape(B, S, H * Dh) @ wo

    def _B_ref(x, w1, b1, w2, b2):
        h = torch.einsum("bsd,df->bsf", x, w1) + b1
        zero = torch.zeros_like(h)
        r = torch.where(h > zero, h, zero)
        h = r * r
        out = torch.einsum("bsf,fd->bsd", h, w2) + b2
        return out

    x = A_x
    g = _sigmoid((x * gate_w).sum(-1, keepdims=True))
    a = _A_ref(x, A_wq, A_wk, A_wv, A_wo)
    b = _B_ref(x, B_w1, B_b1, B_w2, B_b2)
    return g * a + (1 - g) * b
```

```asm
; @launch grid=(256,1,1) block=(512,1,1) lds=163840
.amdgcn_target "amdgcn-amd-amdhsa--gfx950"
.text
.globl gated_mix__grouped_kv_mqa__dense_activation_squared_relu__prompt_kernel
.p2align 8
.type gated_mix__grouped_kv_mqa__dense_activation_squared_relu__prompt_kernel,@function
gated_mix__grouped_kv_mqa__dense_activation_squared_relu__prompt_kernel:
  s_cmp_ge_u32 s2, 256
  s_cbranch_scc1 L_exit
  s_load_dwordx16 s[16:31], s[0:1], 0
  s_load_dwordx8 s[32:39], s[0:1], 64
  s_load_dwordx4 s[40:43], s[0:1], 96
  v_lshrrev_b32 v2, 6, v0
  v_and_b32 v0, 63, v0
  v_readfirstlane_b32 s3, v2

  s_lshr_b32 s12, s2, 3
  s_and_b32 s5, s2, 1
  s_lshl_b32 s5, s5, 3
  s_and_b32 s13, s12, 7
  s_add_u32 s5, s5, s13
  s_bfe_u32 s6, s2, 0x20001
  s_lshl_b32 s6, s6, 2
  s_lshr_b32 s13, s12, 3
  s_add_u32 s6, s6, s13
  s_bfe_u32 s7, s2, 0x20001
  s_lshl_b32 s7, s7, 2
  s_and_b32 s13, s12, 3
  s_add_u32 s7, s7, s13
  s_and_b32 s8, s2, 1
  s_lshr_b32 s9, s12, 2
  s_and_b32 s4, s3, 3

  s_cmp_ge_u32 s3, 4
  s_cbranch_scc1 L_prole
  s_mov_b64 exec, 0
  s_cmp_eq_u32 s4, 0
  s_cbranch_scc1 L_crole
  s_cmp_eq_u32 s4, 1
  s_cbranch_scc1 L_pad_884
  s_cmp_eq_u32 s4, 2
  s_cbranch_scc1 L_pad_17
  s_branch L_pad_34
L_prole:
  s_getpc_b64 s[60:61]
L_pc0:
  s_mov_b32 s62, L_exit-L_pc0
  s_mov_b32 s63, 0x20000
  s_lshl_b32 s12, s12, 2
  s_add_u32 s12, s12, s4
  s_mul_i32 s12, s12, 768
  v_lshlrev_b32 v4, 7, v0
  s_mov_b64 exec, 63
  buffer_load_dword v255, v4, s[60:63], s12 offen
  s_mov_b64 exec, -1
  s_add_u32 s12, s5, s6
  s_and_b32 s69, s12, 3
  s_mov_b32 s10, 1984246288
  s_mov_b32 s11, 4274895497
  s_cmp_eq_u32 s69, 1
  s_cselect_b32 s10, 1969500448, s10
  s_cselect_b32 s11, 4260149672, s11
  s_cmp_eq_u32 s69, 2
  s_cselect_b32 s10, 1733566768, s10
  s_cselect_b32 s11, 4024216472, s11
  s_cmp_eq_u32 s69, 3
  s_cselect_b32 s10, 2253594944, s10
  s_cselect_b32 s11, 4275817111, s11
  s_mov_b32 s74, 0
  v_lshrrev_b32 v3, 3, v0
  v_and_b32 v4, 7, v0
  s_lshl_b32 s12, s5, 7
  s_lshl_b32 s13, s4, 5
  s_add_u32 s12, s12, s13
  v_add_u32 v5, s12, v3
  v_lshlrev_b32 v5, 11, v5
  v_lshrrev_b32 v6, 1, v3
  v_xor_b32 v7, v4, v6
  v_lshl_add_u32 v16, v7, 4, v5
  v_xor_b32 v17, 64, v16
  v_add_u32 v17, 0x4000, v17
  v_add_u32 v18, 0x8000, v16
  v_add_u32 v19, 0x8000, v17
  s_add_u32 s12, s10, s74
  s_and_b32 s12, s12, 15
  s_lshr_b64 s[10:11], s[10:11], 4
  s_lshl_b32 s70, s12, 7
  s_lshl_b32 s71, s12, 17
  s_mul_i32 s72, s12, 458752
  s_waitcnt lgkmcnt(0)
  s_mov_b32 s44, s16
  s_mov_b32 s45, s17
  s_mov_b32 s46, 4194304
  s_mov_b32 s47, 0x20000
  s_lshl_b32 s26, s4, 12
  s_lshl_b32 s27, s4, 11
  s_mul_i32 s73, s4, 7168
  s_setprio 1
  s_add_u32 m0, s26, 90112
  s_nop 0
  buffer_load_dwordx4 v16, s[44:47], s70 offen lds
  s_add_u32 m0, s26, 91136
  s_nop 0
  buffer_load_dwordx4 v17, s[44:47], s70 offen lds
  s_add_u32 m0, s26, 92160
  s_nop 0
  buffer_load_dwordx4 v18, s[44:47], s70 offen lds
  s_add_u32 m0, s26, 93184
  s_nop 0
  buffer_load_dwordx4 v19, s[44:47], s70 offen lds
  s_mov_b32 s48, s18
  s_mov_b32 s49, s19
  s_mov_b32 s50, 2097152
  s_mov_b32 s51, 0x20000
  s_mov_b32 s52, s28
  s_mov_b32 s53, s29
  s_mov_b32 s54, 7340032
  s_mov_b32 s55, 0x20000
  s_lshl_b32 s12, s4, 4
  v_add_u32 v5, s12, v3
  v_lshlrev_b32 v5, 11, v5
  v_and_b32 v7, 1, v6
  v_lshlrev_b32 v7, 1, v7
  v_xor_b32 v7, v4, v7
  v_lshl_add_u32 v7, v7, 4, v5
  s_lshl_b32 s13, s6, 7
  v_add_u32 v20, s13, v7
  v_xor_b32 v21, 64, v20
  v_add_u32 v21, 0x4000, v21
  s_add_u32 m0, s27, 135168
  s_nop 0
  buffer_load_dwordx4 v20, s[48:51], s71 offen lds
  s_add_u32 m0, s27, 136192
  s_nop 0
  buffer_load_dwordx4 v21, s[48:51], s71 offen lds
  s_mul_i32 s13, s6, 448
  s_mul_i32 s12, s12, 7168
  s_add_u32 s13, s13, s12
  v_add_u32 v5, 0, v0
  v_mul_u32_u24 v7, 2341, v5
  v_lshrrev_b32 v7, 16, v7
  v_lshrrev_b32 v8, 3, v7
  v_lshlrev_b32 v8, 1, v8
  v_xor_b32 v5, v5, v8
  v_mul_u32_u24 v7, 6720, v7
  v_lshl_add_u32 v7, v5, 4, v7
  v_add_u32 v22, s13, v7
  s_add_u32 m0, s73, 106496
  s_nop 0
  buffer_load_dwordx4 v22, s[52:55], s72 offen lds
  v_add_u32 v5, 64, v0
  v_mul_u32_u24 v7, 2341, v5
  v_lshrrev_b32 v7, 16, v7
  v_lshrrev_b32 v8, 3, v7
  v_lshlrev_b32 v8, 1, v8
  v_xor_b32 v5, v5, v8
  v_mul_u32_u24 v7, 6720, v7
  v_lshl_add_u32 v7, v5, 4, v7
  v_add_u32 v23, s13, v7
  s_add_u32 m0, s73, 107520
  s_nop 0
  buffer_load_dwordx4 v23, s[52:55], s72 offen lds
  v_add_u32 v5, 128, v0
  v_mul_u32_u24 v7, 2341, v5
  v_lshrrev_b32 v7, 16, v7
  v_lshrrev_b32 v8, 3, v7
  v_lshlrev_b32 v8, 1, v8
  v_xor_b32 v5, v5, v8
  v_mul_u32_u24 v7, 6720, v7
  v_lshl_add_u32 v7, v5, 4, v7
  v_add_u32 v24, s13, v7
  s_add_u32 m0, s73, 108544
  s_nop 0
  buffer_load_dwordx4 v24, s[52:55], s72 offen lds
  v_add_u32 v5, 192, v0
  v_mul_u32_u24 v7, 2341, v5
  v_lshrrev_b32 v7, 16, v7
  v_lshrrev_b32 v8, 3, v7
  v_lshlrev_b32 v8, 1, v8
  v_xor_b32 v5, v5, v8
  v_mul_u32_u24 v7, 6720, v7
  v_lshl_add_u32 v7, v5, 4, v7
  v_add_u32 v25, s13, v7
  s_add_u32 m0, s73, 109568
  s_nop 0
  buffer_load_dwordx4 v25, s[52:55], s72 offen lds
  v_add_u32 v5, 256, v0
  v_mul_u32_u24 v7, 2341, v5
  v_lshrrev_b32 v7, 16, v7
  v_lshrrev_b32 v8, 3, v7
  v_lshlrev_b32 v8, 1, v8
  v_xor_b32 v5, v5, v8
  v_mul_u32_u24 v7, 6720, v7
  v_lshl_add_u32 v7, v5, 4, v7
  v_add_u32 v26, s13, v7
  s_add_u32 m0, s73, 110592
  s_nop 0
  buffer_load_dwordx4 v26, s[52:55], s72 offen lds
  v_add_u32 v5, 320, v0
  v_mul_u32_u24 v7, 2341, v5
  v_lshrrev_b32 v7, 16, v7
  v_lshrrev_b32 v8, 3, v7
  v_lshlrev_b32 v8, 1, v8
  v_xor_b32 v5, v5, v8
  v_mul_u32_u24 v7, 6720, v7
  v_lshl_add_u32 v7, v5, 4, v7
L_pad_17:
  s_cbranch_execz L_crole
  v_add_u32 v27, s13, v7
  s_add_u32 m0, s73, 111616
  s_nop 0
  buffer_load_dwordx4 v27, s[52:55], s72 offen lds
  v_add_u32 v5, 384, v0
  v_mul_u32_u24 v7, 2341, v5
  v_lshrrev_b32 v7, 16, v7
  v_lshrrev_b32 v8, 3, v7
  v_lshlrev_b32 v8, 1, v8
  v_xor_b32 v5, v5, v8
  v_mul_u32_u24 v7, 6720, v7
  v_lshl_add_u32 v7, v5, 4, v7
  v_add_u32 v28, s13, v7
  s_add_u32 m0, s73, 112640
  s_nop 0
  buffer_load_dwordx4 v28, s[52:55], s72 offen lds
  s_setprio 0
  s_add_u32 s12, s10, s74
  s_and_b32 s12, s12, 15
  s_lshr_b64 s[10:11], s[10:11], 4
  s_lshl_b32 s70, s12, 7
  s_lshl_b32 s71, s12, 17
  s_mul_i32 s72, s12, 458752
  s_add_u32 m0, s26, 0
  s_nop 0
  buffer_load_dwordx4 v16, s[44:47], s70 offen lds
  s_add_u32 m0, s26, 1024
  s_nop 0
  buffer_load_dwordx4 v17, s[44:47], s70 offen lds
  s_add_u32 m0, s26, 2048
  s_nop 0
  buffer_load_dwordx4 v18, s[44:47], s70 offen lds
  s_add_u32 m0, s26, 3072
  s_nop 0
  buffer_load_dwordx4 v19, s[44:47], s70 offen lds
  s_mov_b32 s64, s42
  s_mov_b32 s65, s43
  s_mov_b32 s66, 28311552
  s_mov_b32 s67, 0x20000
  s_bitcmp1_b32 s6, 0
  s_cselect_b32 s56, s22, s20
  s_cselect_b32 s57, s23, s21
  s_mov_b32 s58, 65536
  s_mov_b32 s59, 0x20000
  s_mov_b32 s60, s36
  s_mov_b32 s61, s37
  s_mov_b32 s62, 2048
  s_mov_b32 s63, 0x20000
  v_lshlrev_b32 v10, 4, v0
  v_lshlrev_b32 v6, 1, v6
  v_xor_b32 v6, v4, v6
  s_lshl_b32 s12, s4, 3
  v_add_u32 v5, s12, v3
  v_lshlrev_b32 v5, 11, v5
  v_lshl_add_u32 v5, v6, 4, v5
  s_lshl_b32 s12, s9, 8
  s_lshl_b32 s13, s8, 7
  s_add_u32 s12, s12, s13
  v_add_u32 v15, s12, v5
  s_lshl_b32 s12, s4, 11
  v_add_u32 v29, s12, v10
  s_lshr_b32 s75, s6, 1
  s_lshl_b32 s75, s75, 4
  s_lshl_b32 s12, s5, 7
  s_add_u32 s12, s12, s75
  v_lshrrev_b32 v5, 2, v0
  v_and_b32 v6, 3, v0
  v_add_u32 v7, s12, v5
  v_lshlrev_b32 v7, 11, v7
  v_lshl_add_u32 v7, v6, 4, v7
  s_lshl_b32 s12, s4, 6
  v_add_u32 v30, s12, v7
  s_lshr_b32 s68, s74, 1
  v_add_u32 v7, s68, v5
  v_and_b32 v7, 7, v7
  v_lshlrev_b32 v7, 8, v7
  v_lshl_add_u32 v7, v6, 4, v7
  v_add_u32 v2, s12, v7
  s_mul_i32 s12, s4, 3072
  s_add_u32 s12, s12, 151552
  s_mov_b32 s69, s12
  v_add_u32 v31, s12, v10
  v_lshlrev_b32 v6, 3, v6
  v_lshl_add_u32 v6, v5, 6, v6
  v_add_u32 v32, s12, v6
  v_lshrrev_b32 v5, 4, v0
  v_lshl_add_u32 v34, v5, 3, s12
  v_and_b32 v6, 15, v0
  v_lshl_add_u32 v33, v6, 6, v34
  v_mov_b32 v48, 0
  v_mov_b32 v49, 0
  v_mov_b32 v50, 0
  v_mov_b32 v51, 0
  v_mov_b32 v52, 0
  v_mov_b32 v53, 0
  v_mov_b32 v54, 0
  v_mov_b32 v55, 0
  v_mov_b32 v56, 0
  v_mov_b32 v57, 0
  v_mov_b32 v58, 0
  v_mov_b32 v59, 0
  s_waitcnt vmcnt(4)
  s_barrier
  s_setprio 3
  s_add_u32 m0, s73, 16384
  s_nop 0
  buffer_load_dwordx4 v22, s[52:55], s72 offen lds
  s_add_u32 m0, s73, 17408
  s_nop 0
  buffer_load_dwordx4 v23, s[52:55], s72 offen lds
  s_add_u32 m0, s73, 18432
  s_nop 0
  buffer_load_dwordx4 v24, s[52:55], s72 offen lds
  s_add_u32 m0, s73, 19456
  s_nop 0
  buffer_load_dwordx4 v25, s[52:55], s72 offen lds
  s_add_u32 m0, s73, 20480
  s_nop 0
  buffer_load_dwordx4 v26, s[52:55], s72 offen lds
  s_add_u32 m0, s73, 21504
  s_nop 0
  buffer_load_dwordx4 v27, s[52:55], s72 offen lds
  s_add_u32 m0, s73, 22528
  s_nop 0
  buffer_load_dwordx4 v28, s[52:55], s72 offen lds
  s_add_u32 m0, s27, 143360
  s_nop 0
  buffer_load_dwordx4 v20, s[48:51], s71 offen lds
  s_add_u32 m0, s27, 144384
  s_nop 0
  buffer_load_dwordx4 v21, s[48:51], s71 offen lds
  s_mov_b32 m0, s69
  s_nop 0
  buffer_load_dwordx4 v2, s[60:63], 0 offen lds
  s_setprio 0
  s_add_u32 s12, s10, s74
  s_and_b32 s12, s12, 15
  s_lshr_b64 s[10:11], s[10:11], 4
  s_lshl_b32 s70, s12, 7
  s_lshl_b32 s71, s12, 17
  s_mul_i32 s72, s12, 458752
  s_add_u32 m0, s26, 45056
  s_nop 0
  buffer_load_dwordx4 v16, s[44:47], s70 offen lds
  s_add_u32 m0, s26, 46080
  s_nop 0
  buffer_load_dwordx4 v17, s[44:47], s70 offen lds
  s_add_u32 m0, s26, 47104
  s_nop 0
  buffer_load_dwordx4 v18, s[44:47], s70 offen lds
  s_add_u32 m0, s26, 48128
  s_nop 0
  buffer_load_dwordx4 v19, s[44:47], s70 offen lds
  s_add_u32 m0, s73, 61440
  s_nop 0
  buffer_load_dwordx4 v22, s[52:55], s72 offen lds
  s_add_u32 m0, s73, 62464
  s_nop 0
  buffer_load_dwordx4 v23, s[52:55], s72 offen lds
  s_add_u32 m0, s73, 63488
  s_nop 0
  buffer_load_dwordx4 v24, s[52:55], s72 offen lds
  s_waitcnt vmcnt(7)
  ds_read_b64 v[160:161], v34 offset:0
  ds_read_b64 v[162:163], v34 offset:32
  ds_read_b64 v[164:165], v34 offset:64
  ds_read_b64 v[166:167], v34 offset:96
  ds_read_b64 v[168:169], v34 offset:128
  ds_read_b64 v[170:171], v34 offset:160
  ds_read_b64 v[172:173], v34 offset:192
  ds_read_b64 v[174:175], v34 offset:224
  ds_read_b64 v[176:177], v34 offset:256
  ds_read_b64 v[178:179], v34 offset:288
  ds_read_b64 v[180:181], v34 offset:320
  ds_read_b64 v[182:183], v34 offset:352
  s_waitcnt lgkmcnt(4)
  ds_read_b64 v[184:185], v34 offset:384
  ds_read_b64 v[186:187], v34 offset:416
  ds_read_b64 v[188:189], v34 offset:448
  ds_read_b64 v[190:191], v34 offset:480
  s_barrier
  s_setprio 3
  s_add_u32 m0, s73, 64512
  s_nop 0
  buffer_load_dwordx4 v25, s[52:55], s72 offen lds
  s_add_u32 m0, s73, 65536
  s_nop 0
L_pad_34:
  s_cbranch_execz L_crole
  buffer_load_dwordx4 v26, s[52:55], s72 offen lds
  s_add_u32 m0, s73, 66560
  s_nop 0
  buffer_load_dwordx4 v27, s[52:55], s72 offen lds
  s_add_u32 m0, s73, 67584
  s_nop 0
  buffer_load_dwordx4 v28, s[52:55], s72 offen lds
  s_add_u32 m0, s27, 135168
  s_nop 0
  buffer_load_dwordx4 v20, s[48:51], s71 offen lds
  s_add_u32 m0, s27, 136192
  s_nop 0
  buffer_load_dwordx4 v21, s[48:51], s71 offen lds
  s_waitcnt lgkmcnt(0)
  s_add_u32 s13, s68, 0
  s_and_b32 s13, s13, 7
  s_mov_b32 m0, s69
  s_lshl_b32 s12, s13, 13
  buffer_load_dwordx4 v29, s[56:59], s12 offen offset:0 lds
  s_mov_b32 m0, s69
  s_lshl_b32 s12, s13, 13
  buffer_load_dwordx4 v29, s[56:59], s12 offen offset:1024 lds
  s_add_u32 m0, s69, 2048
  s_lshl_b32 s12, s13, 8
  buffer_load_dwordx4 v30, s[44:47], s12 offen lds
  s_setprio 0
  s_add_u32 s12, s10, s74
  s_and_b32 s12, s12, 15
  s_lshr_b64 s[10:11], s[10:11], 4
  s_lshl_b32 s70, s12, 7
  s_lshl_b32 s71, s12, 17
  s_mul_i32 s72, s12, 458752
  s_add_u32 m0, s26, 90112
  s_nop 0
  buffer_load_dwordx4 v16, s[44:47], s70 offen lds
  s_add_u32 m0, s26, 91136
  s_nop 0
  buffer_load_dwordx4 v17, s[44:47], s70 offen lds
  s_add_u32 m0, s26, 92160
  s_nop 0
  buffer_load_dwordx4 v18, s[44:47], s70 offen lds
  s_add_u32 m0, s26, 93184
  s_nop 0
  buffer_load_dwordx4 v19, s[44:47], s70 offen lds
  s_add_u32 m0, s73, 106496
  s_nop 0
  buffer_load_dwordx4 v22, s[52:55], s72 offen lds
  s_add_u32 m0, s73, 107520
  s_nop 0
  buffer_load_dwordx4 v23, s[52:55], s72 offen lds
  s_add_u32 m0, s73, 108544
  s_nop 0
  buffer_load_dwordx4 v24, s[52:55], s72 offen lds
  s_add_u32 m0, s73, 109568
  s_nop 0
  buffer_load_dwordx4 v25, s[52:55], s72 offen lds
  s_add_u32 m0, s73, 110592
  s_nop 0
  buffer_load_dwordx4 v26, s[52:55], s72 offen lds
  s_waitcnt vmcnt(9)
  ds_read_b64_tr_b16 v[128:129], v32 offset:0
  ds_read_b64_tr_b16 v[132:133], v32 offset:32
  ds_read_b64_tr_b16 v[130:131], v32 offset:1024
  ds_read_b64_tr_b16 v[134:135], v32 offset:1056
  ds_read_b64 v[136:137], v33 offset:2048
  ds_read_b64 v[138:139], v33 offset:2080
  s_add_u32 m0, s73, 111616
  s_nop 0
  buffer_load_dwordx4 v27, s[52:55], s72 offen lds
  s_add_u32 m0, s73, 112640
  s_nop 0
  buffer_load_dwordx4 v28, s[52:55], s72 offen lds
  s_waitcnt lgkmcnt(0)
  s_waitcnt vmcnt(11)
  s_barrier
  s_setprio 3
  s_add_u32 m0, s27, 143360
  s_nop 0
  buffer_load_dwordx4 v20, s[48:51], s71 offen lds
  s_add_u32 m0, s27, 144384
  s_nop 0
  buffer_load_dwordx4 v21, s[48:51], s71 offen lds
  s_add_u32 s13, s68, 1
  s_and_b32 s13, s13, 7
  s_mov_b32 m0, s69
  s_lshl_b32 s12, s13, 13
  buffer_load_dwordx4 v29, s[56:59], s12 offen offset:0 lds
  s_mov_b32 m0, s69
  s_lshl_b32 s12, s13, 13
  buffer_load_dwordx4 v29, s[56:59], s12 offen offset:1024 lds
  s_add_u32 m0, s69, 2048
  s_lshl_b32 s12, s13, 8
  buffer_load_dwordx4 v30, s[44:47], s12 offen lds
  s_setprio 0
  s_add_u32 s12, s10, s74
  s_and_b32 s12, s12, 15
  s_lshr_b64 s[10:11], s[10:11], 4
  s_lshl_b32 s70, s12, 7
  s_lshl_b32 s71, s12, 17
  s_mul_i32 s72, s12, 458752
  s_add_u32 m0, s26, 0
  s_nop 0
  buffer_load_dwordx4 v16, s[44:47], s70 offen lds
  s_add_u32 m0, s26, 1024
  s_nop 0
  buffer_load_dwordx4 v17, s[44:47], s70 offen lds
  s_setprio 3
  s_bitcmp1_b32 s6, 0
  s_cbranch_scc1 L_kvv_16
  v_mfma_f32_16x16x32_bf16 v[48:51], v[128:131], v[136:139], v[48:51]
  v_mfma_f32_16x16x32_bf16 v[52:55], v[132:135], v[136:139], v[52:55]
  v_mfma_f32_16x16x32_bf16 v[56:59], v[160:163], v[136:139], v[56:59]
  s_branch L_kve_17
L_kvv_16:
  v_mfma_f32_16x16x32_bf16 v[48:51], v[136:139], v[128:131], v[48:51]
  v_mfma_f32_16x16x32_bf16 v[52:55], v[136:139], v[132:135], v[52:55]
L_kve_17:
  s_setprio 0
  s_add_u32 m0, s26, 2048
  s_nop 0
  buffer_load_dwordx4 v18, s[44:47], s70 offen lds
  s_add_u32 m0, s26, 3072
  s_nop 0
  buffer_load_dwordx4 v19, s[44:47], s70 offen lds
  s_add_u32 m0, s73, 16384
  s_nop 0
  buffer_load_dwordx4 v22, s[52:55], s72 offen lds
  s_add_u32 m0, s73, 17408
  s_nop 0
  buffer_load_dwordx4 v23, s[52:55], s72 offen lds
  s_add_u32 m0, s73, 18432
  s_nop 0
  buffer_load_dwordx4 v24, s[52:55], s72 offen lds
  s_add_u32 m0, s73, 19456
  s_nop 0
  buffer_load_dwordx4 v25, s[52:55], s72 offen lds
  s_add_u32 m0, s73, 20480
  s_nop 0
  buffer_load_dwordx4 v26, s[52:55], s72 offen lds
  s_waitcnt vmcnt(9)
  ds_read_b64_tr_b16 v[140:141], v32 offset:0
  ds_read_b64_tr_b16 v[144:145], v32 offset:32
  ds_read_b64_tr_b16 v[142:143], v32 offset:1024
  ds_read_b64_tr_b16 v[146:147], v32 offset:1056
  ds_read_b64 v[148:149], v33 offset:2048
  ds_read_b64 v[150:151], v33 offset:2080
  s_add_u32 m0, s73, 21504
  s_nop 0
  buffer_load_dwordx4 v27, s[52:55], s72 offen lds
  s_add_u32 m0, s73, 22528
  s_nop 0
  buffer_load_dwordx4 v28, s[52:55], s72 offen lds
  s_waitcnt lgkmcnt(0)
  s_waitcnt vmcnt(11)
  s_barrier
  s_setprio 3
  s_add_u32 m0, s27, 135168
  s_nop 0
  buffer_load_dwordx4 v20, s[48:51], s71 offen lds
  s_add_u32 m0, s27, 136192
  s_nop 0
  buffer_load_dwordx4 v21, s[48:51], s71 offen lds
  s_add_u32 s13, s68, 2
  s_and_b32 s13, s13, 7
  s_mov_b32 m0, s69
  s_lshl_b32 s12, s13, 13
  buffer_load_dwordx4 v29, s[56:59], s12 offen offset:0 lds
  s_mov_b32 m0, s69
  s_lshl_b32 s12, s13, 13
  buffer_load_dwordx4 v29, s[56:59], s12 offen offset:1024 lds
  s_add_u32 m0, s69, 2048
  s_lshl_b32 s12, s13, 8
  buffer_load_dwordx4 v30, s[44:47], s12 offen lds
  s_setprio 0
  s_add_u32 s12, s10, s74
  s_and_b32 s12, s12, 15
  s_lshr_b64 s[10:11], s[10:11], 4
  s_lshl_b32 s70, s12, 7
  s_lshl_b32 s71, s12, 17
  s_mul_i32 s72, s12, 458752
  s_add_u32 m0, s26, 45056
L_pad_51:
  s_cbranch_execz L_pad_119
  s_nop 0
  buffer_load_dwordx4 v16, s[44:47], s70 offen lds
  s_add_u32 m0, s26, 46080
  s_nop 0
  buffer_load_dwordx4 v17, s[44:47], s70 offen lds
  s_setprio 3
  s_bitcmp1_b32 s6, 0
  s_cbranch_scc1 L_kvv_18
  v_mfma_f32_16x16x32_bf16 v[48:51], v[140:143], v[148:151], v[48:51]
  v_mfma_f32_16x16x32_bf16 v[52:55], v[144:147], v[148:151], v[52:55]
  v_mfma_f32_16x16x32_bf16 v[56:59], v[164:167], v[148:151], v[56:59]
  s_branch L_kve_19
L_kvv_18:
  v_mfma_f32_16x16x32_bf16 v[48:51], v[148:151], v[140:143], v[48:51]
  v_mfma_f32_16x16x32_bf16 v[52:55], v[148:151], v[144:147], v[52:55]
L_kve_19:
  s_setprio 0
  s_add_u32 m0, s26, 47104
  s_nop 0
  buffer_load_dwordx4 v18, s[44:47], s70 offen lds
  s_add_u32 m0, s26, 48128
  s_nop 0
  buffer_load_dwordx4 v19, s[44:47], s70 offen lds
  s_add_u32 m0, s73, 61440
  s_nop 0
  buffer_load_dwordx4 v22, s[52:55], s72 offen lds
  s_add_u32 m0, s73, 62464
  s_nop 0
  buffer_load_dwordx4 v23, s[52:55], s72 offen lds
  s_add_u32 m0, s73, 63488
  s_nop 0
  buffer_load_dwordx4 v24, s[52:55], s72 offen lds
  s_add_u32 m0, s73, 64512
  s_nop 0
  buffer_load_dwordx4 v25, s[52:55], s72 offen lds
  s_add_u32 m0, s73, 65536
  s_nop 0
  buffer_load_dwordx4 v26, s[52:55], s72 offen lds
  s_waitcnt vmcnt(9)
  ds_read_b64_tr_b16 v[128:129], v32 offset:0
  ds_read_b64_tr_b16 v[132:133], v32 offset:32
  ds_read_b64_tr_b16 v[130:131], v32 offset:1024
  ds_read_b64_tr_b16 v[134:135], v32 offset:1056
  ds_read_b64 v[136:137], v33 offset:2048
  ds_read_b64 v[138:139], v33 offset:2080
  s_add_u32 m0, s73, 66560
  s_nop 0
  buffer_load_dwordx4 v27, s[52:55], s72 offen lds
  s_add_u32 m0, s73, 67584
  s_nop 0
  buffer_load_dwordx4 v28, s[52:55], s72 offen lds
  s_waitcnt lgkmcnt(0)
  s_waitcnt vmcnt(11)
  s_barrier
  s_setprio 3
  s_add_u32 m0, s27, 143360
  s_nop 0
  buffer_load_dwordx4 v20, s[48:51], s71 offen lds
  s_add_u32 m0, s27, 144384
  s_nop 0
  buffer_load_dwordx4 v21, s[48:51], s71 offen lds
  s_add_u32 s13, s68, 3
  s_and_b32 s13, s13, 7
  s_mov_b32 m0, s69
  s_lshl_b32 s12, s13, 13
  buffer_load_dwordx4 v29, s[56:59], s12 offen offset:0 lds
  s_mov_b32 m0, s69
  s_lshl_b32 s12, s13, 13
  buffer_load_dwordx4 v29, s[56:59], s12 offen offset:1024 lds
  s_add_u32 m0, s69, 2048
  s_lshl_b32 s12, s13, 8
  buffer_load_dwordx4 v30, s[44:47], s12 offen lds
  s_setprio 0
  s_add_u32 s12, s10, s74
  s_and_b32 s12, s12, 15
  s_lshr_b64 s[10:11], s[10:11], 4
  s_lshl_b32 s70, s12, 7
  s_lshl_b32 s71, s12, 17
  s_mul_i32 s72, s12, 458752
  s_add_u32 m0, s26, 90112
  s_nop 0
  buffer_load_dwordx4 v16, s[44:47], s70 offen lds
  s_add_u32 m0, s26, 91136
  s_nop 0
  buffer_load_dwordx4 v17, s[44:47], s70 offen lds
  s_setprio 3
  s_bitcmp1_b32 s6, 0
  s_cbranch_scc1 L_kvv_20
  v_mfma_f32_16x16x32_bf16 v[48:51], v[128:131], v[136:139], v[48:51]
  v_mfma_f32_16x16x32_bf16 v[52:55], v[132:135], v[136:139], v[52:55]
  v_mfma_f32_16x16x32_bf16 v[56:59], v[168:171], v[136:139], v[56:59]
  s_branch L_kve_21
L_kvv_20:
  v_mfma_f32_16x16x32_bf16 v[48:51], v[136:139], v[128:131], v[48:51]
  v_mfma_f32_16x16x32_bf16 v[52:55], v[136:139], v[132:135], v[52:55]
L_kve_21:
  s_setprio 0
  s_add_u32 m0, s26, 92160
  s_nop 0
  buffer_load_dwordx4 v18, s[44:47], s70 offen lds
  s_add_u32 m0, s26, 93184
  s_nop 0
  buffer_load_dwordx4 v19, s[44:47], s70 offen lds
  s_add_u32 m0, s73, 106496
  s_nop 0
  buffer_load_dwordx4 v22, s[52:55], s72 offen lds
  s_add_u32 m0, s73, 107520
  s_nop 0
  buffer_load_dwordx4 v23, s[52:55], s72 offen lds
  s_add_u32 m0, s73, 108544
  s_nop 0
  buffer_load_dwordx4 v24, s[52:55], s72 offen lds
  s_add_u32 m0, s73, 109568
  s_nop 0
  buffer_load_dwordx4 v25, s[52:55], s72 offen lds
  s_add_u32 m0, s73, 110592
  s_nop 0
  buffer_load_dwordx4 v26, s[52:55], s72 offen lds
  s_waitcnt vmcnt(9)
  ds_read_b64_tr_b16 v[140:141], v32 offset:0
  ds_read_b64_tr_b16 v[144:145], v32 offset:32
  ds_read_b64_tr_b16 v[142:143], v32 offset:1024
  ds_read_b64_tr_b16 v[146:147], v32 offset:1056
  ds_read_b64 v[148:149], v33 offset:2048
  ds_read_b64 v[150:151], v33 offset:2080
  s_add_u32 m0, s73, 111616
  s_nop 0
  buffer_load_dwordx4 v27, s[52:55], s72 offen lds
  s_add_u32 m0, s73, 112640
  s_nop 0
  buffer_load_dwordx4 v28, s[52:55], s72 offen lds
  s_waitcnt lgkmcnt(0)
  s_waitcnt vmcnt(11)
  s_barrier
  s_setprio 3
  s_add_u32 m0, s27, 135168
  s_nop 0
  buffer_load_dwordx4 v20, s[48:51], s71 offen lds
  s_add_u32 m0, s27, 136192
  s_nop 0
  buffer_load_dwordx4 v21, s[48:51], s71 offen lds
  s_add_u32 s13, s68, 4
  s_and_b32 s13, s13, 7
  s_mov_b32 m0, s69
  s_lshl_b32 s12, s13, 13
  buffer_load_dwordx4 v29, s[56:59], s12 offen offset:0 lds
  s_mov_b32 m0, s69
  s_lshl_b32 s12, s13, 13
  buffer_load_dwordx4 v29, s[56:59], s12 offen offset:1024 lds
  s_add_u32 m0, s69, 2048
  s_lshl_b32 s12, s13, 8
  buffer_load_dwordx4 v30, s[44:47], s12 offen lds
  s_setprio 0
  s_add_u32 s12, s10, s74
  s_and_b32 s12, s12, 15
  s_lshr_b64 s[10:11], s[10:11], 4
  s_lshl_b32 s70, s12, 7
  s_lshl_b32 s71, s12, 17
  s_mul_i32 s72, s12, 458752
  s_add_u32 m0, s26, 0
  s_nop 0
  buffer_load_dwordx4 v16, s[44:47], s70 offen lds
  s_add_u32 m0, s26, 1024
  s_nop 0
  buffer_load_dwordx4 v17, s[44:47], s70 offen lds
  s_setprio 3
  s_bitcmp1_b32 s6, 0
  s_cbranch_scc1 L_kvv_22
  v_mfma_f32_16x16x32_bf16 v[48:51], v[140:143], v[148:151], v[48:51]
  v_mfma_f32_16x16x32_bf16 v[52:55], v[144:147], v[148:151], v[52:55]
  v_mfma_f32_16x16x32_bf16 v[56:59], v[172:175], v[148:151], v[56:59]
  s_branch L_kve_23
L_kvv_22:
  v_mfma_f32_16x16x32_bf16 v[48:51], v[148:151], v[140:143], v[48:51]
  v_mfma_f32_16x16x32_bf16 v[52:55], v[148:151], v[144:147], v[52:55]
L_kve_23:
  s_setprio 0
  s_add_u32 m0, s26, 2048
  s_nop 0
  buffer_load_dwordx4 v18, s[44:47], s70 offen lds
  s_add_u32 m0, s26, 3072
  s_nop 0
L_pad_68:
  s_cbranch_execz L_pad_136
  buffer_load_dwordx4 v19, s[44:47], s70 offen lds
  s_add_u32 m0, s73, 16384
  s_nop 0
  buffer_load_dwordx4 v22, s[52:55], s72 offen lds
  s_add_u32 m0, s73, 17408
  s_nop 0
  buffer_load_dwordx4 v23, s[52:55], s72 offen lds
  s_add_u32 m0, s73, 18432
  s_nop 0
  buffer_load_dwordx4 v24, s[52:55], s72 offen lds
  s_add_u32 m0, s73, 19456
  s_nop 0
  buffer_load_dwordx4 v25, s[52:55], s72 offen lds
  s_add_u32 m0, s73, 20480
  s_nop 0
  buffer_load_dwordx4 v26, s[52:55], s72 offen lds
  s_waitcnt vmcnt(9)
  ds_read_b64_tr_b16 v[128:129], v32 offset:0
  ds_read_b64_tr_b16 v[132:133], v32 offset:32
  ds_read_b64_tr_b16 v[130:131], v32 offset:1024
  ds_read_b64_tr_b16 v[134:135], v32 offset:1056
  ds_read_b64 v[136:137], v33 offset:2048
  ds_read_b64 v[138:139], v33 offset:2080
  s_add_u32 m0, s73, 21504
  s_nop 0
  buffer_load_dwordx4 v27, s[52:55], s72 offen lds
  s_add_u32 m0, s73, 22528
  s_nop 0
  buffer_load_dwordx4 v28, s[52:55], s72 offen lds
  s_waitcnt lgkmcnt(0)
  s_waitcnt vmcnt(11)
  s_barrier
  s_setprio 3
  s_add_u32 m0, s27, 143360
  s_nop 0
  buffer_load_dwordx4 v20, s[48:51], s71 offen lds
  s_add_u32 m0, s27, 144384
  s_nop 0
  buffer_load_dwordx4 v21, s[48:51], s71 offen lds
  s_add_u32 s13, s68, 5
  s_and_b32 s13, s13, 7
  s_mov_b32 m0, s69
  s_lshl_b32 s12, s13, 13
  buffer_load_dwordx4 v29, s[56:59], s12 offen offset:0 lds
  s_mov_b32 m0, s69
  s_lshl_b32 s12, s13, 13
  buffer_load_dwordx4 v29, s[56:59], s12 offen offset:1024 lds
  s_add_u32 m0, s69, 2048
  s_lshl_b32 s12, s13, 8
  buffer_load_dwordx4 v30, s[44:47], s12 offen lds
  s_setprio 0
  s_add_u32 s12, s10, s74
  s_and_b32 s12, s12, 15
  s_lshr_b64 s[10:11], s[10:11], 4
  s_lshl_b32 s70, s12, 7
  s_lshl_b32 s71, s12, 17
  s_mul_i32 s72, s12, 458752
  s_add_u32 m0, s26, 45056
  s_nop 0
  buffer_load_dwordx4 v16, s[44:47], s70 offen lds
  s_add_u32 m0, s26, 46080
  s_nop 0
  buffer_load_dwordx4 v17, s[44:47], s70 offen lds
  s_setprio 3
  s_bitcmp1_b32 s6, 0
  s_cbranch_scc1 L_kvv_24
  v_mfma_f32_16x16x32_bf16 v[48:51], v[128:131], v[136:139], v[48:51]
  v_mfma_f32_16x16x32_bf16 v[52:55], v[132:135], v[136:139], v[52:55]
  v_mfma_f32_16x16x32_bf16 v[56:59], v[176:179], v[136:139], v[56:59]
  s_branch L_kve_25
L_kvv_24:
  v_mfma_f32_16x16x32_bf16 v[48:51], v[136:139], v[128:131], v[48:51]
  v_mfma_f32_16x16x32_bf16 v[52:55], v[136:139], v[132:135], v[52:55]
L_kve_25:
  s_setprio 0
  s_add_u32 m0, s26, 47104
  s_nop 0
  buffer_load_dwordx4 v18, s[44:47], s70 offen lds
  s_add_u32 m0, s26, 48128
  s_nop 0
  buffer_load_dwordx4 v19, s[44:47], s70 offen lds
  s_add_u32 m0, s73, 61440
  s_nop 0
  buffer_load_dwordx4 v22, s[52:55], s72 offen lds
  s_add_u32 m0, s73, 62464
  s_nop 0
  buffer_load_dwordx4 v23, s[52:55], s72 offen lds
  s_add_u32 m0, s73, 63488
  s_nop 0
  buffer_load_dwordx4 v24, s[52:55], s72 offen lds
  s_add_u32 m0, s73, 64512
  s_nop 0
  buffer_load_dwordx4 v25, s[52:55], s72 offen lds
  s_add_u32 m0, s73, 65536
  s_nop 0
  buffer_load_dwordx4 v26, s[52:55], s72 offen lds
  s_waitcnt vmcnt(9)
  ds_read_b64_tr_b16 v[140:141], v32 offset:0
  ds_read_b64_tr_b16 v[144:145], v32 offset:32
  ds_read_b64_tr_b16 v[142:143], v32 offset:1024
  ds_read_b64_tr_b16 v[146:147], v32 offset:1056
  ds_read_b64 v[148:149], v33 offset:2048
  ds_read_b64 v[150:151], v33 offset:2080
  s_add_u32 m0, s73, 66560
  s_nop 0
  buffer_load_dwordx4 v27, s[52:55], s72 offen lds
  s_add_u32 m0, s73, 67584
  s_nop 0
  buffer_load_dwordx4 v28, s[52:55], s72 offen lds
  s_waitcnt lgkmcnt(0)
  s_waitcnt vmcnt(11)
  s_barrier
  s_setprio 3
  s_add_u32 m0, s27, 135168
  s_nop 0
  buffer_load_dwordx4 v20, s[48:51], s71 offen lds
  s_add_u32 m0, s27, 136192
  s_nop 0
  buffer_load_dwordx4 v21, s[48:51], s71 offen lds
  s_add_u32 s13, s68, 6
  s_and_b32 s13, s13, 7
  s_mov_b32 m0, s69
  s_lshl_b32 s12, s13, 13
  buffer_load_dwordx4 v29, s[56:59], s12 offen offset:0 lds
  s_mov_b32 m0, s69
  s_lshl_b32 s12, s13, 13
  buffer_load_dwordx4 v29, s[56:59], s12 offen offset:1024 lds
  s_add_u32 m0, s69, 2048
  s_lshl_b32 s12, s13, 8
  buffer_load_dwordx4 v30, s[44:47], s12 offen lds
  s_setprio 0
  s_add_u32 s12, s10, s74
  s_and_b32 s12, s12, 15
  s_lshr_b64 s[10:11], s[10:11], 4
  s_lshl_b32 s70, s12, 7
  s_lshl_b32 s71, s12, 17
  s_mul_i32 s72, s12, 458752
  s_add_u32 m0, s26, 90112
  s_nop 0
  buffer_load_dwordx4 v16, s[44:47], s70 offen lds
  s_add_u32 m0, s26, 91136
  s_nop 0
  buffer_load_dwordx4 v17, s[44:47], s70 offen lds
  s_setprio 3
  s_bitcmp1_b32 s6, 0
  s_cbranch_scc1 L_kvv_26
  v_mfma_f32_16x16x32_bf16 v[48:51], v[140:143], v[148:151], v[48:51]
  v_mfma_f32_16x16x32_bf16 v[52:55], v[144:147], v[148:151], v[52:55]
  v_mfma_f32_16x16x32_bf16 v[56:59], v[180:183], v[148:151], v[56:59]
  s_branch L_kve_27
L_kvv_26:
  v_mfma_f32_16x16x32_bf16 v[48:51], v[148:151], v[140:143], v[48:51]
  v_mfma_f32_16x16x32_bf16 v[52:55], v[148:151], v[144:147], v[52:55]
L_kve_27:
  s_setprio 0
  s_add_u32 m0, s26, 92160
  s_nop 0
  buffer_load_dwordx4 v18, s[44:47], s70 offen lds
  s_add_u32 m0, s26, 93184
  s_nop 0
  buffer_load_dwordx4 v19, s[44:47], s70 offen lds
  s_add_u32 m0, s73, 106496
  s_nop 0
  buffer_load_dwordx4 v22, s[52:55], s72 offen lds
  s_add_u32 m0, s73, 107520
  s_nop 0
  buffer_load_dwordx4 v23, s[52:55], s72 offen lds
  s_add_u32 m0, s73, 108544
  s_nop 0
  buffer_load_dwordx4 v24, s[52:55], s72 offen lds
  s_add_u32 m0, s73, 109568
  s_nop 0
  buffer_load_dwordx4 v25, s[52:55], s72 offen lds
  s_add_u32 m0, s73, 110592
  s_nop 0
  buffer_load_dwordx4 v26, s[52:55], s72 offen lds
  s_waitcnt vmcnt(9)
  ds_read_b64_tr_b16 v[128:129], v32 offset:0
  ds_read_b64_tr_b16 v[132:133], v32 offset:32
L_pad_85:
  s_cbranch_execz L_pad_935
  ds_read_b64_tr_b16 v[130:131], v32 offset:1024
  ds_read_b64_tr_b16 v[134:135], v32 offset:1056
  ds_read_b64 v[136:137], v33 offset:2048
  ds_read_b64 v[138:139], v33 offset:2080
  s_add_u32 m0, s73, 111616
  s_nop 0
  buffer_load_dwordx4 v27, s[52:55], s72 offen lds
  s_add_u32 m0, s73, 112640
  s_nop 0
  buffer_load_dwordx4 v28, s[52:55], s72 offen lds
  s_waitcnt lgkmcnt(0)
  s_waitcnt vmcnt(11)
  s_barrier
  s_setprio 3
  s_add_u32 m0, s27, 143360
  s_nop 0
  buffer_load_dwordx4 v20, s[48:51], s71 offen lds
  s_add_u32 m0, s27, 144384
  s_nop 0
  buffer_load_dwordx4 v21, s[48:51], s71 offen lds
  s_add_u32 s13, s68, 7
  s_and_b32 s13, s13, 7
  s_mov_b32 m0, s69
  s_lshl_b32 s12, s13, 13
  buffer_load_dwordx4 v29, s[56:59], s12 offen offset:0 lds
  s_mov_b32 m0, s69
  s_lshl_b32 s12, s13, 13
  buffer_load_dwordx4 v29, s[56:59], s12 offen offset:1024 lds
  s_add_u32 m0, s69, 2048
  s_lshl_b32 s12, s13, 8
  buffer_load_dwordx4 v30, s[44:47], s12 offen lds
  s_setprio 0
  s_add_u32 s12, s10, s74
  s_and_b32 s12, s12, 15
  s_lshr_b64 s[10:11], s[10:11], 4
  s_lshl_b32 s70, s12, 7
  s_lshl_b32 s71, s12, 17
  s_mul_i32 s72, s12, 458752
  s_add_u32 m0, s26, 0
  s_nop 0
  buffer_load_dwordx4 v16, s[44:47], s70 offen lds
  s_add_u32 m0, s26, 1024
  s_nop 0
  buffer_load_dwordx4 v17, s[44:47], s70 offen lds
  s_setprio 3
  s_bitcmp1_b32 s6, 0
  s_cbranch_scc1 L_kvv_28
  v_mfma_f32_16x16x32_bf16 v[48:51], v[128:131], v[136:139], v[48:51]
  v_mfma_f32_16x16x32_bf16 v[52:55], v[132:135], v[136:139], v[52:55]
  v_mfma_f32_16x16x32_bf16 v[56:59], v[184:187], v[136:139], v[56:59]
  s_branch L_kve_29
L_kvv_28:
  v_mfma_f32_16x16x32_bf16 v[48:51], v[136:139], v[128:131], v[48:51]
  v_mfma_f32_16x16x32_bf16 v[52:55], v[136:139], v[132:135], v[52:55]
L_kve_29:
  s_setprio 0
  s_add_u32 m0, s26, 2048
  s_nop 0
  buffer_load_dwordx4 v18, s[44:47], s70 offen lds
  s_add_u32 m0, s26, 3072
  s_nop 0
  buffer_load_dwordx4 v19, s[44:47], s70 offen lds
  s_add_u32 m0, s73, 16384
  s_nop 0
  buffer_load_dwordx4 v22, s[52:55], s72 offen lds
  s_add_u32 m0, s73, 17408
  s_nop 0
  buffer_load_dwordx4 v23, s[52:55], s72 offen lds
  s_add_u32 m0, s73, 18432
  s_nop 0
  buffer_load_dwordx4 v24, s[52:55], s72 offen lds
  s_add_u32 m0, s73, 19456
  s_nop 0
  buffer_load_dwordx4 v25, s[52:55], s72 offen lds
  s_add_u32 m0, s73, 20480
  s_nop 0
  buffer_load_dwordx4 v26, s[52:55], s72 offen lds
  s_waitcnt vmcnt(9)
  ds_read_b64_tr_b16 v[140:141], v32 offset:0
  ds_read_b64_tr_b16 v[144:145], v32 offset:32
  ds_read_b64_tr_b16 v[142:143], v32 offset:1024
  ds_read_b64_tr_b16 v[146:147], v32 offset:1056
  ds_read_b64 v[148:149], v33 offset:2048
  ds_read_b64 v[150:151], v33 offset:2080
  s_add_u32 m0, s73, 21504
  s_nop 0
  buffer_load_dwordx4 v27, s[52:55], s72 offen lds
  s_add_u32 m0, s73, 22528
  s_nop 0
  buffer_load_dwordx4 v28, s[52:55], s72 offen lds
  s_waitcnt lgkmcnt(0)
  s_waitcnt vmcnt(11)
  s_barrier
  s_setprio 3
  s_add_u32 m0, s27, 135168
  s_nop 0
  buffer_load_dwordx4 v20, s[48:51], s71 offen lds
  s_add_u32 m0, s27, 136192
  s_nop 0
  buffer_load_dwordx4 v21, s[48:51], s71 offen lds
  s_mov_b32 s60, s40
  s_mov_b32 s61, s41
  s_mov_b32 s62, 256
  s_mov_b32 s63, 0x20000
  v_and_b32 v5, 15, v0
  v_lshlrev_b32 v5, 2, v5
  buffer_load_dword v35, v5, s[60:63], 0 offen sc1
  s_setprio 0
  s_add_u32 s12, s10, s74
  s_and_b32 s12, s12, 15
  s_lshr_b64 s[10:11], s[10:11], 4
  s_lshl_b32 s70, s12, 7
  s_lshl_b32 s71, s12, 17
  s_mul_i32 s72, s12, 458752
  s_add_u32 m0, s26, 45056
  s_nop 0
  buffer_load_dwordx4 v16, s[44:47], s70 offen lds
  s_add_u32 m0, s26, 46080
  s_nop 0
  buffer_load_dwordx4 v17, s[44:47], s70 offen lds
  s_setprio 3
  s_bitcmp1_b32 s6, 0
  s_cbranch_scc1 L_kvv_30
  v_mfma_f32_16x16x32_bf16 v[48:51], v[140:143], v[148:151], v[48:51]
  v_mfma_f32_16x16x32_bf16 v[52:55], v[144:147], v[148:151], v[52:55]
  v_mfma_f32_16x16x32_bf16 v[56:59], v[188:191], v[148:151], v[56:59]
  s_branch L_kve_31
L_kvv_30:
  v_mfma_f32_16x16x32_bf16 v[48:51], v[148:151], v[140:143], v[48:51]
  v_mfma_f32_16x16x32_bf16 v[52:55], v[148:151], v[144:147], v[52:55]
L_kve_31:
  s_setprio 0
  s_add_u32 m0, s26, 47104
  s_nop 0
  buffer_load_dwordx4 v18, s[44:47], s70 offen lds
  s_add_u32 m0, s26, 48128
  s_nop 0
  buffer_load_dwordx4 v19, s[44:47], s70 offen lds
  s_nop 1
  ds_write_b128 v31, v[48:51]
  ds_write_b128 v31, v[52:55] offset:1024
  ds_write_b32 v31, v56 offset:2048
  s_add_u32 m0, s73, 61440
  s_nop 0
  buffer_load_dwordx4 v22, s[52:55], s72 offen lds
  s_add_u32 m0, s73, 62464
  s_nop 0
  buffer_load_dwordx4 v23, s[52:55], s72 offen lds
  s_add_u32 m0, s73, 63488
  s_nop 0
  buffer_load_dwordx4 v24, s[52:55], s72 offen lds
  s_add_u32 m0, s73, 64512
  s_nop 0
  buffer_load_dwordx4 v25, s[52:55], s72 offen lds
  s_add_u32 m0, s73, 65536
  s_nop 0
  buffer_load_dwordx4 v26, s[52:55], s72 offen lds
  s_add_u32 m0, s73, 66560
  s_nop 0
  buffer_load_dwordx4 v27, s[52:55], s72 offen lds
  s_add_u32 m0, s73, 67584
  s_nop 0
  buffer_load_dwordx4 v28, s[52:55], s72 offen lds
  s_waitcnt lgkmcnt(0)
  s_waitcnt vmcnt(11)
  s_barrier
  s_setprio 3
  s_add_u32 m0, s27, 143360
  s_nop 0
  buffer_load_dwordx4 v20, s[48:51], s71 offen lds
  s_add_u32 m0, s27, 144384
  s_nop 0
  buffer_load_dwordx4 v21, s[48:51], s71 offen lds
  v_and_b32 v5, 15, v0
  v_lshlrev_b32 v5, 2, v5
  v_cmp_eq_u32 vcc, 1, v35
  s_nop 1
  s_cmp_eq_u64 vcc, exec
  s_cbranch_scc1 L_pdone_33
  s_mov_b32 s15, 1048576
L_poll_32:
  buffer_load_dword v4, v5, s[60:63], 0 offen offset:0 sc1
L_pad_102:
  s_cbranch_execz L_pad_952
  s_waitcnt vmcnt(0)
  v_cmp_eq_u32 vcc, 1, v4
  s_nop 1
  s_cmp_eq_u64 vcc, exec
  s_cbranch_scc1 L_pdone_33
  s_sleep 1
  s_sub_u32 s15, s15, 1
  s_cmp_lg_u32 s15, 0
  s_cbranch_scc1 L_poll_32
L_pdone_33:
  s_cmp_lg_u32 s4, 0
  s_cbranch_scc1 L_r9_34
  s_setprio 3
  ds_read_b128 v[64:67], v31 offset:3072
  ds_read_b128 v[68:71], v31 offset:4096
  ds_read_b32 v72, v31 offset:5120
  ds_read_b128 v[76:79], v31 offset:6144
  ds_read_b128 v[80:83], v31 offset:7168
  ds_read_b32 v84, v31 offset:8192
  ds_read_b128 v[88:91], v31 offset:9216
  ds_read_b128 v[92:95], v31 offset:10240
  ds_read_b32 v96, v31 offset:11264
  v_and_b32 v3, 15, v0
  v_bfe_u32 v4, v0, 4, 1
  v_lshrrev_b32 v5, 5, v0
  v_bfe_u32 v8, v0, 3, 1
  v_and_b32 v6, 0x370, v10
  v_lshl_add_u32 v6, v8, 10, v6
  v_and_b32 v7, 0x1f0, v10
  v_lshl_add_u32 v7, v5, 3, v7
  v_lshlrev_b32 v3, 2, v3
  s_waitcnt lgkmcnt(0)
  v_add_f32 v48, v48, v64
  v_add_f32 v49, v49, v65
  v_add_f32 v50, v50, v66
  v_add_f32 v51, v51, v67
  v_add_f32 v52, v52, v68
  v_add_f32 v53, v53, v69
  v_add_f32 v54, v54, v70
  v_add_f32 v55, v55, v71
  v_add_f32 v56, v56, v72
  v_add_f32 v48, v48, v76
  v_add_f32 v49, v49, v77
  v_add_f32 v50, v50, v78
  v_add_f32 v51, v51, v79
  v_add_f32 v52, v52, v80
  v_add_f32 v53, v53, v81
  v_add_f32 v54, v54, v82
  v_add_f32 v55, v55, v83
  v_add_f32 v56, v56, v84
  v_add_f32 v48, v48, v88
  v_add_f32 v49, v49, v89
  v_add_f32 v50, v50, v90
  v_add_f32 v51, v51, v91
  v_add_f32 v52, v52, v92
  v_add_f32 v53, v53, v93
  v_add_f32 v54, v54, v94
  v_add_f32 v55, v55, v95
  v_add_f32 v56, v56, v96
  s_bitcmp1_b32 s6, 0
  s_cselect_b32 s12, 1.0, 1048744942
  v_mul_f32 v48, s12, v48
  v_mul_f32 v49, s12, v49
  v_mul_f32 v50, s12, v50
  v_mul_f32 v51, s12, v51
  v_mul_f32 v52, s12, v52
  v_mul_f32 v53, s12, v53
  v_mul_f32 v54, s12, v54
  v_mul_f32 v55, s12, v55
  v_cvt_pk_bf16_f32 v36, v48, v49
  v_cvt_pk_bf16_f32 v37, v50, v51
  v_cvt_pk_bf16_f32 v38, v52, v53
  v_cvt_pk_bf16_f32 v39, v54, v55
  v_mul_f32 v5, 3216550459, v56
  v_exp_f32 v5, v5
  s_lshl_b32 s12, s5, 1
  s_lshr_b32 s13, s75, 6
  v_add_f32 v5, 1.0, v5
  v_rcp_f32 v5, v5
  s_add_u32 s12, s12, s13
  s_lshl_b32 s12, s12, 13
  s_add_u32 s12, s12, 27262976
  s_bitcmp1_b32 s6, 0
  s_cbranch_scc1 L_r9_34_v
  s_and_b32 s13, s75, 32
  s_lshl_b32 s13, s13, 6
  s_add_u32 s12, s12, s13
  s_and_b32 s13, s75, 16
  s_lshl_b32 s13, s13, 3
  s_add_u32 s12, s12, s13
  buffer_store_dwordx4 v[36:39], v6, s[64:67], s12 offen sc1
  s_lshl_b32 s12, s5, 7
  s_add_u32 s12, s12, s75
  s_lshl_b32 s12, s12, 2
  s_add_u32 s12, s12, 27525120
  s_mov_b64 exec, 0xffff
  buffer_store_dword v5, v3, s[64:67], s12 offen sc1
  s_mov_b64 exec, -1
  s_branch L_r9_34_e
L_r9_34_v:
  s_and_b32 s13, s75, 48
  s_lshl_b32 s13, s13, 5
  s_add_u32 s12, s12, s13
  s_add_u32 s12, s12, 4096
  buffer_store_dwordx2 v[36:37], v7, s[64:67], s12 offen sc1
  buffer_store_dwordx2 v[38:39], v7, s[64:67], s12 offen offset:2048 sc1
L_r9_34_e:
L_r9_34:
  s_setprio 0
  s_add_u32 s12, s10, s74
  s_and_b32 s12, s12, 15
  s_lshr_b64 s[10:11], s[10:11], 4
  s_lshl_b32 s70, s12, 7
  s_lshl_b32 s71, s12, 17
  s_mul_i32 s72, s12, 458752
  s_add_u32 m0, s26, 90112
  s_nop 0
  buffer_load_dwordx4 v16, s[44:47], s70 offen lds
  s_add_u32 m0, s26, 91136
  s_nop 0
  buffer_load_dwordx4 v17, s[44:47], s70 offen lds
  s_add_u32 m0, s26, 92160
  s_nop 0
  buffer_load_dwordx4 v18, s[44:47], s70 offen lds
  s_add_u32 m0, s26, 93184
  s_nop 0
  buffer_load_dwordx4 v19, s[44:47], s70 offen lds
  s_add_u32 m0, s73, 106496
  s_nop 0
  buffer_load_dwordx4 v22, s[52:55], s72 offen lds
  s_add_u32 m0, s73, 107520
  s_nop 0
  buffer_load_dwordx4 v23, s[52:55], s72 offen lds
  s_add_u32 m0, s73, 108544
  s_nop 0
  buffer_load_dwordx4 v24, s[52:55], s72 offen lds
  s_add_u32 m0, s73, 109568
  s_nop 0
  buffer_load_dwordx4 v25, s[52:55], s72 offen lds
  s_add_u32 m0, s73, 110592
  s_nop 0
  buffer_load_dwordx4 v26, s[52:55], s72 offen lds
  s_add_u32 m0, s73, 111616
  s_nop 0
  buffer_load_dwordx4 v27, s[52:55], s72 offen lds
  s_add_u32 m0, s73, 112640
  s_nop 0
  buffer_load_dwordx4 v28, s[52:55], s72 offen lds
  s_waitcnt vmcnt(11)
  s_barrier
  s_cmp_lg_u32 s4, 0
  s_cbranch_scc1 L_r10_35
  s_lshl_b32 s12, s5, 4
  s_add_u32 s12, s12, s6
  s_lshl_b32 s12, s12, 9
  s_add_u32 s12, s12, 27656192
  s_mov_b64 exec, 1
  v_mov_b32 v2, 0
  v_mov_b32 v3, 1
  buffer_store_dword v3, v2, s[64:67], s12 offen offset:12 sc1
  s_mov_b64 exec, -1
L_r10_35:
  s_setprio 3
  s_add_u32 m0, s27, 135168
  s_nop 0
  buffer_load_dwordx4 v20, s[48:51], s71 offen lds
  s_add_u32 m0, s27, 136192
  s_nop 0
  buffer_load_dwordx4 v21, s[48:51], s71 offen lds
  s_setprio 0
  s_add_u32 s12, s10, s74
  s_and_b32 s12, s12, 15
  s_lshr_b64 s[10:11], s[10:11], 4
  s_lshl_b32 s70, s12, 7
  s_lshl_b32 s71, s12, 17
  s_mul_i32 s72, s12, 458752
  s_add_u32 m0, s26, 0
  s_nop 0
  buffer_load_dwordx4 v16, s[44:47], s70 offen lds
  s_add_u32 m0, s26, 1024
  s_nop 0
  buffer_load_dwordx4 v17, s[44:47], s70 offen lds
  s_add_u32 m0, s26, 2048
  s_nop 0
  buffer_load_dwordx4 v18, s[44:47], s70 offen lds
  s_add_u32 m0, s26, 3072
  s_nop 0
  buffer_load_dwordx4 v19, s[44:47], s70 offen lds
  s_add_u32 m0, s73, 16384
  s_nop 0
  buffer_load_dwordx4 v22, s[52:55], s72 offen lds
  s_add_u32 m0, s73, 17408
  s_nop 0
  buffer_load_dwordx4 v23, s[52:55], s72 offen lds
  s_add_u32 m0, s73, 18432
  s_nop 0
  buffer_load_dwordx4 v24, s[52:55], s72 offen lds
  s_add_u32 m0, s73, 19456
  s_nop 0
  buffer_load_dwordx4 v25, s[52:55], s72 offen lds
  s_add_u32 m0, s73, 20480
L_pad_119:
  s_cbranch_execz L_pad_969
  s_nop 0
  buffer_load_dwordx4 v26, s[52:55], s72 offen lds
  s_add_u32 m0, s73, 21504
  s_nop 0
  buffer_load_dwordx4 v27, s[52:55], s72 offen lds
  s_add_u32 m0, s73, 22528
  s_nop 0
  buffer_load_dwordx4 v28, s[52:55], s72 offen lds
  s_waitcnt vmcnt(11)
  s_barrier
  s_setprio 3
  s_add_u32 m0, s27, 143360
  s_nop 0
  buffer_load_dwordx4 v20, s[48:51], s71 offen lds
  s_add_u32 m0, s27, 144384
  s_nop 0
  buffer_load_dwordx4 v21, s[48:51], s71 offen lds
  s_setprio 0
  s_add_u32 s12, s10, s74
  s_and_b32 s12, s12, 15
  s_lshr_b64 s[10:11], s[10:11], 4
  s_lshl_b32 s70, s12, 7
  s_lshl_b32 s71, s12, 17
  s_mul_i32 s72, s12, 458752
  s_add_u32 m0, s26, 45056
  s_nop 0
  buffer_load_dwordx4 v16, s[44:47], s70 offen lds
  s_add_u32 m0, s26, 46080
  s_nop 0
  buffer_load_dwordx4 v17, s[44:47], s70 offen lds
  s_add_u32 m0, s26, 47104
  s_nop 0
  buffer_load_dwordx4 v18, s[44:47], s70 offen lds
  s_add_u32 m0, s26, 48128
  s_nop 0
  buffer_load_dwordx4 v19, s[44:47], s70 offen lds
  s_add_u32 m0, s73, 61440
  s_nop 0
  buffer_load_dwordx4 v22, s[52:55], s72 offen lds
  s_add_u32 m0, s73, 62464
  s_nop 0
  buffer_load_dwordx4 v23, s[52:55], s72 offen lds
  s_add_u32 m0, s73, 63488
  s_nop 0
  buffer_load_dwordx4 v24, s[52:55], s72 offen lds
  s_add_u32 m0, s73, 64512
  s_nop 0
  buffer_load_dwordx4 v25, s[52:55], s72 offen lds
  s_add_u32 m0, s73, 65536
  s_nop 0
  buffer_load_dwordx4 v26, s[52:55], s72 offen lds
  s_add_u32 m0, s73, 66560
  s_nop 0
  buffer_load_dwordx4 v27, s[52:55], s72 offen lds
  s_add_u32 m0, s73, 67584
  s_nop 0
  buffer_load_dwordx4 v28, s[52:55], s72 offen lds
  s_waitcnt vmcnt(11)
  s_barrier
  s_setprio 3
  s_add_u32 m0, s27, 135168
  s_nop 0
  buffer_load_dwordx4 v20, s[48:51], s71 offen lds
  s_add_u32 m0, s27, 136192
  s_nop 0
  buffer_load_dwordx4 v21, s[48:51], s71 offen lds
  s_setprio 0
  s_add_u32 s12, s10, s74
  s_and_b32 s12, s12, 15
  s_lshr_b64 s[10:11], s[10:11], 4
  s_lshl_b32 s70, s12, 7
  s_lshl_b32 s71, s12, 17
  s_mul_i32 s72, s12, 458752
  s_add_u32 m0, s26, 90112
  s_nop 0
  buffer_load_dwordx4 v16, s[44:47], s70 offen lds
  s_add_u32 m0, s26, 91136
  s_nop 0
  buffer_load_dwordx4 v17, s[44:47], s70 offen lds
  s_add_u32 m0, s26, 92160
  s_nop 0
  buffer_load_dwordx4 v18, s[44:47], s70 offen lds
  s_add_u32 m0, s26, 93184
  s_nop 0
  buffer_load_dwordx4 v19, s[44:47], s70 offen lds
  s_add_u32 m0, s73, 106496
  s_nop 0
  buffer_load_dwordx4 v22, s[52:55], s72 offen lds
  s_add_u32 m0, s73, 107520
  s_nop 0
  buffer_load_dwordx4 v23, s[52:55], s72 offen lds
  s_add_u32 m0, s73, 108544
  s_nop 0
  buffer_load_dwordx4 v24, s[52:55], s72 offen lds
  s_add_u32 m0, s73, 109568
  s_nop 0
  buffer_load_dwordx4 v25, s[52:55], s72 offen lds
  s_add_u32 m0, s73, 110592
  s_nop 0
  buffer_load_dwordx4 v26, s[52:55], s72 offen lds
  s_add_u32 m0, s73, 111616
  s_nop 0
  buffer_load_dwordx4 v27, s[52:55], s72 offen lds
  s_add_u32 m0, s73, 112640
  s_nop 0
  buffer_load_dwordx4 v28, s[52:55], s72 offen lds
  s_waitcnt vmcnt(11)
  s_barrier
  s_add_u32 m0, s27, 143360
  s_nop 0
  buffer_load_dwordx4 v20, s[48:51], s71 offen lds
  s_add_u32 m0, s27, 144384
  s_nop 0
  buffer_load_dwordx4 v21, s[48:51], s71 offen lds
  v_lshlrev_b32 v5, 9, v0
  s_lshl_b32 s14, s4, 15
  s_add_u32 s14, s14, 27656192
  buffer_load_dword v35, v5, s[64:67], s14 offen offset:12 sc1
  s_getpc_b64 s[60:61]
L_pc1:
  s_mov_b32 s62, L_exit-L_pc1
  s_lshr_b32 s12, s2, 3
  s_lshl_b32 s12, s12, 2
  s_add_u32 s12, s12, s4
  s_mul_i32 s12, s12, 768
  v_lshlrev_b32 v4, 7, v0
  s_mov_b64 exec, 63
  buffer_load_dword v255, v4, s[60:63], s12 offen
  s_mov_b64 exec, -1
  s_mov_b32 s60, s34
  s_mov_b32 s61, s35
  s_mov_b32 s62, 2048
  s_mov_b32 s63, 0x20000
  s_waitcnt vmcnt(0)
  v_cmp_eq_u32 vcc, 1, v35
  s_nop 1
  s_cmp_eq_u64 vcc, exec
  s_cbranch_scc1 L_pdone_37
  s_mov_b32 s15, 1048576
L_poll_36:
  buffer_load_dword v4, v5, s[64:67], s14 offen offset:12 sc1
  s_waitcnt vmcnt(0)
  v_cmp_eq_u32 vcc, 1, v4
  s_nop 1
  s_cmp_eq_u64 vcc, exec
  s_cbranch_scc1 L_pdone_37
  s_sleep 1
  s_sub_u32 s15, s15, 1
  s_cmp_lg_u32 s15, 0
  s_cbranch_scc1 L_poll_36
L_pdone_37:
  s_mov_b32 s52, s32
  s_mov_b32 s53, s33
  s_mov_b32 s54, 7340032
  s_mov_b32 s55, 0x20000
  s_mov_b32 s48, s24
  s_mov_b32 s49, s25
  s_mov_b32 s50, 2097152
  s_mov_b32 s51, 0x20000
  s_lshl_b32 s10, s4, 10
  v_add_u32 v14, s10, v10
  v_xor_b32 v13, 128, v15
  s_lshl_b32 s28, s7, 2
  s_add_u32 s28, s28, s4
  s_mul_i32 s28, s28, 229376
  s_barrier
  s_add_u32 s11, s5, 0
  s_and_b32 s11, s11, 15
  s_lshl_b32 s11, s11, 14
  s_add_u32 m0, s10, 0
  s_add_u32 s12, s11, 27262976
  buffer_load_dwordx4 v14, s[64:67], s12 offen sc1 lds
  s_add_u32 m0, s10, 4096
  s_add_u32 s12, s11, 27267072
  buffer_load_dwordx4 v14, s[64:67], s12 offen sc1 lds
  s_add_u32 m0, s10, 8192
  s_add_u32 s12, s11, 27271168
  buffer_load_dwordx4 v14, s[64:67], s12 offen sc1 lds
  s_add_u32 m0, s10, 12288
  s_add_u32 s12, s11, 27275264
  buffer_load_dwordx4 v14, s[64:67], s12 offen sc1 lds
  s_add_u32 s11, s5, 1
  s_and_b32 s11, s11, 15
  s_lshl_b32 s11, s11, 14
  s_add_u32 m0, s10, 32768
L_pad_136:
  s_cbranch_execz L_pad_986
  s_add_u32 s12, s11, 27262976
  buffer_load_dwordx4 v14, s[64:67], s12 offen sc1 lds
  s_add_u32 m0, s10, 36864
  s_add_u32 s12, s11, 27267072
  buffer_load_dwordx4 v14, s[64:67], s12 offen sc1 lds
  s_add_u32 m0, s10, 40960
  s_add_u32 s12, s11, 27271168
  buffer_load_dwordx4 v14, s[64:67], s12 offen sc1 lds
  s_add_u32 m0, s10, 45056
  s_add_u32 s12, s11, 27275264
  buffer_load_dwordx4 v14, s[64:67], s12 offen sc1 lds
  s_add_u32 s11, s5, 2
  s_and_b32 s11, s11, 15
  s_lshl_b32 s11, s11, 14
  s_add_u32 m0, s10, 16384
  s_add_u32 s12, s11, 27262976
  buffer_load_dwordx4 v14, s[64:67], s12 offen sc1 lds
  s_add_u32 m0, s10, 20480
  s_add_u32 s12, s11, 27267072
  buffer_load_dwordx4 v14, s[64:67], s12 offen sc1 lds
  s_add_u32 m0, s10, 24576
  s_add_u32 s12, s11, 27271168
  buffer_load_dwordx4 v14, s[64:67], s12 offen sc1 lds
  s_add_u32 m0, s10, 28672
  s_add_u32 s12, s11, 27275264
  buffer_load_dwordx4 v14, s[64:67], s12 offen sc1 lds
  s_waitcnt vmcnt(8)
  s_barrier
  s_lshl_b32 s12, s7, 7
  s_lshl_b32 s13, s4, 5
  s_add_u32 s74, s12, s13
  s_lshl_b32 s13, s74, 2
  s_add_u32 s13, s13, 27525120
  v_and_b32 v3, 15, v0
  v_lshlrev_b32 v3, 2, v3
  buffer_load_dword v60, v3, s[64:67], s13 offen sc1
  buffer_load_dword v61, v3, s[64:67], s13 offen offset:64 sc1
  v_lshrrev_b32 v2, 4, v0
  v_lshlrev_b32 v3, 3, v2
  s_lshl_b32 s12, s9, 8
  s_lshl_b32 s13, s8, 7
  s_add_u32 s13, s13, s12
  buffer_load_dwordx2 v[224:225], v3, s[60:63], s13 offen offset:0
  buffer_load_dwordx2 v[226:227], v3, s[60:63], s13 offen offset:32
  buffer_load_dwordx2 v[228:229], v3, s[60:63], s13 offen offset:64
  buffer_load_dwordx2 v[230:231], v3, s[60:63], s13 offen offset:96
  v_bfe_u32 v3, v0, 2, 2
  v_and_b32 v4, 3, v0
  v_lshlrev_b32 v4, 3, v4
  v_bfe_u32 v6, v0, 3, 2
  v_lshl_add_u32 v4, v6, 5, v4
  v_lshrrev_b32 v6, 2, v0
  v_lshl_add_u32 v7, v6, 7, v4
  v_add_u32 v7, 49152, v7
  v_xor_b32 v16, 0, v7
  v_add_u32 v20, 0x10000, v16
  v_xor_b32 v17, 32, v7
  v_add_u32 v21, 0x10000, v17
  v_xor_b32 v18, 64, v7
  v_add_u32 v22, 0x10000, v18
  v_xor_b32 v19, 96, v7
  v_add_u32 v23, 0x10000, v19
  v_add_u32 v11, 114688, v10
  v_add_u32 v1, 0x1000, v10
  s_lshl_b32 s12, s2, 2
  s_add_u32 s12, s12, s4
  s_lshl_b32 s71, s12, 13
  s_add_u32 s71, s71, 18874368
  s_lshl_b32 s72, s12, 7
  s_add_u32 s72, s72, 27656192
  v_mov_b32 v96, 0
  v_mov_b32 v97, 0
  v_mov_b32 v98, 0
  v_mov_b32 v99, 0
  v_mov_b32 v100, 0
  v_mov_b32 v101, 0
  v_mov_b32 v102, 0
  v_mov_b32 v103, 0
  v_mov_b32 v104, 0
  v_mov_b32 v105, 0
  v_mov_b32 v106, 0
  v_mov_b32 v107, 0
  v_mov_b32 v108, 0
  v_mov_b32 v109, 0
  v_mov_b32 v110, 0
  v_mov_b32 v111, 0
  v_mov_b32 v112, 0
  v_mov_b32 v113, 0
  v_mov_b32 v114, 0
  v_mov_b32 v115, 0
  v_mov_b32 v116, 0
  v_mov_b32 v117, 0
  v_mov_b32 v118, 0
  v_mov_b32 v119, 0
  v_mov_b32 v120, 0
  v_mov_b32 v121, 0
  v_mov_b32 v122, 0
  v_mov_b32 v123, 0
  v_mov_b32 v124, 0
  v_mov_b32 v125, 0
  v_mov_b32 v126, 0
  v_mov_b32 v127, 0
  s_mov_b64 exec, 0
  s_cmp_eq_u32 s4, 0
  s_cbranch_scc1 L_pad_850
  s_cmp_eq_u32 s4, 1
  s_cbranch_scc1 L_pad_1071
  s_cmp_eq_u32 s4, 2
  s_cbranch_scc1 L_pad_1088
  s_branch L_pad_1105
L_ret_s3:
  s_mov_b64 exec, -1
  s_waitcnt vmcnt(0)
  v_lshlrev_b32 v64, 16, v224
  v_and_b32 v65, 0xffff0000, v224
  v_lshlrev_b32 v66, 16, v225
  v_and_b32 v67, 0xffff0000, v225
  v_lshlrev_b32 v68, 16, v224
  v_and_b32 v69, 0xffff0000, v224
  v_lshlrev_b32 v70, 16, v225
  v_and_b32 v71, 0xffff0000, v225
  v_lshlrev_b32 v72, 16, v226
  v_and_b32 v73, 0xffff0000, v226
  v_lshlrev_b32 v74, 16, v227
  v_and_b32 v75, 0xffff0000, v227
  v_lshlrev_b32 v76, 16, v226
  v_and_b32 v77, 0xffff0000, v226
  v_lshlrev_b32 v78, 16, v227
  v_and_b32 v79, 0xffff0000, v227
  v_lshlrev_b32 v80, 16, v228
  v_and_b32 v81, 0xffff0000, v228
  v_lshlrev_b32 v82, 16, v229
  v_and_b32 v83, 0xffff0000, v229
  v_lshlrev_b32 v84, 16, v228
  v_and_b32 v85, 0xffff0000, v228
  v_lshlrev_b32 v86, 16, v229
  v_and_b32 v87, 0xffff0000, v229
  v_lshlrev_b32 v88, 16, v230
  v_and_b32 v89, 0xffff0000, v230
  v_lshlrev_b32 v90, 16, v231
  v_and_b32 v91, 0xffff0000, v231
  v_lshlrev_b32 v92, 16, v230
  v_and_b32 v93, 0xffff0000, v230
  v_lshlrev_b32 v94, 16, v231
  v_and_b32 v95, 0xffff0000, v231
  s_cmp_eq_u32 s8, 1
  s_cbranch_scc1 L_g_odd
  s_lshr_b32 s12, s2, 1
  s_add_u32 s12, s12, 0
  s_and_b32 s12, s12, 3
  s_mul_i32 s20, s12, 917504
  s_lshr_b32 s12, s20, 6
  s_add_u32 s16, s12, s28
  s_lshr_b32 s12, s2, 1
  s_add_u32 s12, s12, 1
  s_and_b32 s12, s12, 3
  s_mul_i32 s21, s12, 917504
  s_lshr_b32 s12, s21, 6
  s_add_u32 s17, s12, s28
  s_lshr_b32 s12, s2, 1
  s_add_u32 s12, s12, 2
  s_and_b32 s12, s12, 3
  s_mul_i32 s22, s12, 917504
  s_lshr_b32 s12, s22, 6
  s_add_u32 s18, s12, s28
  s_lshr_b32 s12, s2, 1
  s_add_u32 s12, s12, 3
  s_and_b32 s12, s12, 3
  s_mul_i32 s23, s12, 917504
  s_lshr_b32 s12, s23, 6
  s_add_u32 s19, s12, s28
  s_waitcnt vmcnt(0)
  s_barrier
  s_add_u32 s11, s5, 3
  s_and_b32 s11, s11, 15
  s_lshl_b32 s11, s11, 14
  s_add_u32 m0, s10, 0
  s_add_u32 s12, s11, 27262976
  buffer_load_dwordx4 v14, s[64:67], s12 offen sc1 lds
  s_add_u32 m0, s10, 4096
  s_add_u32 s12, s11, 27267072
  buffer_load_dwordx4 v14, s[64:67], s12 offen sc1 lds
  s_add_u32 m0, s10, 8192
  s_add_u32 s12, s11, 27271168
  buffer_load_dwordx4 v14, s[64:67], s12 offen sc1 lds
  s_add_u32 m0, s10, 12288
  s_add_u32 s12, s11, 27275264
  buffer_load_dwordx4 v14, s[64:67], s12 offen sc1 lds
  s_add_u32 m0, s10, 131072
  s_add_u32 s12, s20, 0
  buffer_load_dwordx4 v15, s[52:55], s12 offen lds
  s_add_u32 m0, s10, 135168
  s_add_u32 s12, s20, 65536
  buffer_load_dwordx4 v15, s[52:55], s12 offen lds
  s_add_u32 m0, s10, 139264
  s_add_u32 s12, s20, 0
  buffer_load_dwordx4 v13, s[52:55], s12 offen lds
  s_add_u32 m0, s10, 143360
  s_add_u32 s12, s20, 65536
  buffer_load_dwordx4 v13, s[52:55], s12 offen lds
  s_add_u32 m0, s10, 147456
  s_add_u32 s12, s20, 131072
  buffer_load_dwordx4 v15, s[52:55], s12 offen lds
  s_add_u32 m0, s10, 151552
  s_add_u32 s12, s20, 196608
  buffer_load_dwordx4 v15, s[52:55], s12 offen lds
  s_add_u32 m0, s10, 155648
  s_add_u32 s12, s20, 131072
  buffer_load_dwordx4 v13, s[52:55], s12 offen lds
  s_add_u32 m0, s10, 159744
  s_add_u32 s12, s20, 196608
  buffer_load_dwordx4 v13, s[52:55], s12 offen lds
  s_lshl_b32 s12, s2, 2
  s_add_u32 s12, s12, s4
  s_lshl_b32 s12, s12, 11
  v_lshlrev_b32 v4, 7, v0
  s_mov_b64 exec, 0xffff
  buffer_load_dword v9, v4, s[48:51], s12 offen
  s_mov_b64 exec, -1
  s_waitcnt vmcnt(13)
  s_barrier
  s_add_u32 s11, s5, 4
  s_and_b32 s11, s11, 15
  s_lshl_b32 s11, s11, 14
  s_add_u32 m0, s10, 32768
  s_add_u32 s12, s11, 27262976
  buffer_load_dwordx4 v14, s[64:67], s12 offen sc1 lds
  s_add_u32 m0, s10, 36864
  s_add_u32 s12, s11, 27267072
  buffer_load_dwordx4 v14, s[64:67], s12 offen sc1 lds
  s_add_u32 m0, s10, 40960
  s_add_u32 s12, s11, 27271168
  buffer_load_dwordx4 v14, s[64:67], s12 offen sc1 lds
  s_add_u32 m0, s10, 45056
  s_add_u32 s12, s11, 27275264
  buffer_load_dwordx4 v14, s[64:67], s12 offen sc1 lds
  s_add_u32 m0, s10, 49152
  s_add_u32 s12, s20, 262144
  buffer_load_dwordx4 v15, s[52:55], s12 offen lds
  s_add_u32 m0, s10, 53248
  s_add_u32 s12, s20, 327680
  buffer_load_dwordx4 v15, s[52:55], s12 offen lds
  s_add_u32 m0, s10, 57344
  s_add_u32 s12, s20, 262144
  buffer_load_dwordx4 v13, s[52:55], s12 offen lds
  s_add_u32 m0, s10, 61440
  s_add_u32 s12, s20, 327680
  buffer_load_dwordx4 v13, s[52:55], s12 offen lds
  s_waitcnt vmcnt(8)
  s_barrier
  s_add_u32 s11, s5, 5
  s_and_b32 s11, s11, 15
  s_lshl_b32 s11, s11, 14
  s_add_u32 m0, s10, 16384
  s_add_u32 s12, s11, 27262976
  buffer_load_dwordx4 v14, s[64:67], s12 offen sc1 lds
  s_add_u32 m0, s10, 20480
  s_add_u32 s12, s11, 27267072
  buffer_load_dwordx4 v14, s[64:67], s12 offen sc1 lds
  s_add_u32 m0, s10, 24576
  s_add_u32 s12, s11, 27271168
  buffer_load_dwordx4 v14, s[64:67], s12 offen sc1 lds
  s_add_u32 m0, s10, 28672
  s_add_u32 s12, s11, 27275264
  buffer_load_dwordx4 v14, s[64:67], s12 offen sc1 lds
  v_bfe_u32 v5, v0, 1, 4
  v_and_b32 v6, 1, v0
  v_lshl_add_u32 v5, v5, 2, v6
  v_lshlrev_b32 v5, 7, v5
  s_lshl_b32 s13, s7, 6
  s_and_b32 s12, s4, 2
  s_add_u32 s13, s13, s12
  s_lshl_b32 s13, s13, 7
  s_add_u32 s13, s13, 27656192
  s_mov_b32 exec_lo, 262143
  s_mov_b32 exec_hi, 0
  s_mov_b32 s15, 1048576
L_poll_38:
  buffer_load_dword v4, v5, s[64:67], s13 offen offset:0 sc1
  s_waitcnt vmcnt(0)
  v_cmp_eq_u32 vcc, 1, v4
  s_nop 1
  s_cmp_eq_u64 vcc, exec
  s_cbranch_scc1 L_pdone_39
  s_sleep 1
  s_sub_u32 s15, s15, 1
  s_cmp_lg_u32 s15, 0
  s_cbranch_scc1 L_poll_38
L_pdone_39:
  s_mov_b64 exec, -1
  s_add_u32 s69, s16, 0
  buffer_load_dwordx4 v[128:131], v10, s[64:67], s69 offen offset:0 sc1
  buffer_load_dwordx4 v[132:135], v10, s[64:67], s69 offen offset:1024 sc1
  buffer_load_dwordx4 v[136:139], v11, s[64:67], s69 offen offset:0 sc1
  buffer_load_dwordx4 v[140:143], v11, s[64:67], s69 offen offset:1024 sc1
  s_add_u32 s69, s16, 2048
  buffer_load_dwordx4 v[144:147], v10, s[64:67], s69 offen offset:0 sc1
  buffer_load_dwordx4 v[148:151], v10, s[64:67], s69 offen offset:1024 sc1
  buffer_load_dwordx4 v[152:155], v11, s[64:67], s69 offen offset:0 sc1
  buffer_load_dwordx4 v[156:159], v11, s[64:67], s69 offen offset:1024 sc1
  s_add_u32 s69, s16, 4096
  buffer_load_dwordx4 v[160:163], v10, s[64:67], s69 offen offset:0 sc1
  buffer_load_dwordx4 v[164:167], v10, s[64:67], s69 offen offset:1024 sc1
  buffer_load_dwordx4 v[168:171], v11, s[64:67], s69 offen offset:0 sc1
  buffer_load_dwordx4 v[172:175], v11, s[64:67], s69 offen offset:1024 sc1
  s_barrier
  ds_read_b64_tr_b16 v[224:225], v20 offset:16384
  ds_read_b64_tr_b16 v[226:227], v20 offset:18432
  ds_read_b64_tr_b16 v[228:229], v20 offset:20480
  ds_read_b64_tr_b16 v[230:231], v20 offset:22528
  ds_read_b64_tr_b16 v[232:233], v21 offset:16384
  ds_read_b64_tr_b16 v[234:235], v21 offset:18432
  ds_read_b64_tr_b16 v[236:237], v21 offset:20480
  ds_read_b64_tr_b16 v[238:239], v21 offset:22528
  ds_read_b64_tr_b16 v[240:241], v22 offset:16384
  ds_read_b64_tr_b16 v[242:243], v22 offset:18432
  ds_read_b64_tr_b16 v[244:245], v22 offset:20480
  ds_read_b64_tr_b16 v[246:247], v22 offset:22528
  s_waitcnt vmcnt(8)
  s_waitcnt lgkmcnt(8)
  v_mfma_f32_16x16x32_bf16 v[64:67], v[224:227], v[128:131], v[64:67]
  ds_read_b64_tr_b16 v[248:249], v23 offset:16384
  v_mfma_f32_16x16x32_bf16 v[64:67], v[228:231], v[132:135], v[64:67]
  ds_read_b64_tr_b16 v[250:251], v23 offset:18432
  s_add_u32 s69, s16, 6144
  buffer_load_dwordx4 v[176:179], v10, s[64:67], s69 offen offset:0 sc1
  v_mfma_f32_16x16x32_bf16 v[68:71], v[228:231], v[140:143], v[68:71]
  ds_read_b64_tr_b16 v[252:253], v23 offset:20480
  v_mfma_f32_16x16x32_bf16 v[68:71], v[224:227], v[136:139], v[68:71]
  ds_read_b64_tr_b16 v[254:255], v23 offset:22528
  buffer_load_dwordx4 v[180:183], v10, s[64:67], s69 offen offset:1024 sc1
  s_waitcnt lgkmcnt(8)
  v_mfma_f32_16x16x32_bf16 v[76:79], v[232:235], v[136:139], v[76:79]
  ds_read_b64_tr_b16 v[224:225], v20 offset:24576
  v_mfma_f32_16x16x32_bf16 v[76:79], v[236:239], v[140:143], v[76:79]
  ds_read_b64_tr_b16 v[226:227], v20 offset:26624
  buffer_load_dwordx4 v[184:187], v11, s[64:67], s69 offen offset:0 sc1
  v_mfma_f32_16x16x32_bf16 v[72:75], v[236:239], v[132:135], v[72:75]
  ds_read_b64_tr_b16 v[228:229], v20 offset:28672
  v_mfma_f32_16x16x32_bf16 v[72:75], v[232:235], v[128:131], v[72:75]
  ds_read_b64_tr_b16 v[230:231], v20 offset:30720
  buffer_load_dwordx4 v[188:191], v11, s[64:67], s69 offen offset:1024 sc1
  s_waitcnt lgkmcnt(8)
  v_mfma_f32_16x16x32_bf16 v[80:83], v[240:243], v[128:131], v[80:83]
  ds_read_b64_tr_b16 v[232:233], v21 offset:24576
  v_mfma_f32_16x16x32_bf16 v[80:83], v[244:247], v[132:135], v[80:83]
  ds_read_b64_tr_b16 v[234:235], v21 offset:26624
  s_add_u32 m0, s10, 65536
  s_add_u32 s12, s20, 393216
  buffer_load_dwordx4 v15, s[52:55], s12 offen lds
  v_mfma_f32_16x16x32_bf16 v[84:87], v[244:247], v[140:143], v[84:87]
  ds_read_b64_tr_b16 v[236:237], v21 offset:28672
  v_mfma_f32_16x16x32_bf16 v[84:87], v[240:243], v[136:139], v[84:87]
  ds_read_b64_tr_b16 v[238:239], v21 offset:30720
  s_add_u32 m0, s10, 69632
  s_add_u32 s12, s20, 458752
  buffer_load_dwordx4 v15, s[52:55], s12 offen lds
  s_waitcnt lgkmcnt(8)
  v_mfma_f32_16x16x32_bf16 v[92:95], v[248:251], v[136:139], v[92:95]
  ds_read_b64_tr_b16 v[240:241], v22 offset:24576
  v_mfma_f32_16x16x32_bf16 v[92:95], v[252:255], v[140:143], v[92:95]
  ds_read_b64_tr_b16 v[242:243], v22 offset:26624
  s_add_u32 m0, s10, 73728
  s_add_u32 s12, s20, 393216
  buffer_load_dwordx4 v13, s[52:55], s12 offen lds
  v_mfma_f32_16x16x32_bf16 v[88:91], v[252:255], v[132:135], v[88:91]
  ds_read_b64_tr_b16 v[244:245], v22 offset:28672
  v_mfma_f32_16x16x32_bf16 v[88:91], v[248:251], v[128:131], v[88:91]
  ds_read_b64_tr_b16 v[246:247], v22 offset:30720
  s_add_u32 m0, s10, 77824
  s_add_u32 s12, s20, 458752
  buffer_load_dwordx4 v13, s[52:55], s12 offen lds
  s_waitcnt lgkmcnt(8)
  v_mfma_f32_16x16x32_bf16 v[96:99], v[224:227], v[128:131], v[96:99]
  ds_read_b64_tr_b16 v[248:249], v23 offset:24576
  v_mfma_f32_16x16x32_bf16 v[96:99], v[228:231], v[132:135], v[96:99]
  ds_read_b64_tr_b16 v[250:251], v23 offset:26624
  s_add_u32 m0, s10, 81920
  s_add_u32 s12, s20, 524288
  buffer_load_dwordx4 v15, s[52:55], s12 offen lds
  v_mfma_f32_16x16x32_bf16 v[100:103], v[228:231], v[140:143], v[100:103]
  ds_read_b64_tr_b16 v[252:253], v23 offset:28672
  v_mfma_f32_16x16x32_bf16 v[100:103], v[224:227], v[136:139], v[100:103]
  ds_read_b64_tr_b16 v[254:255], v23 offset:30720
  s_add_u32 m0, s10, 86016
  s_add_u32 s12, s20, 589824
  buffer_load_dwordx4 v15, s[52:55], s12 offen lds
  s_waitcnt lgkmcnt(8)
  v_mfma_f32_16x16x32_bf16 v[108:111], v[232:235], v[136:139], v[108:111]
  ds_read_b64_tr_b16 v[224:225], v20 offset:32768
  v_mfma_f32_16x16x32_bf16 v[108:111], v[236:239], v[140:143], v[108:111]
  ds_read_b64_tr_b16 v[226:227], v20 offset:34816
  s_add_u32 m0, s10, 90112
  s_add_u32 s12, s20, 524288
  buffer_load_dwordx4 v13, s[52:55], s12 offen lds
  v_mfma_f32_16x16x32_bf16 v[104:107], v[236:239], v[132:135], v[104:107]
  ds_read_b64_tr_b16 v[228:229], v20 offset:36864
  v_mfma_f32_16x16x32_bf16 v[104:107], v[232:235], v[128:131], v[104:107]
  ds_read_b64_tr_b16 v[230:231], v20 offset:38912
  s_add_u32 m0, s10, 94208
  s_add_u32 s12, s20, 589824
  buffer_load_dwordx4 v13, s[52:55], s12 offen lds
  s_waitcnt lgkmcnt(8)
  v_mfma_f32_16x16x32_bf16 v[112:115], v[240:243], v[128:131], v[112:115]
  ds_read_b64_tr_b16 v[232:233], v21 offset:32768
  v_mfma_f32_16x16x32_bf16 v[112:115], v[244:247], v[132:135], v[112:115]
  ds_read_b64_tr_b16 v[234:235], v21 offset:34816
  s_add_u32 m0, s10, 98304
  s_add_u32 s12, s20, 655360
  buffer_load_dwordx4 v15, s[52:55], s12 offen lds
  v_mfma_f32_16x16x32_bf16 v[116:119], v[244:247], v[140:143], v[116:119]
  ds_read_b64_tr_b16 v[236:237], v21 offset:36864
  v_mfma_f32_16x16x32_bf16 v[116:119], v[240:243], v[136:139], v[116:119]
  ds_read_b64_tr_b16 v[238:239], v21 offset:38912
  s_add_u32 m0, s10, 102400
  s_add_u32 s12, s20, 720896
  buffer_load_dwordx4 v15, s[52:55], s12 offen lds
  s_waitcnt lgkmcnt(8)
  v_mfma_f32_16x16x32_bf16 v[124:127], v[248:251], v[136:139], v[124:127]
  ds_read_b64_tr_b16 v[240:241], v22 offset:32768
  v_mfma_f32_16x16x32_bf16 v[124:127], v[252:255], v[140:143], v[124:127]
  ds_read_b64_tr_b16 v[242:243], v22 offset:34816
  s_add_u32 m0, s10, 106496
  s_add_u32 s12, s20, 655360
  buffer_load_dwordx4 v13, s[52:55], s12 offen lds
  v_mfma_f32_16x16x32_bf16 v[120:123], v[252:255], v[132:135], v[120:123]
  ds_read_b64_tr_b16 v[244:245], v22 offset:36864
  v_mfma_f32_16x16x32_bf16 v[120:123], v[248:251], v[128:131], v[120:123]
  ds_read_b64_tr_b16 v[246:247], v22 offset:38912
  s_add_u32 m0, s10, 110592
  s_add_u32 s12, s20, 720896
  buffer_load_dwordx4 v13, s[52:55], s12 offen lds
  s_waitcnt vmcnt(20)
  s_waitcnt lgkmcnt(8)
  v_mfma_f32_16x16x32_bf16 v[64:67], v[224:227], v[144:147], v[64:67]
  ds_read_b64_tr_b16 v[248:249], v23 offset:32768
  v_mfma_f32_16x16x32_bf16 v[64:67], v[228:231], v[148:151], v[64:67]
  ds_read_b64_tr_b16 v[250:251], v23 offset:34816
  s_add_u32 s69, s16, 8192
  buffer_load_dwordx4 v[192:195], v10, s[64:67], s69 offen offset:0 sc1
  v_mfma_f32_16x16x32_bf16 v[68:71], v[228:231], v[156:159], v[68:71]
  ds_read_b64_tr_b16 v[252:253], v23 offset:36864
  v_mfma_f32_16x16x32_bf16 v[68:71], v[224:227], v[152:155], v[68:71]
  ds_read_b64_tr_b16 v[254:255], v23 offset:38912
  buffer_load_dwordx4 v[196:199], v10, s[64:67], s69 offen offset:1024 sc1
  s_waitcnt lgkmcnt(8)
  v_mfma_f32_16x16x32_bf16 v[76:79], v[232:235], v[152:155], v[76:79]
  ds_read_b64_tr_b16 v[224:225], v20 offset:40960
  v_mfma_f32_16x16x32_bf16 v[76:79], v[236:239], v[156:159], v[76:79]
  ds_read_b64_tr_b16 v[226:227], v20 offset:43008
  buffer_load_dwordx4 v[200:203], v11, s[64:67], s69 offen offset:0 sc1
  v_mfma_f32_16x16x32_bf16 v[72:75], v[236:239], v[148:151], v[72:75]
  ds_read_b64_tr_b16 v[228:229], v20 offset:45056
  v_mfma_f32_16x16x32_bf16 v[72:75], v[232:235], v[144:147], v[72:75]
  ds_read_b64_tr_b16 v[230:231], v20 offset:47104
  buffer_load_dwordx4 v[204:207], v11, s[64:67], s69 offen offset:1024 sc1
  s_waitcnt lgkmcnt(8)
  v_mfma_f32_16x16x32_bf16 v[80:83], v[240:243], v[144:147], v[80:83]
  ds_read_b64_tr_b16 v[232:233], v21 offset:40960
  v_mfma_f32_16x16x32_bf16 v[80:83], v[244:247], v[148:151], v[80:83]
  ds_read_b64_tr_b16 v[234:235], v21 offset:43008
  s_add_u32 m0, s10, 114688
  s_add_u32 s12, s20, 786432
  buffer_load_dwordx4 v15, s[52:55], s12 offen lds
  v_mfma_f32_16x16x32_bf16 v[84:87], v[244:247], v[156:159], v[84:87]
  ds_read_b64_tr_b16 v[236:237], v21 offset:45056
  v_mfma_f32_16x16x32_bf16 v[84:87], v[240:243], v[152:155], v[84:87]
  ds_read_b64_tr_b16 v[238:239], v21 offset:47104
  s_add_u32 m0, s10, 118784
  s_add_u32 s12, s20, 851968
  buffer_load_dwordx4 v15, s[52:55], s12 offen lds
  s_waitcnt lgkmcnt(8)
  v_mfma_f32_16x16x32_bf16 v[92:95], v[248:251], v[152:155], v[92:95]
  ds_read_b64_tr_b16 v[240:241], v22 offset:40960
  v_mfma_f32_16x16x32_bf16 v[92:95], v[252:255], v[156:159], v[92:95]
  ds_read_b64_tr_b16 v[242:243], v22 offset:43008
  s_add_u32 m0, s10, 122880
  s_add_u32 s12, s20, 786432
  buffer_load_dwordx4 v13, s[52:55], s12 offen lds
  v_mfma_f32_16x16x32_bf16 v[88:91], v[252:255], v[148:151], v[88:91]
  ds_read_b64_tr_b16 v[244:245], v22 offset:45056
  v_mfma_f32_16x16x32_bf16 v[88:91], v[248:251], v[144:147], v[88:91]
  ds_read_b64_tr_b16 v[246:247], v22 offset:47104
  s_add_u32 m0, s10, 126976
  s_add_u32 s12, s20, 851968
  buffer_load_dwordx4 v13, s[52:55], s12 offen lds
  s_waitcnt lgkmcnt(8)
  v_mfma_f32_16x16x32_bf16 v[96:99], v[224:227], v[144:147], v[96:99]
  ds_read_b64_tr_b16 v[248:249], v23 offset:40960
  v_mfma_f32_16x16x32_bf16 v[96:99], v[228:231], v[148:151], v[96:99]
  ds_read_b64_tr_b16 v[250:251], v23 offset:43008
  s_add_u32 s11, s5, 6
  s_and_b32 s11, s11, 15
  s_lshl_b32 s11, s11, 14
  s_add_u32 m0, s10, 0
  s_add_u32 s12, s11, 27262976
  buffer_load_dwordx4 v14, s[64:67], s12 offen sc1 lds
  v_mfma_f32_16x16x32_bf16 v[100:103], v[228:231], v[156:159], v[100:103]
  ds_read_b64_tr_b16 v[252:253], v23 offset:45056
  v_mfma_f32_16x16x32_bf16 v[100:103], v[224:227], v[152:155], v[100:103]
  ds_read_b64_tr_b16 v[254:255], v23 offset:47104
  s_add_u32 m0, s10, 4096
  s_add_u32 s12, s11, 27267072
  buffer_load_dwordx4 v14, s[64:67], s12 offen sc1 lds
  s_waitcnt lgkmcnt(8)
  v_mfma_f32_16x16x32_bf16 v[108:111], v[232:235], v[152:155], v[108:111]
  ds_read_b64_tr_b16 v[224:225], v16 offset:0
  v_mfma_f32_16x16x32_bf16 v[108:111], v[236:239], v[156:159], v[108:111]
  ds_read_b64_tr_b16 v[226:227], v16 offset:2048
  s_add_u32 m0, s10, 8192
  s_add_u32 s12, s11, 27271168
  buffer_load_dwordx4 v14, s[64:67], s12 offen sc1 lds
  v_mfma_f32_16x16x32_bf16 v[104:107], v[236:239], v[148:151], v[104:107]
  ds_read_b64_tr_b16 v[228:229], v16 offset:4096
  v_mfma_f32_16x16x32_bf16 v[104:107], v[232:235], v[144:147], v[104:107]
  ds_read_b64_tr_b16 v[230:231], v16 offset:6144
  s_add_u32 m0, s10, 12288
  s_add_u32 s12, s11, 27275264
  buffer_load_dwordx4 v14, s[64:67], s12 offen sc1 lds
  s_waitcnt lgkmcnt(8)
  v_mfma_f32_16x16x32_bf16 v[112:115], v[240:243], v[144:147], v[112:115]
  ds_read_b64_tr_b16 v[232:233], v17 offset:0
  v_mfma_f32_16x16x32_bf16 v[112:115], v[244:247], v[148:151], v[112:115]
  ds_read_b64_tr_b16 v[234:235], v17 offset:2048
  v_mfma_f32_16x16x32_bf16 v[116:119], v[244:247], v[156:159], v[116:119]
  ds_read_b64_tr_b16 v[236:237], v17 offset:4096
  v_mfma_f32_16x16x32_bf16 v[116:119], v[240:243], v[152:155], v[116:119]
  ds_read_b64_tr_b16 v[238:239], v17 offset:6144
  s_waitcnt lgkmcnt(8)
  v_mfma_f32_16x16x32_bf16 v[124:127], v[248:251], v[152:155], v[124:127]
  ds_read_b64_tr_b16 v[240:241], v18 offset:0
  v_mfma_f32_16x16x32_bf16 v[124:127], v[252:255], v[156:159], v[124:127]
  ds_read_b64_tr_b16 v[242:243], v18 offset:2048
  v_mfma_f32_16x16x32_bf16 v[120:123], v[252:255], v[148:151], v[120:123]
  ds_read_b64_tr_b16 v[244:245], v18 offset:4096
  v_mfma_f32_16x16x32_bf16 v[120:123], v[248:251], v[144:147], v[120:123]
  ds_read_b64_tr_b16 v[246:247], v18 offset:6144
  s_waitcnt vmcnt(28)
  s_waitcnt lgkmcnt(8)
  v_mfma_f32_16x16x32_bf16 v[64:67], v[224:227], v[160:163], v[64:67]
  ds_read_b64_tr_b16 v[248:249], v19 offset:0
  v_mfma_f32_16x16x32_bf16 v[64:67], v[228:231], v[164:167], v[64:67]
  ds_read_b64_tr_b16 v[250:251], v19 offset:2048
  s_add_u32 s69, s16, 10240
  buffer_load_dwordx4 v[208:211], v10, s[64:67], s69 offen offset:0 sc1
  v_mfma_f32_16x16x32_bf16 v[68:71], v[228:231], v[172:175], v[68:71]
  ds_read_b64_tr_b16 v[252:253], v19 offset:4096
  v_mfma_f32_16x16x32_bf16 v[68:71], v[224:227], v[168:171], v[68:71]
  ds_read_b64_tr_b16 v[254:255], v19 offset:6144
  buffer_load_dwordx4 v[212:215], v10, s[64:67], s69 offen offset:1024 sc1
  s_waitcnt lgkmcnt(8)
  v_mfma_f32_16x16x32_bf16 v[76:79], v[232:235], v[168:171], v[76:79]
  ds_read_b64_tr_b16 v[224:225], v16 offset:8192
  v_mfma_f32_16x16x32_bf16 v[76:79], v[236:239], v[172:175], v[76:79]
  ds_read_b64_tr_b16 v[226:227], v16 offset:10240
  buffer_load_dwordx4 v[216:219], v11, s[64:67], s69 offen offset:0 sc1
  v_mfma_f32_16x16x32_bf16 v[72:75], v[236:239], v[164:167], v[72:75]
  ds_read_b64_tr_b16 v[228:229], v16 offset:12288
  v_mfma_f32_16x16x32_bf16 v[72:75], v[232:235], v[160:163], v[72:75]
  ds_read_b64_tr_b16 v[230:231], v16 offset:14336
  buffer_load_dwordx4 v[220:223], v11, s[64:67], s69 offen offset:1024 sc1
  s_waitcnt vmcnt(20)
  s_barrier
  s_waitcnt lgkmcnt(8)
  v_mfma_f32_16x16x32_bf16 v[80:83], v[240:243], v[160:163], v[80:83]
  ds_read_b64_tr_b16 v[232:233], v17 offset:8192
  v_mfma_f32_16x16x32_bf16 v[80:83], v[244:247], v[164:167], v[80:83]
  ds_read_b64_tr_b16 v[234:235], v17 offset:10240
  s_add_u32 m0, s10, 131072
  s_add_u32 s12, s21, 0
  buffer_load_dwordx4 v15, s[52:55], s12 offen lds
  v_mfma_f32_16x16x32_bf16 v[84:87], v[244:247], v[172:175], v[84:87]
  ds_read_b64_tr_b16 v[236:237], v17 offset:12288
  v_mfma_f32_16x16x32_bf16 v[84:87], v[240:243], v[168:171], v[84:87]
  ds_read_b64_tr_b16 v[238:239], v17 offset:14336
  s_add_u32 m0, s10, 135168
  s_add_u32 s12, s21, 65536
  buffer_load_dwordx4 v15, s[52:55], s12 offen lds
  s_waitcnt lgkmcnt(8)
  v_mfma_f32_16x16x32_bf16 v[92:95], v[248:251], v[168:171], v[92:95]
  ds_read_b64_tr_b16 v[240:241], v18 offset:8192
  v_mfma_f32_16x16x32_bf16 v[92:95], v[252:255], v[172:175], v[92:95]
  ds_read_b64_tr_b16 v[242:243], v18 offset:10240
  s_add_u32 m0, s10, 139264
  s_add_u32 s12, s21, 0
  buffer_load_dwordx4 v13, s[52:55], s12 offen lds
  v_mfma_f32_16x16x32_bf16 v[88:91], v[252:255], v[164:167], v[88:91]
  ds_read_b64_tr_b16 v[244:245], v18 offset:12288
  v_mfma_f32_16x16x32_bf16 v[88:91], v[248:251], v[160:163], v[88:91]
  ds_read_b64_tr_b16 v[246:247], v18 offset:14336
  s_add_u32 m0, s10, 143360
  s_add_u32 s12, s21, 65536
  buffer_load_dwordx4 v13, s[52:55], s12 offen lds
  s_waitcnt lgkmcnt(8)
  v_mfma_f32_16x16x32_bf16 v[96:99], v[224:227], v[160:163], v[96:99]
  ds_read_b64_tr_b16 v[248:249], v19 offset:8192
  v_mfma_f32_16x16x32_bf16 v[96:99], v[228:231], v[164:167], v[96:99]
  ds_read_b64_tr_b16 v[250:251], v19 offset:10240
  s_add_u32 m0, s10, 147456
  s_add_u32 s12, s21, 131072
  buffer_load_dwordx4 v15, s[52:55], s12 offen lds
  v_mfma_f32_16x16x32_bf16 v[100:103], v[228:231], v[172:175], v[100:103]
  ds_read_b64_tr_b16 v[252:253], v19 offset:12288
  v_mfma_f32_16x16x32_bf16 v[100:103], v[224:227], v[168:171], v[100:103]
  ds_read_b64_tr_b16 v[254:255], v19 offset:14336
  s_add_u32 m0, s10, 151552
  s_add_u32 s12, s21, 196608
  buffer_load_dwordx4 v15, s[52:55], s12 offen lds
  s_waitcnt lgkmcnt(8)
  v_mfma_f32_16x16x32_bf16 v[108:111], v[232:235], v[168:171], v[108:111]
  ds_read_b64_tr_b16 v[224:225], v16 offset:16384
  v_mfma_f32_16x16x32_bf16 v[108:111], v[236:239], v[172:175], v[108:111]
  ds_read_b64_tr_b16 v[226:227], v16 offset:18432
  s_add_u32 m0, s10, 155648
  s_add_u32 s12, s21, 131072
  buffer_load_dwordx4 v13, s[52:55], s12 offen lds
  v_mfma_f32_16x16x32_bf16 v[104:107], v[236:239], v[164:167], v[104:107]
  ds_read_b64_tr_b16 v[228:229], v16 offset:20480
  v_mfma_f32_16x16x32_bf16 v[104:107], v[232:235], v[160:163], v[104:107]
  ds_read_b64_tr_b16 v[230:231], v16 offset:22528
  s_add_u32 m0, s10, 159744
  s_add_u32 s12, s21, 196608
  buffer_load_dwordx4 v13, s[52:55], s12 offen lds
  s_waitcnt lgkmcnt(8)
  v_mfma_f32_16x16x32_bf16 v[112:115], v[240:243], v[160:163], v[112:115]
  ds_read_b64_tr_b16 v[232:233], v17 offset:16384
  v_mfma_f32_16x16x32_bf16 v[112:115], v[244:247], v[164:167], v[112:115]
  ds_read_b64_tr_b16 v[234:235], v17 offset:18432
  s_add_u32 s11, s5, 7
  s_and_b32 s11, s11, 15
  s_lshl_b32 s11, s11, 14
  s_add_u32 m0, s10, 32768
  s_add_u32 s12, s11, 27262976
  buffer_load_dwordx4 v14, s[64:67], s12 offen sc1 lds
  v_mfma_f32_16x16x32_bf16 v[116:119], v[244:247], v[172:175], v[116:119]
  ds_read_b64_tr_b16 v[236:237], v17 offset:20480
  v_mfma_f32_16x16x32_bf16 v[116:119], v[240:243], v[168:171], v[116:119]
  ds_read_b64_tr_b16 v[238:239], v17 offset:22528
  s_add_u32 m0, s10, 36864
  s_add_u32 s12, s11, 27267072
  buffer_load_dwordx4 v14, s[64:67], s12 offen sc1 lds
  s_waitcnt lgkmcnt(8)
  v_mfma_f32_16x16x32_bf16 v[124:127], v[248:251], v[168:171], v[124:127]
  ds_read_b64_tr_b16 v[240:241], v18 offset:16384
  v_mfma_f32_16x16x32_bf16 v[124:127], v[252:255], v[172:175], v[124:127]
  ds_read_b64_tr_b16 v[242:243], v18 offset:18432
  s_add_u32 m0, s10, 40960
  s_add_u32 s12, s11, 27271168
  buffer_load_dwordx4 v14, s[64:67], s12 offen sc1 lds
  v_mfma_f32_16x16x32_bf16 v[120:123], v[252:255], v[164:167], v[120:123]
  ds_read_b64_tr_b16 v[244:245], v18 offset:20480
  v_mfma_f32_16x16x32_bf16 v[120:123], v[248:251], v[160:163], v[120:123]
  ds_read_b64_tr_b16 v[246:247], v18 offset:22528
  s_add_u32 m0, s10, 45056
  s_add_u32 s12, s11, 27275264
  buffer_load_dwordx4 v14, s[64:67], s12 offen sc1 lds
  s_waitcnt lgkmcnt(8)
  v_mfma_f32_16x16x32_bf16 v[64:67], v[224:227], v[176:179], v[64:67]
  ds_read_b64_tr_b16 v[248:249], v19 offset:16384
  v_mfma_f32_16x16x32_bf16 v[64:67], v[228:231], v[180:183], v[64:67]
  ds_read_b64_tr_b16 v[250:251], v19 offset:18432
  s_add_u32 s69, s16, 12288
  buffer_load_dwordx4 v[28:31], v10, s[64:67], s69 offen offset:0 sc1
  v_mfma_f32_16x16x32_bf16 v[68:71], v[228:231], v[188:191], v[68:71]
  ds_read_b64_tr_b16 v[252:253], v19 offset:20480
  v_mfma_f32_16x16x32_bf16 v[68:71], v[224:227], v[184:187], v[68:71]
  ds_read_b64_tr_b16 v[254:255], v19 offset:22528
  buffer_load_dwordx4 v[32:35], v10, s[64:67], s69 offen offset:1024 sc1
  s_waitcnt lgkmcnt(8)
  v_mfma_f32_16x16x32_bf16 v[76:79], v[232:235], v[184:187], v[76:79]
  ds_read_b64_tr_b16 v[224:225], v16 offset:24576
  v_mfma_f32_16x16x32_bf16 v[76:79], v[236:239], v[188:191], v[76:79]
  ds_read_b64_tr_b16 v[226:227], v16 offset:26624
  buffer_load_dwordx4 v[36:39], v11, s[64:67], s69 offen offset:0 sc1
  v_mfma_f32_16x16x32_bf16 v[72:75], v[236:239], v[180:183], v[72:75]
  ds_read_b64_tr_b16 v[228:229], v16 offset:28672
  v_mfma_f32_16x16x32_bf16 v[72:75], v[232:235], v[176:179], v[72:75]
  ds_read_b64_tr_b16 v[230:231], v16 offset:30720
  buffer_load_dwordx4 v[40:43], v11, s[64:67], s69 offen offset:1024 sc1
  s_waitcnt lgkmcnt(8)
  v_mfma_f32_16x16x32_bf16 v[80:83], v[240:243], v[176:179], v[80:83]
  ds_read_b64_tr_b16 v[232:233], v17 offset:24576
  v_mfma_f32_16x16x32_bf16 v[80:83], v[244:247], v[180:183], v[80:83]
  ds_read_b64_tr_b16 v[234:235], v17 offset:26624
  v_mfma_f32_16x16x32_bf16 v[84:87], v[244:247], v[188:191], v[84:87]
  ds_read_b64_tr_b16 v[236:237], v17 offset:28672
  v_mfma_f32_16x16x32_bf16 v[84:87], v[240:243], v[184:187], v[84:87]
  ds_read_b64_tr_b16 v[238:239], v17 offset:30720
  s_waitcnt lgkmcnt(8)
  v_mfma_f32_16x16x32_bf16 v[92:95], v[248:251], v[184:187], v[92:95]
  ds_read_b64_tr_b16 v[240:241], v18 offset:24576
  v_mfma_f32_16x16x32_bf16 v[92:95], v[252:255], v[188:191], v[92:95]
  ds_read_b64_tr_b16 v[242:243], v18 offset:26624
  v_mfma_f32_16x16x32_bf16 v[88:91], v[252:255], v[180:183], v[88:91]
  ds_read_b64_tr_b16 v[244:245], v18 offset:28672
  v_mfma_f32_16x16x32_bf16 v[88:91], v[248:251], v[176:179], v[88:91]
  ds_read_b64_tr_b16 v[246:247], v18 offset:30720
  s_waitcnt lgkmcnt(8)
  v_mfma_f32_16x16x32_bf16 v[96:99], v[224:227], v[176:179], v[96:99]
  ds_read_b64_tr_b16 v[248:249], v19 offset:24576
  v_mfma_f32_16x16x32_bf16 v[96:99], v[228:231], v[180:183], v[96:99]
  ds_read_b64_tr_b16 v[250:251], v19 offset:26624
  v_mfma_f32_16x16x32_bf16 v[100:103], v[228:231], v[188:191], v[100:103]
  ds_read_b64_tr_b16 v[252:253], v19 offset:28672
  v_mfma_f32_16x16x32_bf16 v[100:103], v[224:227], v[184:187], v[100:103]
  ds_read_b64_tr_b16 v[254:255], v19 offset:30720
  s_waitcnt lgkmcnt(8)
  v_mfma_f32_16x16x32_bf16 v[108:111], v[232:235], v[184:187], v[108:111]
  ds_read_b64_tr_b16 v[224:225], v16 offset:32768
  v_mfma_f32_16x16x32_bf16 v[108:111], v[236:239], v[188:191], v[108:111]
  ds_read_b64_tr_b16 v[226:227], v16 offset:34816
  v_mfma_f32_16x16x32_bf16 v[104:107], v[236:239], v[180:183], v[104:107]
  ds_read_b64_tr_b16 v[228:229], v16 offset:36864
  v_mfma_f32_16x16x32_bf16 v[104:107], v[232:235], v[176:179], v[104:107]
  ds_read_b64_tr_b16 v[230:231], v16 offset:38912
  s_waitcnt lgkmcnt(8)
  v_mfma_f32_16x16x32_bf16 v[112:115], v[240:243], v[176:179], v[112:115]
  ds_read_b64_tr_b16 v[232:233], v17 offset:32768
  v_mfma_f32_16x16x32_bf16 v[112:115], v[244:247], v[180:183], v[112:115]
  ds_read_b64_tr_b16 v[234:235], v17 offset:34816
  v_mfma_f32_16x16x32_bf16 v[116:119], v[244:247], v[188:191], v[116:119]
  ds_read_b64_tr_b16 v[236:237], v17 offset:36864
  v_mfma_f32_16x16x32_bf16 v[116:119], v[240:243], v[184:187], v[116:119]
  ds_read_b64_tr_b16 v[238:239], v17 offset:38912
  s_waitcnt lgkmcnt(8)
  v_mfma_f32_16x16x32_bf16 v[124:127], v[248:251], v[184:187], v[124:127]
  ds_read_b64_tr_b16 v[240:241], v18 offset:32768
  v_mfma_f32_16x16x32_bf16 v[124:127], v[252:255], v[188:191], v[124:127]
  ds_read_b64_tr_b16 v[242:243], v18 offset:34816
  v_mfma_f32_16x16x32_bf16 v[120:123], v[252:255], v[180:183], v[120:123]
  ds_read_b64_tr_b16 v[244:245], v18 offset:36864
  v_mfma_f32_16x16x32_bf16 v[120:123], v[248:251], v[176:179], v[120:123]
  ds_read_b64_tr_b16 v[246:247], v18 offset:38912
  s_waitcnt vmcnt(28)
  s_waitcnt lgkmcnt(8)
  v_mfma_f32_16x16x32_bf16 v[64:67], v[224:227], v[192:195], v[64:67]
  ds_read_b64_tr_b16 v[248:249], v19 offset:32768
  v_mfma_f32_16x16x32_bf16 v[64:67], v[228:231], v[196:199], v[64:67]
  ds_read_b64_tr_b16 v[250:251], v19 offset:34816
  s_add_u32 s69, s17, 0
  buffer_load_dwordx4 v[44:47], v10, s[64:67], s69 offen offset:0 sc1
  v_mfma_f32_16x16x32_bf16 v[68:71], v[228:231], v[204:207], v[68:71]
  ds_read_b64_tr_b16 v[252:253], v19 offset:36864
  v_mfma_f32_16x16x32_bf16 v[68:71], v[224:227], v[200:203], v[68:71]
  ds_read_b64_tr_b16 v[254:255], v19 offset:38912
  buffer_load_dwordx4 v[48:51], v10, s[64:67], s69 offen offset:1024 sc1
  s_waitcnt lgkmcnt(8)
  v_mfma_f32_16x16x32_bf16 v[76:79], v[232:235], v[200:203], v[76:79]
  ds_read_b64_tr_b16 v[224:225], v16 offset:40960
  v_mfma_f32_16x16x32_bf16 v[76:79], v[236:239], v[204:207], v[76:79]
  ds_read_b64_tr_b16 v[226:227], v16 offset:43008
  buffer_load_dwordx4 v[52:55], v11, s[64:67], s69 offen offset:0 sc1
  v_mfma_f32_16x16x32_bf16 v[72:75], v[236:239], v[196:199], v[72:75]
  ds_read_b64_tr_b16 v[228:229], v16 offset:45056
  v_mfma_f32_16x16x32_bf16 v[72:75], v[232:235], v[192:195], v[72:75]
  ds_read_b64_tr_b16 v[230:231], v16 offset:47104
  buffer_load_dwordx4 v[56:59], v11, s[64:67], s69 offen offset:1024 sc1
  s_waitcnt lgkmcnt(8)
  v_mfma_f32_16x16x32_bf16 v[80:83], v[240:243], v[192:195], v[80:83]
  ds_read_b64_tr_b16 v[232:233], v17 offset:40960
  v_mfma_f32_16x16x32_bf16 v[80:83], v[244:247], v[196:199], v[80:83]
  ds_read_b64_tr_b16 v[234:235], v17 offset:43008
  v_mfma_f32_16x16x32_bf16 v[84:87], v[244:247], v[204:207], v[84:87]
  ds_read_b64_tr_b16 v[236:237], v17 offset:45056
  v_mfma_f32_16x16x32_bf16 v[84:87], v[240:243], v[200:203], v[84:87]
  ds_read_b64_tr_b16 v[238:239], v17 offset:47104
  s_waitcnt lgkmcnt(8)
  v_mfma_f32_16x16x32_bf16 v[92:95], v[248:251], v[200:203], v[92:95]
  ds_read_b64_tr_b16 v[240:241], v18 offset:40960
  v_mfma_f32_16x16x32_bf16 v[92:95], v[252:255], v[204:207], v[92:95]
  ds_read_b64_tr_b16 v[242:243], v18 offset:43008
  v_mfma_f32_16x16x32_bf16 v[88:91], v[252:255], v[196:199], v[88:91]
  ds_read_b64_tr_b16 v[244:245], v18 offset:45056
  v_mfma_f32_16x16x32_bf16 v[88:91], v[248:251], v[192:195], v[88:91]
  ds_read_b64_tr_b16 v[246:247], v18 offset:47104
  s_waitcnt lgkmcnt(8)
  v_mfma_f32_16x16x32_bf16 v[96:99], v[224:227], v[192:195], v[96:99]
  ds_read_b64_tr_b16 v[248:249], v19 offset:40960
  v_mfma_f32_16x16x32_bf16 v[96:99], v[228:231], v[196:199], v[96:99]
  ds_read_b64_tr_b16 v[250:251], v19 offset:43008
  v_mfma_f32_16x16x32_bf16 v[100:103], v[228:231], v[204:207], v[100:103]
  ds_read_b64_tr_b16 v[252:253], v19 offset:45056
  v_mfma_f32_16x16x32_bf16 v[100:103], v[224:227], v[200:203], v[100:103]
  ds_read_b64_tr_b16 v[254:255], v19 offset:47104
  s_waitcnt vmcnt(16)
  s_barrier
  s_waitcnt lgkmcnt(8)
  v_mfma_f32_16x16x32_bf16 v[108:111], v[232:235], v[200:203], v[108:111]
  ds_read_b64_tr_b16 v[224:225], v16 offset:49152
  v_mfma_f32_16x16x32_bf16 v[108:111], v[236:239], v[204:207], v[108:111]
  ds_read_b64_tr_b16 v[226:227], v16 offset:51200
  s_add_u32 m0, s10, 49152
  s_add_u32 s12, s21, 262144
  buffer_load_dwordx4 v15, s[52:55], s12 offen lds
  v_mfma_f32_16x16x32_bf16 v[104:107], v[236:239], v[196:199], v[104:107]
  ds_read_b64_tr_b16 v[228:229], v16 offset:53248
  v_mfma_f32_16x16x32_bf16 v[104:107], v[232:235], v[192:195], v[104:107]
  ds_read_b64_tr_b16 v[230:231], v16 offset:55296
  s_add_u32 m0, s10, 53248
  s_add_u32 s12, s21, 327680
  buffer_load_dwordx4 v15, s[52:55], s12 offen lds
  s_waitcnt lgkmcnt(8)
  v_mfma_f32_16x16x32_bf16 v[112:115], v[240:243], v[192:195], v[112:115]
  ds_read_b64_tr_b16 v[232:233], v17 offset:49152
  v_mfma_f32_16x16x32_bf16 v[112:115], v[244:247], v[196:199], v[112:115]
  ds_read_b64_tr_b16 v[234:235], v17 offset:51200
  s_add_u32 m0, s10, 57344
  s_add_u32 s12, s21, 262144
  buffer_load_dwordx4 v13, s[52:55], s12 offen lds
  v_mfma_f32_16x16x32_bf16 v[116:119], v[244:247], v[204:207], v[116:119]
  ds_read_b64_tr_b16 v[236:237], v17 offset:53248
  v_mfma_f32_16x16x32_bf16 v[116:119], v[240:243], v[200:203], v[116:119]
  ds_read_b64_tr_b16 v[238:239], v17 offset:55296
  s_add_u32 m0, s10, 61440
  s_add_u32 s12, s21, 327680
  buffer_load_dwordx4 v13, s[52:55], s12 offen lds
  s_waitcnt lgkmcnt(8)
  v_mfma_f32_16x16x32_bf16 v[124:127], v[248:251], v[200:203], v[124:127]
  ds_read_b64_tr_b16 v[240:241], v18 offset:49152
  v_mfma_f32_16x16x32_bf16 v[124:127], v[252:255], v[204:207], v[124:127]
  ds_read_b64_tr_b16 v[242:243], v18 offset:51200
  s_add_u32 m0, s10, 65536
  s_add_u32 s12, s21, 393216
  buffer_load_dwordx4 v15, s[52:55], s12 offen lds
  v_mfma_f32_16x16x32_bf16 v[120:123], v[252:255], v[196:199], v[120:123]
  ds_read_b64_tr_b16 v[244:245], v18 offset:53248
  v_mfma_f32_16x16x32_bf16 v[120:123], v[248:251], v[192:195], v[120:123]
  ds_read_b64_tr_b16 v[246:247], v18 offset:55296
  s_add_u32 m0, s10, 69632
  s_add_u32 s12, s21, 458752
  buffer_load_dwordx4 v15, s[52:55], s12 offen lds
  s_waitcnt lgkmcnt(8)
  v_mfma_f32_16x16x32_bf16 v[64:67], v[224:227], v[208:211], v[64:67]
  ds_read_b64_tr_b16 v[248:249], v19 offset:49152
  v_mfma_f32_16x16x32_bf16 v[64:67], v[228:231], v[212:215], v[64:67]
  ds_read_b64_tr_b16 v[250:251], v19 offset:51200
  s_add_u32 s69, s17, 2048
  buffer_load_dwordx4 v[128:131], v10, s[64:67], s69 offen offset:0 sc1
  v_mfma_f32_16x16x32_bf16 v[68:71], v[228:231], v[220:223], v[68:71]
  ds_read_b64_tr_b16 v[252:253], v19 offset:53248
  v_mfma_f32_16x16x32_bf16 v[68:71], v[224:227], v[216:219], v[68:71]
  ds_read_b64_tr_b16 v[254:255], v19 offset:55296
  buffer_load_dwordx4 v[132:135], v10, s[64:67], s69 offen offset:1024 sc1
  s_waitcnt lgkmcnt(8)
  v_mfma_f32_16x16x32_bf16 v[76:79], v[232:235], v[216:219], v[76:79]
  ds_read_b64_tr_b16 v[224:225], v16 offset:57344
  v_mfma_f32_16x16x32_bf16 v[76:79], v[236:239], v[220:223], v[76:79]
  ds_read_b64_tr_b16 v[226:227], v16 offset:59392
  buffer_load_dwordx4 v[136:139], v11, s[64:67], s69 offen offset:0 sc1
  v_mfma_f32_16x16x32_bf16 v[72:75], v[236:239], v[212:215], v[72:75]
  ds_read_b64_tr_b16 v[228:229], v16 offset:61440
  v_mfma_f32_16x16x32_bf16 v[72:75], v[232:235], v[208:211], v[72:75]
  ds_read_b64_tr_b16 v[230:231], v16 offset:63488
  buffer_load_dwordx4 v[140:143], v11, s[64:67], s69 offen offset:1024 sc1
  s_waitcnt lgkmcnt(8)
  v_mfma_f32_16x16x32_bf16 v[80:83], v[240:243], v[208:211], v[80:83]
  ds_read_b64_tr_b16 v[232:233], v17 offset:57344
  v_mfma_f32_16x16x32_bf16 v[80:83], v[244:247], v[212:215], v[80:83]
  ds_read_b64_tr_b16 v[234:235], v17 offset:59392
  s_add_u32 m0, s10, 73728
  s_add_u32 s12, s21, 393216
  buffer_load_dwordx4 v13, s[52:55], s12 offen lds
  v_mfma_f32_16x16x32_bf16 v[84:87], v[244:247], v[220:223], v[84:87]
  ds_read_b64_tr_b16 v[236:237], v17 offset:61440
  v_mfma_f32_16x16x32_bf16 v[84:87], v[240:243], v[216:219], v[84:87]
  ds_read_b64_tr_b16 v[238:239], v17 offset:63488
  s_add_u32 m0, s10, 77824
  s_add_u32 s12, s21, 458752
  buffer_load_dwordx4 v13, s[52:55], s12 offen lds
  s_waitcnt lgkmcnt(8)
  v_mfma_f32_16x16x32_bf16 v[92:95], v[248:251], v[216:219], v[92:95]
  ds_read_b64_tr_b16 v[240:241], v18 offset:57344
  v_mfma_f32_16x16x32_bf16 v[92:95], v[252:255], v[220:223], v[92:95]
  ds_read_b64_tr_b16 v[242:243], v18 offset:59392
  s_add_u32 s11, s5, 8
  s_and_b32 s11, s11, 15
  s_lshl_b32 s11, s11, 14
  s_add_u32 m0, s10, 16384
  s_add_u32 s12, s11, 27262976
  buffer_load_dwordx4 v14, s[64:67], s12 offen sc1 lds
  v_mfma_f32_16x16x32_bf16 v[88:91], v[252:255], v[212:215], v[88:91]
  ds_read_b64_tr_b16 v[244:245], v18 offset:61440
  v_mfma_f32_16x16x32_bf16 v[88:91], v[248:251], v[208:211], v[88:91]
  ds_read_b64_tr_b16 v[246:247], v18 offset:63488
  s_add_u32 m0, s10, 20480
  s_add_u32 s12, s11, 27267072
  buffer_load_dwordx4 v14, s[64:67], s12 offen sc1 lds
  s_waitcnt lgkmcnt(8)
  v_mfma_f32_16x16x32_bf16 v[96:99], v[224:227], v[208:211], v[96:99]
  ds_read_b64_tr_b16 v[248:249], v19 offset:57344
  v_mfma_f32_16x16x32_bf16 v[96:99], v[228:231], v[212:215], v[96:99]
  ds_read_b64_tr_b16 v[250:251], v19 offset:59392
  s_add_u32 m0, s10, 24576
  s_add_u32 s12, s11, 27271168
  buffer_load_dwordx4 v14, s[64:67], s12 offen sc1 lds
  v_mfma_f32_16x16x32_bf16 v[100:103], v[228:231], v[220:223], v[100:103]
  ds_read_b64_tr_b16 v[252:253], v19 offset:61440
  v_mfma_f32_16x16x32_bf16 v[100:103], v[224:227], v[216:219], v[100:103]
  ds_read_b64_tr_b16 v[254:255], v19 offset:63488
  s_add_u32 m0, s10, 28672
  s_add_u32 s12, s11, 27275264
  buffer_load_dwordx4 v14, s[64:67], s12 offen sc1 lds
  s_waitcnt lgkmcnt(8)
  v_mfma_f32_16x16x32_bf16 v[108:111], v[232:235], v[216:219], v[108:111]
  ds_read_b64_tr_b16 v[224:225], v20 offset:0
  v_mfma_f32_16x16x32_bf16 v[108:111], v[236:239], v[220:223], v[108:111]
  ds_read_b64_tr_b16 v[226:227], v20 offset:2048
  v_mfma_f32_16x16x32_bf16 v[104:107], v[236:239], v[212:215], v[104:107]
  ds_read_b64_tr_b16 v[228:229], v20 offset:4096
  v_mfma_f32_16x16x32_bf16 v[104:107], v[232:235], v[208:211], v[104:107]
  ds_read_b64_tr_b16 v[230:231], v20 offset:6144
  s_waitcnt lgkmcnt(8)
  v_mfma_f32_16x16x32_bf16 v[112:115], v[240:243], v[208:211], v[112:115]
  ds_read_b64_tr_b16 v[232:233], v21 offset:0
  v_mfma_f32_16x16x32_bf16 v[112:115], v[244:247], v[212:215], v[112:115]
  ds_read_b64_tr_b16 v[234:235], v21 offset:2048
  v_mfma_f32_16x16x32_bf16 v[116:119], v[244:247], v[220:223], v[116:119]
  ds_read_b64_tr_b16 v[236:237], v21 offset:4096
  v_mfma_f32_16x16x32_bf16 v[116:119], v[240:243], v[216:219], v[116:119]
  ds_read_b64_tr_b16 v[238:239], v21 offset:6144
  s_waitcnt lgkmcnt(8)
  v_mfma_f32_16x16x32_bf16 v[124:127], v[248:251], v[216:219], v[124:127]
  ds_read_b64_tr_b16 v[240:241], v22 offset:0
  v_mfma_f32_16x16x32_bf16 v[124:127], v[252:255], v[220:223], v[124:127]
  ds_read_b64_tr_b16 v[242:243], v22 offset:2048
  v_mfma_f32_16x16x32_bf16 v[120:123], v[252:255], v[212:215], v[120:123]
  ds_read_b64_tr_b16 v[244:245], v22 offset:4096
  v_mfma_f32_16x16x32_bf16 v[120:123], v[248:251], v[208:211], v[120:123]
  ds_read_b64_tr_b16 v[246:247], v22 offset:6144
  s_waitcnt vmcnt(20)
  s_waitcnt lgkmcnt(8)
  v_mfma_f32_16x16x32_bf16 v[64:67], v[224:227], v[28:31], v[64:67]
  ds_read_b64_tr_b16 v[248:249], v23 offset:0
  v_mfma_f32_16x16x32_bf16 v[64:67], v[228:231], v[32:35], v[64:67]
  ds_read_b64_tr_b16 v[250:251], v23 offset:2048
  s_add_u32 s69, s17, 4096
  buffer_load_dwordx4 v[144:147], v10, s[64:67], s69 offen offset:0 sc1
  v_mfma_f32_16x16x32_bf16 v[68:71], v[228:231], v[40:43], v[68:71]
  ds_read_b64_tr_b16 v[252:253], v23 offset:4096
  v_mfma_f32_16x16x32_bf16 v[68:71], v[224:227], v[36:39], v[68:71]
  ds_read_b64_tr_b16 v[254:255], v23 offset:6144
  buffer_load_dwordx4 v[148:151], v10, s[64:67], s69 offen offset:1024 sc1
  s_waitcnt lgkmcnt(8)
  v_mfma_f32_16x16x32_bf16 v[76:79], v[232:235], v[36:39], v[76:79]
  ds_read_b64_tr_b16 v[224:225], v20 offset:8192
  v_mfma_f32_16x16x32_bf16 v[76:79], v[236:239], v[40:43], v[76:79]
  ds_read_b64_tr_b16 v[226:227], v20 offset:10240
  buffer_load_dwordx4 v[152:155], v11, s[64:67], s69 offen offset:0 sc1
  v_mfma_f32_16x16x32_bf16 v[72:75], v[236:239], v[32:35], v[72:75]
  ds_read_b64_tr_b16 v[228:229], v20 offset:12288
  v_mfma_f32_16x16x32_bf16 v[72:75], v[232:235], v[28:31], v[72:75]
  ds_read_b64_tr_b16 v[230:231], v20 offset:14336
  buffer_load_dwordx4 v[156:159], v11, s[64:67], s69 offen offset:1024 sc1
  s_waitcnt lgkmcnt(8)
  v_mfma_f32_16x16x32_bf16 v[80:83], v[240:243], v[28:31], v[80:83]
  ds_read_b64_tr_b16 v[232:233], v21 offset:8192
  v_mfma_f32_16x16x32_bf16 v[80:83], v[244:247], v[32:35], v[80:83]
  ds_read_b64_tr_b16 v[234:235], v21 offset:10240
  v_mfma_f32_16x16x32_bf16 v[84:87], v[244:247], v[40:43], v[84:87]
  ds_read_b64_tr_b16 v[236:237], v21 offset:12288
  v_mfma_f32_16x16x32_bf16 v[84:87], v[240:243], v[36:39], v[84:87]
  ds_read_b64_tr_b16 v[238:239], v21 offset:14336
  s_waitcnt lgkmcnt(8)
  v_mfma_f32_16x16x32_bf16 v[92:95], v[248:251], v[36:39], v[92:95]
  ds_read_b64_tr_b16 v[240:241], v22 offset:8192
  v_mfma_f32_16x16x32_bf16 v[92:95], v[252:255], v[40:43], v[92:95]
  ds_read_b64_tr_b16 v[242:243], v22 offset:10240
  v_mfma_f32_16x16x32_bf16 v[88:91], v[252:255], v[32:35], v[88:91]
  ds_read_b64_tr_b16 v[244:245], v22 offset:12288
  v_mfma_f32_16x16x32_bf16 v[88:91], v[248:251], v[28:31], v[88:91]
  ds_read_b64_tr_b16 v[246:247], v22 offset:14336
  s_waitcnt lgkmcnt(8)
  v_mfma_f32_16x16x32_bf16 v[96:99], v[224:227], v[28:31], v[96:99]
  ds_read_b64_tr_b16 v[248:249], v23 offset:8192
  v_mfma_f32_16x16x32_bf16 v[96:99], v[228:231], v[32:35], v[96:99]
  ds_read_b64_tr_b16 v[250:251], v23 offset:10240
  v_mfma_f32_16x16x32_bf16 v[100:103], v[228:231], v[40:43], v[100:103]
  ds_read_b64_tr_b16 v[252:253], v23 offset:12288
  v_mfma_f32_16x16x32_bf16 v[100:103], v[224:227], v[36:39], v[100:103]
  ds_read_b64_tr_b16 v[254:255], v23 offset:14336
  s_waitcnt lgkmcnt(8)
  v_mfma_f32_16x16x32_bf16 v[108:111], v[232:235], v[36:39], v[108:111]
  ds_read_b64_tr_b16 v[224:225], v20 offset:16384
  v_mfma_f32_16x16x32_bf16 v[108:111], v[236:239], v[40:43], v[108:111]
  ds_read_b64_tr_b16 v[226:227], v20 offset:18432
  v_mfma_f32_16x16x32_bf16 v[104:107], v[236:239], v[32:35], v[104:107]
  ds_read_b64_tr_b16 v[228:229], v20 offset:20480
  v_mfma_f32_16x16x32_bf16 v[104:107], v[232:235], v[28:31], v[104:107]
  ds_read_b64_tr_b16 v[230:231], v20 offset:22528
  s_waitcnt lgkmcnt(8)
  v_mfma_f32_16x16x32_bf16 v[112:115], v[240:243], v[28:31], v[112:115]
  ds_read_b64_tr_b16 v[232:233], v21 offset:16384
  v_mfma_f32_16x16x32_bf16 v[112:115], v[244:247], v[32:35], v[112:115]
  ds_read_b64_tr_b16 v[234:235], v21 offset:18432
  v_mfma_f32_16x16x32_bf16 v[116:119], v[244:247], v[40:43], v[116:119]
  ds_read_b64_tr_b16 v[236:237], v21 offset:20480
  v_mfma_f32_16x16x32_bf16 v[116:119], v[240:243], v[36:39], v[116:119]
  ds_read_b64_tr_b16 v[238:239], v21 offset:22528
  s_waitcnt lgkmcnt(8)
  v_mfma_f32_16x16x32_bf16 v[124:127], v[248:251], v[36:39], v[124:127]
  ds_read_b64_tr_b16 v[240:241], v22 offset:16384
  v_mfma_f32_16x16x32_bf16 v[124:127], v[252:255], v[40:43], v[124:127]
  ds_read_b64_tr_b16 v[242:243], v22 offset:18432
  v_mfma_f32_16x16x32_bf16 v[120:123], v[252:255], v[32:35], v[120:123]
  ds_read_b64_tr_b16 v[244:245], v22 offset:20480
  v_mfma_f32_16x16x32_bf16 v[120:123], v[248:251], v[28:31], v[120:123]
  ds_read_b64_tr_b16 v[246:247], v22 offset:22528
  s_waitcnt vmcnt(16)
  s_barrier
  s_waitcnt lgkmcnt(8)
  v_mfma_f32_16x16x32_bf16 v[64:67], v[224:227], v[44:47], v[64:67]
  ds_read_b64_tr_b16 v[248:249], v23 offset:16384
  v_mfma_f32_16x16x32_bf16 v[64:67], v[228:231], v[48:51], v[64:67]
  ds_read_b64_tr_b16 v[250:251], v23 offset:18432
  s_add_u32 s69, s17, 6144
  buffer_load_dwordx4 v[160:163], v10, s[64:67], s69 offen offset:0 sc1
  v_mfma_f32_16x16x32_bf16 v[68:71], v[228:231], v[56:59], v[68:71]
  ds_read_b64_tr_b16 v[252:253], v23 offset:20480
  v_mfma_f32_16x16x32_bf16 v[68:71], v[224:227], v[52:55], v[68:71]
  ds_read_b64_tr_b16 v[254:255], v23 offset:22528
  buffer_load_dwordx4 v[164:167], v10, s[64:67], s69 offen offset:1024 sc1
  s_waitcnt lgkmcnt(8)
  v_mfma_f32_16x16x32_bf16 v[76:79], v[232:235], v[52:55], v[76:79]
  ds_read_b64_tr_b16 v[224:225], v20 offset:24576
  v_mfma_f32_16x16x32_bf16 v[76:79], v[236:239], v[56:59], v[76:79]
  ds_read_b64_tr_b16 v[226:227], v20 offset:26624
  buffer_load_dwordx4 v[168:171], v11, s[64:67], s69 offen offset:0 sc1
  v_mfma_f32_16x16x32_bf16 v[72:75], v[236:239], v[48:51], v[72:75]
  ds_read_b64_tr_b16 v[228:229], v20 offset:28672
  v_mfma_f32_16x16x32_bf16 v[72:75], v[232:235], v[44:47], v[72:75]
  ds_read_b64_tr_b16 v[230:231], v20 offset:30720
  buffer_load_dwordx4 v[172:175], v11, s[64:67], s69 offen offset:1024 sc1
  s_waitcnt lgkmcnt(8)
  v_mfma_f32_16x16x32_bf16 v[80:83], v[240:243], v[44:47], v[80:83]
  ds_read_b64_tr_b16 v[232:233], v21 offset:24576
  v_mfma_f32_16x16x32_bf16 v[80:83], v[244:247], v[48:51], v[80:83]
  ds_read_b64_tr_b16 v[234:235], v21 offset:26624
  s_add_u32 m0, s10, 81920
  s_add_u32 s12, s21, 524288
  buffer_load_dwordx4 v15, s[52:55], s12 offen lds
  v_mfma_f32_16x16x32_bf16 v[84:87], v[244:247], v[56:59], v[84:87]
  ds_read_b64_tr_b16 v[236:237], v21 offset:28672
  v_mfma_f32_16x16x32_bf16 v[84:87], v[240:243], v[52:55], v[84:87]
  ds_read_b64_tr_b16 v[238:239], v21 offset:30720
  s_add_u32 m0, s10, 86016
  s_add_u32 s12, s21, 589824
  buffer_load_dwordx4 v15, s[52:55], s12 offen lds
  s_waitcnt lgkmcnt(8)
  v_mfma_f32_16x16x32_bf16 v[92:95], v[248:251], v[52:55], v[92:95]
  ds_read_b64_tr_b16 v[240:241], v22 offset:24576
  v_mfma_f32_16x16x32_bf16 v[92:95], v[252:255], v[56:59], v[92:95]
  ds_read_b64_tr_b16 v[242:243], v22 offset:26624
  s_add_u32 m0, s10, 90112
  s_add_u32 s12, s21, 524288
  buffer_load_dwordx4 v13, s[52:55], s12 offen lds
  v_mfma_f32_16x16x32_bf16 v[88:91], v[252:255], v[48:51], v[88:91]
  ds_read_b64_tr_b16 v[244:245], v22 offset:28672
  v_mfma_f32_16x16x32_bf16 v[88:91], v[248:251], v[44:47], v[88:91]
  ds_read_b64_tr_b16 v[246:247], v22 offset:30720
  s_add_u32 m0, s10, 94208
  s_add_u32 s12, s21, 589824
  buffer_load_dwordx4 v13, s[52:55], s12 offen lds
  s_waitcnt lgkmcnt(8)
  v_mfma_f32_16x16x32_bf16 v[96:99], v[224:227], v[44:47], v[96:99]
  ds_read_b64_tr_b16 v[248:249], v23 offset:24576
  v_mfma_f32_16x16x32_bf16 v[96:99], v[228:231], v[48:51], v[96:99]
  ds_read_b64_tr_b16 v[250:251], v23 offset:26624
  s_add_u32 m0, s10, 98304
  s_add_u32 s12, s21, 655360
  buffer_load_dwordx4 v15, s[52:55], s12 offen lds
  v_mfma_f32_16x16x32_bf16 v[100:103], v[228:231], v[56:59], v[100:103]
  ds_read_b64_tr_b16 v[252:253], v23 offset:28672
  v_mfma_f32_16x16x32_bf16 v[100:103], v[224:227], v[52:55], v[100:103]
  ds_read_b64_tr_b16 v[254:255], v23 offset:30720
  s_add_u32 m0, s10, 102400
  s_add_u32 s12, s21, 720896
  buffer_load_dwordx4 v15, s[52:55], s12 offen lds
  s_waitcnt lgkmcnt(8)
  v_mfma_f32_16x16x32_bf16 v[108:111], v[232:235], v[52:55], v[108:111]
  ds_read_b64_tr_b16 v[224:225], v20 offset:32768
  v_mfma_f32_16x16x32_bf16 v[108:111], v[236:239], v[56:59], v[108:111]
  ds_read_b64_tr_b16 v[226:227], v20 offset:34816
  s_add_u32 m0, s10, 106496
  s_add_u32 s12, s21, 655360
  buffer_load_dwordx4 v13, s[52:55], s12 offen lds
  v_mfma_f32_16x16x32_bf16 v[104:107], v[236:239], v[48:51], v[104:107]
  ds_read_b64_tr_b16 v[228:229], v20 offset:36864
  v_mfma_f32_16x16x32_bf16 v[104:107], v[232:235], v[44:47], v[104:107]
  ds_read_b64_tr_b16 v[230:231], v20 offset:38912
  s_add_u32 m0, s10, 110592
  s_add_u32 s12, s21, 720896
  buffer_load_dwordx4 v13, s[52:55], s12 offen lds
  s_waitcnt lgkmcnt(8)
  v_mfma_f32_16x16x32_bf16 v[112:115], v[240:243], v[44:47], v[112:115]
  ds_read_b64_tr_b16 v[232:233], v21 offset:32768
  v_mfma_f32_16x16x32_bf16 v[112:115], v[244:247], v[48:51], v[112:115]
  ds_read_b64_tr_b16 v[234:235], v21 offset:34816
  s_add_u32 m0, s10, 114688
  s_add_u32 s12, s21, 786432
  buffer_load_dwordx4 v15, s[52:55], s12 offen lds
  v_mfma_f32_16x16x32_bf16 v[116:119], v[244:247], v[56:59], v[116:119]
  ds_read_b64_tr_b16 v[236:237], v21 offset:36864
  v_mfma_f32_16x16x32_bf16 v[116:119], v[240:243], v[52:55], v[116:119]
  ds_read_b64_tr_b16 v[238:239], v21 offset:38912
  s_add_u32 m0, s10, 118784
  s_add_u32 s12, s21, 851968
  buffer_load_dwordx4 v15, s[52:55], s12 offen lds
  s_waitcnt lgkmcnt(8)
  v_mfma_f32_16x16x32_bf16 v[124:127], v[248:251], v[52:55], v[124:127]
  ds_read_b64_tr_b16 v[240:241], v22 offset:32768
  v_mfma_f32_16x16x32_bf16 v[124:127], v[252:255], v[56:59], v[124:127]
  ds_read_b64_tr_b16 v[242:243], v22 offset:34816
  s_add_u32 m0, s10, 122880
  s_add_u32 s12, s21, 786432
  buffer_load_dwordx4 v13, s[52:55], s12 offen lds
  v_mfma_f32_16x16x32_bf16 v[120:123], v[252:255], v[48:51], v[120:123]
  ds_read_b64_tr_b16 v[244:245], v22 offset:36864
  v_mfma_f32_16x16x32_bf16 v[120:123], v[248:251], v[44:47], v[120:123]
  ds_read_b64_tr_b16 v[246:247], v22 offset:38912
  s_add_u32 m0, s10, 126976
  s_add_u32 s12, s21, 851968
  buffer_load_dwordx4 v13, s[52:55], s12 offen lds
  s_waitcnt vmcnt(26)
  s_waitcnt lgkmcnt(8)
  v_mfma_f32_16x16x32_bf16 v[64:67], v[224:227], v[128:131], v[64:67]
  ds_read_b64_tr_b16 v[248:249], v23 offset:32768
  v_mfma_f32_16x16x32_bf16 v[64:67], v[228:231], v[132:135], v[64:67]
  ds_read_b64_tr_b16 v[250:251], v23 offset:34816
  s_add_u32 s69, s17, 8192
  buffer_load_dwordx4 v[176:179], v10, s[64:67], s69 offen offset:0 sc1
  v_mfma_f32_16x16x32_bf16 v[68:71], v[228:231], v[140:143], v[68:71]
  ds_read_b64_tr_b16 v[252:253], v23 offset:36864
  v_mfma_f32_16x16x32_bf16 v[68:71], v[224:227], v[136:139], v[68:71]
  ds_read_b64_tr_b16 v[254:255], v23 offset:38912
  buffer_load_dwordx4 v[180:183], v10, s[64:67], s69 offen offset:1024 sc1
  s_waitcnt lgkmcnt(8)
  v_mfma_f32_16x16x32_bf16 v[76:79], v[232:235], v[136:139], v[76:79]
  ds_read_b64_tr_b16 v[224:225], v20 offset:40960
  v_mfma_f32_16x16x32_bf16 v[76:79], v[236:239], v[140:143], v[76:79]
  ds_read_b64_tr_b16 v[226:227], v20 offset:43008
  buffer_load_dwordx4 v[184:187], v11, s[64:67], s69 offen offset:0 sc1
  v_mfma_f32_16x16x32_bf16 v[72:75], v[236:239], v[132:135], v[72:75]
  ds_read_b64_tr_b16 v[228:229], v20 offset:45056
  v_mfma_f32_16x16x32_bf16 v[72:75], v[232:235], v[128:131], v[72:75]
  ds_read_b64_tr_b16 v[230:231], v20 offset:47104
  buffer_load_dwordx4 v[188:191], v11, s[64:67], s69 offen offset:1024 sc1
  s_waitcnt lgkmcnt(8)
  v_mfma_f32_16x16x32_bf16 v[80:83], v[240:243], v[128:131], v[80:83]
  ds_read_b64_tr_b16 v[232:233], v21 offset:40960
  v_mfma_f32_16x16x32_bf16 v[80:83], v[244:247], v[132:135], v[80:83]
  ds_read_b64_tr_b16 v[234:235], v21 offset:43008
  s_add_u32 s11, s5, 9
  s_and_b32 s11, s11, 15
  s_lshl_b32 s11, s11, 14
  s_add_u32 m0, s10, 0
  s_add_u32 s12, s11, 27262976
  buffer_load_dwordx4 v14, s[64:67], s12 offen sc1 lds
  v_mfma_f32_16x16x32_bf16 v[84:87], v[244:247], v[140:143], v[84:87]
  ds_read_b64_tr_b16 v[236:237], v21 offset:45056
  v_mfma_f32_16x16x32_bf16 v[84:87], v[240:243], v[136:139], v[84:87]
  ds_read_b64_tr_b16 v[238:239], v21 offset:47104
  s_add_u32 m0, s10, 4096
  s_add_u32 s12, s11, 27267072
  buffer_load_dwordx4 v14, s[64:67], s12 offen sc1 lds
  s_waitcnt lgkmcnt(8)
  v_mfma_f32_16x16x32_bf16 v[92:95], v[248:251], v[136:139], v[92:95]
  ds_read_b64_tr_b16 v[240:241], v22 offset:40960
  v_mfma_f32_16x16x32_bf16 v[92:95], v[252:255], v[140:143], v[92:95]
  ds_read_b64_tr_b16 v[242:243], v22 offset:43008
  s_add_u32 m0, s10, 8192
  s_add_u32 s12, s11, 27271168
  buffer_load_dwordx4 v14, s[64:67], s12 offen sc1 lds
  v_mfma_f32_16x16x32_bf16 v[88:91], v[252:255], v[132:135], v[88:91]
  ds_read_b64_tr_b16 v[244:245], v22 offset:45056
  v_mfma_f32_16x16x32_bf16 v[88:91], v[248:251], v[128:131], v[88:91]
  ds_read_b64_tr_b16 v[246:247], v22 offset:47104
  s_add_u32 m0, s10, 12288
  s_add_u32 s12, s11, 27275264
  buffer_load_dwordx4 v14, s[64:67], s12 offen sc1 lds
  s_waitcnt lgkmcnt(8)
  v_mfma_f32_16x16x32_bf16 v[96:99], v[224:227], v[128:131], v[96:99]
  ds_read_b64_tr_b16 v[248:249], v23 offset:40960
  v_mfma_f32_16x16x32_bf16 v[96:99], v[228:231], v[132:135], v[96:99]
  ds_read_b64_tr_b16 v[250:251], v23 offset:43008
  v_mfma_f32_16x16x32_bf16 v[100:103], v[228:231], v[140:143], v[100:103]
  ds_read_b64_tr_b16 v[252:253], v23 offset:45056
  v_mfma_f32_16x16x32_bf16 v[100:103], v[224:227], v[136:139], v[100:103]
  ds_read_b64_tr_b16 v[254:255], v23 offset:47104
  s_waitcnt lgkmcnt(8)
  v_mfma_f32_16x16x32_bf16 v[108:111], v[232:235], v[136:139], v[108:111]
  ds_read_b64_tr_b16 v[224:225], v16 offset:0
  v_mfma_f32_16x16x32_bf16 v[108:111], v[236:239], v[140:143], v[108:111]
  ds_read_b64_tr_b16 v[226:227], v16 offset:2048
  v_mfma_f32_16x16x32_bf16 v[104:107], v[236:239], v[132:135], v[104:107]
  ds_read_b64_tr_b16 v[228:229], v16 offset:4096
  v_mfma_f32_16x16x32_bf16 v[104:107], v[232:235], v[128:131], v[104:107]
  ds_read_b64_tr_b16 v[230:231], v16 offset:6144
  s_waitcnt lgkmcnt(8)
  v_mfma_f32_16x16x32_bf16 v[112:115], v[240:243], v[128:131], v[112:115]
  ds_read_b64_tr_b16 v[232:233], v17 offset:0
  v_mfma_f32_16x16x32_bf16 v[112:115], v[244:247], v[132:135], v[112:115]
  ds_read_b64_tr_b16 v[234:235], v17 offset:2048
  v_mfma_f32_16x16x32_bf16 v[116:119], v[244:247], v[140:143], v[116:119]
  ds_read_b64_tr_b16 v[236:237], v17 offset:4096
  v_mfma_f32_16x16x32_bf16 v[116:119], v[240:243], v[136:139], v[116:119]
  ds_read_b64_tr_b16 v[238:239], v17 offset:6144
  s_waitcnt lgkmcnt(8)
  v_mfma_f32_16x16x32_bf16 v[124:127], v[248:251], v[136:139], v[124:127]
  ds_read_b64_tr_b16 v[240:241], v18 offset:0
  v_mfma_f32_16x16x32_bf16 v[124:127], v[252:255], v[140:143], v[124:127]
  ds_read_b64_tr_b16 v[242:243], v18 offset:2048
  v_mfma_f32_16x16x32_bf16 v[120:123], v[252:255], v[132:135], v[120:123]
  ds_read_b64_tr_b16 v[244:245], v18 offset:4096
  v_mfma_f32_16x16x32_bf16 v[120:123], v[248:251], v[128:131], v[120:123]
  ds_read_b64_tr_b16 v[246:247], v18 offset:6144
  s_waitcnt vmcnt(24)
  s_waitcnt lgkmcnt(8)
  v_mfma_f32_16x16x32_bf16 v[64:67], v[224:227], v[144:147], v[64:67]
  ds_read_b64_tr_b16 v[248:249], v19 offset:0
  v_mfma_f32_16x16x32_bf16 v[64:67], v[228:231], v[148:151], v[64:67]
  ds_read_b64_tr_b16 v[250:251], v19 offset:2048
  s_add_u32 s69, s17, 10240
  buffer_load_dwordx4 v[192:195], v10, s[64:67], s69 offen offset:0 sc1
  v_mfma_f32_16x16x32_bf16 v[68:71], v[228:231], v[156:159], v[68:71]
  ds_read_b64_tr_b16 v[252:253], v19 offset:4096
  v_mfma_f32_16x16x32_bf16 v[68:71], v[224:227], v[152:155], v[68:71]
  ds_read_b64_tr_b16 v[254:255], v19 offset:6144
  buffer_load_dwordx4 v[196:199], v10, s[64:67], s69 offen offset:1024 sc1
  s_waitcnt lgkmcnt(8)
  v_mfma_f32_16x16x32_bf16 v[76:79], v[232:235], v[152:155], v[76:79]
  ds_read_b64_tr_b16 v[224:225], v16 offset:8192
  v_mfma_f32_16x16x32_bf16 v[76:79], v[236:239], v[156:159], v[76:79]
  ds_read_b64_tr_b16 v[226:227], v16 offset:10240
  buffer_load_dwordx4 v[200:203], v11, s[64:67], s69 offen offset:0 sc1
  v_mfma_f32_16x16x32_bf16 v[72:75], v[236:239], v[148:151], v[72:75]
  ds_read_b64_tr_b16 v[228:229], v16 offset:12288
  v_mfma_f32_16x16x32_bf16 v[72:75], v[232:235], v[144:147], v[72:75]
  ds_read_b64_tr_b16 v[230:231], v16 offset:14336
  buffer_load_dwordx4 v[204:207], v11, s[64:67], s69 offen offset:1024 sc1
  s_waitcnt lgkmcnt(8)
  v_mfma_f32_16x16x32_bf16 v[80:83], v[240:243], v[144:147], v[80:83]
  ds_read_b64_tr_b16 v[232:233], v17 offset:8192
  v_mfma_f32_16x16x32_bf16 v[80:83], v[244:247], v[148:151], v[80:83]
  ds_read_b64_tr_b16 v[234:235], v17 offset:10240
  v_mfma_f32_16x16x32_bf16 v[84:87], v[244:247], v[156:159], v[84:87]
  ds_read_b64_tr_b16 v[236:237], v17 offset:12288
  v_mfma_f32_16x16x32_bf16 v[84:87], v[240:243], v[152:155], v[84:87]
  ds_read_b64_tr_b16 v[238:239], v17 offset:14336
  s_waitcnt vmcnt(16)
  s_barrier
  s_waitcnt lgkmcnt(8)
  v_mfma_f32_16x16x32_bf16 v[92:95], v[248:251], v[152:155], v[92:95]
  ds_read_b64_tr_b16 v[240:241], v18 offset:8192
  v_mfma_f32_16x16x32_bf16 v[92:95], v[252:255], v[156:159], v[92:95]
  ds_read_b64_tr_b16 v[242:243], v18 offset:10240
  s_add_u32 m0, s10, 131072
  s_add_u32 s12, s22, 0
  buffer_load_dwordx4 v15, s[52:55], s12 offen lds
  v_mfma_f32_16x16x32_bf16 v[88:91], v[252:255], v[148:151], v[88:91]
  ds_read_b64_tr_b16 v[244:245], v18 offset:12288
  v_mfma_f32_16x16x32_bf16 v[88:91], v[248:251], v[144:147], v[88:91]
  ds_read_b64_tr_b16 v[246:247], v18 offset:14336
  s_add_u32 m0, s10, 135168
  s_add_u32 s12, s22, 65536
  buffer_load_dwordx4 v15, s[52:55], s12 offen lds
  s_waitcnt lgkmcnt(8)
  v_mfma_f32_16x16x32_bf16 v[96:99], v[224:227], v[144:147], v[96:99]
  ds_read_b64_tr_b16 v[248:249], v19 offset:8192
  v_mfma_f32_16x16x32_bf16 v[96:99], v[228:231], v[148:151], v[96:99]
  ds_read_b64_tr_b16 v[250:251], v19 offset:10240
  s_add_u32 m0, s10, 139264
  s_add_u32 s12, s22, 0
  buffer_load_dwordx4 v13, s[52:55], s12 offen lds
  v_mfma_f32_16x16x32_bf16 v[100:103], v[228:231], v[156:159], v[100:103]
  ds_read_b64_tr_b16 v[252:253], v19 offset:12288
  v_mfma_f32_16x16x32_bf16 v[100:103], v[224:227], v[152:155], v[100:103]
  ds_read_b64_tr_b16 v[254:255], v19 offset:14336
  s_add_u32 m0, s10, 143360
  s_add_u32 s12, s22, 65536
  buffer_load_dwordx4 v13, s[52:55], s12 offen lds
  s_waitcnt lgkmcnt(8)
  v_mfma_f32_16x16x32_bf16 v[108:111], v[232:235], v[152:155], v[108:111]
  ds_read_b64_tr_b16 v[224:225], v16 offset:16384
  v_mfma_f32_16x16x32_bf16 v[108:111], v[236:239], v[156:159], v[108:111]
  ds_read_b64_tr_b16 v[226:227], v16 offset:18432
  s_add_u32 m0, s10, 147456
  s_add_u32 s12, s22, 131072
  buffer_load_dwordx4 v15, s[52:55], s12 offen lds
  v_mfma_f32_16x16x32_bf16 v[104:107], v[236:239], v[148:151], v[104:107]
  ds_read_b64_tr_b16 v[228:229], v16 offset:20480
  v_mfma_f32_16x16x32_bf16 v[104:107], v[232:235], v[144:147], v[104:107]
  ds_read_b64_tr_b16 v[230:231], v16 offset:22528
  s_add_u32 m0, s10, 151552
  s_add_u32 s12, s22, 196608
  buffer_load_dwordx4 v15, s[52:55], s12 offen lds
  s_waitcnt lgkmcnt(8)
  v_mfma_f32_16x16x32_bf16 v[112:115], v[240:243], v[144:147], v[112:115]
  ds_read_b64_tr_b16 v[232:233], v17 offset:16384
  v_mfma_f32_16x16x32_bf16 v[112:115], v[244:247], v[148:151], v[112:115]
  ds_read_b64_tr_b16 v[234:235], v17 offset:18432
  s_add_u32 m0, s10, 155648
  s_add_u32 s12, s22, 131072
  buffer_load_dwordx4 v13, s[52:55], s12 offen lds
  v_mfma_f32_16x16x32_bf16 v[116:119], v[244:247], v[156:159], v[116:119]
  ds_read_b64_tr_b16 v[236:237], v17 offset:20480
  v_mfma_f32_16x16x32_bf16 v[116:119], v[240:243], v[152:155], v[116:119]
  ds_read_b64_tr_b16 v[238:239], v17 offset:22528
  s_add_u32 m0, s10, 159744
  s_add_u32 s12, s22, 196608
  buffer_load_dwordx4 v13, s[52:55], s12 offen lds
  s_waitcnt lgkmcnt(8)
  v_mfma_f32_16x16x32_bf16 v[124:127], v[248:251], v[152:155], v[124:127]
  ds_read_b64_tr_b16 v[240:241], v18 offset:16384
  v_mfma_f32_16x16x32_bf16 v[124:127], v[252:255], v[156:159], v[124:127]
  ds_read_b64_tr_b16 v[242:243], v18 offset:18432
  s_add_u32 s11, s5, 10
  s_and_b32 s11, s11, 15
  s_lshl_b32 s11, s11, 14
  s_add_u32 m0, s10, 32768
  s_add_u32 s12, s11, 27262976
  buffer_load_dwordx4 v14, s[64:67], s12 offen sc1 lds
  v_mfma_f32_16x16x32_bf16 v[120:123], v[252:255], v[148:151], v[120:123]
  ds_read_b64_tr_b16 v[244:245], v18 offset:20480
  v_mfma_f32_16x16x32_bf16 v[120:123], v[248:251], v[144:147], v[120:123]
  ds_read_b64_tr_b16 v[246:247], v18 offset:22528
  s_add_u32 m0, s10, 36864
  s_add_u32 s12, s11, 27267072
  buffer_load_dwordx4 v14, s[64:67], s12 offen sc1 lds
  s_waitcnt lgkmcnt(8)
  v_mfma_f32_16x16x32_bf16 v[64:67], v[224:227], v[160:163], v[64:67]
  ds_read_b64_tr_b16 v[248:249], v19 offset:16384
  v_mfma_f32_16x16x32_bf16 v[64:67], v[228:231], v[164:167], v[64:67]
  ds_read_b64_tr_b16 v[250:251], v19 offset:18432
  s_add_u32 s69, s17, 12288
  buffer_load_dwordx4 v[208:211], v10, s[64:67], s69 offen offset:0 sc1
  v_mfma_f32_16x16x32_bf16 v[68:71], v[228:231], v[172:175], v[68:71]
  ds_read_b64_tr_b16 v[252:253], v19 offset:20480
  v_mfma_f32_16x16x32_bf16 v[68:71], v[224:227], v[168:171], v[68:71]
  ds_read_b64_tr_b16 v[254:255], v19 offset:22528
  buffer_load_dwordx4 v[212:215], v10, s[64:67], s69 offen offset:1024 sc1
  s_waitcnt lgkmcnt(8)
  v_mfma_f32_16x16x32_bf16 v[76:79], v[232:235], v[168:171], v[76:79]
  ds_read_b64_tr_b16 v[224:225], v16 offset:24576
  v_mfma_f32_16x16x32_bf16 v[76:79], v[236:239], v[172:175], v[76:79]
  ds_read_b64_tr_b16 v[226:227], v16 offset:26624
  buffer_load_dwordx4 v[216:219], v11, s[64:67], s69 offen offset:0 sc1
  v_mfma_f32_16x16x32_bf16 v[72:75], v[236:239], v[164:167], v[72:75]
  ds_read_b64_tr_b16 v[228:229], v16 offset:28672
  v_mfma_f32_16x16x32_bf16 v[72:75], v[232:235], v[160:163], v[72:75]
  ds_read_b64_tr_b16 v[230:231], v16 offset:30720
  buffer_load_dwordx4 v[220:223], v11, s[64:67], s69 offen offset:1024 sc1
  s_waitcnt lgkmcnt(8)
  v_mfma_f32_16x16x32_bf16 v[80:83], v[240:243], v[160:163], v[80:83]
  ds_read_b64_tr_b16 v[232:233], v17 offset:24576
  v_mfma_f32_16x16x32_bf16 v[80:83], v[244:247], v[164:167], v[80:83]
  ds_read_b64_tr_b16 v[234:235], v17 offset:26624
  s_add_u32 m0, s10, 40960
  s_add_u32 s12, s11, 27271168
  buffer_load_dwordx4 v14, s[64:67], s12 offen sc1 lds
  v_mfma_f32_16x16x32_bf16 v[84:87], v[244:247], v[172:175], v[84:87]
  ds_read_b64_tr_b16 v[236:237], v17 offset:28672
  v_mfma_f32_16x16x32_bf16 v[84:87], v[240:243], v[168:171], v[84:87]
  ds_read_b64_tr_b16 v[238:239], v17 offset:30720
  s_add_u32 m0, s10, 45056
  s_add_u32 s12, s11, 27275264
  buffer_load_dwordx4 v14, s[64:67], s12 offen sc1 lds
  s_waitcnt lgkmcnt(8)
  v_mfma_f32_16x16x32_bf16 v[92:95], v[248:251], v[168:171], v[92:95]
  ds_read_b64_tr_b16 v[240:241], v18 offset:24576
  v_mfma_f32_16x16x32_bf16 v[92:95], v[252:255], v[172:175], v[92:95]
  ds_read_b64_tr_b16 v[242:243], v18 offset:26624
  v_mfma_f32_16x16x32_bf16 v[88:91], v[252:255], v[164:167], v[88:91]
  ds_read_b64_tr_b16 v[244:245], v18 offset:28672
  v_mfma_f32_16x16x32_bf16 v[88:91], v[248:251], v[160:163], v[88:91]
  ds_read_b64_tr_b16 v[246:247], v18 offset:30720
  s_waitcnt lgkmcnt(8)
  v_mfma_f32_16x16x32_bf16 v[96:99], v[224:227], v[160:163], v[96:99]
  ds_read_b64_tr_b16 v[248:249], v19 offset:24576
  v_mfma_f32_16x16x32_bf16 v[96:99], v[228:231], v[164:167], v[96:99]
  ds_read_b64_tr_b16 v[250:251], v19 offset:26624
  v_mfma_f32_16x16x32_bf16 v[100:103], v[228:231], v[172:175], v[100:103]
  ds_read_b64_tr_b16 v[252:253], v19 offset:28672
  v_mfma_f32_16x16x32_bf16 v[100:103], v[224:227], v[168:171], v[100:103]
  ds_read_b64_tr_b16 v[254:255], v19 offset:30720
  s_waitcnt lgkmcnt(8)
  v_mfma_f32_16x16x32_bf16 v[108:111], v[232:235], v[168:171], v[108:111]
  ds_read_b64_tr_b16 v[224:225], v16 offset:32768
  v_mfma_f32_16x16x32_bf16 v[108:111], v[236:239], v[172:175], v[108:111]
  ds_read_b64_tr_b16 v[226:227], v16 offset:34816
  v_mfma_f32_16x16x32_bf16 v[104:107], v[236:239], v[164:167], v[104:107]
  ds_read_b64_tr_b16 v[228:229], v16 offset:36864
  v_mfma_f32_16x16x32_bf16 v[104:107], v[232:235], v[160:163], v[104:107]
  ds_read_b64_tr_b16 v[230:231], v16 offset:38912
  s_waitcnt lgkmcnt(8)
  v_mfma_f32_16x16x32_bf16 v[112:115], v[240:243], v[160:163], v[112:115]
  ds_read_b64_tr_b16 v[232:233], v17 offset:32768
  v_mfma_f32_16x16x32_bf16 v[112:115], v[244:247], v[164:167], v[112:115]
  ds_read_b64_tr_b16 v[234:235], v17 offset:34816
  v_mfma_f32_16x16x32_bf16 v[116:119], v[244:247], v[172:175], v[116:119]
  ds_read_b64_tr_b16 v[236:237], v17 offset:36864
  v_mfma_f32_16x16x32_bf16 v[116:119], v[240:243], v[168:171], v[116:119]
  ds_read_b64_tr_b16 v[238:239], v17 offset:38912
  s_waitcnt lgkmcnt(8)
  v_mfma_f32_16x16x32_bf16 v[124:127], v[248:251], v[168:171], v[124:127]
  ds_read_b64_tr_b16 v[240:241], v18 offset:32768
  v_mfma_f32_16x16x32_bf16 v[124:127], v[252:255], v[172:175], v[124:127]
  ds_read_b64_tr_b16 v[242:243], v18 offset:34816
  v_mfma_f32_16x16x32_bf16 v[120:123], v[252:255], v[164:167], v[120:123]
  ds_read_b64_tr_b16 v[244:245], v18 offset:36864
  v_mfma_f32_16x16x32_bf16 v[120:123], v[248:251], v[160:163], v[120:123]
  ds_read_b64_tr_b16 v[246:247], v18 offset:38912
  s_waitcnt vmcnt(24)
  s_waitcnt lgkmcnt(8)
  v_mfma_f32_16x16x32_bf16 v[64:67], v[224:227], v[176:179], v[64:67]
  ds_read_b64_tr_b16 v[248:249], v19 offset:32768
  v_mfma_f32_16x16x32_bf16 v[64:67], v[228:231], v[180:183], v[64:67]
  ds_read_b64_tr_b16 v[250:251], v19 offset:34816
  s_add_u32 s69, s18, 0
  buffer_load_dwordx4 v[28:31], v10, s[64:67], s69 offen offset:0 sc1
  v_mfma_f32_16x16x32_bf16 v[68:71], v[228:231], v[188:191], v[68:71]
  ds_read_b64_tr_b16 v[252:253], v19 offset:36864
  v_mfma_f32_16x16x32_bf16 v[68:71], v[224:227], v[184:187], v[68:71]
  ds_read_b64_tr_b16 v[254:255], v19 offset:38912
  buffer_load_dwordx4 v[32:35], v10, s[64:67], s69 offen offset:1024 sc1
  s_waitcnt lgkmcnt(8)
  v_mfma_f32_16x16x32_bf16 v[76:79], v[232:235], v[184:187], v[76:79]
  ds_read_b64_tr_b16 v[224:225], v16 offset:40960
  v_mfma_f32_16x16x32_bf16 v[76:79], v[236:239], v[188:191], v[76:79]
  ds_read_b64_tr_b16 v[226:227], v16 offset:43008
  buffer_load_dwordx4 v[36:39], v11, s[64:67], s69 offen offset:0 sc1
  v_mfma_f32_16x16x32_bf16 v[72:75], v[236:239], v[180:183], v[72:75]
  ds_read_b64_tr_b16 v[228:229], v16 offset:45056
  v_mfma_f32_16x16x32_bf16 v[72:75], v[232:235], v[176:179], v[72:75]
  ds_read_b64_tr_b16 v[230:231], v16 offset:47104
  buffer_load_dwordx4 v[40:43], v11, s[64:67], s69 offen offset:1024 sc1
  s_waitcnt lgkmcnt(8)
  v_mfma_f32_16x16x32_bf16 v[80:83], v[240:243], v[176:179], v[80:83]
  ds_read_b64_tr_b16 v[232:233], v17 offset:40960
  v_mfma_f32_16x16x32_bf16 v[80:83], v[244:247], v[180:183], v[80:83]
  ds_read_b64_tr_b16 v[234:235], v17 offset:43008
  v_mfma_f32_16x16x32_bf16 v[84:87], v[244:247], v[188:191], v[84:87]
  ds_read_b64_tr_b16 v[236:237], v17 offset:45056
  v_mfma_f32_16x16x32_bf16 v[84:87], v[240:243], v[184:187], v[84:87]
  ds_read_b64_tr_b16 v[238:239], v17 offset:47104
  s_waitcnt lgkmcnt(8)
  v_mfma_f32_16x16x32_bf16 v[92:95], v[248:251], v[184:187], v[92:95]
  ds_read_b64_tr_b16 v[240:241], v18 offset:40960
  v_mfma_f32_16x16x32_bf16 v[92:95], v[252:255], v[188:191], v[92:95]
  ds_read_b64_tr_b16 v[242:243], v18 offset:43008
  v_mfma_f32_16x16x32_bf16 v[88:91], v[252:255], v[180:183], v[88:91]
  ds_read_b64_tr_b16 v[244:245], v18 offset:45056
  v_mfma_f32_16x16x32_bf16 v[88:91], v[248:251], v[176:179], v[88:91]
  ds_read_b64_tr_b16 v[246:247], v18 offset:47104
  s_waitcnt lgkmcnt(8)
  v_mfma_f32_16x16x32_bf16 v[96:99], v[224:227], v[176:179], v[96:99]
  ds_read_b64_tr_b16 v[248:249], v19 offset:40960
  v_mfma_f32_16x16x32_bf16 v[96:99], v[228:231], v[180:183], v[96:99]
  ds_read_b64_tr_b16 v[250:251], v19 offset:43008
  v_mfma_f32_16x16x32_bf16 v[100:103], v[228:231], v[188:191], v[100:103]
  ds_read_b64_tr_b16 v[252:253], v19 offset:45056
  v_mfma_f32_16x16x32_bf16 v[100:103], v[224:227], v[184:187], v[100:103]
  ds_read_b64_tr_b16 v[254:255], v19 offset:47104
  s_waitcnt lgkmcnt(8)
  v_mfma_f32_16x16x32_bf16 v[108:111], v[232:235], v[184:187], v[108:111]
  ds_read_b64_tr_b16 v[224:225], v16 offset:49152
  v_mfma_f32_16x16x32_bf16 v[108:111], v[236:239], v[188:191], v[108:111]
  ds_read_b64_tr_b16 v[226:227], v16 offset:51200
  v_mfma_f32_16x16x32_bf16 v[104:107], v[236:239], v[180:183], v[104:107]
  ds_read_b64_tr_b16 v[228:229], v16 offset:53248
  v_mfma_f32_16x16x32_bf16 v[104:107], v[232:235], v[176:179], v[104:107]
  ds_read_b64_tr_b16 v[230:231], v16 offset:55296
  s_waitcnt vmcnt(16)
  s_barrier
  s_waitcnt lgkmcnt(8)
  v_mfma_f32_16x16x32_bf16 v[112:115], v[240:243], v[176:179], v[112:115]
  ds_read_b64_tr_b16 v[232:233], v17 offset:49152
  v_mfma_f32_16x16x32_bf16 v[112:115], v[244:247], v[180:183], v[112:115]
  ds_read_b64_tr_b16 v[234:235], v17 offset:51200
  s_add_u32 m0, s10, 49152
  s_add_u32 s12, s22, 262144
  buffer_load_dwordx4 v15, s[52:55], s12 offen lds
  v_mfma_f32_16x16x32_bf16 v[116:119], v[244:247], v[188:191], v[116:119]
  ds_read_b64_tr_b16 v[236:237], v17 offset:53248
  v_mfma_f32_16x16x32_bf16 v[116:119], v[240:243], v[184:187], v[116:119]
  ds_read_b64_tr_b16 v[238:239], v17 offset:55296
  s_add_u32 m0, s10, 53248
  s_add_u32 s12, s22, 327680
  buffer_load_dwordx4 v15, s[52:55], s12 offen lds
  s_waitcnt lgkmcnt(8)
  v_mfma_f32_16x16x32_bf16 v[124:127], v[248:251], v[184:187], v[124:127]
  ds_read_b64_tr_b16 v[240:241], v18 offset:49152
  v_mfma_f32_16x16x32_bf16 v[124:127], v[252:255], v[188:191], v[124:127]
  ds_read_b64_tr_b16 v[242:243], v18 offset:51200
  s_add_u32 m0, s10, 57344
  s_add_u32 s12, s22, 262144
  buffer_load_dwordx4 v13, s[52:55], s12 offen lds
  v_mfma_f32_16x16x32_bf16 v[120:123], v[252:255], v[180:183], v[120:123]
  ds_read_b64_tr_b16 v[244:245], v18 offset:53248
  v_mfma_f32_16x16x32_bf16 v[120:123], v[248:251], v[176:179], v[120:123]
  ds_read_b64_tr_b16 v[246:247], v18 offset:55296
  s_add_u32 m0, s10, 61440
  s_add_u32 s12, s22, 327680
  buffer_load_dwordx4 v13, s[52:55], s12 offen lds
  s_waitcnt lgkmcnt(8)
  v_mfma_f32_16x16x32_bf16 v[64:67], v[224:227], v[192:195], v[64:67]
  ds_read_b64_tr_b16 v[248:249], v19 offset:49152
  v_mfma_f32_16x16x32_bf16 v[64:67], v[228:231], v[196:199], v[64:67]
  ds_read_b64_tr_b16 v[250:251], v19 offset:51200
  s_add_u32 s69, s18, 2048
  buffer_load_dwordx4 v[44:47], v10, s[64:67], s69 offen offset:0 sc1
  v_mfma_f32_16x16x32_bf16 v[68:71], v[228:231], v[204:207], v[68:71]
  ds_read_b64_tr_b16 v[252:253], v19 offset:53248
  v_mfma_f32_16x16x32_bf16 v[68:71], v[224:227], v[200:203], v[68:71]
  ds_read_b64_tr_b16 v[254:255], v19 offset:55296
  buffer_load_dwordx4 v[48:51], v10, s[64:67], s69 offen offset:1024 sc1
  s_waitcnt lgkmcnt(8)
  v_mfma_f32_16x16x32_bf16 v[76:79], v[232:235], v[200:203], v[76:79]
  ds_read_b64_tr_b16 v[224:225], v16 offset:57344
  v_mfma_f32_16x16x32_bf16 v[76:79], v[236:239], v[204:207], v[76:79]
  ds_read_b64_tr_b16 v[226:227], v16 offset:59392
  buffer_load_dwordx4 v[52:55], v11, s[64:67], s69 offen offset:0 sc1
  v_mfma_f32_16x16x32_bf16 v[72:75], v[236:239], v[196:199], v[72:75]
  ds_read_b64_tr_b16 v[228:229], v16 offset:61440
  v_mfma_f32_16x16x32_bf16 v[72:75], v[232:235], v[192:195], v[72:75]
  ds_read_b64_tr_b16 v[230:231], v16 offset:63488
  buffer_load_dwordx4 v[56:59], v11, s[64:67], s69 offen offset:1024 sc1
  s_waitcnt lgkmcnt(8)
  v_mfma_f32_16x16x32_bf16 v[80:83], v[240:243], v[192:195], v[80:83]
  ds_read_b64_tr_b16 v[232:233], v17 offset:57344
  v_mfma_f32_16x16x32_bf16 v[80:83], v[244:247], v[196:199], v[80:83]
  ds_read_b64_tr_b16 v[234:235], v17 offset:59392
  s_add_u32 m0, s10, 65536
  s_add_u32 s12, s22, 393216
  buffer_load_dwordx4 v15, s[52:55], s12 offen lds
  v_mfma_f32_16x16x32_bf16 v[84:87], v[244:247], v[204:207], v[84:87]
  ds_read_b64_tr_b16 v[236:237], v17 offset:61440
  v_mfma_f32_16x16x32_bf16 v[84:87], v[240:243], v[200:203], v[84:87]
  ds_read_b64_tr_b16 v[238:239], v17 offset:63488
  s_add_u32 m0, s10, 69632
  s_add_u32 s12, s22, 458752
  buffer_load_dwordx4 v15, s[52:55], s12 offen lds
  s_waitcnt lgkmcnt(8)
  v_mfma_f32_16x16x32_bf16 v[92:95], v[248:251], v[200:203], v[92:95]
  ds_read_b64_tr_b16 v[240:241], v18 offset:57344
  v_mfma_f32_16x16x32_bf16 v[92:95], v[252:255], v[204:207], v[92:95]
  ds_read_b64_tr_b16 v[242:243], v18 offset:59392
  s_add_u32 m0, s10, 73728
  s_add_u32 s12, s22, 393216
  buffer_load_dwordx4 v13, s[52:55], s12 offen lds
  v_mfma_f32_16x16x32_bf16 v[88:91], v[252:255], v[196:199], v[88:91]
  ds_read_b64_tr_b16 v[244:245], v18 offset:61440
  v_mfma_f32_16x16x32_bf16 v[88:91], v[248:251], v[192:195], v[88:91]
  ds_read_b64_tr_b16 v[246:247], v18 offset:63488
  s_add_u32 m0, s10, 77824
  s_add_u32 s12, s22, 458752
  buffer_load_dwordx4 v13, s[52:55], s12 offen lds
  s_waitcnt lgkmcnt(8)
  v_mfma_f32_16x16x32_bf16 v[96:99], v[224:227], v[192:195], v[96:99]
  ds_read_b64_tr_b16 v[248:249], v19 offset:57344
  v_mfma_f32_16x16x32_bf16 v[96:99], v[228:231], v[196:199], v[96:99]
  ds_read_b64_tr_b16 v[250:251], v19 offset:59392
  s_add_u32 s11, s5, 11
  s_and_b32 s11, s11, 15
  s_lshl_b32 s11, s11, 14
  s_add_u32 m0, s10, 16384
  s_add_u32 s12, s11, 27262976
  buffer_load_dwordx4 v14, s[64:67], s12 offen sc1 lds
  v_mfma_f32_16x16x32_bf16 v[100:103], v[228:231], v[204:207], v[100:103]
  ds_read_b64_tr_b16 v[252:253], v19 offset:61440
  v_mfma_f32_16x16x32_bf16 v[100:103], v[224:227], v[200:203], v[100:103]
  ds_read_b64_tr_b16 v[254:255], v19 offset:63488
  s_add_u32 m0, s10, 20480
  s_add_u32 s12, s11, 27267072
  buffer_load_dwordx4 v14, s[64:67], s12 offen sc1 lds
  s_waitcnt lgkmcnt(8)
  v_mfma_f32_16x16x32_bf16 v[108:111], v[232:235], v[200:203], v[108:111]
  ds_read_b64_tr_b16 v[224:225], v20 offset:0
  v_mfma_f32_16x16x32_bf16 v[108:111], v[236:239], v[204:207], v[108:111]
  ds_read_b64_tr_b16 v[226:227], v20 offset:2048
  s_add_u32 m0, s10, 24576
  s_add_u32 s12, s11, 27271168
  buffer_load_dwordx4 v14, s[64:67], s12 offen sc1 lds
  v_mfma_f32_16x16x32_bf16 v[104:107], v[236:239], v[196:199], v[104:107]
  ds_read_b64_tr_b16 v[228:229], v20 offset:4096
  v_mfma_f32_16x16x32_bf16 v[104:107], v[232:235], v[192:195], v[104:107]
  ds_read_b64_tr_b16 v[230:231], v20 offset:6144
  s_add_u32 m0, s10, 28672
  s_add_u32 s12, s11, 27275264
  buffer_load_dwordx4 v14, s[64:67], s12 offen sc1 lds
  s_waitcnt lgkmcnt(8)
  v_mfma_f32_16x16x32_bf16 v[112:115], v[240:243], v[192:195], v[112:115]
  ds_read_b64_tr_b16 v[232:233], v21 offset:0
  v_mfma_f32_16x16x32_bf16 v[112:115], v[244:247], v[196:199], v[112:115]
  ds_read_b64_tr_b16 v[234:235], v21 offset:2048
  v_mfma_f32_16x16x32_bf16 v[116:119], v[244:247], v[204:207], v[116:119]
  ds_read_b64_tr_b16 v[236:237], v21 offset:4096
  v_mfma_f32_16x16x32_bf16 v[116:119], v[240:243], v[200:203], v[116:119]
  ds_read_b64_tr_b16 v[238:239], v21 offset:6144
  s_waitcnt lgkmcnt(8)
  v_mfma_f32_16x16x32_bf16 v[124:127], v[248:251], v[200:203], v[124:127]
  ds_read_b64_tr_b16 v[240:241], v22 offset:0
  v_mfma_f32_16x16x32_bf16 v[124:127], v[252:255], v[204:207], v[124:127]
  ds_read_b64_tr_b16 v[242:243], v22 offset:2048
  v_mfma_f32_16x16x32_bf16 v[120:123], v[252:255], v[196:199], v[120:123]
  ds_read_b64_tr_b16 v[244:245], v22 offset:4096
  v_mfma_f32_16x16x32_bf16 v[120:123], v[248:251], v[192:195], v[120:123]
  ds_read_b64_tr_b16 v[246:247], v22 offset:6144
  s_waitcnt vmcnt(22)
  s_waitcnt lgkmcnt(8)
  v_mfma_f32_16x16x32_bf16 v[64:67], v[224:227], v[208:211], v[64:67]
  ds_read_b64_tr_b16 v[248:249], v23 offset:0
  v_mfma_f32_16x16x32_bf16 v[64:67], v[228:231], v[212:215], v[64:67]
  ds_read_b64_tr_b16 v[250:251], v23 offset:2048
  s_add_u32 s69, s18, 4096
  buffer_load_dwordx4 v[128:131], v10, s[64:67], s69 offen offset:0 sc1
  v_mfma_f32_16x16x32_bf16 v[68:71], v[228:231], v[220:223], v[68:71]
  ds_read_b64_tr_b16 v[252:253], v23 offset:4096
  v_mfma_f32_16x16x32_bf16 v[68:71], v[224:227], v[216:219], v[68:71]
  ds_read_b64_tr_b16 v[254:255], v23 offset:6144
  buffer_load_dwordx4 v[132:135], v10, s[64:67], s69 offen offset:1024 sc1
  s_waitcnt lgkmcnt(8)
  v_mfma_f32_16x16x32_bf16 v[76:79], v[232:235], v[216:219], v[76:79]
  ds_read_b64_tr_b16 v[224:225], v20 offset:8192
  v_mfma_f32_16x16x32_bf16 v[76:79], v[236:239], v[220:223], v[76:79]
  ds_read_b64_tr_b16 v[226:227], v20 offset:10240
  buffer_load_dwordx4 v[136:139], v11, s[64:67], s69 offen offset:0 sc1
  v_mfma_f32_16x16x32_bf16 v[72:75], v[236:239], v[212:215], v[72:75]
  ds_read_b64_tr_b16 v[228:229], v20 offset:12288
  v_mfma_f32_16x16x32_bf16 v[72:75], v[232:235], v[208:211], v[72:75]
  ds_read_b64_tr_b16 v[230:231], v20 offset:14336
  buffer_load_dwordx4 v[140:143], v11, s[64:67], s69 offen offset:1024 sc1
  s_waitcnt lgkmcnt(8)
  v_mfma_f32_16x16x32_bf16 v[80:83], v[240:243], v[208:211], v[80:83]
  ds_read_b64_tr_b16 v[232:233], v21 offset:8192
  v_mfma_f32_16x16x32_bf16 v[80:83], v[244:247], v[212:215], v[80:83]
  ds_read_b64_tr_b16 v[234:235], v21 offset:10240
  v_mfma_f32_16x16x32_bf16 v[84:87], v[244:247], v[220:223], v[84:87]
  ds_read_b64_tr_b16 v[236:237], v21 offset:12288
  v_mfma_f32_16x16x32_bf16 v[84:87], v[240:243], v[216:219], v[84:87]
  ds_read_b64_tr_b16 v[238:239], v21 offset:14336
  s_waitcnt lgkmcnt(8)
  v_mfma_f32_16x16x32_bf16 v[92:95], v[248:251], v[216:219], v[92:95]
  ds_read_b64_tr_b16 v[240:241], v22 offset:8192
  v_mfma_f32_16x16x32_bf16 v[92:95], v[252:255], v[220:223], v[92:95]
  ds_read_b64_tr_b16 v[242:243], v22 offset:10240
  v_mfma_f32_16x16x32_bf16 v[88:91], v[252:255], v[212:215], v[88:91]
  ds_read_b64_tr_b16 v[244:245], v22 offset:12288
  v_mfma_f32_16x16x32_bf16 v[88:91], v[248:251], v[208:211], v[88:91]
  ds_read_b64_tr_b16 v[246:247], v22 offset:14336
  s_waitcnt lgkmcnt(8)
  v_mfma_f32_16x16x32_bf16 v[96:99], v[224:227], v[208:211], v[96:99]
  ds_read_b64_tr_b16 v[248:249], v23 offset:8192
  v_mfma_f32_16x16x32_bf16 v[96:99], v[228:231], v[212:215], v[96:99]
  ds_read_b64_tr_b16 v[250:251], v23 offset:10240
  v_mfma_f32_16x16x32_bf16 v[100:103], v[228:231], v[220:223], v[100:103]
  ds_read_b64_tr_b16 v[252:253], v23 offset:12288
  v_mfma_f32_16x16x32_bf16 v[100:103], v[224:227], v[216:219], v[100:103]
  ds_read_b64_tr_b16 v[254:255], v23 offset:14336
  s_waitcnt lgkmcnt(8)
  v_mfma_f32_16x16x32_bf16 v[108:111], v[232:235], v[216:219], v[108:111]
  ds_read_b64_tr_b16 v[224:225], v20 offset:16384
  v_mfma_f32_16x16x32_bf16 v[108:111], v[236:239], v[220:223], v[108:111]
  ds_read_b64_tr_b16 v[226:227], v20 offset:18432
  v_mfma_f32_16x16x32_bf16 v[104:107], v[236:239], v[212:215], v[104:107]
  ds_read_b64_tr_b16 v[228:229], v20 offset:20480
  v_mfma_f32_16x16x32_bf16 v[104:107], v[232:235], v[208:211], v[104:107]
  ds_read_b64_tr_b16 v[230:231], v20 offset:22528
  s_waitcnt lgkmcnt(8)
  v_mfma_f32_16x16x32_bf16 v[112:115], v[240:243], v[208:211], v[112:115]
  ds_read_b64_tr_b16 v[232:233], v21 offset:16384
  v_mfma_f32_16x16x32_bf16 v[112:115], v[244:247], v[212:215], v[112:115]
  ds_read_b64_tr_b16 v[234:235], v21 offset:18432
  v_mfma_f32_16x16x32_bf16 v[116:119], v[244:247], v[220:223], v[116:119]
  ds_read_b64_tr_b16 v[236:237], v21 offset:20480
  v_mfma_f32_16x16x32_bf16 v[116:119], v[240:243], v[216:219], v[116:119]
  ds_read_b64_tr_b16 v[238:239], v21 offset:22528
  s_waitcnt lgkmcnt(8)
  v_mfma_f32_16x16x32_bf16 v[124:127], v[248:251], v[216:219], v[124:127]
  ds_read_b64_tr_b16 v[240:241], v22 offset:16384
  v_mfma_f32_16x16x32_bf16 v[124:127], v[252:255], v[220:223], v[124:127]
  ds_read_b64_tr_b16 v[242:243], v22 offset:18432
  v_mfma_f32_16x16x32_bf16 v[120:123], v[252:255], v[212:215], v[120:123]
  ds_read_b64_tr_b16 v[244:245], v22 offset:20480
  v_mfma_f32_16x16x32_bf16 v[120:123], v[248:251], v[208:211], v[120:123]
  ds_read_b64_tr_b16 v[246:247], v22 offset:22528
  s_waitcnt vmcnt(20)
  s_waitcnt lgkmcnt(8)
  v_mfma_f32_16x16x32_bf16 v[64:67], v[224:227], v[28:31], v[64:67]
  ds_read_b64_tr_b16 v[248:249], v23 offset:16384
  v_mfma_f32_16x16x32_bf16 v[64:67], v[228:231], v[32:35], v[64:67]
  ds_read_b64_tr_b16 v[250:251], v23 offset:18432
  s_add_u32 s69, s18, 6144
  buffer_load_dwordx4 v[144:147], v10, s[64:67], s69 offen offset:0 sc1
  v_mfma_f32_16x16x32_bf16 v[68:71], v[228:231], v[40:43], v[68:71]
  ds_read_b64_tr_b16 v[252:253], v23 offset:20480
  v_mfma_f32_16x16x32_bf16 v[68:71], v[224:227], v[36:39], v[68:71]
  ds_read_b64_tr_b16 v[254:255], v23 offset:22528
  buffer_load_dwordx4 v[148:151], v10, s[64:67], s69 offen offset:1024 sc1
  s_waitcnt vmcnt(18)
  s_barrier
  s_waitcnt lgkmcnt(8)
  v_mfma_f32_16x16x32_bf16 v[76:79], v[232:235], v[36:39], v[76:79]
  ds_read_b64_tr_b16 v[224:225], v20 offset:24576
  v_mfma_f32_16x16x32_bf16 v[76:79], v[236:239], v[40:43], v[76:79]
  ds_read_b64_tr_b16 v[226:227], v20 offset:26624
  buffer_load_dwordx4 v[152:155], v11, s[64:67], s69 offen offset:0 sc1
  v_mfma_f32_16x16x32_bf16 v[72:75], v[236:239], v[32:35], v[72:75]
  ds_read_b64_tr_b16 v[228:229], v20 offset:28672
  v_mfma_f32_16x16x32_bf16 v[72:75], v[232:235], v[28:31], v[72:75]
  ds_read_b64_tr_b16 v[230:231], v20 offset:30720
  buffer_load_dwordx4 v[156:159], v11, s[64:67], s69 offen offset:1024 sc1
  s_waitcnt lgkmcnt(8)
  v_mfma_f32_16x16x32_bf16 v[80:83], v[240:243], v[28:31], v[80:83]
  ds_read_b64_tr_b16 v[232:233], v21 offset:24576
  v_mfma_f32_16x16x32_bf16 v[80:83], v[244:247], v[32:35], v[80:83]
  ds_read_b64_tr_b16 v[234:235], v21 offset:26624
  s_add_u32 m0, s10, 81920
  s_add_u32 s12, s22, 524288
  buffer_load_dwordx4 v15, s[52:55], s12 offen lds
  v_mfma_f32_16x16x32_bf16 v[84:87], v[244:247], v[40:43], v[84:87]
  ds_read_b64_tr_b16 v[236:237], v21 offset:28672
  v_mfma_f32_16x16x32_bf16 v[84:87], v[240:243], v[36:39], v[84:87]
  ds_read_b64_tr_b16 v[238:239], v21 offset:30720
  s_add_u32 m0, s10, 86016
  s_add_u32 s12, s22, 589824
  buffer_load_dwordx4 v15, s[52:55], s12 offen lds
  s_waitcnt lgkmcnt(8)
  v_mfma_f32_16x16x32_bf16 v[92:95], v[248:251], v[36:39], v[92:95]
  ds_read_b64_tr_b16 v[240:241], v22 offset:24576
  v_mfma_f32_16x16x32_bf16 v[92:95], v[252:255], v[40:43], v[92:95]
  ds_read_b64_tr_b16 v[242:243], v22 offset:26624
  s_add_u32 m0, s10, 90112
  s_add_u32 s12, s22, 524288
  buffer_load_dwordx4 v13, s[52:55], s12 offen lds
  v_mfma_f32_16x16x32_bf16 v[88:91], v[252:255], v[32:35], v[88:91]
  ds_read_b64_tr_b16 v[244:245], v22 offset:28672
  v_mfma_f32_16x16x32_bf16 v[88:91], v[248:251], v[28:31], v[88:91]
  ds_read_b64_tr_b16 v[246:247], v22 offset:30720
  s_add_u32 m0, s10, 94208
  s_add_u32 s12, s22, 589824
  buffer_load_dwordx4 v13, s[52:55], s12 offen lds
  s_waitcnt lgkmcnt(8)
  v_mfma_f32_16x16x32_bf16 v[96:99], v[224:227], v[28:31], v[96:99]
  ds_read_b64_tr_b16 v[248:249], v23 offset:24576
  v_mfma_f32_16x16x32_bf16 v[96:99], v[228:231], v[32:35], v[96:99]
  ds_read_b64_tr_b16 v[250:251], v23 offset:26624
  s_add_u32 m0, s10, 98304
  s_add_u32 s12, s22, 655360
  buffer_load_dwordx4 v15, s[52:55], s12 offen lds
  v_mfma_f32_16x16x32_bf16 v[100:103], v[228:231], v[40:43], v[100:103]
  ds_read_b64_tr_b16 v[252:253], v23 offset:28672
  v_mfma_f32_16x16x32_bf16 v[100:103], v[224:227], v[36:39], v[100:103]
  ds_read_b64_tr_b16 v[254:255], v23 offset:30720
  s_add_u32 m0, s10, 102400
  s_add_u32 s12, s22, 720896
  buffer_load_dwordx4 v15, s[52:55], s12 offen lds
  s_waitcnt lgkmcnt(8)
  v_mfma_f32_16x16x32_bf16 v[108:111], v[232:235], v[36:39], v[108:111]
  ds_read_b64_tr_b16 v[224:225], v20 offset:32768
  v_mfma_f32_16x16x32_bf16 v[108:111], v[236:239], v[40:43], v[108:111]
  ds_read_b64_tr_b16 v[226:227], v20 offset:34816
  s_add_u32 m0, s10, 106496
  s_add_u32 s12, s22, 655360
  buffer_load_dwordx4 v13, s[52:55], s12 offen lds
  v_mfma_f32_16x16x32_bf16 v[104:107], v[236:239], v[32:35], v[104:107]
  ds_read_b64_tr_b16 v[228:229], v20 offset:36864
  v_mfma_f32_16x16x32_bf16 v[104:107], v[232:235], v[28:31], v[104:107]
  ds_read_b64_tr_b16 v[230:231], v20 offset:38912
  s_add_u32 m0, s10, 110592
  s_add_u32 s12, s22, 720896
  buffer_load_dwordx4 v13, s[52:55], s12 offen lds
  s_waitcnt lgkmcnt(8)
  v_mfma_f32_16x16x32_bf16 v[112:115], v[240:243], v[28:31], v[112:115]
  ds_read_b64_tr_b16 v[232:233], v21 offset:32768
  v_mfma_f32_16x16x32_bf16 v[112:115], v[244:247], v[32:35], v[112:115]
  ds_read_b64_tr_b16 v[234:235], v21 offset:34816
  s_add_u32 m0, s10, 114688
  s_add_u32 s12, s22, 786432
  buffer_load_dwordx4 v13, s[52:55], s12 offen lds
  v_mfma_f32_16x16x32_bf16 v[116:119], v[244:247], v[40:43], v[116:119]
  ds_read_b64_tr_b16 v[236:237], v21 offset:36864
  v_mfma_f32_16x16x32_bf16 v[116:119], v[240:243], v[36:39], v[116:119]
  ds_read_b64_tr_b16 v[238:239], v21 offset:38912
  s_add_u32 m0, s10, 118784
  s_add_u32 s12, s22, 851968
  buffer_load_dwordx4 v13, s[52:55], s12 offen lds
  s_waitcnt lgkmcnt(8)
  v_mfma_f32_16x16x32_bf16 v[124:127], v[248:251], v[36:39], v[124:127]
  ds_read_b64_tr_b16 v[240:241], v22 offset:32768
  v_mfma_f32_16x16x32_bf16 v[124:127], v[252:255], v[40:43], v[124:127]
  ds_read_b64_tr_b16 v[242:243], v22 offset:34816
  s_add_u32 m0, s10, 122880
  s_add_u32 s12, s23, 0
  buffer_load_dwordx4 v13, s[52:55], s12 offen lds
  v_mfma_f32_16x16x32_bf16 v[120:123], v[252:255], v[32:35], v[120:123]
  ds_read_b64_tr_b16 v[244:245], v22 offset:36864
  v_mfma_f32_16x16x32_bf16 v[120:123], v[248:251], v[28:31], v[120:123]
  ds_read_b64_tr_b16 v[246:247], v22 offset:38912
  s_add_u32 m0, s10, 126976
  s_add_u32 s12, s23, 65536
  buffer_load_dwordx4 v13, s[52:55], s12 offen lds
  s_waitcnt vmcnt(28)
  s_waitcnt lgkmcnt(8)
  v_mfma_f32_16x16x32_bf16 v[64:67], v[224:227], v[44:47], v[64:67]
  ds_read_b64_tr_b16 v[248:249], v23 offset:32768
  v_mfma_f32_16x16x32_bf16 v[64:67], v[228:231], v[48:51], v[64:67]
  ds_read_b64_tr_b16 v[250:251], v23 offset:34816
  s_add_u32 s69, s18, 8192
  buffer_load_dwordx4 v[160:163], v10, s[64:67], s69 offen offset:0 sc1
  v_mfma_f32_16x16x32_bf16 v[68:71], v[228:231], v[56:59], v[68:71]
  ds_read_b64_tr_b16 v[252:253], v23 offset:36864
  v_mfma_f32_16x16x32_bf16 v[68:71], v[224:227], v[52:55], v[68:71]
  ds_read_b64_tr_b16 v[254:255], v23 offset:38912
  buffer_load_dwordx4 v[164:167], v10, s[64:67], s69 offen offset:1024 sc1
  s_waitcnt lgkmcnt(8)
  v_mfma_f32_16x16x32_bf16 v[76:79], v[232:235], v[52:55], v[76:79]
  ds_read_b64_tr_b16 v[224:225], v20 offset:40960
  v_mfma_f32_16x16x32_bf16 v[76:79], v[236:239], v[56:59], v[76:79]
  ds_read_b64_tr_b16 v[226:227], v20 offset:43008
  buffer_load_dwordx4 v[168:171], v11, s[64:67], s69 offen offset:0 sc1
  v_mfma_f32_16x16x32_bf16 v[72:75], v[236:239], v[48:51], v[72:75]
  ds_read_b64_tr_b16 v[228:229], v20 offset:45056
  v_mfma_f32_16x16x32_bf16 v[72:75], v[232:235], v[44:47], v[72:75]
  ds_read_b64_tr_b16 v[230:231], v20 offset:47104
  buffer_load_dwordx4 v[172:175], v11, s[64:67], s69 offen offset:1024 sc1
  s_waitcnt lgkmcnt(8)
  v_mfma_f32_16x16x32_bf16 v[80:83], v[240:243], v[44:47], v[80:83]
  ds_read_b64_tr_b16 v[232:233], v21 offset:40960
  v_mfma_f32_16x16x32_bf16 v[80:83], v[244:247], v[48:51], v[80:83]
  ds_read_b64_tr_b16 v[234:235], v21 offset:43008
  s_add_u32 s11, s5, 12
  s_and_b32 s11, s11, 15
  s_lshl_b32 s11, s11, 14
  s_add_u32 m0, s10, 0
  s_add_u32 s12, s11, 27262976
  buffer_load_dwordx4 v14, s[64:67], s12 offen sc1 lds
  v_mfma_f32_16x16x32_bf16 v[84:87], v[244:247], v[56:59], v[84:87]
  ds_read_b64_tr_b16 v[236:237], v21 offset:45056
  v_mfma_f32_16x16x32_bf16 v[84:87], v[240:243], v[52:55], v[84:87]
  ds_read_b64_tr_b16 v[238:239], v21 offset:47104
  s_add_u32 m0, s10, 4096
  s_add_u32 s12, s11, 27267072
  buffer_load_dwordx4 v14, s[64:67], s12 offen sc1 lds
  s_waitcnt lgkmcnt(8)
  v_mfma_f32_16x16x32_bf16 v[92:95], v[248:251], v[52:55], v[92:95]
  ds_read_b64_tr_b16 v[240:241], v22 offset:40960
  v_mfma_f32_16x16x32_bf16 v[92:95], v[252:255], v[56:59], v[92:95]
  ds_read_b64_tr_b16 v[242:243], v22 offset:43008
  s_add_u32 m0, s10, 8192
  s_add_u32 s12, s11, 27271168
  buffer_load_dwordx4 v14, s[64:67], s12 offen sc1 lds
  v_mfma_f32_16x16x32_bf16 v[88:91], v[252:255], v[48:51], v[88:91]
  ds_read_b64_tr_b16 v[244:245], v22 offset:45056
  v_mfma_f32_16x16x32_bf16 v[88:91], v[248:251], v[44:47], v[88:91]
  ds_read_b64_tr_b16 v[246:247], v22 offset:47104
  s_add_u32 m0, s10, 12288
  s_add_u32 s12, s11, 27275264
  buffer_load_dwordx4 v14, s[64:67], s12 offen sc1 lds
  s_waitcnt lgkmcnt(8)
  v_mfma_f32_16x16x32_bf16 v[96:99], v[224:227], v[44:47], v[96:99]
  ds_read_b64_tr_b16 v[248:249], v23 offset:40960
  v_mfma_f32_16x16x32_bf16 v[96:99], v[228:231], v[48:51], v[96:99]
  ds_read_b64_tr_b16 v[250:251], v23 offset:43008
  v_mfma_f32_16x16x32_bf16 v[100:103], v[228:231], v[56:59], v[100:103]
  ds_read_b64_tr_b16 v[252:253], v23 offset:45056
  v_mfma_f32_16x16x32_bf16 v[100:103], v[224:227], v[52:55], v[100:103]
  ds_read_b64_tr_b16 v[254:255], v23 offset:47104
  s_waitcnt lgkmcnt(8)
  v_mfma_f32_16x16x32_bf16 v[108:111], v[232:235], v[52:55], v[108:111]
  ds_read_b64_tr_b16 v[224:225], v16 offset:0
  v_mfma_f32_16x16x32_bf16 v[108:111], v[236:239], v[56:59], v[108:111]
  ds_read_b64_tr_b16 v[226:227], v16 offset:2048
  v_mfma_f32_16x16x32_bf16 v[104:107], v[236:239], v[48:51], v[104:107]
  ds_read_b64_tr_b16 v[228:229], v16 offset:4096
  v_mfma_f32_16x16x32_bf16 v[104:107], v[232:235], v[44:47], v[104:107]
  ds_read_b64_tr_b16 v[230:231], v16 offset:6144
  s_waitcnt lgkmcnt(8)
  v_mfma_f32_16x16x32_bf16 v[112:115], v[240:243], v[44:47], v[112:115]
  ds_read_b64_tr_b16 v[232:233], v17 offset:0
  v_mfma_f32_16x16x32_bf16 v[112:115], v[244:247], v[48:51], v[112:115]
  ds_read_b64_tr_b16 v[234:235], v17 offset:2048
  v_mfma_f32_16x16x32_bf16 v[116:119], v[244:247], v[56:59], v[116:119]
  ds_read_b64_tr_b16 v[236:237], v17 offset:4096
  v_mfma_f32_16x16x32_bf16 v[116:119], v[240:243], v[52:55], v[116:119]
  ds_read_b64_tr_b16 v[238:239], v17 offset:6144
  s_waitcnt lgkmcnt(8)
  v_mfma_f32_16x16x32_bf16 v[124:127], v[248:251], v[52:55], v[124:127]
  ds_read_b64_tr_b16 v[240:241], v18 offset:0
  v_mfma_f32_16x16x32_bf16 v[124:127], v[252:255], v[56:59], v[124:127]
  ds_read_b64_tr_b16 v[242:243], v18 offset:2048
  v_mfma_f32_16x16x32_bf16 v[120:123], v[252:255], v[48:51], v[120:123]
  ds_read_b64_tr_b16 v[244:245], v18 offset:4096
  v_mfma_f32_16x16x32_bf16 v[120:123], v[248:251], v[44:47], v[120:123]
  ds_read_b64_tr_b16 v[246:247], v18 offset:6144
  s_waitcnt vmcnt(24)
  s_waitcnt lgkmcnt(8)
  v_mfma_f32_16x16x32_bf16 v[64:67], v[224:227], v[128:131], v[64:67]
  ds_read_b64_tr_b16 v[248:249], v19 offset:0
  v_mfma_f32_16x16x32_bf16 v[64:67], v[228:231], v[132:135], v[64:67]
  ds_read_b64_tr_b16 v[250:251], v19 offset:2048
  s_add_u32 s69, s18, 10240
  buffer_load_dwordx4 v[176:179], v10, s[64:67], s69 offen offset:0 sc1
  v_mfma_f32_16x16x32_bf16 v[68:71], v[228:231], v[140:143], v[68:71]
  ds_read_b64_tr_b16 v[252:253], v19 offset:4096
  v_mfma_f32_16x16x32_bf16 v[68:71], v[224:227], v[136:139], v[68:71]
  ds_read_b64_tr_b16 v[254:255], v19 offset:6144
  buffer_load_dwordx4 v[180:183], v10, s[64:67], s69 offen offset:1024 sc1
  s_waitcnt lgkmcnt(8)
  v_mfma_f32_16x16x32_bf16 v[76:79], v[232:235], v[136:139], v[76:79]
  ds_read_b64_tr_b16 v[224:225], v16 offset:8192
  v_mfma_f32_16x16x32_bf16 v[76:79], v[236:239], v[140:143], v[76:79]
  ds_read_b64_tr_b16 v[226:227], v16 offset:10240
  buffer_load_dwordx4 v[184:187], v11, s[64:67], s69 offen offset:0 sc1
  v_mfma_f32_16x16x32_bf16 v[72:75], v[236:239], v[132:135], v[72:75]
  ds_read_b64_tr_b16 v[228:229], v16 offset:12288
  v_mfma_f32_16x16x32_bf16 v[72:75], v[232:235], v[128:131], v[72:75]
  ds_read_b64_tr_b16 v[230:231], v16 offset:14336
  buffer_load_dwordx4 v[188:191], v11, s[64:67], s69 offen offset:1024 sc1
  s_waitcnt lgkmcnt(8)
  v_mfma_f32_16x16x32_bf16 v[80:83], v[240:243], v[128:131], v[80:83]
  ds_read_b64_tr_b16 v[232:233], v17 offset:8192
  v_mfma_f32_16x16x32_bf16 v[80:83], v[244:247], v[132:135], v[80:83]
  ds_read_b64_tr_b16 v[234:235], v17 offset:10240
  v_mfma_f32_16x16x32_bf16 v[84:87], v[244:247], v[140:143], v[84:87]
  ds_read_b64_tr_b16 v[236:237], v17 offset:12288
  v_mfma_f32_16x16x32_bf16 v[84:87], v[240:243], v[136:139], v[84:87]
  ds_read_b64_tr_b16 v[238:239], v17 offset:14336
  s_waitcnt lgkmcnt(8)
  v_mfma_f32_16x16x32_bf16 v[92:95], v[248:251], v[136:139], v[92:95]
  ds_read_b64_tr_b16 v[240:241], v18 offset:8192
  v_mfma_f32_16x16x32_bf16 v[92:95], v[252:255], v[140:143], v[92:95]
  ds_read_b64_tr_b16 v[242:243], v18 offset:10240
  v_mfma_f32_16x16x32_bf16 v[88:91], v[252:255], v[132:135], v[88:91]
  ds_read_b64_tr_b16 v[244:245], v18 offset:12288
  v_mfma_f32_16x16x32_bf16 v[88:91], v[248:251], v[128:131], v[88:91]
  ds_read_b64_tr_b16 v[246:247], v18 offset:14336
  s_waitcnt vmcnt(16)
  s_barrier
  s_waitcnt lgkmcnt(8)
  v_mfma_f32_16x16x32_bf16 v[96:99], v[224:227], v[128:131], v[96:99]
  ds_read_b64_tr_b16 v[248:249], v19 offset:8192
  v_mfma_f32_16x16x32_bf16 v[96:99], v[228:231], v[132:135], v[96:99]
  ds_read_b64_tr_b16 v[250:251], v19 offset:10240
  s_add_u32 m0, s10, 131072
  s_add_u32 s12, s23, 131072
  buffer_load_dwordx4 v13, s[52:55], s12 offen lds
  v_mfma_f32_16x16x32_bf16 v[100:103], v[228:231], v[140:143], v[100:103]
  ds_read_b64_tr_b16 v[252:253], v19 offset:12288
  v_mfma_f32_16x16x32_bf16 v[100:103], v[224:227], v[136:139], v[100:103]
  ds_read_b64_tr_b16 v[254:255], v19 offset:14336
  s_add_u32 m0, s10, 135168
  s_add_u32 s12, s23, 196608
  buffer_load_dwordx4 v13, s[52:55], s12 offen lds
  s_waitcnt lgkmcnt(8)
  v_mfma_f32_16x16x32_bf16 v[108:111], v[232:235], v[136:139], v[108:111]
  ds_read_b64_tr_b16 v[224:225], v16 offset:16384
  v_mfma_f32_16x16x32_bf16 v[108:111], v[236:239], v[140:143], v[108:111]
  ds_read_b64_tr_b16 v[226:227], v16 offset:18432
  s_add_u32 m0, s10, 139264
  s_add_u32 s12, s23, 262144
  buffer_load_dwordx4 v13, s[52:55], s12 offen lds
  v_mfma_f32_16x16x32_bf16 v[104:107], v[236:239], v[132:135], v[104:107]
  ds_read_b64_tr_b16 v[228:229], v16 offset:20480
  v_mfma_f32_16x16x32_bf16 v[104:107], v[232:235], v[128:131], v[104:107]
  ds_read_b64_tr_b16 v[230:231], v16 offset:22528
  s_add_u32 m0, s10, 143360
  s_add_u32 s12, s23, 327680
  buffer_load_dwordx4 v13, s[52:55], s12 offen lds
  s_waitcnt lgkmcnt(8)
  v_mfma_f32_16x16x32_bf16 v[112:115], v[240:243], v[128:131], v[112:115]
  ds_read_b64_tr_b16 v[232:233], v17 offset:16384
  v_mfma_f32_16x16x32_bf16 v[112:115], v[244:247], v[132:135], v[112:115]
  ds_read_b64_tr_b16 v[234:235], v17 offset:18432
  s_add_u32 m0, s10, 147456
  s_add_u32 s12, s23, 393216
  buffer_load_dwordx4 v13, s[52:55], s12 offen lds
  v_mfma_f32_16x16x32_bf16 v[116:119], v[244:247], v[140:143], v[116:119]
  ds_read_b64_tr_b16 v[236:237], v17 offset:20480
  v_mfma_f32_16x16x32_bf16 v[116:119], v[240:243], v[136:139], v[116:119]
  ds_read_b64_tr_b16 v[238:239], v17 offset:22528
  s_add_u32 m0, s10, 151552
  s_add_u32 s12, s23, 458752
  buffer_load_dwordx4 v13, s[52:55], s12 offen lds
  s_waitcnt lgkmcnt(8)
  v_mfma_f32_16x16x32_bf16 v[124:127], v[248:251], v[136:139], v[124:127]
  ds_read_b64_tr_b16 v[240:241], v18 offset:16384
  v_mfma_f32_16x16x32_bf16 v[124:127], v[252:255], v[140:143], v[124:127]
  ds_read_b64_tr_b16 v[242:243], v18 offset:18432
  s_add_u32 m0, s10, 155648
  s_add_u32 s12, s23, 524288
  buffer_load_dwordx4 v13, s[52:55], s12 offen lds
  v_mfma_f32_16x16x32_bf16 v[120:123], v[252:255], v[132:135], v[120:123]
  ds_read_b64_tr_b16 v[244:245], v18 offset:20480
  v_mfma_f32_16x16x32_bf16 v[120:123], v[248:251], v[128:131], v[120:123]
  ds_read_b64_tr_b16 v[246:247], v18 offset:22528
  s_add_u32 m0, s10, 159744
  s_add_u32 s12, s23, 589824
  buffer_load_dwordx4 v13, s[52:55], s12 offen lds
  s_waitcnt lgkmcnt(8)
  v_mfma_f32_16x16x32_bf16 v[64:67], v[224:227], v[144:147], v[64:67]
  ds_read_b64_tr_b16 v[248:249], v19 offset:16384
  v_mfma_f32_16x16x32_bf16 v[64:67], v[228:231], v[148:151], v[64:67]
  ds_read_b64_tr_b16 v[250:251], v19 offset:18432
  s_add_u32 s69, s18, 12288
  buffer_load_dwordx4 v[192:195], v10, s[64:67], s69 offen offset:0 sc1
  v_mfma_f32_16x16x32_bf16 v[68:71], v[228:231], v[156:159], v[68:71]
  ds_read_b64_tr_b16 v[252:253], v19 offset:20480
  v_mfma_f32_16x16x32_bf16 v[68:71], v[224:227], v[152:155], v[68:71]
  ds_read_b64_tr_b16 v[254:255], v19 offset:22528
  buffer_load_dwordx4 v[196:199], v10, s[64:67], s69 offen offset:1024 sc1
  s_waitcnt lgkmcnt(8)
  v_mfma_f32_16x16x32_bf16 v[76:79], v[232:235], v[152:155], v[76:79]
  ds_read_b64_tr_b16 v[224:225], v16 offset:24576
  v_mfma_f32_16x16x32_bf16 v[76:79], v[236:239], v[156:159], v[76:79]
  ds_read_b64_tr_b16 v[226:227], v16 offset:26624
  buffer_load_dwordx4 v[200:203], v11, s[64:67], s69 offen offset:0 sc1
  v_mfma_f32_16x16x32_bf16 v[72:75], v[236:239], v[148:151], v[72:75]
  ds_read_b64_tr_b16 v[228:229], v16 offset:28672
  v_mfma_f32_16x16x32_bf16 v[72:75], v[232:235], v[144:147], v[72:75]
  ds_read_b64_tr_b16 v[230:231], v16 offset:30720
  buffer_load_dwordx4 v[204:207], v11, s[64:67], s69 offen offset:1024 sc1
  s_waitcnt lgkmcnt(8)
  v_mfma_f32_16x16x32_bf16 v[80:83], v[240:243], v[144:147], v[80:83]
  ds_read_b64_tr_b16 v[232:233], v17 offset:24576
  v_mfma_f32_16x16x32_bf16 v[80:83], v[244:247], v[148:151], v[80:83]
  ds_read_b64_tr_b16 v[234:235], v17 offset:26624
  s_add_u32 s11, s5, 13
  s_and_b32 s11, s11, 15
  s_lshl_b32 s11, s11, 14
  s_add_u32 m0, s10, 32768
  s_add_u32 s12, s11, 27262976
  buffer_load_dwordx4 v14, s[64:67], s12 offen sc1 lds
  v_mfma_f32_16x16x32_bf16 v[84:87], v[244:247], v[156:159], v[84:87]
  ds_read_b64_tr_b16 v[236:237], v17 offset:28672
  v_mfma_f32_16x16x32_bf16 v[84:87], v[240:243], v[152:155], v[84:87]
  ds_read_b64_tr_b16 v[238:239], v17 offset:30720
  s_add_u32 m0, s10, 36864
  s_add_u32 s12, s11, 27267072
  buffer_load_dwordx4 v14, s[64:67], s12 offen sc1 lds
  s_waitcnt lgkmcnt(8)
  v_mfma_f32_16x16x32_bf16 v[92:95], v[248:251], v[152:155], v[92:95]
  ds_read_b64_tr_b16 v[240:241], v18 offset:24576
  v_mfma_f32_16x16x32_bf16 v[92:95], v[252:255], v[156:159], v[92:95]
  ds_read_b64_tr_b16 v[242:243], v18 offset:26624
  s_add_u32 m0, s10, 40960
  s_add_u32 s12, s11, 27271168
  buffer_load_dwordx4 v14, s[64:67], s12 offen sc1 lds
  v_mfma_f32_16x16x32_bf16 v[88:91], v[252:255], v[148:151], v[88:91]
  ds_read_b64_tr_b16 v[244:245], v18 offset:28672
  v_mfma_f32_16x16x32_bf16 v[88:91], v[248:251], v[144:147], v[88:91]
  ds_read_b64_tr_b16 v[246:247], v18 offset:30720
  s_add_u32 m0, s10, 45056
  s_add_u32 s12, s11, 27275264
  buffer_load_dwordx4 v14, s[64:67], s12 offen sc1 lds
  s_waitcnt lgkmcnt(8)
  v_mfma_f32_16x16x32_bf16 v[96:99], v[224:227], v[144:147], v[96:99]
  ds_read_b64_tr_b16 v[248:249], v19 offset:24576
  v_mfma_f32_16x16x32_bf16 v[96:99], v[228:231], v[148:151], v[96:99]
  ds_read_b64_tr_b16 v[250:251], v19 offset:26624
  s_add_u32 s69, s19, 0
  buffer_load_dwordx4 v[208:211], v10, s[64:67], s69 offen offset:0 sc1
  v_mfma_f32_16x16x32_bf16 v[100:103], v[228:231], v[156:159], v[100:103]
  ds_read_b64_tr_b16 v[252:253], v19 offset:28672
  v_mfma_f32_16x16x32_bf16 v[100:103], v[224:227], v[152:155], v[100:103]
  ds_read_b64_tr_b16 v[254:255], v19 offset:30720
  buffer_load_dwordx4 v[212:215], v10, s[64:67], s69 offen offset:1024 sc1
  s_waitcnt lgkmcnt(8)
  v_mfma_f32_16x16x32_bf16 v[108:111], v[232:235], v[152:155], v[108:111]
  ds_read_b64_tr_b16 v[224:225], v16 offset:32768
  v_mfma_f32_16x16x32_bf16 v[108:111], v[236:239], v[156:159], v[108:111]
  ds_read_b64_tr_b16 v[226:227], v16 offset:34816
  buffer_load_dwordx4 v[216:219], v11, s[64:67], s69 offen offset:0 sc1
  v_mfma_f32_16x16x32_bf16 v[104:107], v[236:239], v[148:151], v[104:107]
  ds_read_b64_tr_b16 v[228:229], v16 offset:36864
  v_mfma_f32_16x16x32_bf16 v[104:107], v[232:235], v[144:147], v[104:107]
  ds_read_b64_tr_b16 v[230:231], v16 offset:38912
  buffer_load_dwordx4 v[220:223], v11, s[64:67], s69 offen offset:1024 sc1
  s_waitcnt lgkmcnt(8)
  v_mfma_f32_16x16x32_bf16 v[112:115], v[240:243], v[144:147], v[112:115]
  ds_read_b64_tr_b16 v[232:233], v17 offset:32768
  v_mfma_f32_16x16x32_bf16 v[112:115], v[244:247], v[148:151], v[112:115]
  ds_read_b64_tr_b16 v[234:235], v17 offset:34816
  v_mfma_f32_16x16x32_bf16 v[116:119], v[244:247], v[156:159], v[116:119]
  ds_read_b64_tr_b16 v[236:237], v17 offset:36864
  v_mfma_f32_16x16x32_bf16 v[116:119], v[240:243], v[152:155], v[116:119]
  ds_read_b64_tr_b16 v[238:239], v17 offset:38912
  s_waitcnt lgkmcnt(8)
  v_mfma_f32_16x16x32_bf16 v[124:127], v[248:251], v[152:155], v[124:127]
  ds_read_b64_tr_b16 v[240:241], v18 offset:32768
  v_mfma_f32_16x16x32_bf16 v[124:127], v[252:255], v[156:159], v[124:127]
  ds_read_b64_tr_b16 v[242:243], v18 offset:34816
  v_mfma_f32_16x16x32_bf16 v[120:123], v[252:255], v[148:151], v[120:123]
  ds_read_b64_tr_b16 v[244:245], v18 offset:36864
  v_mfma_f32_16x16x32_bf16 v[120:123], v[248:251], v[144:147], v[120:123]
  ds_read_b64_tr_b16 v[246:247], v18 offset:38912
  s_waitcnt vmcnt(28)
  s_waitcnt lgkmcnt(8)
  v_mfma_f32_16x16x32_bf16 v[64:67], v[224:227], v[160:163], v[64:67]
  ds_read_b64_tr_b16 v[248:249], v19 offset:32768
  v_mfma_f32_16x16x32_bf16 v[64:67], v[228:231], v[164:167], v[64:67]
  ds_read_b64_tr_b16 v[250:251], v19 offset:34816
  s_add_u32 s69, s19, 2048
  buffer_load_dwordx4 v[28:31], v10, s[64:67], s69 offen offset:0 sc1
  v_mfma_f32_16x16x32_bf16 v[68:71], v[228:231], v[172:175], v[68:71]
  ds_read_b64_tr_b16 v[252:253], v19 offset:36864
  v_mfma_f32_16x16x32_bf16 v[68:71], v[224:227], v[168:171], v[68:71]
  ds_read_b64_tr_b16 v[254:255], v19 offset:38912
  buffer_load_dwordx4 v[32:35], v10, s[64:67], s69 offen offset:1024 sc1
  s_waitcnt lgkmcnt(8)
  v_mfma_f32_16x16x32_bf16 v[76:79], v[232:235], v[168:171], v[76:79]
  ds_read_b64_tr_b16 v[224:225], v16 offset:40960
  v_mfma_f32_16x16x32_bf16 v[76:79], v[236:239], v[172:175], v[76:79]
  ds_read_b64_tr_b16 v[226:227], v16 offset:43008
  buffer_load_dwordx4 v[36:39], v11, s[64:67], s69 offen offset:0 sc1
  v_mfma_f32_16x16x32_bf16 v[72:75], v[236:239], v[164:167], v[72:75]
  ds_read_b64_tr_b16 v[228:229], v16 offset:45056
  v_mfma_f32_16x16x32_bf16 v[72:75], v[232:235], v[160:163], v[72:75]
  ds_read_b64_tr_b16 v[230:231], v16 offset:47104
  buffer_load_dwordx4 v[40:43], v11, s[64:67], s69 offen offset:1024 sc1
  s_waitcnt lgkmcnt(8)
  v_mfma_f32_16x16x32_bf16 v[80:83], v[240:243], v[160:163], v[80:83]
  ds_read_b64_tr_b16 v[232:233], v17 offset:40960
  v_mfma_f32_16x16x32_bf16 v[80:83], v[244:247], v[164:167], v[80:83]
  ds_read_b64_tr_b16 v[234:235], v17 offset:43008
  v_mfma_f32_16x16x32_bf16 v[84:87], v[244:247], v[172:175], v[84:87]
  ds_read_b64_tr_b16 v[236:237], v17 offset:45056
  v_mfma_f32_16x16x32_bf16 v[84:87], v[240:243], v[168:171], v[84:87]
  ds_read_b64_tr_b16 v[238:239], v17 offset:47104
  s_waitcnt lgkmcnt(8)
  v_mfma_f32_16x16x32_bf16 v[92:95], v[248:251], v[168:171], v[92:95]
  ds_read_b64_tr_b16 v[240:241], v18 offset:40960
  v_mfma_f32_16x16x32_bf16 v[92:95], v[252:255], v[172:175], v[92:95]
  ds_read_b64_tr_b16 v[242:243], v18 offset:43008
  v_mfma_f32_16x16x32_bf16 v[88:91], v[252:255], v[164:167], v[88:91]
  ds_read_b64_tr_b16 v[244:245], v18 offset:45056
  v_mfma_f32_16x16x32_bf16 v[88:91], v[248:251], v[160:163], v[88:91]
  ds_read_b64_tr_b16 v[246:247], v18 offset:47104
  s_waitcnt lgkmcnt(8)
  v_mfma_f32_16x16x32_bf16 v[96:99], v[224:227], v[160:163], v[96:99]
  ds_read_b64_tr_b16 v[248:249], v19 offset:40960
  v_mfma_f32_16x16x32_bf16 v[96:99], v[228:231], v[164:167], v[96:99]
  ds_read_b64_tr_b16 v[250:251], v19 offset:43008
  s_add_u32 s69, s19, 4096
  buffer_load_dwordx4 v[44:47], v10, s[64:67], s69 offen offset:0 sc1
  v_mfma_f32_16x16x32_bf16 v[100:103], v[228:231], v[172:175], v[100:103]
  ds_read_b64_tr_b16 v[252:253], v19 offset:45056
  v_mfma_f32_16x16x32_bf16 v[100:103], v[224:227], v[168:171], v[100:103]
  ds_read_b64_tr_b16 v[254:255], v19 offset:47104
  buffer_load_dwordx4 v[48:51], v10, s[64:67], s69 offen offset:1024 sc1
  s_waitcnt lgkmcnt(8)
  v_mfma_f32_16x16x32_bf16 v[108:111], v[232:235], v[168:171], v[108:111]
  ds_read_b64_tr_b16 v[224:225], v16 offset:49152
  v_mfma_f32_16x16x32_bf16 v[108:111], v[236:239], v[172:175], v[108:111]
  ds_read_b64_tr_b16 v[226:227], v16 offset:51200
  buffer_load_dwordx4 v[52:55], v11, s[64:67], s69 offen offset:0 sc1
  v_mfma_f32_16x16x32_bf16 v[104:107], v[236:239], v[164:167], v[104:107]
  ds_read_b64_tr_b16 v[228:229], v16 offset:53248
  v_mfma_f32_16x16x32_bf16 v[104:107], v[232:235], v[160:163], v[104:107]
  ds_read_b64_tr_b16 v[230:231], v16 offset:55296
  buffer_load_dwordx4 v[56:59], v11, s[64:67], s69 offen offset:1024 sc1
  s_waitcnt lgkmcnt(8)
  v_mfma_f32_16x16x32_bf16 v[112:115], v[240:243], v[160:163], v[112:115]
  ds_read_b64_tr_b16 v[232:233], v17 offset:49152
  v_mfma_f32_16x16x32_bf16 v[112:115], v[244:247], v[164:167], v[112:115]
  ds_read_b64_tr_b16 v[234:235], v17 offset:51200
  v_mfma_f32_16x16x32_bf16 v[116:119], v[244:247], v[172:175], v[116:119]
  ds_read_b64_tr_b16 v[236:237], v17 offset:53248
  v_mfma_f32_16x16x32_bf16 v[116:119], v[240:243], v[168:171], v[116:119]
  ds_read_b64_tr_b16 v[238:239], v17 offset:55296
  s_waitcnt vmcnt(24)
  s_barrier
  s_waitcnt lgkmcnt(8)
  v_mfma_f32_16x16x32_bf16 v[124:127], v[248:251], v[168:171], v[124:127]
  ds_read_b64_tr_b16 v[240:241], v18 offset:49152
  v_mfma_f32_16x16x32_bf16 v[124:127], v[252:255], v[172:175], v[124:127]
  ds_read_b64_tr_b16 v[242:243], v18 offset:51200
  s_add_u32 m0, s10, 49152
  s_add_u32 s12, s23, 655360
  buffer_load_dwordx4 v13, s[52:55], s12 offen lds
  v_mfma_f32_16x16x32_bf16 v[120:123], v[252:255], v[164:167], v[120:123]
  ds_read_b64_tr_b16 v[244:245], v18 offset:53248
  v_mfma_f32_16x16x32_bf16 v[120:123], v[248:251], v[160:163], v[120:123]
  ds_read_b64_tr_b16 v[246:247], v18 offset:55296
  s_add_u32 m0, s10, 53248
  s_add_u32 s12, s23, 720896
  buffer_load_dwordx4 v13, s[52:55], s12 offen lds
  s_waitcnt lgkmcnt(8)
  v_mfma_f32_16x16x32_bf16 v[64:67], v[224:227], v[176:179], v[64:67]
  ds_read_b64_tr_b16 v[248:249], v19 offset:49152
  v_mfma_f32_16x16x32_bf16 v[64:67], v[228:231], v[180:183], v[64:67]
  ds_read_b64_tr_b16 v[250:251], v19 offset:51200
  s_add_u32 s69, s19, 6144
  buffer_load_dwordx4 v[128:131], v10, s[64:67], s69 offen offset:0 sc1
  v_mfma_f32_16x16x32_bf16 v[68:71], v[228:231], v[188:191], v[68:71]
  ds_read_b64_tr_b16 v[252:253], v19 offset:53248
  v_mfma_f32_16x16x32_bf16 v[68:71], v[224:227], v[184:187], v[68:71]
  ds_read_b64_tr_b16 v[254:255], v19 offset:55296
  buffer_load_dwordx4 v[132:135], v10, s[64:67], s69 offen offset:1024 sc1
  s_waitcnt lgkmcnt(8)
  v_mfma_f32_16x16x32_bf16 v[76:79], v[232:235], v[184:187], v[76:79]
  ds_read_b64_tr_b16 v[224:225], v16 offset:57344
  v_mfma_f32_16x16x32_bf16 v[76:79], v[236:239], v[188:191], v[76:79]
  ds_read_b64_tr_b16 v[226:227], v16 offset:59392
  buffer_load_dwordx4 v[136:139], v11, s[64:67], s69 offen offset:0 sc1
  v_mfma_f32_16x16x32_bf16 v[72:75], v[236:239], v[180:183], v[72:75]
  ds_read_b64_tr_b16 v[228:229], v16 offset:61440
  v_mfma_f32_16x16x32_bf16 v[72:75], v[232:235], v[176:179], v[72:75]
  ds_read_b64_tr_b16 v[230:231], v16 offset:63488
  buffer_load_dwordx4 v[140:143], v11, s[64:67], s69 offen offset:1024 sc1
  s_waitcnt lgkmcnt(8)
  v_mfma_f32_16x16x32_bf16 v[80:83], v[240:243], v[176:179], v[80:83]
  ds_read_b64_tr_b16 v[232:233], v17 offset:57344
  v_mfma_f32_16x16x32_bf16 v[80:83], v[244:247], v[180:183], v[80:83]
  ds_read_b64_tr_b16 v[234:235], v17 offset:59392
  s_add_u32 m0, s10, 57344
  s_add_u32 s12, s23, 786432
  buffer_load_dwordx4 v13, s[52:55], s12 offen lds
  v_mfma_f32_16x16x32_bf16 v[84:87], v[244:247], v[188:191], v[84:87]
  ds_read_b64_tr_b16 v[236:237], v17 offset:61440
  v_mfma_f32_16x16x32_bf16 v[84:87], v[240:243], v[184:187], v[84:87]
  ds_read_b64_tr_b16 v[238:239], v17 offset:63488
  s_add_u32 m0, s10, 61440
  s_add_u32 s12, s23, 851968
  buffer_load_dwordx4 v13, s[52:55], s12 offen lds
  s_waitcnt lgkmcnt(8)
  v_mfma_f32_16x16x32_bf16 v[92:95], v[248:251], v[184:187], v[92:95]
  ds_read_b64_tr_b16 v[240:241], v18 offset:57344
  v_mfma_f32_16x16x32_bf16 v[92:95], v[252:255], v[188:191], v[92:95]
  ds_read_b64_tr_b16 v[242:243], v18 offset:59392
  s_add_u32 m0, s10, 65536
  s_mov_b32 s12, 3670016
  buffer_load_dwordx4 v13, s[52:55], s12 offen lds
  v_mfma_f32_16x16x32_bf16 v[88:91], v[252:255], v[180:183], v[88:91]
  ds_read_b64_tr_b16 v[244:245], v18 offset:61440
  v_mfma_f32_16x16x32_bf16 v[88:91], v[248:251], v[176:179], v[88:91]
  ds_read_b64_tr_b16 v[246:247], v18 offset:63488
  s_add_u32 m0, s10, 69632
  s_mov_b32 s12, 3735552
  buffer_load_dwordx4 v13, s[52:55], s12 offen lds
  s_waitcnt lgkmcnt(8)
  v_mfma_f32_16x16x32_bf16 v[96:99], v[224:227], v[176:179], v[96:99]
  ds_read_b64_tr_b16 v[248:249], v19 offset:57344
  v_mfma_f32_16x16x32_bf16 v[96:99], v[228:231], v[180:183], v[96:99]
  ds_read_b64_tr_b16 v[250:251], v19 offset:59392
  s_add_u32 s69, s19, 8192
  buffer_load_dwordx4 v[144:147], v10, s[64:67], s69 offen offset:0 sc1
  v_mfma_f32_16x16x32_bf16 v[100:103], v[228:231], v[188:191], v[100:103]
  ds_read_b64_tr_b16 v[252:253], v19 offset:61440
  v_mfma_f32_16x16x32_bf16 v[100:103], v[224:227], v[184:187], v[100:103]
  ds_read_b64_tr_b16 v[254:255], v19 offset:63488
  buffer_load_dwordx4 v[148:151], v10, s[64:67], s69 offen offset:1024 sc1
  s_waitcnt lgkmcnt(8)
  v_mfma_f32_16x16x32_bf16 v[108:111], v[232:235], v[184:187], v[108:111]
  ds_read_b64_tr_b16 v[224:225], v20 offset:0
  v_mfma_f32_16x16x32_bf16 v[108:111], v[236:239], v[188:191], v[108:111]
  ds_read_b64_tr_b16 v[226:227], v20 offset:2048
  buffer_load_dwordx4 v[152:155], v11, s[64:67], s69 offen offset:0 sc1
  v_mfma_f32_16x16x32_bf16 v[104:107], v[236:239], v[180:183], v[104:107]
  ds_read_b64_tr_b16 v[228:229], v20 offset:4096
  v_mfma_f32_16x16x32_bf16 v[104:107], v[232:235], v[176:179], v[104:107]
  ds_read_b64_tr_b16 v[230:231], v20 offset:6144
  buffer_load_dwordx4 v[156:159], v11, s[64:67], s69 offen offset:1024 sc1
  s_waitcnt lgkmcnt(8)
  v_mfma_f32_16x16x32_bf16 v[112:115], v[240:243], v[176:179], v[112:115]
  ds_read_b64_tr_b16 v[232:233], v21 offset:0
  v_mfma_f32_16x16x32_bf16 v[112:115], v[244:247], v[180:183], v[112:115]
  ds_read_b64_tr_b16 v[234:235], v21 offset:2048
  s_add_u32 m0, s10, 73728
  s_mov_b32 s12, 3801088
  buffer_load_dwordx4 v13, s[52:55], s12 offen lds
  v_mfma_f32_16x16x32_bf16 v[116:119], v[244:247], v[188:191], v[116:119]
  ds_read_b64_tr_b16 v[236:237], v21 offset:4096
  v_mfma_f32_16x16x32_bf16 v[116:119], v[240:243], v[184:187], v[116:119]
  ds_read_b64_tr_b16 v[238:239], v21 offset:6144
  s_add_u32 m0, s10, 77824
  s_mov_b32 s12, 3866624
  buffer_load_dwordx4 v13, s[52:55], s12 offen lds
  s_waitcnt lgkmcnt(8)
  v_mfma_f32_16x16x32_bf16 v[124:127], v[248:251], v[184:187], v[124:127]
  ds_read_b64_tr_b16 v[240:241], v22 offset:0
  v_mfma_f32_16x16x32_bf16 v[124:127], v[252:255], v[188:191], v[124:127]
  ds_read_b64_tr_b16 v[242:243], v22 offset:2048
  s_add_u32 s11, s5, 14
  s_and_b32 s11, s11, 15
  s_lshl_b32 s11, s11, 14
  s_add_u32 m0, s10, 16384
  s_add_u32 s12, s11, 27262976
  buffer_load_dwordx4 v14, s[64:67], s12 offen sc1 lds
  v_mfma_f32_16x16x32_bf16 v[120:123], v[252:255], v[180:183], v[120:123]
  ds_read_b64_tr_b16 v[244:245], v22 offset:4096
  v_mfma_f32_16x16x32_bf16 v[120:123], v[248:251], v[176:179], v[120:123]
  ds_read_b64_tr_b16 v[246:247], v22 offset:6144
  s_add_u32 m0, s10, 20480
  s_add_u32 s12, s11, 27267072
  buffer_load_dwordx4 v14, s[64:67], s12 offen sc1 lds
  s_waitcnt vmcnt(34)
  s_waitcnt lgkmcnt(8)
  v_mfma_f32_16x16x32_bf16 v[96:99], v[224:227], v[192:195], v[96:99]
  ds_read_b64_tr_b16 v[248:249], v23 offset:0
  v_mfma_f32_16x16x32_bf16 v[96:99], v[228:231], v[196:199], v[96:99]
  ds_read_b64_tr_b16 v[250:251], v23 offset:2048
  s_add_u32 s69, s19, 10240
  buffer_load_dwordx4 v[160:163], v10, s[64:67], s69 offen offset:0 sc1
  v_mfma_f32_16x16x32_bf16 v[100:103], v[228:231], v[204:207], v[100:103]
  ds_read_b64_tr_b16 v[252:253], v23 offset:4096
  v_mfma_f32_16x16x32_bf16 v[100:103], v[224:227], v[200:203], v[100:103]
  ds_read_b64_tr_b16 v[254:255], v23 offset:6144
  buffer_load_dwordx4 v[164:167], v10, s[64:67], s69 offen offset:1024 sc1
  s_waitcnt lgkmcnt(8)
  v_mfma_f32_16x16x32_bf16 v[108:111], v[232:235], v[200:203], v[108:111]
  ds_read_b64_tr_b16 v[224:225], v20 offset:8192
  v_mfma_f32_16x16x32_bf16 v[108:111], v[236:239], v[204:207], v[108:111]
  ds_read_b64_tr_b16 v[226:227], v20 offset:10240
  buffer_load_dwordx4 v[168:171], v11, s[64:67], s69 offen offset:0 sc1
  v_mfma_f32_16x16x32_bf16 v[104:107], v[236:239], v[196:199], v[104:107]
  ds_read_b64_tr_b16 v[228:229], v20 offset:12288
  v_mfma_f32_16x16x32_bf16 v[104:107], v[232:235], v[192:195], v[104:107]
  ds_read_b64_tr_b16 v[230:231], v20 offset:14336
  buffer_load_dwordx4 v[172:175], v11, s[64:67], s69 offen offset:1024 sc1
  s_waitcnt lgkmcnt(8)
  v_mfma_f32_16x16x32_bf16 v[112:115], v[240:243], v[192:195], v[112:115]
  ds_read_b64_tr_b16 v[232:233], v21 offset:8192
  v_mfma_f32_16x16x32_bf16 v[112:115], v[244:247], v[196:199], v[112:115]
  ds_read_b64_tr_b16 v[234:235], v21 offset:10240
  s_add_u32 m0, s10, 24576
  s_add_u32 s12, s11, 27271168
  buffer_load_dwordx4 v14, s[64:67], s12 offen sc1 lds
  v_mfma_f32_16x16x32_bf16 v[116:119], v[244:247], v[204:207], v[116:119]
  ds_read_b64_tr_b16 v[236:237], v21 offset:12288
  v_mfma_f32_16x16x32_bf16 v[116:119], v[240:243], v[200:203], v[116:119]
  ds_read_b64_tr_b16 v[238:239], v21 offset:14336
  s_add_u32 m0, s10, 28672
  s_add_u32 s12, s11, 27275264
  buffer_load_dwordx4 v14, s[64:67], s12 offen sc1 lds
  s_waitcnt lgkmcnt(8)
  v_mfma_f32_16x16x32_bf16 v[124:127], v[248:251], v[200:203], v[124:127]
  ds_read_b64_tr_b16 v[240:241], v22 offset:8192
  v_mfma_f32_16x16x32_bf16 v[124:127], v[252:255], v[204:207], v[124:127]
  ds_read_b64_tr_b16 v[242:243], v22 offset:10240
  v_mfma_f32_16x16x32_bf16 v[120:123], v[252:255], v[196:199], v[120:123]
  ds_read_b64_tr_b16 v[244:245], v22 offset:12288
  v_mfma_f32_16x16x32_bf16 v[120:123], v[248:251], v[192:195], v[120:123]
  ds_read_b64_tr_b16 v[246:247], v22 offset:14336
  s_waitcnt vmcnt(32)
  s_waitcnt lgkmcnt(8)
  v_mfma_f32_16x16x32_bf16 v[96:99], v[224:227], v[208:211], v[96:99]
  ds_read_b64_tr_b16 v[248:249], v23 offset:8192
  v_mfma_f32_16x16x32_bf16 v[96:99], v[228:231], v[212:215], v[96:99]
  ds_read_b64_tr_b16 v[250:251], v23 offset:10240
  s_add_u32 s69, s19, 12288
  buffer_load_dwordx4 v[176:179], v10, s[64:67], s69 offen offset:0 sc1
  v_mfma_f32_16x16x32_bf16 v[100:103], v[228:231], v[220:223], v[100:103]
  ds_read_b64_tr_b16 v[252:253], v23 offset:12288
  v_mfma_f32_16x16x32_bf16 v[100:103], v[224:227], v[216:219], v[100:103]
  ds_read_b64_tr_b16 v[254:255], v23 offset:14336
  buffer_load_dwordx4 v[180:183], v10, s[64:67], s69 offen offset:1024 sc1
  s_waitcnt lgkmcnt(8)
  v_mfma_f32_16x16x32_bf16 v[108:111], v[232:235], v[216:219], v[108:111]
  ds_read_b64_tr_b16 v[224:225], v20 offset:16384
  v_mfma_f32_16x16x32_bf16 v[108:111], v[236:239], v[220:223], v[108:111]
  ds_read_b64_tr_b16 v[226:227], v20 offset:18432
  buffer_load_dwordx4 v[184:187], v11, s[64:67], s69 offen offset:0 sc1
  v_mfma_f32_16x16x32_bf16 v[104:107], v[236:239], v[212:215], v[104:107]
  ds_read_b64_tr_b16 v[228:229], v20 offset:20480
  v_mfma_f32_16x16x32_bf16 v[104:107], v[232:235], v[208:211], v[104:107]
  ds_read_b64_tr_b16 v[230:231], v20 offset:22528
  buffer_load_dwordx4 v[188:191], v11, s[64:67], s69 offen offset:1024 sc1
  s_waitcnt lgkmcnt(8)
  v_mfma_f32_16x16x32_bf16 v[112:115], v[240:243], v[208:211], v[112:115]
  ds_read_b64_tr_b16 v[232:233], v21 offset:16384
  v_mfma_f32_16x16x32_bf16 v[112:115], v[244:247], v[212:215], v[112:115]
  ds_read_b64_tr_b16 v[234:235], v21 offset:18432
  v_mfma_f32_16x16x32_bf16 v[116:119], v[244:247], v[220:223], v[116:119]
  ds_read_b64_tr_b16 v[236:237], v21 offset:20480
  v_mfma_f32_16x16x32_bf16 v[116:119], v[240:243], v[216:219], v[116:119]
  ds_read_b64_tr_b16 v[238:239], v21 offset:22528
  s_waitcnt lgkmcnt(8)
  v_mfma_f32_16x16x32_bf16 v[124:127], v[248:251], v[216:219], v[124:127]
  ds_read_b64_tr_b16 v[240:241], v22 offset:16384
  v_mfma_f32_16x16x32_bf16 v[124:127], v[252:255], v[220:223], v[124:127]
  ds_read_b64_tr_b16 v[242:243], v22 offset:18432
  v_mfma_f32_16x16x32_bf16 v[120:123], v[252:255], v[212:215], v[120:123]
  ds_read_b64_tr_b16 v[244:245], v22 offset:20480
  v_mfma_f32_16x16x32_bf16 v[120:123], v[248:251], v[208:211], v[120:123]
  ds_read_b64_tr_b16 v[246:247], v22 offset:22528
  s_waitcnt vmcnt(32)
  s_waitcnt lgkmcnt(8)
  v_mfma_f32_16x16x32_bf16 v[96:99], v[224:227], v[28:31], v[96:99]
  ds_read_b64_tr_b16 v[248:249], v23 offset:16384
  v_mfma_f32_16x16x32_bf16 v[96:99], v[228:231], v[32:35], v[96:99]
  ds_read_b64_tr_b16 v[250:251], v23 offset:18432
  s_add_u32 s69, s28, 57344
  buffer_load_dwordx4 v[192:195], v10, s[64:67], s69 offen offset:0 sc1
  v_mfma_f32_16x16x32_bf16 v[100:103], v[228:231], v[40:43], v[100:103]
  ds_read_b64_tr_b16 v[252:253], v23 offset:20480
  v_mfma_f32_16x16x32_bf16 v[100:103], v[224:227], v[36:39], v[100:103]
  ds_read_b64_tr_b16 v[254:255], v23 offset:22528
  buffer_load_dwordx4 v[196:199], v10, s[64:67], s69 offen offset:1024 sc1
  s_waitcnt lgkmcnt(8)
  v_mfma_f32_16x16x32_bf16 v[108:111], v[232:235], v[36:39], v[108:111]
  ds_read_b64_tr_b16 v[224:225], v20 offset:24576
  v_mfma_f32_16x16x32_bf16 v[108:111], v[236:239], v[40:43], v[108:111]
  ds_read_b64_tr_b16 v[226:227], v20 offset:26624
  buffer_load_dwordx4 v[200:203], v11, s[64:67], s69 offen offset:0 sc1
  v_mfma_f32_16x16x32_bf16 v[104:107], v[236:239], v[32:35], v[104:107]
  ds_read_b64_tr_b16 v[228:229], v20 offset:28672
  v_mfma_f32_16x16x32_bf16 v[104:107], v[232:235], v[28:31], v[104:107]
  ds_read_b64_tr_b16 v[230:231], v20 offset:30720
  buffer_load_dwordx4 v[204:207], v11, s[64:67], s69 offen offset:1024 sc1
  s_waitcnt vmcnt(24)
  s_barrier
  s_waitcnt lgkmcnt(8)
  v_mfma_f32_16x16x32_bf16 v[112:115], v[240:243], v[28:31], v[112:115]
  ds_read_b64_tr_b16 v[232:233], v21 offset:24576
  v_mfma_f32_16x16x32_bf16 v[112:115], v[244:247], v[32:35], v[112:115]
  ds_read_b64_tr_b16 v[234:235], v21 offset:26624
  s_add_u32 s11, s5, 15
  s_and_b32 s11, s11, 15
  s_lshl_b32 s11, s11, 14
  s_add_u32 m0, s10, 0
  s_add_u32 s12, s11, 27262976
  buffer_load_dwordx4 v14, s[64:67], s12 offen sc1 lds
  v_mfma_f32_16x16x32_bf16 v[116:119], v[244:247], v[40:43], v[116:119]
  ds_read_b64_tr_b16 v[236:237], v21 offset:28672
  v_mfma_f32_16x16x32_bf16 v[116:119], v[240:243], v[36:39], v[116:119]
  ds_read_b64_tr_b16 v[238:239], v21 offset:30720
  s_add_u32 m0, s10, 4096
  s_add_u32 s12, s11, 27267072
  buffer_load_dwordx4 v14, s[64:67], s12 offen sc1 lds
  s_waitcnt lgkmcnt(8)
  v_mfma_f32_16x16x32_bf16 v[124:127], v[248:251], v[36:39], v[124:127]
  ds_read_b64_tr_b16 v[240:241], v22 offset:24576
  v_mfma_f32_16x16x32_bf16 v[124:127], v[252:255], v[40:43], v[124:127]
  ds_read_b64_tr_b16 v[242:243], v22 offset:26624
  s_add_u32 m0, s10, 8192
  s_add_u32 s12, s11, 27271168
  buffer_load_dwordx4 v14, s[64:67], s12 offen sc1 lds
  v_mfma_f32_16x16x32_bf16 v[120:123], v[252:255], v[32:35], v[120:123]
  ds_read_b64_tr_b16 v[244:245], v22 offset:28672
  v_mfma_f32_16x16x32_bf16 v[120:123], v[248:251], v[28:31], v[120:123]
  ds_read_b64_tr_b16 v[246:247], v22 offset:30720
  s_add_u32 m0, s10, 12288
  s_add_u32 s12, s11, 27275264
  buffer_load_dwordx4 v14, s[64:67], s12 offen sc1 lds
  s_waitcnt lgkmcnt(8)
  v_mfma_f32_16x16x32_bf16 v[96:99], v[224:227], v[44:47], v[96:99]
  ds_read_b64_tr_b16 v[248:249], v23 offset:24576
  v_mfma_f32_16x16x32_bf16 v[96:99], v[228:231], v[48:51], v[96:99]
  ds_read_b64_tr_b16 v[250:251], v23 offset:26624
  s_add_u32 s69, s28, 59392
  buffer_load_dwordx4 v[208:211], v10, s[64:67], s69 offen offset:0 sc1
  v_mfma_f32_16x16x32_bf16 v[100:103], v[228:231], v[56:59], v[100:103]
  ds_read_b64_tr_b16 v[252:253], v23 offset:28672
  v_mfma_f32_16x16x32_bf16 v[100:103], v[224:227], v[52:55], v[100:103]
  ds_read_b64_tr_b16 v[254:255], v23 offset:30720
  buffer_load_dwordx4 v[212:215], v10, s[64:67], s69 offen offset:1024 sc1
  s_waitcnt lgkmcnt(8)
  v_mfma_f32_16x16x32_bf16 v[108:111], v[232:235], v[52:55], v[108:111]
  ds_read_b64_tr_b16 v[224:225], v20 offset:32768
  v_mfma_f32_16x16x32_bf16 v[108:111], v[236:239], v[56:59], v[108:111]
  ds_read_b64_tr_b16 v[226:227], v20 offset:34816
  buffer_load_dwordx4 v[216:219], v11, s[64:67], s69 offen offset:0 sc1
  v_mfma_f32_16x16x32_bf16 v[104:107], v[236:239], v[48:51], v[104:107]
  ds_read_b64_tr_b16 v[228:229], v20 offset:36864
  v_mfma_f32_16x16x32_bf16 v[104:107], v[232:235], v[44:47], v[104:107]
  ds_read_b64_tr_b16 v[230:231], v20 offset:38912
  buffer_load_dwordx4 v[220:223], v11, s[64:67], s69 offen offset:1024 sc1
  s_waitcnt lgkmcnt(8)
  v_mfma_f32_16x16x32_bf16 v[112:115], v[240:243], v[44:47], v[112:115]
  ds_read_b64_tr_b16 v[232:233], v21 offset:32768
  v_mfma_f32_16x16x32_bf16 v[112:115], v[244:247], v[48:51], v[112:115]
  ds_read_b64_tr_b16 v[234:235], v21 offset:34816
  s_add_u32 m0, s10, 81920
  s_mov_b32 s12, 3801088
  buffer_load_dwordx4 v15, s[52:55], s12 offen lds
  v_mfma_f32_16x16x32_bf16 v[116:119], v[244:247], v[56:59], v[116:119]
  ds_read_b64_tr_b16 v[236:237], v21 offset:36864
  v_mfma_f32_16x16x32_bf16 v[116:119], v[240:243], v[52:55], v[116:119]
  ds_read_b64_tr_b16 v[238:239], v21 offset:38912
  s_add_u32 m0, s10, 86016
  s_mov_b32 s12, 3866624
  buffer_load_dwordx4 v15, s[52:55], s12 offen lds
  s_waitcnt lgkmcnt(8)
  v_mfma_f32_16x16x32_bf16 v[124:127], v[248:251], v[52:55], v[124:127]
  ds_read_b64_tr_b16 v[240:241], v22 offset:32768
  v_mfma_f32_16x16x32_bf16 v[124:127], v[252:255], v[56:59], v[124:127]
  ds_read_b64_tr_b16 v[242:243], v22 offset:34816
  s_add_u32 m0, s10, 90112
  s_mov_b32 s12, 3670016
  buffer_load_dwordx4 v15, s[52:55], s12 offen lds
  v_mfma_f32_16x16x32_bf16 v[120:123], v[252:255], v[48:51], v[120:123]
  ds_read_b64_tr_b16 v[244:245], v22 offset:36864
  v_mfma_f32_16x16x32_bf16 v[120:123], v[248:251], v[44:47], v[120:123]
  ds_read_b64_tr_b16 v[246:247], v22 offset:38912
  s_add_u32 m0, s10, 94208
  s_mov_b32 s12, 3735552
  buffer_load_dwordx4 v15, s[52:55], s12 offen lds
  s_waitcnt lgkmcnt(8)
  v_mfma_f32_16x16x32_bf16 v[96:99], v[224:227], v[128:131], v[96:99]
  ds_read_b64_tr_b16 v[248:249], v23 offset:32768
  v_mfma_f32_16x16x32_bf16 v[96:99], v[228:231], v[132:135], v[96:99]
  ds_read_b64_tr_b16 v[250:251], v23 offset:34816
  s_add_u32 m0, s10, 98304
  s_add_u32 s12, s23, 786432
  buffer_load_dwordx4 v15, s[52:55], s12 offen lds
  v_mfma_f32_16x16x32_bf16 v[100:103], v[228:231], v[140:143], v[100:103]
  ds_read_b64_tr_b16 v[252:253], v23 offset:36864
  v_mfma_f32_16x16x32_bf16 v[100:103], v[224:227], v[136:139], v[100:103]
  ds_read_b64_tr_b16 v[254:255], v23 offset:38912
  s_add_u32 m0, s10, 102400
  s_add_u32 s12, s23, 851968
  buffer_load_dwordx4 v15, s[52:55], s12 offen lds
  s_waitcnt lgkmcnt(8)
  v_mfma_f32_16x16x32_bf16 v[108:111], v[232:235], v[136:139], v[108:111]
  ds_read_b64_tr_b16 v[224:225], v20 offset:40960
  v_mfma_f32_16x16x32_bf16 v[108:111], v[236:239], v[140:143], v[108:111]
  ds_read_b64_tr_b16 v[226:227], v20 offset:43008
  s_add_u32 m0, s10, 106496
  s_add_u32 s12, s23, 655360
  buffer_load_dwordx4 v15, s[52:55], s12 offen lds
  v_mfma_f32_16x16x32_bf16 v[104:107], v[236:239], v[132:135], v[104:107]
  ds_read_b64_tr_b16 v[228:229], v20 offset:45056
  v_mfma_f32_16x16x32_bf16 v[104:107], v[232:235], v[128:131], v[104:107]
  ds_read_b64_tr_b16 v[230:231], v20 offset:47104
  s_add_u32 m0, s10, 110592
  s_add_u32 s12, s23, 720896
  buffer_load_dwordx4 v15, s[52:55], s12 offen lds
  s_waitcnt lgkmcnt(8)
  v_mfma_f32_16x16x32_bf16 v[112:115], v[240:243], v[128:131], v[112:115]
  ds_read_b64_tr_b16 v[232:233], v21 offset:40960
  v_mfma_f32_16x16x32_bf16 v[112:115], v[244:247], v[132:135], v[112:115]
  ds_read_b64_tr_b16 v[234:235], v21 offset:43008
  s_add_u32 m0, s10, 114688
  s_add_u32 s12, s23, 524288
  buffer_load_dwordx4 v15, s[52:55], s12 offen lds
  v_mfma_f32_16x16x32_bf16 v[116:119], v[244:247], v[140:143], v[116:119]
  ds_read_b64_tr_b16 v[236:237], v21 offset:45056
  v_mfma_f32_16x16x32_bf16 v[116:119], v[240:243], v[136:139], v[116:119]
  ds_read_b64_tr_b16 v[238:239], v21 offset:47104
  s_add_u32 m0, s10, 118784
  s_add_u32 s12, s23, 589824
  buffer_load_dwordx4 v15, s[52:55], s12 offen lds
  s_waitcnt lgkmcnt(8)
  v_mfma_f32_16x16x32_bf16 v[124:127], v[248:251], v[136:139], v[124:127]
  ds_read_b64_tr_b16 v[240:241], v22 offset:40960
  v_mfma_f32_16x16x32_bf16 v[124:127], v[252:255], v[140:143], v[124:127]
  ds_read_b64_tr_b16 v[242:243], v22 offset:43008
  s_add_u32 m0, s10, 122880
  s_add_u32 s12, s23, 393216
  buffer_load_dwordx4 v15, s[52:55], s12 offen lds
  v_mfma_f32_16x16x32_bf16 v[120:123], v[252:255], v[132:135], v[120:123]
  ds_read_b64_tr_b16 v[244:245], v22 offset:45056
  v_mfma_f32_16x16x32_bf16 v[120:123], v[248:251], v[128:131], v[120:123]
  ds_read_b64_tr_b16 v[246:247], v22 offset:47104
  s_add_u32 m0, s10, 126976
  s_add_u32 s12, s23, 458752
  buffer_load_dwordx4 v15, s[52:55], s12 offen lds
  s_waitcnt vmcnt(38)
  s_waitcnt lgkmcnt(8)
  v_mfma_f32_16x16x32_bf16 v[96:99], v[224:227], v[144:147], v[96:99]
  ds_read_b64_tr_b16 v[248:249], v23 offset:40960
  v_mfma_f32_16x16x32_bf16 v[96:99], v[228:231], v[148:151], v[96:99]
  ds_read_b64_tr_b16 v[250:251], v23 offset:43008
  v_mfma_f32_16x16x32_bf16 v[100:103], v[228:231], v[156:159], v[100:103]
  ds_read_b64_tr_b16 v[252:253], v23 offset:45056
  v_mfma_f32_16x16x32_bf16 v[100:103], v[224:227], v[152:155], v[100:103]
  ds_read_b64_tr_b16 v[254:255], v23 offset:47104
  s_waitcnt lgkmcnt(8)
  v_mfma_f32_16x16x32_bf16 v[108:111], v[232:235], v[152:155], v[108:111]
  ds_read_b64_tr_b16 v[224:225], v16 offset:0
  v_mfma_f32_16x16x32_bf16 v[108:111], v[236:239], v[156:159], v[108:111]
  ds_read_b64_tr_b16 v[226:227], v16 offset:2048
  v_mfma_f32_16x16x32_bf16 v[104:107], v[236:239], v[148:151], v[104:107]
  ds_read_b64_tr_b16 v[228:229], v16 offset:4096
  v_mfma_f32_16x16x32_bf16 v[104:107], v[232:235], v[144:147], v[104:107]
  ds_read_b64_tr_b16 v[230:231], v16 offset:6144
  s_waitcnt lgkmcnt(8)
  v_mfma_f32_16x16x32_bf16 v[112:115], v[240:243], v[144:147], v[112:115]
  ds_read_b64_tr_b16 v[232:233], v17 offset:0
  v_mfma_f32_16x16x32_bf16 v[112:115], v[244:247], v[148:151], v[112:115]
  ds_read_b64_tr_b16 v[234:235], v17 offset:2048
  v_mfma_f32_16x16x32_bf16 v[116:119], v[244:247], v[156:159], v[116:119]
  ds_read_b64_tr_b16 v[236:237], v17 offset:4096
  v_mfma_f32_16x16x32_bf16 v[116:119], v[240:243], v[152:155], v[116:119]
  ds_read_b64_tr_b16 v[238:239], v17 offset:6144
  s_waitcnt lgkmcnt(8)
  v_mfma_f32_16x16x32_bf16 v[124:127], v[248:251], v[152:155], v[124:127]
  ds_read_b64_tr_b16 v[240:241], v18 offset:0
  v_mfma_f32_16x16x32_bf16 v[124:127], v[252:255], v[156:159], v[124:127]
  ds_read_b64_tr_b16 v[242:243], v18 offset:2048
  v_mfma_f32_16x16x32_bf16 v[120:123], v[252:255], v[148:151], v[120:123]
  ds_read_b64_tr_b16 v[244:245], v18 offset:4096
  v_mfma_f32_16x16x32_bf16 v[120:123], v[248:251], v[144:147], v[120:123]
  ds_read_b64_tr_b16 v[246:247], v18 offset:6144
  s_waitcnt vmcnt(28)
  s_barrier
  s_waitcnt lgkmcnt(8)
  v_mfma_f32_16x16x32_bf16 v[96:99], v[224:227], v[160:163], v[96:99]
  ds_read_b64_tr_b16 v[248:249], v19 offset:0
  v_mfma_f32_16x16x32_bf16 v[96:99], v[228:231], v[164:167], v[96:99]
  ds_read_b64_tr_b16 v[250:251], v19 offset:2048
  s_add_u32 m0, s10, 131072
  s_add_u32 s12, s23, 262144
  buffer_load_dwordx4 v15, s[52:55], s12 offen lds
  v_mfma_f32_16x16x32_bf16 v[100:103], v[228:231], v[172:175], v[100:103]
  ds_read_b64_tr_b16 v[252:253], v19 offset:4096
  v_mfma_f32_16x16x32_bf16 v[100:103], v[224:227], v[168:171], v[100:103]
  ds_read_b64_tr_b16 v[254:255], v19 offset:6144
  s_add_u32 m0, s10, 135168
  s_add_u32 s12, s23, 327680
  buffer_load_dwordx4 v15, s[52:55], s12 offen lds
  s_waitcnt lgkmcnt(8)
  v_mfma_f32_16x16x32_bf16 v[108:111], v[232:235], v[168:171], v[108:111]
  ds_read_b64_tr_b16 v[224:225], v16 offset:8192
  v_mfma_f32_16x16x32_bf16 v[108:111], v[236:239], v[172:175], v[108:111]
  ds_read_b64_tr_b16 v[226:227], v16 offset:10240
  s_add_u32 m0, s10, 139264
  s_add_u32 s12, s23, 131072
  buffer_load_dwordx4 v15, s[52:55], s12 offen lds
  v_mfma_f32_16x16x32_bf16 v[104:107], v[236:239], v[164:167], v[104:107]
  ds_read_b64_tr_b16 v[228:229], v16 offset:12288
  v_mfma_f32_16x16x32_bf16 v[104:107], v[232:235], v[160:163], v[104:107]
  ds_read_b64_tr_b16 v[230:231], v16 offset:14336
  s_add_u32 m0, s10, 143360
  s_add_u32 s12, s23, 196608
  buffer_load_dwordx4 v15, s[52:55], s12 offen lds
  s_waitcnt lgkmcnt(8)
  v_mfma_f32_16x16x32_bf16 v[112:115], v[240:243], v[160:163], v[112:115]
  ds_read_b64_tr_b16 v[232:233], v17 offset:8192
  v_mfma_f32_16x16x32_bf16 v[112:115], v[244:247], v[164:167], v[112:115]
  ds_read_b64_tr_b16 v[234:235], v17 offset:10240
  s_add_u32 m0, s10, 147456
  s_add_u32 s12, s23, 0
  buffer_load_dwordx4 v15, s[52:55], s12 offen lds
  v_mfma_f32_16x16x32_bf16 v[116:119], v[244:247], v[172:175], v[116:119]
  ds_read_b64_tr_b16 v[236:237], v17 offset:12288
  v_mfma_f32_16x16x32_bf16 v[116:119], v[240:243], v[168:171], v[116:119]
  ds_read_b64_tr_b16 v[238:239], v17 offset:14336
  s_add_u32 m0, s10, 151552
  s_add_u32 s12, s23, 65536
  buffer_load_dwordx4 v15, s[52:55], s12 offen lds
  s_waitcnt lgkmcnt(8)
  v_mfma_f32_16x16x32_bf16 v[124:127], v[248:251], v[168:171], v[124:127]
  ds_read_b64_tr_b16 v[240:241], v18 offset:8192
  v_mfma_f32_16x16x32_bf16 v[124:127], v[252:255], v[172:175], v[124:127]
  ds_read_b64_tr_b16 v[242:243], v18 offset:10240
  s_add_u32 m0, s10, 155648
  s_add_u32 s12, s22, 786432
  buffer_load_dwordx4 v15, s[52:55], s12 offen lds
  v_mfma_f32_16x16x32_bf16 v[120:123], v[252:255], v[164:167], v[120:123]
  ds_read_b64_tr_b16 v[244:245], v18 offset:12288
  v_mfma_f32_16x16x32_bf16 v[120:123], v[248:251], v[160:163], v[120:123]
  ds_read_b64_tr_b16 v[246:247], v18 offset:14336
  s_add_u32 m0, s10, 159744
  s_add_u32 s12, s22, 851968
  buffer_load_dwordx4 v15, s[52:55], s12 offen lds
  s_waitcnt vmcnt(32)
  s_waitcnt lgkmcnt(8)
  v_mfma_f32_16x16x32_bf16 v[96:99], v[224:227], v[176:179], v[96:99]
  ds_read_b64_tr_b16 v[248:249], v19 offset:8192
  v_mfma_f32_16x16x32_bf16 v[96:99], v[228:231], v[180:183], v[96:99]
  ds_read_b64_tr_b16 v[250:251], v19 offset:10240
  v_mfma_f32_16x16x32_bf16 v[100:103], v[228:231], v[188:191], v[100:103]
  ds_read_b64_tr_b16 v[252:253], v19 offset:12288
  v_mfma_f32_16x16x32_bf16 v[100:103], v[224:227], v[184:187], v[100:103]
  ds_read_b64_tr_b16 v[254:255], v19 offset:14336
  s_waitcnt lgkmcnt(8)
  v_mfma_f32_16x16x32_bf16 v[108:111], v[232:235], v[184:187], v[108:111]
  ds_read_b64_tr_b16 v[224:225], v16 offset:16384
  v_mfma_f32_16x16x32_bf16 v[108:111], v[236:239], v[188:191], v[108:111]
  ds_read_b64_tr_b16 v[226:227], v16 offset:18432
  v_mfma_f32_16x16x32_bf16 v[104:107], v[236:239], v[180:183], v[104:107]
  ds_read_b64_tr_b16 v[228:229], v16 offset:20480
  v_mfma_f32_16x16x32_bf16 v[104:107], v[232:235], v[176:179], v[104:107]
  ds_read_b64_tr_b16 v[230:231], v16 offset:22528
  s_waitcnt lgkmcnt(8)
  v_mfma_f32_16x16x32_bf16 v[112:115], v[240:243], v[176:179], v[112:115]
  ds_read_b64_tr_b16 v[232:233], v17 offset:16384
  v_mfma_f32_16x16x32_bf16 v[112:115], v[244:247], v[180:183], v[112:115]
  ds_read_b64_tr_b16 v[234:235], v17 offset:18432
  v_mfma_f32_16x16x32_bf16 v[116:119], v[244:247], v[188:191], v[116:119]
  ds_read_b64_tr_b16 v[236:237], v17 offset:20480
  v_mfma_f32_16x16x32_bf16 v[116:119], v[240:243], v[184:187], v[116:119]
  ds_read_b64_tr_b16 v[238:239], v17 offset:22528
  s_waitcnt lgkmcnt(8)
  v_mfma_f32_16x16x32_bf16 v[124:127], v[248:251], v[184:187], v[124:127]
  ds_read_b64_tr_b16 v[240:241], v18 offset:16384
  v_mfma_f32_16x16x32_bf16 v[124:127], v[252:255], v[188:191], v[124:127]
  ds_read_b64_tr_b16 v[242:243], v18 offset:18432
  v_mfma_f32_16x16x32_bf16 v[120:123], v[252:255], v[180:183], v[120:123]
  ds_read_b64_tr_b16 v[244:245], v18 offset:20480
  v_mfma_f32_16x16x32_bf16 v[120:123], v[248:251], v[176:179], v[120:123]
  ds_read_b64_tr_b16 v[246:247], v18 offset:22528
  s_waitcnt vmcnt(28)
  s_waitcnt lgkmcnt(8)
  v_mfma_f32_16x16x32_bf16 v[96:99], v[224:227], v[192:195], v[96:99]
  ds_read_b64_tr_b16 v[248:249], v19 offset:16384
  v_mfma_f32_16x16x32_bf16 v[96:99], v[228:231], v[196:199], v[96:99]
  ds_read_b64_tr_b16 v[250:251], v19 offset:18432
  v_mfma_f32_16x16x32_bf16 v[100:103], v[228:231], v[204:207], v[100:103]
  ds_read_b64_tr_b16 v[252:253], v19 offset:20480
  v_mfma_f32_16x16x32_bf16 v[100:103], v[224:227], v[200:203], v[100:103]
  ds_read_b64_tr_b16 v[254:255], v19 offset:22528
  s_waitcnt lgkmcnt(8)
  v_mfma_f32_16x16x32_bf16 v[108:111], v[232:235], v[200:203], v[108:111]
  ds_read_b64_tr_b16 v[224:225], v16 offset:24576
  v_mfma_f32_16x16x32_bf16 v[108:111], v[236:239], v[204:207], v[108:111]
  ds_read_b64_tr_b16 v[226:227], v16 offset:26624
  v_mfma_f32_16x16x32_bf16 v[104:107], v[236:239], v[196:199], v[104:107]
  ds_read_b64_tr_b16 v[228:229], v16 offset:28672
  v_mfma_f32_16x16x32_bf16 v[104:107], v[232:235], v[192:195], v[104:107]
  ds_read_b64_tr_b16 v[230:231], v16 offset:30720
  s_waitcnt vmcnt(12)
  s_barrier
  s_waitcnt lgkmcnt(8)
  v_mfma_f32_16x16x32_bf16 v[112:115], v[240:243], v[192:195], v[112:115]
  ds_read_b64_tr_b16 v[232:233], v17 offset:24576
  v_mfma_f32_16x16x32_bf16 v[112:115], v[244:247], v[196:199], v[112:115]
  ds_read_b64_tr_b16 v[234:235], v17 offset:26624
  s_add_u32 m0, s10, 49152
  s_mov_b32 s12, 786432
  buffer_load_dwordx4 v15, s[48:51], s12 offen lds
  v_mfma_f32_16x16x32_bf16 v[116:119], v[244:247], v[204:207], v[116:119]
  ds_read_b64_tr_b16 v[236:237], v17 offset:28672
  v_mfma_f32_16x16x32_bf16 v[116:119], v[240:243], v[200:203], v[116:119]
  ds_read_b64_tr_b16 v[238:239], v17 offset:30720
  s_add_u32 m0, s10, 53248
  s_mov_b32 s12, 851968
  buffer_load_dwordx4 v15, s[48:51], s12 offen lds
  s_waitcnt lgkmcnt(8)
  v_mfma_f32_16x16x32_bf16 v[124:127], v[248:251], v[200:203], v[124:127]
  ds_read_b64_tr_b16 v[240:241], v18 offset:24576
  v_mfma_f32_16x16x32_bf16 v[124:127], v[252:255], v[204:207], v[124:127]
  ds_read_b64_tr_b16 v[242:243], v18 offset:26624
  s_add_u32 m0, s10, 57344
  s_mov_b32 s12, 917504
  buffer_load_dwordx4 v15, s[48:51], s12 offen lds
  v_mfma_f32_16x16x32_bf16 v[120:123], v[252:255], v[196:199], v[120:123]
  ds_read_b64_tr_b16 v[244:245], v18 offset:28672
  v_mfma_f32_16x16x32_bf16 v[120:123], v[248:251], v[192:195], v[120:123]
  ds_read_b64_tr_b16 v[246:247], v18 offset:30720
  s_add_u32 m0, s10, 61440
  s_mov_b32 s12, 983040
  buffer_load_dwordx4 v15, s[48:51], s12 offen lds
  s_waitcnt lgkmcnt(8)
  v_mfma_f32_16x16x32_bf16 v[96:99], v[224:227], v[208:211], v[96:99]
  ds_read_b64_tr_b16 v[248:249], v19 offset:24576
  v_mfma_f32_16x16x32_bf16 v[96:99], v[228:231], v[212:215], v[96:99]
  ds_read_b64_tr_b16 v[250:251], v19 offset:26624
  v_mfma_f32_16x16x32_bf16 v[100:103], v[228:231], v[220:223], v[100:103]
  ds_read_b64_tr_b16 v[252:253], v19 offset:28672
  v_mfma_f32_16x16x32_bf16 v[100:103], v[224:227], v[216:219], v[100:103]
  ds_read_b64_tr_b16 v[254:255], v19 offset:30720
  s_waitcnt lgkmcnt(8)
  v_mfma_f32_16x16x32_bf16 v[108:111], v[232:235], v[216:219], v[108:111]
  ds_read_b64_tr_b16 v[224:225], v16 offset:32768
  v_mfma_f32_16x16x32_bf16 v[108:111], v[236:239], v[220:223], v[108:111]
  ds_read_b64_tr_b16 v[226:227], v16 offset:34816
  v_mfma_f32_16x16x32_bf16 v[104:107], v[236:239], v[212:215], v[104:107]
  ds_read_b64_tr_b16 v[228:229], v16 offset:36864
  v_mfma_f32_16x16x32_bf16 v[104:107], v[232:235], v[208:211], v[104:107]
  ds_read_b64_tr_b16 v[230:231], v16 offset:38912
  s_waitcnt lgkmcnt(8)
  v_mfma_f32_16x16x32_bf16 v[112:115], v[240:243], v[208:211], v[112:115]
  ds_read_b64_tr_b16 v[232:233], v17 offset:32768
  v_mfma_f32_16x16x32_bf16 v[112:115], v[244:247], v[212:215], v[112:115]
  ds_read_b64_tr_b16 v[234:235], v17 offset:34816
  v_mfma_f32_16x16x32_bf16 v[116:119], v[244:247], v[220:223], v[116:119]
  ds_read_b64_tr_b16 v[236:237], v17 offset:36864
  v_mfma_f32_16x16x32_bf16 v[116:119], v[240:243], v[216:219], v[116:119]
  ds_read_b64_tr_b16 v[238:239], v17 offset:38912
  s_waitcnt lgkmcnt(8)
  v_mfma_f32_16x16x32_bf16 v[124:127], v[248:251], v[216:219], v[124:127]
  ds_read_b64_tr_b16 v[240:241], v18 offset:32768
  v_mfma_f32_16x16x32_bf16 v[124:127], v[252:255], v[220:223], v[124:127]
  ds_read_b64_tr_b16 v[242:243], v18 offset:34816
  v_mfma_f32_16x16x32_bf16 v[120:123], v[252:255], v[212:215], v[120:123]
  ds_read_b64_tr_b16 v[244:245], v18 offset:36864
  v_mfma_f32_16x16x32_bf16 v[120:123], v[248:251], v[208:211], v[120:123]
  ds_read_b64_tr_b16 v[246:247], v18 offset:38912
  s_waitcnt lgkmcnt(8)
  v_mfma_f32_16x16x32_bf16 v[64:67], v[224:227], v[208:211], v[64:67]
  ds_read_b64_tr_b16 v[248:249], v19 offset:32768
  v_mfma_f32_16x16x32_bf16 v[64:67], v[228:231], v[212:215], v[64:67]
  ds_read_b64_tr_b16 v[250:251], v19 offset:34816
  v_mfma_f32_16x16x32_bf16 v[68:71], v[228:231], v[220:223], v[68:71]
  ds_read_b64_tr_b16 v[252:253], v19 offset:36864
  v_mfma_f32_16x16x32_bf16 v[68:71], v[224:227], v[216:219], v[68:71]
  ds_read_b64_tr_b16 v[254:255], v19 offset:38912
  s_waitcnt lgkmcnt(8)
  v_mfma_f32_16x16x32_bf16 v[76:79], v[232:235], v[216:219], v[76:79]
  ds_read_b64_tr_b16 v[224:225], v16 offset:40960
  v_mfma_f32_16x16x32_bf16 v[76:79], v[236:239], v[220:223], v[76:79]
  ds_read_b64_tr_b16 v[226:227], v16 offset:43008
  v_mfma_f32_16x16x32_bf16 v[72:75], v[236:239], v[212:215], v[72:75]
  ds_read_b64_tr_b16 v[228:229], v16 offset:45056
  v_mfma_f32_16x16x32_bf16 v[72:75], v[232:235], v[208:211], v[72:75]
  ds_read_b64_tr_b16 v[230:231], v16 offset:47104
  s_waitcnt lgkmcnt(8)
  v_mfma_f32_16x16x32_bf16 v[80:83], v[240:243], v[208:211], v[80:83]
  ds_read_b64_tr_b16 v[232:233], v17 offset:40960
  v_mfma_f32_16x16x32_bf16 v[80:83], v[244:247], v[212:215], v[80:83]
  ds_read_b64_tr_b16 v[234:235], v17 offset:43008
  v_cvt_pk_bf16_f32 v96, v96, v97
  v_cvt_pk_bf16_f32 v97, v98, v99
  v_cvt_pk_bf16_f32 v98, v100, v101
  v_cvt_pk_bf16_f32 v99, v102, v103
  buffer_store_dwordx4 v[96:99], v10, s[64:67], s71 offen offset:0 sc1
  v_mfma_f32_16x16x32_bf16 v[84:87], v[244:247], v[220:223], v[84:87]
  ds_read_b64_tr_b16 v[236:237], v17 offset:45056
  v_mfma_f32_16x16x32_bf16 v[84:87], v[240:243], v[216:219], v[84:87]
  ds_read_b64_tr_b16 v[238:239], v17 offset:47104
  s_waitcnt lgkmcnt(8)
  v_mfma_f32_16x16x32_bf16 v[92:95], v[248:251], v[216:219], v[92:95]
  ds_read_b64_tr_b16 v[240:241], v18 offset:40960
  v_mfma_f32_16x16x32_bf16 v[92:95], v[252:255], v[220:223], v[92:95]
  ds_read_b64_tr_b16 v[242:243], v18 offset:43008
  v_cvt_pk_bf16_f32 v104, v104, v105
  v_cvt_pk_bf16_f32 v105, v106, v107
  v_cvt_pk_bf16_f32 v106, v108, v109
  v_cvt_pk_bf16_f32 v107, v110, v111
  buffer_store_dwordx4 v[104:107], v10, s[64:67], s71 offen offset:1024 sc1
  v_mfma_f32_16x16x32_bf16 v[88:91], v[252:255], v[212:215], v[88:91]
  ds_read_b64_tr_b16 v[244:245], v18 offset:45056
  v_mfma_f32_16x16x32_bf16 v[88:91], v[248:251], v[208:211], v[88:91]
  ds_read_b64_tr_b16 v[246:247], v18 offset:47104
  s_waitcnt lgkmcnt(8)
  v_mfma_f32_16x16x32_bf16 v[64:67], v[224:227], v[192:195], v[64:67]
  ds_read_b64_tr_b16 v[248:249], v19 offset:40960
  v_mfma_f32_16x16x32_bf16 v[64:67], v[228:231], v[196:199], v[64:67]
  ds_read_b64_tr_b16 v[250:251], v19 offset:43008
  v_cvt_pk_bf16_f32 v112, v112, v113
  v_cvt_pk_bf16_f32 v113, v114, v115
  v_cvt_pk_bf16_f32 v114, v116, v117
  v_cvt_pk_bf16_f32 v115, v118, v119
  buffer_store_dwordx4 v[112:115], v10, s[64:67], s71 offen offset:2048 sc1
  v_mfma_f32_16x16x32_bf16 v[68:71], v[228:231], v[204:207], v[68:71]
  ds_read_b64_tr_b16 v[252:253], v19 offset:45056
  v_mfma_f32_16x16x32_bf16 v[68:71], v[224:227], v[200:203], v[68:71]
  ds_read_b64_tr_b16 v[254:255], v19 offset:47104
  s_waitcnt lgkmcnt(8)
  v_mfma_f32_16x16x32_bf16 v[76:79], v[232:235], v[200:203], v[76:79]
  ds_read_b64_tr_b16 v[224:225], v16 offset:49152
  v_mfma_f32_16x16x32_bf16 v[76:79], v[236:239], v[204:207], v[76:79]
  ds_read_b64_tr_b16 v[226:227], v16 offset:51200
  v_cvt_pk_bf16_f32 v120, v120, v121
  v_cvt_pk_bf16_f32 v121, v122, v123
  v_cvt_pk_bf16_f32 v122, v124, v125
  v_cvt_pk_bf16_f32 v123, v126, v127
  buffer_store_dwordx4 v[120:123], v10, s[64:67], s71 offen offset:3072 sc1
  v_mfma_f32_16x16x32_bf16 v[72:75], v[236:239], v[196:199], v[72:75]
  ds_read_b64_tr_b16 v[228:229], v16 offset:53248
  v_mfma_f32_16x16x32_bf16 v[72:75], v[232:235], v[192:195], v[72:75]
  ds_read_b64_tr_b16 v[230:231], v16 offset:55296
  s_waitcnt lgkmcnt(8)
  v_mfma_f32_16x16x32_bf16 v[80:83], v[240:243], v[192:195], v[80:83]
  ds_read_b64_tr_b16 v[232:233], v17 offset:49152
  v_mfma_f32_16x16x32_bf16 v[80:83], v[244:247], v[196:199], v[80:83]
  ds_read_b64_tr_b16 v[234:235], v17 offset:51200
  v_mfma_f32_16x16x32_bf16 v[84:87], v[244:247], v[204:207], v[84:87]
  ds_read_b64_tr_b16 v[236:237], v17 offset:53248
  v_mfma_f32_16x16x32_bf16 v[84:87], v[240:243], v[200:203], v[84:87]
  ds_read_b64_tr_b16 v[238:239], v17 offset:55296
  s_waitcnt lgkmcnt(8)
  v_mfma_f32_16x16x32_bf16 v[92:95], v[248:251], v[200:203], v[92:95]
  ds_read_b64_tr_b16 v[240:241], v18 offset:49152
  v_mfma_f32_16x16x32_bf16 v[92:95], v[252:255], v[204:207], v[92:95]
  ds_read_b64_tr_b16 v[242:243], v18 offset:51200
  v_mfma_f32_16x16x32_bf16 v[88:91], v[252:255], v[196:199], v[88:91]
  ds_read_b64_tr_b16 v[244:245], v18 offset:53248
  v_mfma_f32_16x16x32_bf16 v[88:91], v[248:251], v[192:195], v[88:91]
  ds_read_b64_tr_b16 v[246:247], v18 offset:55296
  s_waitcnt lgkmcnt(8)
  v_mfma_f32_16x16x32_bf16 v[64:67], v[224:227], v[176:179], v[64:67]
  ds_read_b64_tr_b16 v[248:249], v19 offset:49152
  v_mfma_f32_16x16x32_bf16 v[64:67], v[228:231], v[180:183], v[64:67]
  ds_read_b64_tr_b16 v[250:251], v19 offset:51200
  s_add_u32 s69, s19, 0
  buffer_load_dwordx4 v[208:211], v10, s[64:67], s69 offen offset:0 sc1
  v_mfma_f32_16x16x32_bf16 v[68:71], v[228:231], v[188:191], v[68:71]
  ds_read_b64_tr_b16 v[252:253], v19 offset:53248
  v_mfma_f32_16x16x32_bf16 v[68:71], v[224:227], v[184:187], v[68:71]
  ds_read_b64_tr_b16 v[254:255], v19 offset:55296
  buffer_load_dwordx4 v[212:215], v10, s[64:67], s69 offen offset:1024 sc1
  s_waitcnt lgkmcnt(8)
  v_mfma_f32_16x16x32_bf16 v[76:79], v[232:235], v[184:187], v[76:79]
  ds_read_b64_tr_b16 v[224:225], v16 offset:57344
  v_mfma_f32_16x16x32_bf16 v[76:79], v[236:239], v[188:191], v[76:79]
  ds_read_b64_tr_b16 v[226:227], v16 offset:59392
  buffer_load_dwordx4 v[216:219], v11, s[64:67], s69 offen offset:0 sc1
  v_mfma_f32_16x16x32_bf16 v[72:75], v[236:239], v[180:183], v[72:75]
  ds_read_b64_tr_b16 v[228:229], v16 offset:61440
  v_mfma_f32_16x16x32_bf16 v[72:75], v[232:235], v[176:179], v[72:75]
  ds_read_b64_tr_b16 v[230:231], v16 offset:63488
  buffer_load_dwordx4 v[220:223], v11, s[64:67], s69 offen offset:1024 sc1
  s_waitcnt lgkmcnt(8)
  v_mfma_f32_16x16x32_bf16 v[80:83], v[240:243], v[176:179], v[80:83]
  ds_read_b64_tr_b16 v[232:233], v17 offset:57344
  v_mfma_f32_16x16x32_bf16 v[80:83], v[244:247], v[180:183], v[80:83]
  ds_read_b64_tr_b16 v[234:235], v17 offset:59392
  v_mfma_f32_16x16x32_bf16 v[84:87], v[244:247], v[188:191], v[84:87]
  ds_read_b64_tr_b16 v[236:237], v17 offset:61440
  v_mfma_f32_16x16x32_bf16 v[84:87], v[240:243], v[184:187], v[84:87]
  ds_read_b64_tr_b16 v[238:239], v17 offset:63488
  s_waitcnt lgkmcnt(8)
  v_mfma_f32_16x16x32_bf16 v[92:95], v[248:251], v[184:187], v[92:95]
  ds_read_b64_tr_b16 v[240:241], v18 offset:57344
  v_mfma_f32_16x16x32_bf16 v[92:95], v[252:255], v[188:191], v[92:95]
  ds_read_b64_tr_b16 v[242:243], v18 offset:59392
  v_mfma_f32_16x16x32_bf16 v[88:91], v[252:255], v[180:183], v[88:91]
  ds_read_b64_tr_b16 v[244:245], v18 offset:61440
  v_mfma_f32_16x16x32_bf16 v[88:91], v[248:251], v[176:179], v[88:91]
  ds_read_b64_tr_b16 v[246:247], v18 offset:63488
  s_waitcnt lgkmcnt(8)
  v_mfma_f32_16x16x32_bf16 v[64:67], v[224:227], v[160:163], v[64:67]
  ds_read_b64_tr_b16 v[248:249], v19 offset:57344
  v_mfma_f32_16x16x32_bf16 v[64:67], v[228:231], v[164:167], v[64:67]
  ds_read_b64_tr_b16 v[250:251], v19 offset:59392
  s_add_u32 s69, s18, 12288
  buffer_load_dwordx4 v[192:195], v10, s[64:67], s69 offen offset:0 sc1
  v_mfma_f32_16x16x32_bf16 v[68:71], v[228:231], v[172:175], v[68:71]
  ds_read_b64_tr_b16 v[252:253], v19 offset:61440
  v_mfma_f32_16x16x32_bf16 v[68:71], v[224:227], v[168:171], v[68:71]
  ds_read_b64_tr_b16 v[254:255], v19 offset:63488
  buffer_load_dwordx4 v[196:199], v10, s[64:67], s69 offen offset:1024 sc1
  s_waitcnt vmcnt(18)
  s_barrier
  s_waitcnt lgkmcnt(8)
  v_mfma_f32_16x16x32_bf16 v[76:79], v[232:235], v[168:171], v[76:79]
  ds_read_b64_tr_b16 v[224:225], v20 offset:0
  v_mfma_f32_16x16x32_bf16 v[76:79], v[236:239], v[172:175], v[76:79]
  ds_read_b64_tr_b16 v[226:227], v20 offset:2048
  buffer_load_dwordx4 v[200:203], v11, s[64:67], s69 offen offset:0 sc1
  v_mfma_f32_16x16x32_bf16 v[72:75], v[236:239], v[164:167], v[72:75]
  ds_read_b64_tr_b16 v[228:229], v20 offset:4096
  v_mfma_f32_16x16x32_bf16 v[72:75], v[232:235], v[160:163], v[72:75]
  ds_read_b64_tr_b16 v[230:231], v20 offset:6144
  buffer_load_dwordx4 v[204:207], v11, s[64:67], s69 offen offset:1024 sc1
  s_waitcnt vmcnt(8)
  s_mov_b64 exec, 1
  v_mov_b32 v2, 0
  v_mov_b32 v3, 1
  buffer_store_dword v3, v2, s[64:67], s72 offen offset:8 sc1
  s_mov_b64 exec, -1
  s_nop 3
  s_waitcnt lgkmcnt(8)
  v_mfma_f32_16x16x32_bf16 v[80:83], v[240:243], v[160:163], v[80:83]
  ds_read_b64_tr_b16 v[232:233], v21 offset:0
  v_mfma_f32_16x16x32_bf16 v[80:83], v[244:247], v[164:167], v[80:83]
  ds_read_b64_tr_b16 v[234:235], v21 offset:2048
  s_add_u32 m0, s10, 32768
  s_mov_b32 s12, 524288
  buffer_load_dwordx4 v15, s[48:51], s12 offen lds
  v_mfma_f32_16x16x32_bf16 v[84:87], v[244:247], v[172:175], v[84:87]
  ds_read_b64_tr_b16 v[236:237], v21 offset:4096
  v_mfma_f32_16x16x32_bf16 v[84:87], v[240:243], v[168:171], v[84:87]
  ds_read_b64_tr_b16 v[238:239], v21 offset:6144
  s_add_u32 m0, s10, 36864
  s_mov_b32 s12, 589824
  buffer_load_dwordx4 v15, s[48:51], s12 offen lds
  s_waitcnt lgkmcnt(8)
  v_mfma_f32_16x16x32_bf16 v[92:95], v[248:251], v[168:171], v[92:95]
  ds_read_b64_tr_b16 v[240:241], v22 offset:0
  v_mfma_f32_16x16x32_bf16 v[92:95], v[252:255], v[172:175], v[92:95]
  ds_read_b64_tr_b16 v[242:243], v22 offset:2048
  s_add_u32 m0, s10, 40960
  s_mov_b32 s12, 655360
  buffer_load_dwordx4 v15, s[48:51], s12 offen lds
  v_mfma_f32_16x16x32_bf16 v[88:91], v[252:255], v[164:167], v[88:91]
  ds_read_b64_tr_b16 v[244:245], v22 offset:4096
  v_mfma_f32_16x16x32_bf16 v[88:91], v[248:251], v[160:163], v[88:91]
  ds_read_b64_tr_b16 v[246:247], v22 offset:6144
  s_add_u32 m0, s10, 45056
  s_mov_b32 s12, 720896
  buffer_load_dwordx4 v15, s[48:51], s12 offen lds
  s_waitcnt lgkmcnt(8)
  v_mfma_f32_16x16x32_bf16 v[64:67], v[224:227], v[144:147], v[64:67]
  ds_read_b64_tr_b16 v[248:249], v23 offset:0
  v_mfma_f32_16x16x32_bf16 v[64:67], v[228:231], v[148:151], v[64:67]
  ds_read_b64_tr_b16 v[250:251], v23 offset:2048
  s_add_u32 m0, s10, 65536
  s_mov_b32 s12, 1048576
  buffer_load_dwordx4 v15, s[48:51], s12 offen lds
  v_mfma_f32_16x16x32_bf16 v[68:71], v[228:231], v[156:159], v[68:71]
  ds_read_b64_tr_b16 v[252:253], v23 offset:4096
  v_mfma_f32_16x16x32_bf16 v[68:71], v[224:227], v[152:155], v[68:71]
  ds_read_b64_tr_b16 v[254:255], v23 offset:6144
  s_add_u32 m0, s10, 69632
  s_mov_b32 s12, 1114112
  buffer_load_dwordx4 v15, s[48:51], s12 offen lds
  s_waitcnt lgkmcnt(8)
  v_mfma_f32_16x16x32_bf16 v[76:79], v[232:235], v[152:155], v[76:79]
  ds_read_b64_tr_b16 v[224:225], v20 offset:8192
  v_mfma_f32_16x16x32_bf16 v[76:79], v[236:239], v[156:159], v[76:79]
  ds_read_b64_tr_b16 v[226:227], v20 offset:10240
  s_add_u32 m0, s10, 73728
  s_mov_b32 s12, 1179648
  buffer_load_dwordx4 v15, s[48:51], s12 offen lds
  v_mfma_f32_16x16x32_bf16 v[72:75], v[236:239], v[148:151], v[72:75]
  ds_read_b64_tr_b16 v[228:229], v20 offset:12288
  v_mfma_f32_16x16x32_bf16 v[72:75], v[232:235], v[144:147], v[72:75]
  ds_read_b64_tr_b16 v[230:231], v20 offset:14336
  s_add_u32 m0, s10, 77824
  s_mov_b32 s12, 1245184
  buffer_load_dwordx4 v15, s[48:51], s12 offen lds
  s_waitcnt lgkmcnt(8)
  v_mfma_f32_16x16x32_bf16 v[80:83], v[240:243], v[144:147], v[80:83]
  ds_read_b64_tr_b16 v[232:233], v21 offset:8192
  v_mfma_f32_16x16x32_bf16 v[80:83], v[244:247], v[148:151], v[80:83]
  ds_read_b64_tr_b16 v[234:235], v21 offset:10240
  s_add_u32 m0, s10, 81920
  s_mov_b32 s12, 1310720
  buffer_load_dwordx4 v15, s[48:51], s12 offen lds
  v_mfma_f32_16x16x32_bf16 v[84:87], v[244:247], v[156:159], v[84:87]
  ds_read_b64_tr_b16 v[236:237], v21 offset:12288
  v_mfma_f32_16x16x32_bf16 v[84:87], v[240:243], v[152:155], v[84:87]
  ds_read_b64_tr_b16 v[238:239], v21 offset:14336
  s_add_u32 m0, s10, 86016
  s_mov_b32 s12, 1376256
  buffer_load_dwordx4 v15, s[48:51], s12 offen lds
  s_waitcnt lgkmcnt(8)
  v_mfma_f32_16x16x32_bf16 v[92:95], v[248:251], v[152:155], v[92:95]
  ds_read_b64_tr_b16 v[240:241], v22 offset:8192
  v_mfma_f32_16x16x32_bf16 v[92:95], v[252:255], v[156:159], v[92:95]
  ds_read_b64_tr_b16 v[242:243], v22 offset:10240
  s_add_u32 m0, s10, 90112
  s_mov_b32 s12, 1441792
  buffer_load_dwordx4 v15, s[48:51], s12 offen lds
  v_mfma_f32_16x16x32_bf16 v[88:91], v[252:255], v[148:151], v[88:91]
  ds_read_b64_tr_b16 v[244:245], v22 offset:12288
  v_mfma_f32_16x16x32_bf16 v[88:91], v[248:251], v[144:147], v[88:91]
  ds_read_b64_tr_b16 v[246:247], v22 offset:14336
  s_add_u32 m0, s10, 94208
  s_mov_b32 s12, 1507328
  buffer_load_dwordx4 v15, s[48:51], s12 offen lds
  s_waitcnt lgkmcnt(8)
  v_mfma_f32_16x16x32_bf16 v[64:67], v[224:227], v[128:131], v[64:67]
  ds_read_b64_tr_b16 v[248:249], v23 offset:8192
  v_mfma_f32_16x16x32_bf16 v[64:67], v[228:231], v[132:135], v[64:67]
  ds_read_b64_tr_b16 v[250:251], v23 offset:10240
  v_mfma_f32_16x16x32_bf16 v[68:71], v[228:231], v[140:143], v[68:71]
  ds_read_b64_tr_b16 v[252:253], v23 offset:12288
  v_mfma_f32_16x16x32_bf16 v[68:71], v[224:227], v[136:139], v[68:71]
  ds_read_b64_tr_b16 v[254:255], v23 offset:14336
  s_waitcnt lgkmcnt(8)
  v_mfma_f32_16x16x32_bf16 v[76:79], v[232:235], v[136:139], v[76:79]
  ds_read_b64_tr_b16 v[224:225], v20 offset:16384
  v_mfma_f32_16x16x32_bf16 v[76:79], v[236:239], v[140:143], v[76:79]
  ds_read_b64_tr_b16 v[226:227], v20 offset:18432
  v_mfma_f32_16x16x32_bf16 v[72:75], v[236:239], v[132:135], v[72:75]
  ds_read_b64_tr_b16 v[228:229], v20 offset:20480
  v_mfma_f32_16x16x32_bf16 v[72:75], v[232:235], v[128:131], v[72:75]
  ds_read_b64_tr_b16 v[230:231], v20 offset:22528
  s_barrier
  s_waitcnt lgkmcnt(8)
  v_mfma_f32_16x16x32_bf16 v[80:83], v[240:243], v[128:131], v[80:83]
  ds_read_b64_tr_b16 v[232:233], v21 offset:16384
  v_mfma_f32_16x16x32_bf16 v[80:83], v[244:247], v[132:135], v[80:83]
  ds_read_b64_tr_b16 v[234:235], v21 offset:18432
  s_xor_b32 s14, s72, 512
  v_mov_b32 v5, 0
  buffer_load_dword v9, v5, s[64:67], s14 offen offset:8 sc1
  v_mfma_f32_16x16x32_bf16 v[84:87], v[244:247], v[140:143], v[84:87]
  ds_read_b64_tr_b16 v[236:237], v21 offset:20480
  v_mfma_f32_16x16x32_bf16 v[84:87], v[240:243], v[136:139], v[84:87]
  ds_read_b64_tr_b16 v[238:239], v21 offset:22528
  s_add_u32 m0, s10, 16384
  s_mov_b32 s12, 262144
  buffer_load_dwordx4 v15, s[48:51], s12 offen lds
  s_waitcnt lgkmcnt(8)
  v_mfma_f32_16x16x32_bf16 v[92:95], v[248:251], v[136:139], v[92:95]
  ds_read_b64_tr_b16 v[240:241], v22 offset:16384
  v_mfma_f32_16x16x32_bf16 v[92:95], v[252:255], v[140:143], v[92:95]
  ds_read_b64_tr_b16 v[242:243], v22 offset:18432
  s_add_u32 m0, s10, 20480
  s_mov_b32 s12, 327680
  buffer_load_dwordx4 v15, s[48:51], s12 offen lds
  v_mfma_f32_16x16x32_bf16 v[88:91], v[252:255], v[132:135], v[88:91]
  ds_read_b64_tr_b16 v[244:245], v22 offset:20480
  v_mfma_f32_16x16x32_bf16 v[88:91], v[248:251], v[128:131], v[88:91]
  ds_read_b64_tr_b16 v[246:247], v22 offset:22528
  s_add_u32 m0, s10, 24576
  s_mov_b32 s12, 393216
  buffer_load_dwordx4 v15, s[48:51], s12 offen lds
  s_waitcnt lgkmcnt(8)
  v_mfma_f32_16x16x32_bf16 v[64:67], v[224:227], v[44:47], v[64:67]
  ds_read_b64_tr_b16 v[248:249], v23 offset:16384
  v_mfma_f32_16x16x32_bf16 v[64:67], v[228:231], v[48:51], v[64:67]
  ds_read_b64_tr_b16 v[250:251], v23 offset:18432
  s_add_u32 m0, s10, 28672
  s_mov_b32 s12, 458752
  buffer_load_dwordx4 v15, s[48:51], s12 offen lds
  v_mfma_f32_16x16x32_bf16 v[68:71], v[228:231], v[56:59], v[68:71]
  ds_read_b64_tr_b16 v[252:253], v23 offset:20480
  v_mfma_f32_16x16x32_bf16 v[68:71], v[224:227], v[52:55], v[68:71]
  ds_read_b64_tr_b16 v[254:255], v23 offset:22528
  s_add_u32 m0, s10, 98304
  s_mov_b32 s12, 1572864
  buffer_load_dwordx4 v15, s[48:51], s12 offen lds
  s_waitcnt lgkmcnt(8)
  v_mfma_f32_16x16x32_bf16 v[76:79], v[232:235], v[52:55], v[76:79]
  ds_read_b64_tr_b16 v[224:225], v20 offset:24576
  v_mfma_f32_16x16x32_bf16 v[76:79], v[236:239], v[56:59], v[76:79]
  ds_read_b64_tr_b16 v[226:227], v20 offset:26624
  s_add_u32 m0, s10, 102400
  s_mov_b32 s12, 1638400
  buffer_load_dwordx4 v15, s[48:51], s12 offen lds
  v_mfma_f32_16x16x32_bf16 v[72:75], v[236:239], v[48:51], v[72:75]
  ds_read_b64_tr_b16 v[228:229], v20 offset:28672
  v_mfma_f32_16x16x32_bf16 v[72:75], v[232:235], v[44:47], v[72:75]
  ds_read_b64_tr_b16 v[230:231], v20 offset:30720
  s_add_u32 m0, s10, 106496
  s_mov_b32 s12, 1703936
  buffer_load_dwordx4 v15, s[48:51], s12 offen lds
  s_waitcnt lgkmcnt(8)
  v_mfma_f32_16x16x32_bf16 v[80:83], v[240:243], v[44:47], v[80:83]
  ds_read_b64_tr_b16 v[232:233], v21 offset:24576
  v_mfma_f32_16x16x32_bf16 v[80:83], v[244:247], v[48:51], v[80:83]
  ds_read_b64_tr_b16 v[234:235], v21 offset:26624
  s_add_u32 m0, s10, 110592
  s_mov_b32 s12, 1769472
  buffer_load_dwordx4 v15, s[48:51], s12 offen lds
  v_mfma_f32_16x16x32_bf16 v[84:87], v[244:247], v[56:59], v[84:87]
  ds_read_b64_tr_b16 v[236:237], v21 offset:28672
  v_mfma_f32_16x16x32_bf16 v[84:87], v[240:243], v[52:55], v[84:87]
  ds_read_b64_tr_b16 v[238:239], v21 offset:30720
  s_waitcnt lgkmcnt(8)
  v_mfma_f32_16x16x32_bf16 v[92:95], v[248:251], v[52:55], v[92:95]
  ds_read_b64_tr_b16 v[240:241], v22 offset:24576
  v_mfma_f32_16x16x32_bf16 v[92:95], v[252:255], v[56:59], v[92:95]
  ds_read_b64_tr_b16 v[242:243], v22 offset:26624
  v_mfma_f32_16x16x32_bf16 v[88:91], v[252:255], v[48:51], v[88:91]
  ds_read_b64_tr_b16 v[244:245], v22 offset:28672
  v_mfma_f32_16x16x32_bf16 v[88:91], v[248:251], v[44:47], v[88:91]
  ds_read_b64_tr_b16 v[246:247], v22 offset:30720
  s_waitcnt vmcnt(8)
  v_cmp_eq_u32 vcc, 1, v9
  s_xor_b32 s71, s71, 32768
  s_mov_b32 s70, 0
  s_cmp_eq_u64 vcc, exec
  s_cbranch_scc0 L_g_npe
  s_mov_b32 s70, 1
  buffer_load_dwordx4 v[96:99], v10, s[64:67], s71 offen offset:0 sc1
  buffer_load_dwordx4 v[100:103], v10, s[64:67], s71 offen offset:1024 sc1
  buffer_load_dwordx4 v[104:107], v10, s[64:67], s71 offen offset:2048 sc1
  buffer_load_dwordx4 v[108:111], v10, s[64:67], s71 offen offset:3072 sc1
L_g_npe:
  s_waitcnt lgkmcnt(8)
  v_mfma_f32_16x16x32_bf16 v[64:67], v[224:227], v[28:31], v[64:67]
  ds_read_b64_tr_b16 v[248:249], v23 offset:24576
  v_mfma_f32_16x16x32_bf16 v[64:67], v[228:231], v[32:35], v[64:67]
  ds_read_b64_tr_b16 v[250:251], v23 offset:26624
  v_mfma_f32_16x16x32_bf16 v[68:71], v[228:231], v[40:43], v[68:71]
  ds_read_b64_tr_b16 v[252:253], v23 offset:28672
  v_mfma_f32_16x16x32_bf16 v[68:71], v[224:227], v[36:39], v[68:71]
  ds_read_b64_tr_b16 v[254:255], v23 offset:30720
  s_waitcnt lgkmcnt(8)
  v_mfma_f32_16x16x32_bf16 v[76:79], v[232:235], v[36:39], v[76:79]
  ds_read_b64_tr_b16 v[224:225], v20 offset:32768
  v_mfma_f32_16x16x32_bf16 v[76:79], v[236:239], v[40:43], v[76:79]
  ds_read_b64_tr_b16 v[226:227], v20 offset:34816
  v_mfma_f32_16x16x32_bf16 v[72:75], v[236:239], v[32:35], v[72:75]
  ds_read_b64_tr_b16 v[228:229], v20 offset:36864
  v_mfma_f32_16x16x32_bf16 v[72:75], v[232:235], v[28:31], v[72:75]
  ds_read_b64_tr_b16 v[230:231], v20 offset:38912
  s_waitcnt lgkmcnt(8)
  v_mfma_f32_16x16x32_bf16 v[80:83], v[240:243], v[28:31], v[80:83]
  ds_read_b64_tr_b16 v[232:233], v21 offset:32768
  v_mfma_f32_16x16x32_bf16 v[80:83], v[244:247], v[32:35], v[80:83]
  ds_read_b64_tr_b16 v[234:235], v21 offset:34816
  v_mfma_f32_16x16x32_bf16 v[84:87], v[244:247], v[40:43], v[84:87]
  ds_read_b64_tr_b16 v[236:237], v21 offset:36864
  v_mfma_f32_16x16x32_bf16 v[84:87], v[240:243], v[36:39], v[84:87]
  ds_read_b64_tr_b16 v[238:239], v21 offset:38912
  s_waitcnt lgkmcnt(8)
  v_mfma_f32_16x16x32_bf16 v[92:95], v[248:251], v[36:39], v[92:95]
  ds_read_b64_tr_b16 v[240:241], v22 offset:32768
  v_mfma_f32_16x16x32_bf16 v[92:95], v[252:255], v[40:43], v[92:95]
  ds_read_b64_tr_b16 v[242:243], v22 offset:34816
  v_mfma_f32_16x16x32_bf16 v[88:91], v[252:255], v[32:35], v[88:91]
  ds_read_b64_tr_b16 v[244:245], v22 offset:36864
  v_mfma_f32_16x16x32_bf16 v[88:91], v[248:251], v[28:31], v[88:91]
  ds_read_b64_tr_b16 v[246:247], v22 offset:38912
  s_barrier
  s_add_u32 m0, s10, 114688
  s_mov_b32 s12, 1835008
  buffer_load_dwordx4 v15, s[48:51], s12 offen lds
  s_add_u32 m0, s10, 118784
  s_mov_b32 s12, 1900544
  buffer_load_dwordx4 v15, s[48:51], s12 offen lds
  s_add_u32 m0, s10, 122880
  s_mov_b32 s12, 1966080
  buffer_load_dwordx4 v15, s[48:51], s12 offen lds
  s_add_u32 m0, s10, 126976
  s_mov_b32 s12, 2031616
  buffer_load_dwordx4 v15, s[48:51], s12 offen lds
  s_add_u32 m0, s10, 0
  s_mov_b32 s12, 0
  buffer_load_dwordx4 v15, s[48:51], s12 offen lds
  s_add_u32 m0, s10, 4096
  s_mov_b32 s12, 65536
  buffer_load_dwordx4 v15, s[48:51], s12 offen lds
  s_add_u32 m0, s10, 8192
  s_mov_b32 s12, 131072
  buffer_load_dwordx4 v15, s[48:51], s12 offen lds
  s_add_u32 m0, s10, 12288
  s_mov_b32 s12, 196608
  buffer_load_dwordx4 v15, s[48:51], s12 offen lds
  s_waitcnt lgkmcnt(8)
  v_mfma_f32_16x16x32_bf16 v[64:67], v[224:227], v[208:211], v[64:67]
  ds_read_b64_tr_b16 v[248:249], v23 offset:32768
  v_mfma_f32_16x16x32_bf16 v[64:67], v[228:231], v[212:215], v[64:67]
  ds_read_b64_tr_b16 v[250:251], v23 offset:34816
  v_mfma_f32_16x16x32_bf16 v[68:71], v[228:231], v[220:223], v[68:71]
  ds_read_b64_tr_b16 v[252:253], v23 offset:36864
  v_mfma_f32_16x16x32_bf16 v[68:71], v[224:227], v[216:219], v[68:71]
  ds_read_b64_tr_b16 v[254:255], v23 offset:38912
  s_waitcnt lgkmcnt(8)
  v_mfma_f32_16x16x32_bf16 v[76:79], v[232:235], v[216:219], v[76:79]
  ds_read_b64_tr_b16 v[224:225], v20 offset:40960
  v_mfma_f32_16x16x32_bf16 v[76:79], v[236:239], v[220:223], v[76:79]
  ds_read_b64_tr_b16 v[226:227], v20 offset:43008
  v_mfma_f32_16x16x32_bf16 v[72:75], v[236:239], v[212:215], v[72:75]
  ds_read_b64_tr_b16 v[228:229], v20 offset:45056
  v_mfma_f32_16x16x32_bf16 v[72:75], v[232:235], v[208:211], v[72:75]
  ds_read_b64_tr_b16 v[230:231], v20 offset:47104
  s_waitcnt lgkmcnt(8)
  v_mfma_f32_16x16x32_bf16 v[80:83], v[240:243], v[208:211], v[80:83]
  ds_read_b64_tr_b16 v[232:233], v21 offset:40960
  v_mfma_f32_16x16x32_bf16 v[80:83], v[244:247], v[212:215], v[80:83]
  ds_read_b64_tr_b16 v[234:235], v21 offset:43008
  v_mfma_f32_16x16x32_bf16 v[84:87], v[244:247], v[220:223], v[84:87]
  ds_read_b64_tr_b16 v[236:237], v21 offset:45056
  v_mfma_f32_16x16x32_bf16 v[84:87], v[240:243], v[216:219], v[84:87]
  ds_read_b64_tr_b16 v[238:239], v21 offset:47104
  s_waitcnt lgkmcnt(8)
  v_mfma_f32_16x16x32_bf16 v[92:95], v[248:251], v[216:219], v[92:95]
  ds_read_b64_tr_b16 v[240:241], v22 offset:40960
  v_mfma_f32_16x16x32_bf16 v[92:95], v[252:255], v[220:223], v[92:95]
  ds_read_b64_tr_b16 v[242:243], v22 offset:43008
  v_mfma_f32_16x16x32_bf16 v[88:91], v[252:255], v[212:215], v[88:91]
  ds_read_b64_tr_b16 v[244:245], v22 offset:45056
  v_mfma_f32_16x16x32_bf16 v[88:91], v[248:251], v[208:211], v[88:91]
  ds_read_b64_tr_b16 v[246:247], v22 offset:47104
  s_waitcnt lgkmcnt(8)
  v_mfma_f32_16x16x32_bf16 v[64:67], v[224:227], v[192:195], v[64:67]
  ds_read_b64_tr_b16 v[248:249], v23 offset:40960
  v_mfma_f32_16x16x32_bf16 v[64:67], v[228:231], v[196:199], v[64:67]
  ds_read_b64_tr_b16 v[250:251], v23 offset:43008
  v_mfma_f32_16x16x32_bf16 v[68:71], v[228:231], v[204:207], v[68:71]
  ds_read_b64_tr_b16 v[252:253], v23 offset:45056
  v_mfma_f32_16x16x32_bf16 v[68:71], v[224:227], v[200:203], v[68:71]
  ds_read_b64_tr_b16 v[254:255], v23 offset:47104
  s_waitcnt lgkmcnt(8)
  v_mfma_f32_16x16x32_bf16 v[76:79], v[232:235], v[200:203], v[76:79]
  v_mfma_f32_16x16x32_bf16 v[76:79], v[236:239], v[204:207], v[76:79]
  v_mfma_f32_16x16x32_bf16 v[72:75], v[236:239], v[196:199], v[72:75]
  v_mfma_f32_16x16x32_bf16 v[72:75], v[232:235], v[192:195], v[72:75]
  s_waitcnt lgkmcnt(6)
  v_mfma_f32_16x16x32_bf16 v[80:83], v[240:243], v[192:195], v[80:83]
  s_waitcnt lgkmcnt(4)
  v_mfma_f32_16x16x32_bf16 v[80:83], v[244:247], v[196:199], v[80:83]
  v_mfma_f32_16x16x32_bf16 v[84:87], v[244:247], v[204:207], v[84:87]
  v_mfma_f32_16x16x32_bf16 v[84:87], v[240:243], v[200:203], v[84:87]
  s_waitcnt lgkmcnt(2)
  v_mfma_f32_16x16x32_bf16 v[92:95], v[248:251], v[200:203], v[92:95]
  s_waitcnt lgkmcnt(0)
  v_mfma_f32_16x16x32_bf16 v[92:95], v[252:255], v[204:207], v[92:95]
  v_mfma_f32_16x16x32_bf16 v[88:91], v[252:255], v[196:199], v[88:91]
  v_mfma_f32_16x16x32_bf16 v[88:91], v[248:251], v[192:195], v[88:91]
  s_waitcnt vmcnt(8)
  s_waitcnt lgkmcnt(0)
  s_branch L_g_tail
.fill 213, 4, 0xbf800000
L_g_odd:
  s_lshr_b32 s12, s2, 1
  s_add_u32 s12, s12, 0
  s_and_b32 s12, s12, 3
  s_mul_i32 s20, s12, 786432
  s_lshr_b32 s12, s20, 6
  s_add_u32 s16, s12, s28
  s_lshr_b32 s12, s2, 1
  s_add_u32 s12, s12, 1
  s_and_b32 s12, s12, 3
  s_mul_i32 s21, s12, 786432
  s_lshr_b32 s12, s21, 6
  s_add_u32 s17, s12, s28
  s_lshr_b32 s12, s2, 1
  s_add_u32 s12, s12, 2
  s_and_b32 s12, s12, 3
  s_mul_i32 s22, s12, 786432
  s_lshr_b32 s12, s22, 6
  s_add_u32 s18, s12, s28
  s_lshr_b32 s12, s2, 1
  s_add_u32 s12, s12, 3
  s_and_b32 s12, s12, 3
  s_mul_i32 s23, s12, 786432
  s_lshr_b32 s12, s23, 6
  s_add_u32 s19, s12, s28
  s_waitcnt vmcnt(0)
  s_barrier
  s_add_u32 s11, s5, 3
  s_and_b32 s11, s11, 15
  s_lshl_b32 s11, s11, 14
  s_add_u32 m0, s10, 0
  s_add_u32 s12, s11, 27262976
  buffer_load_dwordx4 v14, s[64:67], s12 offen sc1 lds
  s_add_u32 m0, s10, 4096
  s_add_u32 s12, s11, 27267072
  buffer_load_dwordx4 v14, s[64:67], s12 offen sc1 lds
  s_add_u32 m0, s10, 8192
  s_add_u32 s12, s11, 27271168
  buffer_load_dwordx4 v14, s[64:67], s12 offen sc1 lds
  s_add_u32 m0, s10, 12288
  s_add_u32 s12, s11, 27275264
  buffer_load_dwordx4 v14, s[64:67], s12 offen sc1 lds
  s_add_u32 m0, s10, 81920
  s_add_u32 s12, s20, 3932160
  buffer_load_dwordx4 v15, s[52:55], s12 offen lds
  s_add_u32 m0, s10, 86016
  s_add_u32 s12, s20, 3997696
  buffer_load_dwordx4 v15, s[52:55], s12 offen lds
  s_add_u32 m0, s10, 90112
  s_add_u32 s12, s20, 3932160
  buffer_load_dwordx4 v13, s[52:55], s12 offen lds
  s_add_u32 m0, s10, 94208
  s_add_u32 s12, s20, 3997696
  buffer_load_dwordx4 v13, s[52:55], s12 offen lds
  s_add_u32 m0, s10, 98304
  s_add_u32 s12, s20, 4063232
  buffer_load_dwordx4 v15, s[52:55], s12 offen lds
  s_add_u32 m0, s10, 102400
  s_add_u32 s12, s20, 4128768
  buffer_load_dwordx4 v15, s[52:55], s12 offen lds
  s_add_u32 m0, s10, 106496
  s_add_u32 s12, s20, 4063232
  buffer_load_dwordx4 v13, s[52:55], s12 offen lds
  s_add_u32 m0, s10, 110592
  s_add_u32 s12, s20, 4128768
  buffer_load_dwordx4 v13, s[52:55], s12 offen lds
  s_lshl_b32 s12, s2, 2
  s_add_u32 s12, s12, s4
  s_lshl_b32 s12, s12, 11
  v_lshlrev_b32 v4, 7, v0
  s_mov_b64 exec, 0xffff
  buffer_load_dword v9, v4, s[48:51], s12 offen
  s_mov_b64 exec, -1
  s_waitcnt vmcnt(13)
  s_barrier
  s_add_u32 s11, s5, 4
  s_and_b32 s11, s11, 15
  s_lshl_b32 s11, s11, 14
  s_add_u32 m0, s10, 32768
  s_add_u32 s12, s11, 27262976
  buffer_load_dwordx4 v14, s[64:67], s12 offen sc1 lds
  s_add_u32 m0, s10, 36864
  s_add_u32 s12, s11, 27267072
  buffer_load_dwordx4 v14, s[64:67], s12 offen sc1 lds
  s_add_u32 m0, s10, 40960
  s_add_u32 s12, s11, 27271168
  buffer_load_dwordx4 v14, s[64:67], s12 offen sc1 lds
  s_add_u32 m0, s10, 45056
  s_add_u32 s12, s11, 27275264
  buffer_load_dwordx4 v14, s[64:67], s12 offen sc1 lds
  s_add_u32 m0, s10, 114688
  s_add_u32 s12, s20, 4194304
  buffer_load_dwordx4 v15, s[52:55], s12 offen lds
  s_add_u32 m0, s10, 118784
  s_add_u32 s12, s20, 4259840
  buffer_load_dwordx4 v15, s[52:55], s12 offen lds
  s_add_u32 m0, s10, 122880
  s_add_u32 s12, s20, 4194304
  buffer_load_dwordx4 v13, s[52:55], s12 offen lds
  s_add_u32 m0, s10, 126976
  s_add_u32 s12, s20, 4259840
  buffer_load_dwordx4 v13, s[52:55], s12 offen lds
  s_waitcnt vmcnt(8)
  s_barrier
  s_add_u32 s11, s5, 5
  s_and_b32 s11, s11, 15
  s_lshl_b32 s11, s11, 14
  s_add_u32 m0, s10, 16384
  s_add_u32 s12, s11, 27262976
  buffer_load_dwordx4 v14, s[64:67], s12 offen sc1 lds
  s_add_u32 m0, s10, 20480
  s_add_u32 s12, s11, 27267072
  buffer_load_dwordx4 v14, s[64:67], s12 offen sc1 lds
  s_add_u32 m0, s10, 24576
  s_add_u32 s12, s11, 27271168
  buffer_load_dwordx4 v14, s[64:67], s12 offen sc1 lds
  s_add_u32 m0, s10, 28672
  s_add_u32 s12, s11, 27275264
  buffer_load_dwordx4 v14, s[64:67], s12 offen sc1 lds
  v_bfe_u32 v5, v0, 1, 4
  v_and_b32 v6, 1, v0
  v_lshl_add_u32 v5, v5, 2, v6
  v_lshlrev_b32 v5, 7, v5
  s_lshl_b32 s13, s7, 6
  s_and_b32 s12, s4, 2
  s_add_u32 s13, s13, s12
  s_lshl_b32 s13, s13, 7
  s_add_u32 s13, s13, 27656192
  s_mov_b32 exec_lo, 4294901760
  s_mov_b32 exec_hi, 0
  s_mov_b32 s15, 1048576
L_poll_40:
  buffer_load_dword v4, v5, s[64:67], s13 offen offset:0 sc1
  s_waitcnt vmcnt(0)
  v_cmp_eq_u32 vcc, 1, v4
  s_nop 1
  s_cmp_eq_u64 vcc, exec
  s_cbranch_scc1 L_pdone_41
  s_sleep 1
  s_sub_u32 s15, s15, 1
  s_cmp_lg_u32 s15, 0
  s_cbranch_scc1 L_poll_40
L_pdone_41:
  s_mov_b64 exec, -1
  s_add_u32 s69, s16, 61440
  buffer_load_dwordx4 v[128:131], v10, s[64:67], s69 offen offset:0 sc1
  buffer_load_dwordx4 v[132:135], v10, s[64:67], s69 offen offset:1024 sc1
  buffer_load_dwordx4 v[136:139], v11, s[64:67], s69 offen offset:0 sc1
  buffer_load_dwordx4 v[140:143], v11, s[64:67], s69 offen offset:1024 sc1
  s_add_u32 s69, s16, 63488
  buffer_load_dwordx4 v[144:147], v10, s[64:67], s69 offen offset:0 sc1
  buffer_load_dwordx4 v[148:151], v10, s[64:67], s69 offen offset:1024 sc1
  buffer_load_dwordx4 v[152:155], v11, s[64:67], s69 offen offset:0 sc1
  buffer_load_dwordx4 v[156:159], v11, s[64:67], s69 offen offset:1024 sc1
  s_add_u32 s69, s16, 65536
  buffer_load_dwordx4 v[160:163], v10, s[64:67], s69 offen offset:0 sc1
  buffer_load_dwordx4 v[164:167], v10, s[64:67], s69 offen offset:1024 sc1
  buffer_load_dwordx4 v[168:171], v11, s[64:67], s69 offen offset:0 sc1
  buffer_load_dwordx4 v[172:175], v11, s[64:67], s69 offen offset:1024 sc1
  s_barrier
  ds_read_b64_tr_b16 v[224:225], v16 offset:32768
  ds_read_b64_tr_b16 v[226:227], v16 offset:34816
  ds_read_b64_tr_b16 v[228:229], v16 offset:36864
  ds_read_b64_tr_b16 v[230:231], v16 offset:38912
  ds_read_b64_tr_b16 v[232:233], v17 offset:32768
  ds_read_b64_tr_b16 v[234:235], v17 offset:34816
  ds_read_b64_tr_b16 v[236:237], v17 offset:36864
  ds_read_b64_tr_b16 v[238:239], v17 offset:38912
  ds_read_b64_tr_b16 v[240:241], v18 offset:32768
  ds_read_b64_tr_b16 v[242:243], v18 offset:34816
  ds_read_b64_tr_b16 v[244:245], v18 offset:36864
  ds_read_b64_tr_b16 v[246:247], v18 offset:38912
  s_waitcnt vmcnt(8)
  s_waitcnt lgkmcnt(8)
  v_mfma_f32_16x16x32_bf16 v[64:67], v[224:227], v[128:131], v[64:67]
  ds_read_b64_tr_b16 v[248:249], v19 offset:32768
  v_mfma_f32_16x16x32_bf16 v[64:67], v[228:231], v[132:135], v[64:67]
  ds_read_b64_tr_b16 v[250:251], v19 offset:34816
  s_add_u32 s69, s16, 67584
  buffer_load_dwordx4 v[176:179], v10, s[64:67], s69 offen offset:0 sc1
  v_mfma_f32_16x16x32_bf16 v[68:71], v[228:231], v[140:143], v[68:71]
  ds_read_b64_tr_b16 v[252:253], v19 offset:36864
  v_mfma_f32_16x16x32_bf16 v[68:71], v[224:227], v[136:139], v[68:71]
  ds_read_b64_tr_b16 v[254:255], v19 offset:38912
  buffer_load_dwordx4 v[180:183], v10, s[64:67], s69 offen offset:1024 sc1
  s_waitcnt lgkmcnt(8)
  v_mfma_f32_16x16x32_bf16 v[76:79], v[232:235], v[136:139], v[76:79]
  ds_read_b64_tr_b16 v[224:225], v16 offset:40960
  v_mfma_f32_16x16x32_bf16 v[76:79], v[236:239], v[140:143], v[76:79]
  ds_read_b64_tr_b16 v[226:227], v16 offset:43008
  buffer_load_dwordx4 v[184:187], v11, s[64:67], s69 offen offset:0 sc1
  v_mfma_f32_16x16x32_bf16 v[72:75], v[236:239], v[132:135], v[72:75]
  ds_read_b64_tr_b16 v[228:229], v16 offset:45056
  v_mfma_f32_16x16x32_bf16 v[72:75], v[232:235], v[128:131], v[72:75]
  ds_read_b64_tr_b16 v[230:231], v16 offset:47104
  buffer_load_dwordx4 v[188:191], v11, s[64:67], s69 offen offset:1024 sc1
  s_waitcnt lgkmcnt(8)
  v_mfma_f32_16x16x32_bf16 v[80:83], v[240:243], v[128:131], v[80:83]
  ds_read_b64_tr_b16 v[232:233], v17 offset:40960
  v_mfma_f32_16x16x32_bf16 v[80:83], v[244:247], v[132:135], v[80:83]
  ds_read_b64_tr_b16 v[234:235], v17 offset:43008
  s_add_u32 m0, s10, 131072
  s_add_u32 s12, s20, 4325376
  buffer_load_dwordx4 v15, s[52:55], s12 offen lds
  v_mfma_f32_16x16x32_bf16 v[84:87], v[244:247], v[140:143], v[84:87]
  ds_read_b64_tr_b16 v[236:237], v17 offset:45056
  v_mfma_f32_16x16x32_bf16 v[84:87], v[240:243], v[136:139], v[84:87]
  ds_read_b64_tr_b16 v[238:239], v17 offset:47104
  s_add_u32 m0, s10, 135168
  s_add_u32 s12, s20, 4390912
  buffer_load_dwordx4 v15, s[52:55], s12 offen lds
  s_waitcnt lgkmcnt(8)
  v_mfma_f32_16x16x32_bf16 v[92:95], v[248:251], v[136:139], v[92:95]
  ds_read_b64_tr_b16 v[240:241], v18 offset:40960
  v_mfma_f32_16x16x32_bf16 v[92:95], v[252:255], v[140:143], v[92:95]
  ds_read_b64_tr_b16 v[242:243], v18 offset:43008
  s_add_u32 m0, s10, 139264
  s_add_u32 s12, s20, 4325376
  buffer_load_dwordx4 v13, s[52:55], s12 offen lds
  v_mfma_f32_16x16x32_bf16 v[88:91], v[252:255], v[132:135], v[88:91]
  ds_read_b64_tr_b16 v[244:245], v18 offset:45056
  v_mfma_f32_16x16x32_bf16 v[88:91], v[248:251], v[128:131], v[88:91]
  ds_read_b64_tr_b16 v[246:247], v18 offset:47104
  s_add_u32 m0, s10, 143360
  s_add_u32 s12, s20, 4390912
  buffer_load_dwordx4 v13, s[52:55], s12 offen lds
  s_waitcnt lgkmcnt(8)
  v_mfma_f32_16x16x32_bf16 v[96:99], v[224:227], v[128:131], v[96:99]
  ds_read_b64_tr_b16 v[248:249], v19 offset:40960
  v_mfma_f32_16x16x32_bf16 v[96:99], v[228:231], v[132:135], v[96:99]
  ds_read_b64_tr_b16 v[250:251], v19 offset:43008
  s_add_u32 m0, s10, 147456
  s_add_u32 s12, s20, 4456448
  buffer_load_dwordx4 v15, s[52:55], s12 offen lds
  v_mfma_f32_16x16x32_bf16 v[100:103], v[228:231], v[140:143], v[100:103]
  ds_read_b64_tr_b16 v[252:253], v19 offset:45056
  v_mfma_f32_16x16x32_bf16 v[100:103], v[224:227], v[136:139], v[100:103]
  ds_read_b64_tr_b16 v[254:255], v19 offset:47104
  s_add_u32 m0, s10, 151552
  s_add_u32 s12, s20, 4521984
  buffer_load_dwordx4 v15, s[52:55], s12 offen lds
  s_waitcnt lgkmcnt(8)
  v_mfma_f32_16x16x32_bf16 v[108:111], v[232:235], v[136:139], v[108:111]
  ds_read_b64_tr_b16 v[224:225], v16 offset:49152
  v_mfma_f32_16x16x32_bf16 v[108:111], v[236:239], v[140:143], v[108:111]
  ds_read_b64_tr_b16 v[226:227], v16 offset:51200
  s_add_u32 m0, s10, 155648
  s_add_u32 s12, s20, 4456448
  buffer_load_dwordx4 v13, s[52:55], s12 offen lds
  v_mfma_f32_16x16x32_bf16 v[104:107], v[236:239], v[132:135], v[104:107]
  ds_read_b64_tr_b16 v[228:229], v16 offset:53248
  v_mfma_f32_16x16x32_bf16 v[104:107], v[232:235], v[128:131], v[104:107]
  ds_read_b64_tr_b16 v[230:231], v16 offset:55296
  s_add_u32 m0, s10, 159744
  s_add_u32 s12, s20, 4521984
  buffer_load_dwordx4 v13, s[52:55], s12 offen lds
  s_waitcnt lgkmcnt(8)
  v_mfma_f32_16x16x32_bf16 v[112:115], v[240:243], v[128:131], v[112:115]
  ds_read_b64_tr_b16 v[232:233], v17 offset:49152
  v_mfma_f32_16x16x32_bf16 v[112:115], v[244:247], v[132:135], v[112:115]
  ds_read_b64_tr_b16 v[234:235], v17 offset:51200
  s_add_u32 m0, s10, 49152
  s_add_u32 s12, s20, 4587520
  buffer_load_dwordx4 v15, s[52:55], s12 offen lds
  v_mfma_f32_16x16x32_bf16 v[116:119], v[244:247], v[140:143], v[116:119]
  ds_read_b64_tr_b16 v[236:237], v17 offset:53248
  v_mfma_f32_16x16x32_bf16 v[116:119], v[240:243], v[136:139], v[116:119]
  ds_read_b64_tr_b16 v[238:239], v17 offset:55296
  s_add_u32 m0, s10, 53248
  s_add_u32 s12, s20, 4653056
  buffer_load_dwordx4 v15, s[52:55], s12 offen lds
  s_waitcnt lgkmcnt(8)
  v_mfma_f32_16x16x32_bf16 v[124:127], v[248:251], v[136:139], v[124:127]
  ds_read_b64_tr_b16 v[240:241], v18 offset:49152
  v_mfma_f32_16x16x32_bf16 v[124:127], v[252:255], v[140:143], v[124:127]
  ds_read_b64_tr_b16 v[242:243], v18 offset:51200
  s_add_u32 m0, s10, 57344
  s_add_u32 s12, s20, 4587520
  buffer_load_dwordx4 v13, s[52:55], s12 offen lds
  v_mfma_f32_16x16x32_bf16 v[120:123], v[252:255], v[132:135], v[120:123]
  ds_read_b64_tr_b16 v[244:245], v18 offset:53248
  v_mfma_f32_16x16x32_bf16 v[120:123], v[248:251], v[128:131], v[120:123]
  ds_read_b64_tr_b16 v[246:247], v18 offset:55296
  s_add_u32 m0, s10, 61440
  s_add_u32 s12, s20, 4653056
  buffer_load_dwordx4 v13, s[52:55], s12 offen lds
  s_waitcnt vmcnt(20)
  s_waitcnt lgkmcnt(8)
  v_mfma_f32_16x16x32_bf16 v[64:67], v[224:227], v[144:147], v[64:67]
  ds_read_b64_tr_b16 v[248:249], v19 offset:49152
  v_mfma_f32_16x16x32_bf16 v[64:67], v[228:231], v[148:151], v[64:67]
  ds_read_b64_tr_b16 v[250:251], v19 offset:51200
  s_add_u32 s69, s16, 69632
  buffer_load_dwordx4 v[192:195], v10, s[64:67], s69 offen offset:0 sc1
  v_mfma_f32_16x16x32_bf16 v[68:71], v[228:231], v[156:159], v[68:71]
  ds_read_b64_tr_b16 v[252:253], v19 offset:53248
  v_mfma_f32_16x16x32_bf16 v[68:71], v[224:227], v[152:155], v[68:71]
  ds_read_b64_tr_b16 v[254:255], v19 offset:55296
  buffer_load_dwordx4 v[196:199], v10, s[64:67], s69 offen offset:1024 sc1
  s_waitcnt lgkmcnt(8)
  v_mfma_f32_16x16x32_bf16 v[76:79], v[232:235], v[152:155], v[76:79]
  ds_read_b64_tr_b16 v[224:225], v16 offset:57344
  v_mfma_f32_16x16x32_bf16 v[76:79], v[236:239], v[156:159], v[76:79]
  ds_read_b64_tr_b16 v[226:227], v16 offset:59392
  buffer_load_dwordx4 v[200:203], v11, s[64:67], s69 offen offset:0 sc1
  v_mfma_f32_16x16x32_bf16 v[72:75], v[236:239], v[148:151], v[72:75]
  ds_read_b64_tr_b16 v[228:229], v16 offset:61440
  v_mfma_f32_16x16x32_bf16 v[72:75], v[232:235], v[144:147], v[72:75]
  ds_read_b64_tr_b16 v[230:231], v16 offset:63488
  buffer_load_dwordx4 v[204:207], v11, s[64:67], s69 offen offset:1024 sc1
  s_waitcnt lgkmcnt(8)
  v_mfma_f32_16x16x32_bf16 v[80:83], v[240:243], v[144:147], v[80:83]
  ds_read_b64_tr_b16 v[232:233], v17 offset:57344
  v_mfma_f32_16x16x32_bf16 v[80:83], v[244:247], v[148:151], v[80:83]
  ds_read_b64_tr_b16 v[234:235], v17 offset:59392
  s_add_u32 m0, s10, 65536
  s_add_u32 s12, s21, 3932160
  buffer_load_dwordx4 v15, s[52:55], s12 offen lds
  v_mfma_f32_16x16x32_bf16 v[84:87], v[244:247], v[156:159], v[84:87]
  ds_read_b64_tr_b16 v[236:237], v17 offset:61440
  v_mfma_f32_16x16x32_bf16 v[84:87], v[240:243], v[152:155], v[84:87]
  ds_read_b64_tr_b16 v[238:239], v17 offset:63488
  s_add_u32 m0, s10, 69632
  s_add_u32 s12, s21, 3997696
  buffer_load_dwordx4 v15, s[52:55], s12 offen lds
  s_waitcnt lgkmcnt(8)
  v_mfma_f32_16x16x32_bf16 v[92:95], v[248:251], v[152:155], v[92:95]
  ds_read_b64_tr_b16 v[240:241], v18 offset:57344
  v_mfma_f32_16x16x32_bf16 v[92:95], v[252:255], v[156:159], v[92:95]
  ds_read_b64_tr_b16 v[242:243], v18 offset:59392
  s_add_u32 m0, s10, 73728
  s_add_u32 s12, s21, 3932160
  buffer_load_dwordx4 v13, s[52:55], s12 offen lds
  v_mfma_f32_16x16x32_bf16 v[88:91], v[252:255], v[148:151], v[88:91]
  ds_read_b64_tr_b16 v[244:245], v18 offset:61440
  v_mfma_f32_16x16x32_bf16 v[88:91], v[248:251], v[144:147], v[88:91]
  ds_read_b64_tr_b16 v[246:247], v18 offset:63488
  s_add_u32 m0, s10, 77824
  s_add_u32 s12, s21, 3997696
  buffer_load_dwordx4 v13, s[52:55], s12 offen lds
  s_waitcnt lgkmcnt(8)
  v_mfma_f32_16x16x32_bf16 v[96:99], v[224:227], v[144:147], v[96:99]
  ds_read_b64_tr_b16 v[248:249], v19 offset:57344
  v_mfma_f32_16x16x32_bf16 v[96:99], v[228:231], v[148:151], v[96:99]
  ds_read_b64_tr_b16 v[250:251], v19 offset:59392
  s_add_u32 s11, s5, 6
  s_and_b32 s11, s11, 15
  s_lshl_b32 s11, s11, 14
  s_add_u32 m0, s10, 0
  s_add_u32 s12, s11, 27262976
  buffer_load_dwordx4 v14, s[64:67], s12 offen sc1 lds
  v_mfma_f32_16x16x32_bf16 v[100:103], v[228:231], v[156:159], v[100:103]
  ds_read_b64_tr_b16 v[252:253], v19 offset:61440
  v_mfma_f32_16x16x32_bf16 v[100:103], v[224:227], v[152:155], v[100:103]
  ds_read_b64_tr_b16 v[254:255], v19 offset:63488
  s_add_u32 m0, s10, 4096
  s_add_u32 s12, s11, 27267072
  buffer_load_dwordx4 v14, s[64:67], s12 offen sc1 lds
  s_waitcnt lgkmcnt(8)
  v_mfma_f32_16x16x32_bf16 v[108:111], v[232:235], v[152:155], v[108:111]
  ds_read_b64_tr_b16 v[224:225], v20 offset:0
  v_mfma_f32_16x16x32_bf16 v[108:111], v[236:239], v[156:159], v[108:111]
  ds_read_b64_tr_b16 v[226:227], v20 offset:2048
  s_add_u32 m0, s10, 8192
  s_add_u32 s12, s11, 27271168
  buffer_load_dwordx4 v14, s[64:67], s12 offen sc1 lds
  v_mfma_f32_16x16x32_bf16 v[104:107], v[236:239], v[148:151], v[104:107]
  ds_read_b64_tr_b16 v[228:229], v20 offset:4096
  v_mfma_f32_16x16x32_bf16 v[104:107], v[232:235], v[144:147], v[104:107]
  ds_read_b64_tr_b16 v[230:231], v20 offset:6144
  s_add_u32 m0, s10, 12288
  s_add_u32 s12, s11, 27275264
  buffer_load_dwordx4 v14, s[64:67], s12 offen sc1 lds
  s_waitcnt lgkmcnt(8)
  v_mfma_f32_16x16x32_bf16 v[112:115], v[240:243], v[144:147], v[112:115]
  ds_read_b64_tr_b16 v[232:233], v21 offset:0
  v_mfma_f32_16x16x32_bf16 v[112:115], v[244:247], v[148:151], v[112:115]
  ds_read_b64_tr_b16 v[234:235], v21 offset:2048
  v_mfma_f32_16x16x32_bf16 v[116:119], v[244:247], v[156:159], v[116:119]
  ds_read_b64_tr_b16 v[236:237], v21 offset:4096
  v_mfma_f32_16x16x32_bf16 v[116:119], v[240:243], v[152:155], v[116:119]
  ds_read_b64_tr_b16 v[238:239], v21 offset:6144
  s_waitcnt lgkmcnt(8)
  v_mfma_f32_16x16x32_bf16 v[124:127], v[248:251], v[152:155], v[124:127]
  ds_read_b64_tr_b16 v[240:241], v22 offset:0
  v_mfma_f32_16x16x32_bf16 v[124:127], v[252:255], v[156:159], v[124:127]
  ds_read_b64_tr_b16 v[242:243], v22 offset:2048
  v_mfma_f32_16x16x32_bf16 v[120:123], v[252:255], v[148:151], v[120:123]
  ds_read_b64_tr_b16 v[244:245], v22 offset:4096
  v_mfma_f32_16x16x32_bf16 v[120:123], v[248:251], v[144:147], v[120:123]
  ds_read_b64_tr_b16 v[246:247], v22 offset:6144
  s_waitcnt vmcnt(16)
  s_barrier
  s_waitcnt lgkmcnt(8)
  v_mfma_f32_16x16x32_bf16 v[64:67], v[224:227], v[160:163], v[64:67]
  ds_read_b64_tr_b16 v[248:249], v23 offset:0
  v_mfma_f32_16x16x32_bf16 v[64:67], v[228:231], v[164:167], v[64:67]
  ds_read_b64_tr_b16 v[250:251], v23 offset:2048
  s_add_u32 s69, s16, 71680
  buffer_load_dwordx4 v[208:211], v10, s[64:67], s69 offen offset:0 sc1
  v_mfma_f32_16x16x32_bf16 v[68:71], v[228:231], v[172:175], v[68:71]
  ds_read_b64_tr_b16 v[252:253], v23 offset:4096
  v_mfma_f32_16x16x32_bf16 v[68:71], v[224:227], v[168:171], v[68:71]
  ds_read_b64_tr_b16 v[254:255], v23 offset:6144
  buffer_load_dwordx4 v[212:215], v10, s[64:67], s69 offen offset:1024 sc1
  s_waitcnt lgkmcnt(8)
  v_mfma_f32_16x16x32_bf16 v[76:79], v[232:235], v[168:171], v[76:79]
  ds_read_b64_tr_b16 v[224:225], v20 offset:8192
  v_mfma_f32_16x16x32_bf16 v[76:79], v[236:239], v[172:175], v[76:79]
  ds_read_b64_tr_b16 v[226:227], v20 offset:10240
  buffer_load_dwordx4 v[216:219], v11, s[64:67], s69 offen offset:0 sc1
  v_mfma_f32_16x16x32_bf16 v[72:75], v[236:239], v[164:167], v[72:75]
  ds_read_b64_tr_b16 v[228:229], v20 offset:12288
  v_mfma_f32_16x16x32_bf16 v[72:75], v[232:235], v[160:163], v[72:75]
  ds_read_b64_tr_b16 v[230:231], v20 offset:14336
  buffer_load_dwordx4 v[220:223], v11, s[64:67], s69 offen offset:1024 sc1
  s_waitcnt lgkmcnt(8)
  v_mfma_f32_16x16x32_bf16 v[80:83], v[240:243], v[160:163], v[80:83]
  ds_read_b64_tr_b16 v[232:233], v21 offset:8192
  v_mfma_f32_16x16x32_bf16 v[80:83], v[244:247], v[164:167], v[80:83]
  ds_read_b64_tr_b16 v[234:235], v21 offset:10240
  s_add_u32 m0, s10, 81920
  s_add_u32 s12, s21, 4063232
  buffer_load_dwordx4 v15, s[52:55], s12 offen lds
  v_mfma_f32_16x16x32_bf16 v[84:87], v[244:247], v[172:175], v[84:87]
  ds_read_b64_tr_b16 v[236:237], v21 offset:12288
  v_mfma_f32_16x16x32_bf16 v[84:87], v[240:243], v[168:171], v[84:87]
  ds_read_b64_tr_b16 v[238:239], v21 offset:14336
  s_add_u32 m0, s10, 86016
  s_add_u32 s12, s21, 4128768
  buffer_load_dwordx4 v15, s[52:55], s12 offen lds
  s_waitcnt lgkmcnt(8)
  v_mfma_f32_16x16x32_bf16 v[92:95], v[248:251], v[168:171], v[92:95]
  ds_read_b64_tr_b16 v[240:241], v22 offset:8192
  v_mfma_f32_16x16x32_bf16 v[92:95], v[252:255], v[172:175], v[92:95]
  ds_read_b64_tr_b16 v[242:243], v22 offset:10240
  s_add_u32 m0, s10, 90112
  s_add_u32 s12, s21, 4063232
  buffer_load_dwordx4 v13, s[52:55], s12 offen lds
  v_mfma_f32_16x16x32_bf16 v[88:91], v[252:255], v[164:167], v[88:91]
  ds_read_b64_tr_b16 v[244:245], v22 offset:12288
  v_mfma_f32_16x16x32_bf16 v[88:91], v[248:251], v[160:163], v[88:91]
  ds_read_b64_tr_b16 v[246:247], v22 offset:14336
  s_add_u32 m0, s10, 94208
  s_add_u32 s12, s21, 4128768
  buffer_load_dwordx4 v13, s[52:55], s12 offen lds
  s_waitcnt lgkmcnt(8)
  v_mfma_f32_16x16x32_bf16 v[96:99], v[224:227], v[160:163], v[96:99]
  ds_read_b64_tr_b16 v[248:249], v23 offset:8192
  v_mfma_f32_16x16x32_bf16 v[96:99], v[228:231], v[164:167], v[96:99]
  ds_read_b64_tr_b16 v[250:251], v23 offset:10240
  s_add_u32 m0, s10, 98304
  s_add_u32 s12, s21, 4194304
  buffer_load_dwordx4 v15, s[52:55], s12 offen lds
  v_mfma_f32_16x16x32_bf16 v[100:103], v[228:231], v[172:175], v[100:103]
  ds_read_b64_tr_b16 v[252:253], v23 offset:12288
  v_mfma_f32_16x16x32_bf16 v[100:103], v[224:227], v[168:171], v[100:103]
  ds_read_b64_tr_b16 v[254:255], v23 offset:14336
  s_add_u32 m0, s10, 102400
  s_add_u32 s12, s21, 4259840
  buffer_load_dwordx4 v15, s[52:55], s12 offen lds
  s_waitcnt lgkmcnt(8)
  v_mfma_f32_16x16x32_bf16 v[108:111], v[232:235], v[168:171], v[108:111]
  ds_read_b64_tr_b16 v[224:225], v20 offset:16384
  v_mfma_f32_16x16x32_bf16 v[108:111], v[236:239], v[172:175], v[108:111]
  ds_read_b64_tr_b16 v[226:227], v20 offset:18432
  s_add_u32 m0, s10, 106496
  s_add_u32 s12, s21, 4194304
  buffer_load_dwordx4 v13, s[52:55], s12 offen lds
  v_mfma_f32_16x16x32_bf16 v[104:107], v[236:239], v[164:167], v[104:107]
  ds_read_b64_tr_b16 v[228:229], v20 offset:20480
  v_mfma_f32_16x16x32_bf16 v[104:107], v[232:235], v[160:163], v[104:107]
  ds_read_b64_tr_b16 v[230:231], v20 offset:22528
  s_add_u32 m0, s10, 110592
  s_add_u32 s12, s21, 4259840
  buffer_load_dwordx4 v13, s[52:55], s12 offen lds
  s_waitcnt lgkmcnt(8)
  v_mfma_f32_16x16x32_bf16 v[112:115], v[240:243], v[160:163], v[112:115]
  ds_read_b64_tr_b16 v[232:233], v21 offset:16384
  v_mfma_f32_16x16x32_bf16 v[112:115], v[244:247], v[164:167], v[112:115]
  ds_read_b64_tr_b16 v[234:235], v21 offset:18432
  s_add_u32 s11, s5, 7
  s_and_b32 s11, s11, 15
  s_lshl_b32 s11, s11, 14
  s_add_u32 m0, s10, 32768
  s_add_u32 s12, s11, 27262976
  buffer_load_dwordx4 v14, s[64:67], s12 offen sc1 lds
  v_mfma_f32_16x16x32_bf16 v[116:119], v[244:247], v[172:175], v[116:119]
  ds_read_b64_tr_b16 v[236:237], v21 offset:20480
  v_mfma_f32_16x16x32_bf16 v[116:119], v[240:243], v[168:171], v[116:119]
  ds_read_b64_tr_b16 v[238:239], v21 offset:22528
  s_add_u32 m0, s10, 36864
  s_add_u32 s12, s11, 27267072
  buffer_load_dwordx4 v14, s[64:67], s12 offen sc1 lds
  s_waitcnt lgkmcnt(8)
  v_mfma_f32_16x16x32_bf16 v[124:127], v[248:251], v[168:171], v[124:127]
  ds_read_b64_tr_b16 v[240:241], v22 offset:16384
  v_mfma_f32_16x16x32_bf16 v[124:127], v[252:255], v[172:175], v[124:127]
  ds_read_b64_tr_b16 v[242:243], v22 offset:18432
  s_add_u32 m0, s10, 40960
  s_add_u32 s12, s11, 27271168
  buffer_load_dwordx4 v14, s[64:67], s12 offen sc1 lds
  v_mfma_f32_16x16x32_bf16 v[120:123], v[252:255], v[164:167], v[120:123]
  ds_read_b64_tr_b16 v[244:245], v22 offset:20480
  v_mfma_f32_16x16x32_bf16 v[120:123], v[248:251], v[160:163], v[120:123]
  ds_read_b64_tr_b16 v[246:247], v22 offset:22528
  s_add_u32 m0, s10, 45056
  s_add_u32 s12, s11, 27275264
  buffer_load_dwordx4 v14, s[64:67], s12 offen sc1 lds
  s_waitcnt lgkmcnt(8)
  v_mfma_f32_16x16x32_bf16 v[64:67], v[224:227], v[176:179], v[64:67]
  ds_read_b64_tr_b16 v[248:249], v23 offset:16384
  v_mfma_f32_16x16x32_bf16 v[64:67], v[228:231], v[180:183], v[64:67]
  ds_read_b64_tr_b16 v[250:251], v23 offset:18432
  s_add_u32 s69, s17, 61440
  buffer_load_dwordx4 v[28:31], v10, s[64:67], s69 offen offset:0 sc1
  v_mfma_f32_16x16x32_bf16 v[68:71], v[228:231], v[188:191], v[68:71]
  ds_read_b64_tr_b16 v[252:253], v23 offset:20480
  v_mfma_f32_16x16x32_bf16 v[68:71], v[224:227], v[184:187], v[68:71]
  ds_read_b64_tr_b16 v[254:255], v23 offset:22528
  buffer_load_dwordx4 v[32:35], v10, s[64:67], s69 offen offset:1024 sc1
  s_waitcnt lgkmcnt(8)
  v_mfma_f32_16x16x32_bf16 v[76:79], v[232:235], v[184:187], v[76:79]
  ds_read_b64_tr_b16 v[224:225], v20 offset:24576
  v_mfma_f32_16x16x32_bf16 v[76:79], v[236:239], v[188:191], v[76:79]
  ds_read_b64_tr_b16 v[226:227], v20 offset:26624
  buffer_load_dwordx4 v[36:39], v11, s[64:67], s69 offen offset:0 sc1
  v_mfma_f32_16x16x32_bf16 v[72:75], v[236:239], v[180:183], v[72:75]
  ds_read_b64_tr_b16 v[228:229], v20 offset:28672
  v_mfma_f32_16x16x32_bf16 v[72:75], v[232:235], v[176:179], v[72:75]
  ds_read_b64_tr_b16 v[230:231], v20 offset:30720
  buffer_load_dwordx4 v[40:43], v11, s[64:67], s69 offen offset:1024 sc1
  s_waitcnt lgkmcnt(8)
  v_mfma_f32_16x16x32_bf16 v[80:83], v[240:243], v[176:179], v[80:83]
  ds_read_b64_tr_b16 v[232:233], v21 offset:24576
  v_mfma_f32_16x16x32_bf16 v[80:83], v[244:247], v[180:183], v[80:83]
  ds_read_b64_tr_b16 v[234:235], v21 offset:26624
  v_mfma_f32_16x16x32_bf16 v[84:87], v[244:247], v[188:191], v[84:87]
  ds_read_b64_tr_b16 v[236:237], v21 offset:28672
  v_mfma_f32_16x16x32_bf16 v[84:87], v[240:243], v[184:187], v[84:87]
  ds_read_b64_tr_b16 v[238:239], v21 offset:30720
  s_waitcnt lgkmcnt(8)
  v_mfma_f32_16x16x32_bf16 v[92:95], v[248:251], v[184:187], v[92:95]
  ds_read_b64_tr_b16 v[240:241], v22 offset:24576
  v_mfma_f32_16x16x32_bf16 v[92:95], v[252:255], v[188:191], v[92:95]
  ds_read_b64_tr_b16 v[242:243], v22 offset:26624
  v_mfma_f32_16x16x32_bf16 v[88:91], v[252:255], v[180:183], v[88:91]
  ds_read_b64_tr_b16 v[244:245], v22 offset:28672
  v_mfma_f32_16x16x32_bf16 v[88:91], v[248:251], v[176:179], v[88:91]
  ds_read_b64_tr_b16 v[246:247], v22 offset:30720
  s_waitcnt lgkmcnt(8)
  v_mfma_f32_16x16x32_bf16 v[96:99], v[224:227], v[176:179], v[96:99]
  ds_read_b64_tr_b16 v[248:249], v23 offset:24576
  v_mfma_f32_16x16x32_bf16 v[96:99], v[228:231], v[180:183], v[96:99]
  ds_read_b64_tr_b16 v[250:251], v23 offset:26624
  v_mfma_f32_16x16x32_bf16 v[100:103], v[228:231], v[188:191], v[100:103]
  ds_read_b64_tr_b16 v[252:253], v23 offset:28672
  v_mfma_f32_16x16x32_bf16 v[100:103], v[224:227], v[184:187], v[100:103]
  ds_read_b64_tr_b16 v[254:255], v23 offset:30720
  s_waitcnt lgkmcnt(8)
  v_mfma_f32_16x16x32_bf16 v[108:111], v[232:235], v[184:187], v[108:111]
  ds_read_b64_tr_b16 v[224:225], v20 offset:32768
  v_mfma_f32_16x16x32_bf16 v[108:111], v[236:239], v[188:191], v[108:111]
  ds_read_b64_tr_b16 v[226:227], v20 offset:34816
  v_mfma_f32_16x16x32_bf16 v[104:107], v[236:239], v[180:183], v[104:107]
  ds_read_b64_tr_b16 v[228:229], v20 offset:36864
  v_mfma_f32_16x16x32_bf16 v[104:107], v[232:235], v[176:179], v[104:107]
  ds_read_b64_tr_b16 v[230:231], v20 offset:38912
  s_waitcnt lgkmcnt(8)
  v_mfma_f32_16x16x32_bf16 v[112:115], v[240:243], v[176:179], v[112:115]
  ds_read_b64_tr_b16 v[232:233], v21 offset:32768
  v_mfma_f32_16x16x32_bf16 v[112:115], v[244:247], v[180:183], v[112:115]
  ds_read_b64_tr_b16 v[234:235], v21 offset:34816
  v_mfma_f32_16x16x32_bf16 v[116:119], v[244:247], v[188:191], v[116:119]
  ds_read_b64_tr_b16 v[236:237], v21 offset:36864
  v_mfma_f32_16x16x32_bf16 v[116:119], v[240:243], v[184:187], v[116:119]
  ds_read_b64_tr_b16 v[238:239], v21 offset:38912
  s_waitcnt lgkmcnt(8)
  v_mfma_f32_16x16x32_bf16 v[124:127], v[248:251], v[184:187], v[124:127]
  ds_read_b64_tr_b16 v[240:241], v22 offset:32768
  v_mfma_f32_16x16x32_bf16 v[124:127], v[252:255], v[188:191], v[124:127]
  ds_read_b64_tr_b16 v[242:243], v22 offset:34816
  v_mfma_f32_16x16x32_bf16 v[120:123], v[252:255], v[180:183], v[120:123]
  ds_read_b64_tr_b16 v[244:245], v22 offset:36864
  v_mfma_f32_16x16x32_bf16 v[120:123], v[248:251], v[176:179], v[120:123]
  ds_read_b64_tr_b16 v[246:247], v22 offset:38912
  s_waitcnt vmcnt(20)
  s_barrier
  s_waitcnt lgkmcnt(8)
  v_mfma_f32_16x16x32_bf16 v[64:67], v[224:227], v[192:195], v[64:67]
  ds_read_b64_tr_b16 v[248:249], v23 offset:32768
  v_mfma_f32_16x16x32_bf16 v[64:67], v[228:231], v[196:199], v[64:67]
  ds_read_b64_tr_b16 v[250:251], v23 offset:34816
  s_add_u32 s69, s17, 63488
  buffer_load_dwordx4 v[44:47], v10, s[64:67], s69 offen offset:0 sc1
  v_mfma_f32_16x16x32_bf16 v[68:71], v[228:231], v[204:207], v[68:71]
  ds_read_b64_tr_b16 v[252:253], v23 offset:36864
  v_mfma_f32_16x16x32_bf16 v[68:71], v[224:227], v[200:203], v[68:71]
  ds_read_b64_tr_b16 v[254:255], v23 offset:38912
  buffer_load_dwordx4 v[48:51], v10, s[64:67], s69 offen offset:1024 sc1
  s_waitcnt lgkmcnt(8)
  v_mfma_f32_16x16x32_bf16 v[76:79], v[232:235], v[200:203], v[76:79]
  ds_read_b64_tr_b16 v[224:225], v20 offset:40960
  v_mfma_f32_16x16x32_bf16 v[76:79], v[236:239], v[204:207], v[76:79]
  ds_read_b64_tr_b16 v[226:227], v20 offset:43008
  buffer_load_dwordx4 v[52:55], v11, s[64:67], s69 offen offset:0 sc1
  v_mfma_f32_16x16x32_bf16 v[72:75], v[236:239], v[196:199], v[72:75]
  ds_read_b64_tr_b16 v[228:229], v20 offset:45056
  v_mfma_f32_16x16x32_bf16 v[72:75], v[232:235], v[192:195], v[72:75]
  ds_read_b64_tr_b16 v[230:231], v20 offset:47104
  buffer_load_dwordx4 v[56:59], v11, s[64:67], s69 offen offset:1024 sc1
  s_waitcnt lgkmcnt(8)
  v_mfma_f32_16x16x32_bf16 v[80:83], v[240:243], v[192:195], v[80:83]
  ds_read_b64_tr_b16 v[232:233], v21 offset:40960
  v_mfma_f32_16x16x32_bf16 v[80:83], v[244:247], v[196:199], v[80:83]
  ds_read_b64_tr_b16 v[234:235], v21 offset:43008
  s_add_u32 m0, s10, 114688
  s_add_u32 s12, s21, 4325376
  buffer_load_dwordx4 v15, s[52:55], s12 offen lds
  v_mfma_f32_16x16x32_bf16 v[84:87], v[244:247], v[204:207], v[84:87]
  ds_read_b64_tr_b16 v[236:237], v21 offset:45056
  v_mfma_f32_16x16x32_bf16 v[84:87], v[240:243], v[200:203], v[84:87]
  ds_read_b64_tr_b16 v[238:239], v21 offset:47104
  s_add_u32 m0, s10, 118784
  s_add_u32 s12, s21, 4390912
  buffer_load_dwordx4 v15, s[52:55], s12 offen lds
  s_waitcnt lgkmcnt(8)
  v_mfma_f32_16x16x32_bf16 v[92:95], v[248:251], v[200:203], v[92:95]
  ds_read_b64_tr_b16 v[240:241], v22 offset:40960
  v_mfma_f32_16x16x32_bf16 v[92:95], v[252:255], v[204:207], v[92:95]
  ds_read_b64_tr_b16 v[242:243], v22 offset:43008
  s_add_u32 m0, s10, 122880
  s_add_u32 s12, s21, 4325376
  buffer_load_dwordx4 v13, s[52:55], s12 offen lds
  v_mfma_f32_16x16x32_bf16 v[88:91], v[252:255], v[196:199], v[88:91]
  ds_read_b64_tr_b16 v[244:245], v22 offset:45056
  v_mfma_f32_16x16x32_bf16 v[88:91], v[248:251], v[192:195], v[88:91]
  ds_read_b64_tr_b16 v[246:247], v22 offset:47104
  s_add_u32 m0, s10, 126976
  s_add_u32 s12, s21, 4390912
  buffer_load_dwordx4 v13, s[52:55], s12 offen lds
  s_waitcnt lgkmcnt(8)
  v_mfma_f32_16x16x32_bf16 v[96:99], v[224:227], v[192:195], v[96:99]
  ds_read_b64_tr_b16 v[248:249], v23 offset:40960
  v_mfma_f32_16x16x32_bf16 v[96:99], v[228:231], v[196:199], v[96:99]
  ds_read_b64_tr_b16 v[250:251], v23 offset:43008
  s_add_u32 m0, s10, 131072
  s_add_u32 s12, s21, 4456448
  buffer_load_dwordx4 v15, s[52:55], s12 offen lds
  v_mfma_f32_16x16x32_bf16 v[100:103], v[228:231], v[204:207], v[100:103]
  ds_read_b64_tr_b16 v[252:253], v23 offset:45056
  v_mfma_f32_16x16x32_bf16 v[100:103], v[224:227], v[200:203], v[100:103]
  ds_read_b64_tr_b16 v[254:255], v23 offset:47104
  s_add_u32 m0, s10, 135168
  s_add_u32 s12, s21, 4521984
  buffer_load_dwordx4 v15, s[52:55], s12 offen lds
  s_waitcnt lgkmcnt(8)
  v_mfma_f32_16x16x32_bf16 v[108:111], v[232:235], v[200:203], v[108:111]
  ds_read_b64_tr_b16 v[224:225], v16 offset:0
  v_mfma_f32_16x16x32_bf16 v[108:111], v[236:239], v[204:207], v[108:111]
  ds_read_b64_tr_b16 v[226:227], v16 offset:2048
  s_add_u32 m0, s10, 139264
  s_add_u32 s12, s21, 4456448
  buffer_load_dwordx4 v13, s[52:55], s12 offen lds
  v_mfma_f32_16x16x32_bf16 v[104:107], v[236:239], v[196:199], v[104:107]
  ds_read_b64_tr_b16 v[228:229], v16 offset:4096
  v_mfma_f32_16x16x32_bf16 v[104:107], v[232:235], v[192:195], v[104:107]
  ds_read_b64_tr_b16 v[230:231], v16 offset:6144
  s_add_u32 m0, s10, 143360
  s_add_u32 s12, s21, 4521984
  buffer_load_dwordx4 v13, s[52:55], s12 offen lds
  s_waitcnt lgkmcnt(8)
  v_mfma_f32_16x16x32_bf16 v[112:115], v[240:243], v[192:195], v[112:115]
  ds_read_b64_tr_b16 v[232:233], v17 offset:0
  v_mfma_f32_16x16x32_bf16 v[112:115], v[244:247], v[196:199], v[112:115]
  ds_read_b64_tr_b16 v[234:235], v17 offset:2048
  s_add_u32 s11, s5, 8
  s_and_b32 s11, s11, 15
  s_lshl_b32 s11, s11, 14
  s_add_u32 m0, s10, 16384
  s_add_u32 s12, s11, 27262976
  buffer_load_dwordx4 v14, s[64:67], s12 offen sc1 lds
  v_mfma_f32_16x16x32_bf16 v[116:119], v[244:247], v[204:207], v[116:119]
  ds_read_b64_tr_b16 v[236:237], v17 offset:4096
  v_mfma_f32_16x16x32_bf16 v[116:119], v[240:243], v[200:203], v[116:119]
  ds_read_b64_tr_b16 v[238:239], v17 offset:6144
  s_add_u32 m0, s10, 20480
  s_add_u32 s12, s11, 27267072
  buffer_load_dwordx4 v14, s[64:67], s12 offen sc1 lds
  s_waitcnt lgkmcnt(8)
  v_mfma_f32_16x16x32_bf16 v[124:127], v[248:251], v[200:203], v[124:127]
  ds_read_b64_tr_b16 v[240:241], v18 offset:0
  v_mfma_f32_16x16x32_bf16 v[124:127], v[252:255], v[204:207], v[124:127]
  ds_read_b64_tr_b16 v[242:243], v18 offset:2048
  s_add_u32 m0, s10, 24576
  s_add_u32 s12, s11, 27271168
  buffer_load_dwordx4 v14, s[64:67], s12 offen sc1 lds
  v_mfma_f32_16x16x32_bf16 v[120:123], v[252:255], v[196:199], v[120:123]
  ds_read_b64_tr_b16 v[244:245], v18 offset:4096
  v_mfma_f32_16x16x32_bf16 v[120:123], v[248:251], v[192:195], v[120:123]
  ds_read_b64_tr_b16 v[246:247], v18 offset:6144
  s_add_u32 m0, s10, 28672
  s_add_u32 s12, s11, 27275264
  buffer_load_dwordx4 v14, s[64:67], s12 offen sc1 lds
  s_waitcnt vmcnt(32)
  s_waitcnt lgkmcnt(8)
  v_mfma_f32_16x16x32_bf16 v[64:67], v[224:227], v[208:211], v[64:67]
  ds_read_b64_tr_b16 v[248:249], v19 offset:0
  v_mfma_f32_16x16x32_bf16 v[64:67], v[228:231], v[212:215], v[64:67]
  ds_read_b64_tr_b16 v[250:251], v19 offset:2048
  s_add_u32 s69, s17, 65536
  buffer_load_dwordx4 v[128:131], v10, s[64:67], s69 offen offset:0 sc1
  v_mfma_f32_16x16x32_bf16 v[68:71], v[228:231], v[220:223], v[68:71]
  ds_read_b64_tr_b16 v[252:253], v19 offset:4096
  v_mfma_f32_16x16x32_bf16 v[68:71], v[224:227], v[216:219], v[68:71]
  ds_read_b64_tr_b16 v[254:255], v19 offset:6144
  buffer_load_dwordx4 v[132:135], v10, s[64:67], s69 offen offset:1024 sc1
  s_waitcnt lgkmcnt(8)
  v_mfma_f32_16x16x32_bf16 v[76:79], v[232:235], v[216:219], v[76:79]
  ds_read_b64_tr_b16 v[224:225], v16 offset:8192
  v_mfma_f32_16x16x32_bf16 v[76:79], v[236:239], v[220:223], v[76:79]
  ds_read_b64_tr_b16 v[226:227], v16 offset:10240
  buffer_load_dwordx4 v[136:139], v11, s[64:67], s69 offen offset:0 sc1
  v_mfma_f32_16x16x32_bf16 v[72:75], v[236:239], v[212:215], v[72:75]
  ds_read_b64_tr_b16 v[228:229], v16 offset:12288
  v_mfma_f32_16x16x32_bf16 v[72:75], v[232:235], v[208:211], v[72:75]
  ds_read_b64_tr_b16 v[230:231], v16 offset:14336
  buffer_load_dwordx4 v[140:143], v11, s[64:67], s69 offen offset:1024 sc1
  s_waitcnt lgkmcnt(8)
  v_mfma_f32_16x16x32_bf16 v[80:83], v[240:243], v[208:211], v[80:83]
  ds_read_b64_tr_b16 v[232:233], v17 offset:8192
  v_mfma_f32_16x16x32_bf16 v[80:83], v[244:247], v[212:215], v[80:83]
  ds_read_b64_tr_b16 v[234:235], v17 offset:10240
  v_mfma_f32_16x16x32_bf16 v[84:87], v[244:247], v[220:223], v[84:87]
  ds_read_b64_tr_b16 v[236:237], v17 offset:12288
  v_mfma_f32_16x16x32_bf16 v[84:87], v[240:243], v[216:219], v[84:87]
  ds_read_b64_tr_b16 v[238:239], v17 offset:14336
  s_waitcnt lgkmcnt(8)
  v_mfma_f32_16x16x32_bf16 v[92:95], v[248:251], v[216:219], v[92:95]
  ds_read_b64_tr_b16 v[240:241], v18 offset:8192
  v_mfma_f32_16x16x32_bf16 v[92:95], v[252:255], v[220:223], v[92:95]
  ds_read_b64_tr_b16 v[242:243], v18 offset:10240
  v_mfma_f32_16x16x32_bf16 v[88:91], v[252:255], v[212:215], v[88:91]
  ds_read_b64_tr_b16 v[244:245], v18 offset:12288
  v_mfma_f32_16x16x32_bf16 v[88:91], v[248:251], v[208:211], v[88:91]
  ds_read_b64_tr_b16 v[246:247], v18 offset:14336
  s_waitcnt lgkmcnt(8)
  v_mfma_f32_16x16x32_bf16 v[96:99], v[224:227], v[208:211], v[96:99]
  ds_read_b64_tr_b16 v[248:249], v19 offset:8192
  v_mfma_f32_16x16x32_bf16 v[96:99], v[228:231], v[212:215], v[96:99]
  ds_read_b64_tr_b16 v[250:251], v19 offset:10240
  v_mfma_f32_16x16x32_bf16 v[100:103], v[228:231], v[220:223], v[100:103]
  ds_read_b64_tr_b16 v[252:253], v19 offset:12288
  v_mfma_f32_16x16x32_bf16 v[100:103], v[224:227], v[216:219], v[100:103]
  ds_read_b64_tr_b16 v[254:255], v19 offset:14336
  s_waitcnt lgkmcnt(8)
  v_mfma_f32_16x16x32_bf16 v[108:111], v[232:235], v[216:219], v[108:111]
  ds_read_b64_tr_b16 v[224:225], v16 offset:16384
  v_mfma_f32_16x16x32_bf16 v[108:111], v[236:239], v[220:223], v[108:111]
  ds_read_b64_tr_b16 v[226:227], v16 offset:18432
  v_mfma_f32_16x16x32_bf16 v[104:107], v[236:239], v[212:215], v[104:107]
  ds_read_b64_tr_b16 v[228:229], v16 offset:20480
  v_mfma_f32_16x16x32_bf16 v[104:107], v[232:235], v[208:211], v[104:107]
  ds_read_b64_tr_b16 v[230:231], v16 offset:22528
  s_waitcnt lgkmcnt(8)
  v_mfma_f32_16x16x32_bf16 v[112:115], v[240:243], v[208:211], v[112:115]
  ds_read_b64_tr_b16 v[232:233], v17 offset:16384
  v_mfma_f32_16x16x32_bf16 v[112:115], v[244:247], v[212:215], v[112:115]
  ds_read_b64_tr_b16 v[234:235], v17 offset:18432
  v_mfma_f32_16x16x32_bf16 v[116:119], v[244:247], v[220:223], v[116:119]
  ds_read_b64_tr_b16 v[236:237], v17 offset:20480
  v_mfma_f32_16x16x32_bf16 v[116:119], v[240:243], v[216:219], v[116:119]
  ds_read_b64_tr_b16 v[238:239], v17 offset:22528
  s_waitcnt lgkmcnt(8)
  v_mfma_f32_16x16x32_bf16 v[124:127], v[248:251], v[216:219], v[124:127]
  ds_read_b64_tr_b16 v[240:241], v18 offset:16384
  v_mfma_f32_16x16x32_bf16 v[124:127], v[252:255], v[220:223], v[124:127]
  ds_read_b64_tr_b16 v[242:243], v18 offset:18432
  v_mfma_f32_16x16x32_bf16 v[120:123], v[252:255], v[212:215], v[120:123]
  ds_read_b64_tr_b16 v[244:245], v18 offset:20480
  v_mfma_f32_16x16x32_bf16 v[120:123], v[248:251], v[208:211], v[120:123]
  ds_read_b64_tr_b16 v[246:247], v18 offset:22528
  s_waitcnt vmcnt(24)
  s_barrier
  s_waitcnt vmcnt(20)
  s_waitcnt lgkmcnt(8)
  v_mfma_f32_16x16x32_bf16 v[64:67], v[224:227], v[28:31], v[64:67]
  ds_read_b64_tr_b16 v[248:249], v19 offset:16384
  v_mfma_f32_16x16x32_bf16 v[64:67], v[228:231], v[32:35], v[64:67]
  ds_read_b64_tr_b16 v[250:251], v19 offset:18432
  s_add_u32 s69, s17, 67584
  buffer_load_dwordx4 v[144:147], v10, s[64:67], s69 offen offset:0 sc1
  v_mfma_f32_16x16x32_bf16 v[68:71], v[228:231], v[40:43], v[68:71]
  ds_read_b64_tr_b16 v[252:253], v19 offset:20480
  v_mfma_f32_16x16x32_bf16 v[68:71], v[224:227], v[36:39], v[68:71]
  ds_read_b64_tr_b16 v[254:255], v19 offset:22528
  buffer_load_dwordx4 v[148:151], v10, s[64:67], s69 offen offset:1024 sc1
  s_waitcnt lgkmcnt(8)
  v_mfma_f32_16x16x32_bf16 v[76:79], v[232:235], v[36:39], v[76:79]
  ds_read_b64_tr_b16 v[224:225], v16 offset:24576
  v_mfma_f32_16x16x32_bf16 v[76:79], v[236:239], v[40:43], v[76:79]
  ds_read_b64_tr_b16 v[226:227], v16 offset:26624
  buffer_load_dwordx4 v[152:155], v11, s[64:67], s69 offen offset:0 sc1
  v_mfma_f32_16x16x32_bf16 v[72:75], v[236:239], v[32:35], v[72:75]
  ds_read_b64_tr_b16 v[228:229], v16 offset:28672
  v_mfma_f32_16x16x32_bf16 v[72:75], v[232:235], v[28:31], v[72:75]
  ds_read_b64_tr_b16 v[230:231], v16 offset:30720
  buffer_load_dwordx4 v[156:159], v11, s[64:67], s69 offen offset:1024 sc1
  s_waitcnt lgkmcnt(8)
  v_mfma_f32_16x16x32_bf16 v[80:83], v[240:243], v[28:31], v[80:83]
  ds_read_b64_tr_b16 v[232:233], v17 offset:24576
  v_mfma_f32_16x16x32_bf16 v[80:83], v[244:247], v[32:35], v[80:83]
  ds_read_b64_tr_b16 v[234:235], v17 offset:26624
  s_add_u32 m0, s10, 147456
  s_add_u32 s12, s21, 4587520
  buffer_load_dwordx4 v15, s[52:55], s12 offen lds
  v_mfma_f32_16x16x32_bf16 v[84:87], v[244:247], v[40:43], v[84:87]
  ds_read_b64_tr_b16 v[236:237], v17 offset:28672
  v_mfma_f32_16x16x32_bf16 v[84:87], v[240:243], v[36:39], v[84:87]
  ds_read_b64_tr_b16 v[238:239], v17 offset:30720
  s_add_u32 m0, s10, 151552
  s_add_u32 s12, s21, 4653056
  buffer_load_dwordx4 v15, s[52:55], s12 offen lds
  s_waitcnt lgkmcnt(8)
  v_mfma_f32_16x16x32_bf16 v[92:95], v[248:251], v[36:39], v[92:95]
  ds_read_b64_tr_b16 v[240:241], v18 offset:24576
  v_mfma_f32_16x16x32_bf16 v[92:95], v[252:255], v[40:43], v[92:95]
  ds_read_b64_tr_b16 v[242:243], v18 offset:26624
  s_add_u32 m0, s10, 155648
  s_add_u32 s12, s21, 4587520
  buffer_load_dwordx4 v13, s[52:55], s12 offen lds
  v_mfma_f32_16x16x32_bf16 v[88:91], v[252:255], v[32:35], v[88:91]
  ds_read_b64_tr_b16 v[244:245], v18 offset:28672
  v_mfma_f32_16x16x32_bf16 v[88:91], v[248:251], v[28:31], v[88:91]
  ds_read_b64_tr_b16 v[246:247], v18 offset:30720
  s_add_u32 m0, s10, 159744
  s_add_u32 s12, s21, 4653056
  buffer_load_dwordx4 v13, s[52:55], s12 offen lds
  s_waitcnt lgkmcnt(8)
  v_mfma_f32_16x16x32_bf16 v[96:99], v[224:227], v[28:31], v[96:99]
  ds_read_b64_tr_b16 v[248:249], v19 offset:24576
  v_mfma_f32_16x16x32_bf16 v[96:99], v[228:231], v[32:35], v[96:99]
  ds_read_b64_tr_b16 v[250:251], v19 offset:26624
  s_add_u32 m0, s10, 49152
  s_add_u32 s12, s22, 3932160
  buffer_load_dwordx4 v15, s[52:55], s12 offen lds
  v_mfma_f32_16x16x32_bf16 v[100:103], v[228:231], v[40:43], v[100:103]
  ds_read_b64_tr_b16 v[252:253], v19 offset:28672
  v_mfma_f32_16x16x32_bf16 v[100:103], v[224:227], v[36:39], v[100:103]
  ds_read_b64_tr_b16 v[254:255], v19 offset:30720
  s_add_u32 m0, s10, 53248
  s_add_u32 s12, s22, 3997696
  buffer_load_dwordx4 v15, s[52:55], s12 offen lds
  s_waitcnt lgkmcnt(8)
  v_mfma_f32_16x16x32_bf16 v[108:111], v[232:235], v[36:39], v[108:111]
  ds_read_b64_tr_b16 v[224:225], v16 offset:32768
  v_mfma_f32_16x16x32_bf16 v[108:111], v[236:239], v[40:43], v[108:111]
  ds_read_b64_tr_b16 v[226:227], v16 offset:34816
  s_add_u32 m0, s10, 57344
  s_add_u32 s12, s22, 3932160
  buffer_load_dwordx4 v13, s[52:55], s12 offen lds
  v_mfma_f32_16x16x32_bf16 v[104:107], v[236:239], v[32:35], v[104:107]
  ds_read_b64_tr_b16 v[228:229], v16 offset:36864
  v_mfma_f32_16x16x32_bf16 v[104:107], v[232:235], v[28:31], v[104:107]
  ds_read_b64_tr_b16 v[230:231], v16 offset:38912
  s_add_u32 m0, s10, 61440
  s_add_u32 s12, s22, 3997696
  buffer_load_dwordx4 v13, s[52:55], s12 offen lds
  s_waitcnt lgkmcnt(8)
  v_mfma_f32_16x16x32_bf16 v[112:115], v[240:243], v[28:31], v[112:115]
  ds_read_b64_tr_b16 v[232:233], v17 offset:32768
  v_mfma_f32_16x16x32_bf16 v[112:115], v[244:247], v[32:35], v[112:115]
  ds_read_b64_tr_b16 v[234:235], v17 offset:34816
  s_add_u32 s11, s5, 9
  s_and_b32 s11, s11, 15
  s_lshl_b32 s11, s11, 14
  s_add_u32 m0, s10, 0
  s_add_u32 s12, s11, 27262976
  buffer_load_dwordx4 v14, s[64:67], s12 offen sc1 lds
  v_mfma_f32_16x16x32_bf16 v[116:119], v[244:247], v[40:43], v[116:119]
  ds_read_b64_tr_b16 v[236:237], v17 offset:36864
  v_mfma_f32_16x16x32_bf16 v[116:119], v[240:243], v[36:39], v[116:119]
  ds_read_b64_tr_b16 v[238:239], v17 offset:38912
  s_add_u32 m0, s10, 4096
  s_add_u32 s12, s11, 27267072
  buffer_load_dwordx4 v14, s[64:67], s12 offen sc1 lds
  s_waitcnt lgkmcnt(8)
  v_mfma_f32_16x16x32_bf16 v[124:127], v[248:251], v[36:39], v[124:127]
  ds_read_b64_tr_b16 v[240:241], v18 offset:32768
  v_mfma_f32_16x16x32_bf16 v[124:127], v[252:255], v[40:43], v[124:127]
  ds_read_b64_tr_b16 v[242:243], v18 offset:34816
  s_add_u32 m0, s10, 8192
  s_add_u32 s12, s11, 27271168
  buffer_load_dwordx4 v14, s[64:67], s12 offen sc1 lds
  v_mfma_f32_16x16x32_bf16 v[120:123], v[252:255], v[32:35], v[120:123]
  ds_read_b64_tr_b16 v[244:245], v18 offset:36864
  v_mfma_f32_16x16x32_bf16 v[120:123], v[248:251], v[28:31], v[120:123]
  ds_read_b64_tr_b16 v[246:247], v18 offset:38912
  s_add_u32 m0, s10, 12288
  s_add_u32 s12, s11, 27275264
  buffer_load_dwordx4 v14, s[64:67], s12 offen sc1 lds
  s_waitcnt vmcnt(32)
  s_waitcnt lgkmcnt(8)
  v_mfma_f32_16x16x32_bf16 v[64:67], v[224:227], v[44:47], v[64:67]
  ds_read_b64_tr_b16 v[248:249], v19 offset:32768
  v_mfma_f32_16x16x32_bf16 v[64:67], v[228:231], v[48:51], v[64:67]
  ds_read_b64_tr_b16 v[250:251], v19 offset:34816
  s_add_u32 s69, s17, 69632
  buffer_load_dwordx4 v[160:163], v10, s[64:67], s69 offen offset:0 sc1
  v_mfma_f32_16x16x32_bf16 v[68:71], v[228:231], v[56:59], v[68:71]
  ds_read_b64_tr_b16 v[252:253], v19 offset:36864
  v_mfma_f32_16x16x32_bf16 v[68:71], v[224:227], v[52:55], v[68:71]
  ds_read_b64_tr_b16 v[254:255], v19 offset:38912
  buffer_load_dwordx4 v[164:167], v10, s[64:67], s69 offen offset:1024 sc1
  s_waitcnt lgkmcnt(8)
  v_mfma_f32_16x16x32_bf16 v[76:79], v[232:235], v[52:55], v[76:79]
  ds_read_b64_tr_b16 v[224:225], v16 offset:40960
  v_mfma_f32_16x16x32_bf16 v[76:79], v[236:239], v[56:59], v[76:79]
  ds_read_b64_tr_b16 v[226:227], v16 offset:43008
  buffer_load_dwordx4 v[168:171], v11, s[64:67], s69 offen offset:0 sc1
  v_mfma_f32_16x16x32_bf16 v[72:75], v[236:239], v[48:51], v[72:75]
  ds_read_b64_tr_b16 v[228:229], v16 offset:45056
  v_mfma_f32_16x16x32_bf16 v[72:75], v[232:235], v[44:47], v[72:75]
  ds_read_b64_tr_b16 v[230:231], v16 offset:47104
  buffer_load_dwordx4 v[172:175], v11, s[64:67], s69 offen offset:1024 sc1
  s_waitcnt lgkmcnt(8)
  v_mfma_f32_16x16x32_bf16 v[80:83], v[240:243], v[44:47], v[80:83]
  ds_read_b64_tr_b16 v[232:233], v17 offset:40960
  v_mfma_f32_16x16x32_bf16 v[80:83], v[244:247], v[48:51], v[80:83]
  ds_read_b64_tr_b16 v[234:235], v17 offset:43008
  v_mfma_f32_16x16x32_bf16 v[84:87], v[244:247], v[56:59], v[84:87]
  ds_read_b64_tr_b16 v[236:237], v17 offset:45056
  v_mfma_f32_16x16x32_bf16 v[84:87], v[240:243], v[52:55], v[84:87]
  ds_read_b64_tr_b16 v[238:239], v17 offset:47104
  s_waitcnt lgkmcnt(8)
  v_mfma_f32_16x16x32_bf16 v[92:95], v[248:251], v[52:55], v[92:95]
  ds_read_b64_tr_b16 v[240:241], v18 offset:40960
  v_mfma_f32_16x16x32_bf16 v[92:95], v[252:255], v[56:59], v[92:95]
  ds_read_b64_tr_b16 v[242:243], v18 offset:43008
  v_mfma_f32_16x16x32_bf16 v[88:91], v[252:255], v[48:51], v[88:91]
  ds_read_b64_tr_b16 v[244:245], v18 offset:45056
  v_mfma_f32_16x16x32_bf16 v[88:91], v[248:251], v[44:47], v[88:91]
  ds_read_b64_tr_b16 v[246:247], v18 offset:47104
  s_waitcnt lgkmcnt(8)
  v_mfma_f32_16x16x32_bf16 v[96:99], v[224:227], v[44:47], v[96:99]
  ds_read_b64_tr_b16 v[248:249], v19 offset:40960
  v_mfma_f32_16x16x32_bf16 v[96:99], v[228:231], v[48:51], v[96:99]
  ds_read_b64_tr_b16 v[250:251], v19 offset:43008
  v_mfma_f32_16x16x32_bf16 v[100:103], v[228:231], v[56:59], v[100:103]
  ds_read_b64_tr_b16 v[252:253], v19 offset:45056
  v_mfma_f32_16x16x32_bf16 v[100:103], v[224:227], v[52:55], v[100:103]
  ds_read_b64_tr_b16 v[254:255], v19 offset:47104
  s_waitcnt lgkmcnt(8)
  v_mfma_f32_16x16x32_bf16 v[108:111], v[232:235], v[52:55], v[108:111]
  ds_read_b64_tr_b16 v[224:225], v16 offset:49152
  v_mfma_f32_16x16x32_bf16 v[108:111], v[236:239], v[56:59], v[108:111]
  ds_read_b64_tr_b16 v[226:227], v16 offset:51200
  v_mfma_f32_16x16x32_bf16 v[104:107], v[236:239], v[48:51], v[104:107]
  ds_read_b64_tr_b16 v[228:229], v16 offset:53248
  v_mfma_f32_16x16x32_bf16 v[104:107], v[232:235], v[44:47], v[104:107]
  ds_read_b64_tr_b16 v[230:231], v16 offset:55296
  s_waitcnt lgkmcnt(8)
  v_mfma_f32_16x16x32_bf16 v[112:115], v[240:243], v[44:47], v[112:115]
  ds_read_b64_tr_b16 v[232:233], v17 offset:49152
  v_mfma_f32_16x16x32_bf16 v[112:115], v[244:247], v[48:51], v[112:115]
  ds_read_b64_tr_b16 v[234:235], v17 offset:51200
  v_mfma_f32_16x16x32_bf16 v[116:119], v[244:247], v[56:59], v[116:119]
  ds_read_b64_tr_b16 v[236:237], v17 offset:53248
  v_mfma_f32_16x16x32_bf16 v[116:119], v[240:243], v[52:55], v[116:119]
  ds_read_b64_tr_b16 v[238:239], v17 offset:55296
  s_waitcnt lgkmcnt(8)
  v_mfma_f32_16x16x32_bf16 v[124:127], v[248:251], v[52:55], v[124:127]
  ds_read_b64_tr_b16 v[240:241], v18 offset:49152
  v_mfma_f32_16x16x32_bf16 v[124:127], v[252:255], v[56:59], v[124:127]
  ds_read_b64_tr_b16 v[242:243], v18 offset:51200
  v_mfma_f32_16x16x32_bf16 v[120:123], v[252:255], v[48:51], v[120:123]
  ds_read_b64_tr_b16 v[244:245], v18 offset:53248
  v_mfma_f32_16x16x32_bf16 v[120:123], v[248:251], v[44:47], v[120:123]
  ds_read_b64_tr_b16 v[246:247], v18 offset:55296
  s_waitcnt vmcnt(20)
  s_waitcnt lgkmcnt(8)
  v_mfma_f32_16x16x32_bf16 v[64:67], v[224:227], v[128:131], v[64:67]
  ds_read_b64_tr_b16 v[248:249], v19 offset:49152
  v_mfma_f32_16x16x32_bf16 v[64:67], v[228:231], v[132:135], v[64:67]
  ds_read_b64_tr_b16 v[250:251], v19 offset:51200
  s_add_u32 s69, s17, 71680
  buffer_load_dwordx4 v[176:179], v10, s[64:67], s69 offen offset:0 sc1
  v_mfma_f32_16x16x32_bf16 v[68:71], v[228:231], v[140:143], v[68:71]
  ds_read_b64_tr_b16 v[252:253], v19 offset:53248
  v_mfma_f32_16x16x32_bf16 v[68:71], v[224:227], v[136:139], v[68:71]
  ds_read_b64_tr_b16 v[254:255], v19 offset:55296
  buffer_load_dwordx4 v[180:183], v10, s[64:67], s69 offen offset:1024 sc1
  s_barrier
  s_waitcnt lgkmcnt(8)
  v_mfma_f32_16x16x32_bf16 v[76:79], v[232:235], v[136:139], v[76:79]
  ds_read_b64_tr_b16 v[224:225], v16 offset:57344
  v_mfma_f32_16x16x32_bf16 v[76:79], v[236:239], v[140:143], v[76:79]
  ds_read_b64_tr_b16 v[226:227], v16 offset:59392
  buffer_load_dwordx4 v[184:187], v11, s[64:67], s69 offen offset:0 sc1
  v_mfma_f32_16x16x32_bf16 v[72:75], v[236:239], v[132:135], v[72:75]
  ds_read_b64_tr_b16 v[228:229], v16 offset:61440
  v_mfma_f32_16x16x32_bf16 v[72:75], v[232:235], v[128:131], v[72:75]
  ds_read_b64_tr_b16 v[230:231], v16 offset:63488
  buffer_load_dwordx4 v[188:191], v11, s[64:67], s69 offen offset:1024 sc1
  s_waitcnt lgkmcnt(8)
  v_mfma_f32_16x16x32_bf16 v[80:83], v[240:243], v[128:131], v[80:83]
  ds_read_b64_tr_b16 v[232:233], v17 offset:57344
  v_mfma_f32_16x16x32_bf16 v[80:83], v[244:247], v[132:135], v[80:83]
  ds_read_b64_tr_b16 v[234:235], v17 offset:59392
  s_add_u32 m0, s10, 65536
  s_add_u32 s12, s22, 4063232
  buffer_load_dwordx4 v15, s[52:55], s12 offen lds
  v_mfma_f32_16x16x32_bf16 v[84:87], v[244:247], v[140:143], v[84:87]
  ds_read_b64_tr_b16 v[236:237], v17 offset:61440
  v_mfma_f32_16x16x32_bf16 v[84:87], v[240:243], v[136:139], v[84:87]
  ds_read_b64_tr_b16 v[238:239], v17 offset:63488
  s_add_u32 m0, s10, 69632
  s_add_u32 s12, s22, 4128768
  buffer_load_dwordx4 v15, s[52:55], s12 offen lds
  s_waitcnt lgkmcnt(8)
  v_mfma_f32_16x16x32_bf16 v[92:95], v[248:251], v[136:139], v[92:95]
  ds_read_b64_tr_b16 v[240:241], v18 offset:57344
  v_mfma_f32_16x16x32_bf16 v[92:95], v[252:255], v[140:143], v[92:95]
  ds_read_b64_tr_b16 v[242:243], v18 offset:59392
  s_add_u32 m0, s10, 73728
  s_add_u32 s12, s22, 4063232
  buffer_load_dwordx4 v13, s[52:55], s12 offen lds
  v_mfma_f32_16x16x32_bf16 v[88:91], v[252:255], v[132:135], v[88:91]
  ds_read_b64_tr_b16 v[244:245], v18 offset:61440
  v_mfma_f32_16x16x32_bf16 v[88:91], v[248:251], v[128:131], v[88:91]
  ds_read_b64_tr_b16 v[246:247], v18 offset:63488
  s_add_u32 m0, s10, 77824
  s_add_u32 s12, s22, 4128768
  buffer_load_dwordx4 v13, s[52:55], s12 offen lds
  s_waitcnt lgkmcnt(8)
  v_mfma_f32_16x16x32_bf16 v[96:99], v[224:227], v[128:131], v[96:99]
  ds_read_b64_tr_b16 v[248:249], v19 offset:57344
  v_mfma_f32_16x16x32_bf16 v[96:99], v[228:231], v[132:135], v[96:99]
  ds_read_b64_tr_b16 v[250:251], v19 offset:59392
  s_add_u32 m0, s10, 81920
  s_add_u32 s12, s22, 4194304
  buffer_load_dwordx4 v15, s[52:55], s12 offen lds
  v_mfma_f32_16x16x32_bf16 v[100:103], v[228:231], v[140:143], v[100:103]
  ds_read_b64_tr_b16 v[252:253], v19 offset:61440
  v_mfma_f32_16x16x32_bf16 v[100:103], v[224:227], v[136:139], v[100:103]
  ds_read_b64_tr_b16 v[254:255], v19 offset:63488
  s_add_u32 m0, s10, 86016
  s_add_u32 s12, s22, 4259840
  buffer_load_dwordx4 v15, s[52:55], s12 offen lds
  s_waitcnt lgkmcnt(8)
  v_mfma_f32_16x16x32_bf16 v[108:111], v[232:235], v[136:139], v[108:111]
  ds_read_b64_tr_b16 v[224:225], v20 offset:0
  v_mfma_f32_16x16x32_bf16 v[108:111], v[236:239], v[140:143], v[108:111]
  ds_read_b64_tr_b16 v[226:227], v20 offset:2048
  s_add_u32 m0, s10, 90112
  s_add_u32 s12, s22, 4194304
  buffer_load_dwordx4 v13, s[52:55], s12 offen lds
  v_mfma_f32_16x16x32_bf16 v[104:107], v[236:239], v[132:135], v[104:107]
  ds_read_b64_tr_b16 v[228:229], v20 offset:4096
  v_mfma_f32_16x16x32_bf16 v[104:107], v[232:235], v[128:131], v[104:107]
  ds_read_b64_tr_b16 v[230:231], v20 offset:6144
  s_add_u32 m0, s10, 94208
  s_add_u32 s12, s22, 4259840
  buffer_load_dwordx4 v13, s[52:55], s12 offen lds
  s_waitcnt lgkmcnt(8)
  v_mfma_f32_16x16x32_bf16 v[112:115], v[240:243], v[128:131], v[112:115]
  ds_read_b64_tr_b16 v[232:233], v21 offset:0
  v_mfma_f32_16x16x32_bf16 v[112:115], v[244:247], v[132:135], v[112:115]
  ds_read_b64_tr_b16 v[234:235], v21 offset:2048
  s_add_u32 s11, s5, 10
  s_and_b32 s11, s11, 15
  s_lshl_b32 s11, s11, 14
  s_add_u32 m0, s10, 32768
  s_add_u32 s12, s11, 27262976
  buffer_load_dwordx4 v14, s[64:67], s12 offen sc1 lds
  v_mfma_f32_16x16x32_bf16 v[116:119], v[244:247], v[140:143], v[116:119]
  ds_read_b64_tr_b16 v[236:237], v21 offset:4096
  v_mfma_f32_16x16x32_bf16 v[116:119], v[240:243], v[136:139], v[116:119]
  ds_read_b64_tr_b16 v[238:239], v21 offset:6144
  s_add_u32 m0, s10, 36864
  s_add_u32 s12, s11, 27267072
  buffer_load_dwordx4 v14, s[64:67], s12 offen sc1 lds
  s_waitcnt lgkmcnt(8)
  v_mfma_f32_16x16x32_bf16 v[124:127], v[248:251], v[136:139], v[124:127]
  ds_read_b64_tr_b16 v[240:241], v22 offset:0
  v_mfma_f32_16x16x32_bf16 v[124:127], v[252:255], v[140:143], v[124:127]
  ds_read_b64_tr_b16 v[242:243], v22 offset:2048
  s_add_u32 m0, s10, 40960
  s_add_u32 s12, s11, 27271168
  buffer_load_dwordx4 v14, s[64:67], s12 offen sc1 lds
  v_mfma_f32_16x16x32_bf16 v[120:123], v[252:255], v[132:135], v[120:123]
  ds_read_b64_tr_b16 v[244:245], v22 offset:4096
  v_mfma_f32_16x16x32_bf16 v[120:123], v[248:251], v[128:131], v[120:123]
  ds_read_b64_tr_b16 v[246:247], v22 offset:6144
  s_add_u32 m0, s10, 45056
  s_add_u32 s12, s11, 27275264
  buffer_load_dwordx4 v14, s[64:67], s12 offen sc1 lds
  s_waitcnt vmcnt(32)
  s_waitcnt lgkmcnt(8)
  v_mfma_f32_16x16x32_bf16 v[64:67], v[224:227], v[144:147], v[64:67]
  ds_read_b64_tr_b16 v[248:249], v23 offset:0
  v_mfma_f32_16x16x32_bf16 v[64:67], v[228:231], v[148:151], v[64:67]
  ds_read_b64_tr_b16 v[250:251], v23 offset:2048
  s_add_u32 s69, s18, 61440
  buffer_load_dwordx4 v[192:195], v10, s[64:67], s69 offen offset:0 sc1
  v_mfma_f32_16x16x32_bf16 v[68:71], v[228:231], v[156:159], v[68:71]
  ds_read_b64_tr_b16 v[252:253], v23 offset:4096
  v_mfma_f32_16x16x32_bf16 v[68:71], v[224:227], v[152:155], v[68:71]
  ds_read_b64_tr_b16 v[254:255], v23 offset:6144
  buffer_load_dwordx4 v[196:199], v10, s[64:67], s69 offen offset:1024 sc1
  s_waitcnt lgkmcnt(8)
  v_mfma_f32_16x16x32_bf16 v[76:79], v[232:235], v[152:155], v[76:79]
  ds_read_b64_tr_b16 v[224:225], v20 offset:8192
  v_mfma_f32_16x16x32_bf16 v[76:79], v[236:239], v[156:159], v[76:79]
  ds_read_b64_tr_b16 v[226:227], v20 offset:10240
  buffer_load_dwordx4 v[200:203], v11, s[64:67], s69 offen offset:0 sc1
  v_mfma_f32_16x16x32_bf16 v[72:75], v[236:239], v[148:151], v[72:75]
  ds_read_b64_tr_b16 v[228:229], v20 offset:12288
  v_mfma_f32_16x16x32_bf16 v[72:75], v[232:235], v[144:147], v[72:75]
  ds_read_b64_tr_b16 v[230:231], v20 offset:14336
  buffer_load_dwordx4 v[204:207], v11, s[64:67], s69 offen offset:1024 sc1
  s_waitcnt lgkmcnt(8)
  v_mfma_f32_16x16x32_bf16 v[80:83], v[240:243], v[144:147], v[80:83]
  ds_read_b64_tr_b16 v[232:233], v21 offset:8192
  v_mfma_f32_16x16x32_bf16 v[80:83], v[244:247], v[148:151], v[80:83]
  ds_read_b64_tr_b16 v[234:235], v21 offset:10240
  v_mfma_f32_16x16x32_bf16 v[84:87], v[244:247], v[156:159], v[84:87]
  ds_read_b64_tr_b16 v[236:237], v21 offset:12288
  v_mfma_f32_16x16x32_bf16 v[84:87], v[240:243], v[152:155], v[84:87]
  ds_read_b64_tr_b16 v[238:239], v21 offset:14336
  s_waitcnt lgkmcnt(8)
  v_mfma_f32_16x16x32_bf16 v[92:95], v[248:251], v[152:155], v[92:95]
  ds_read_b64_tr_b16 v[240:241], v22 offset:8192
  v_mfma_f32_16x16x32_bf16 v[92:95], v[252:255], v[156:159], v[92:95]
  ds_read_b64_tr_b16 v[242:243], v22 offset:10240
  v_mfma_f32_16x16x32_bf16 v[88:91], v[252:255], v[148:151], v[88:91]
  ds_read_b64_tr_b16 v[244:245], v22 offset:12288
  v_mfma_f32_16x16x32_bf16 v[88:91], v[248:251], v[144:147], v[88:91]
  ds_read_b64_tr_b16 v[246:247], v22 offset:14336
  s_waitcnt lgkmcnt(8)
  v_mfma_f32_16x16x32_bf16 v[96:99], v[224:227], v[144:147], v[96:99]
  ds_read_b64_tr_b16 v[248:249], v23 offset:8192
  v_mfma_f32_16x16x32_bf16 v[96:99], v[228:231], v[148:151], v[96:99]
  ds_read_b64_tr_b16 v[250:251], v23 offset:10240
  v_mfma_f32_16x16x32_bf16 v[100:103], v[228:231], v[156:159], v[100:103]
  ds_read_b64_tr_b16 v[252:253], v23 offset:12288
  v_mfma_f32_16x16x32_bf16 v[100:103], v[224:227], v[152:155], v[100:103]
  ds_read_b64_tr_b16 v[254:255], v23 offset:14336
  s_waitcnt lgkmcnt(8)
  v_mfma_f32_16x16x32_bf16 v[108:111], v[232:235], v[152:155], v[108:111]
  ds_read_b64_tr_b16 v[224:225], v20 offset:16384
  v_mfma_f32_16x16x32_bf16 v[108:111], v[236:239], v[156:159], v[108:111]
  ds_read_b64_tr_b16 v[226:227], v20 offset:18432
  v_mfma_f32_16x16x32_bf16 v[104:107], v[236:239], v[148:151], v[104:107]
  ds_read_b64_tr_b16 v[228:229], v20 offset:20480
  v_mfma_f32_16x16x32_bf16 v[104:107], v[232:235], v[144:147], v[104:107]
  ds_read_b64_tr_b16 v[230:231], v20 offset:22528
  s_waitcnt lgkmcnt(8)
  v_mfma_f32_16x16x32_bf16 v[112:115], v[240:243], v[144:147], v[112:115]
  ds_read_b64_tr_b16 v[232:233], v21 offset:16384
  v_mfma_f32_16x16x32_bf16 v[112:115], v[244:247], v[148:151], v[112:115]
  ds_read_b64_tr_b16 v[234:235], v21 offset:18432
  v_mfma_f32_16x16x32_bf16 v[116:119], v[244:247], v[156:159], v[116:119]
  ds_read_b64_tr_b16 v[236:237], v21 offset:20480
  v_mfma_f32_16x16x32_bf16 v[116:119], v[240:243], v[152:155], v[116:119]
  ds_read_b64_tr_b16 v[238:239], v21 offset:22528
  s_waitcnt lgkmcnt(8)
  v_mfma_f32_16x16x32_bf16 v[124:127], v[248:251], v[152:155], v[124:127]
  ds_read_b64_tr_b16 v[240:241], v22 offset:16384
  v_mfma_f32_16x16x32_bf16 v[124:127], v[252:255], v[156:159], v[124:127]
  ds_read_b64_tr_b16 v[242:243], v22 offset:18432
  v_mfma_f32_16x16x32_bf16 v[120:123], v[252:255], v[148:151], v[120:123]
  ds_read_b64_tr_b16 v[244:245], v22 offset:20480
  v_mfma_f32_16x16x32_bf16 v[120:123], v[248:251], v[144:147], v[120:123]
  ds_read_b64_tr_b16 v[246:247], v22 offset:22528
  s_waitcnt vmcnt(20)
  s_waitcnt lgkmcnt(8)
  v_mfma_f32_16x16x32_bf16 v[64:67], v[224:227], v[160:163], v[64:67]
  ds_read_b64_tr_b16 v[248:249], v23 offset:16384
  v_mfma_f32_16x16x32_bf16 v[64:67], v[228:231], v[164:167], v[64:67]
  ds_read_b64_tr_b16 v[250:251], v23 offset:18432
  s_add_u32 s69, s18, 63488
  buffer_load_dwordx4 v[208:211], v10, s[64:67], s69 offen offset:0 sc1
  v_mfma_f32_16x16x32_bf16 v[68:71], v[228:231], v[172:175], v[68:71]
  ds_read_b64_tr_b16 v[252:253], v23 offset:20480
  v_mfma_f32_16x16x32_bf16 v[68:71], v[224:227], v[168:171], v[68:71]
  ds_read_b64_tr_b16 v[254:255], v23 offset:22528
  buffer_load_dwordx4 v[212:215], v10, s[64:67], s69 offen offset:1024 sc1
  s_barrier
  s_waitcnt lgkmcnt(8)
  v_mfma_f32_16x16x32_bf16 v[76:79], v[232:235], v[168:171], v[76:79]
  ds_read_b64_tr_b16 v[224:225], v20 offset:24576
  v_mfma_f32_16x16x32_bf16 v[76:79], v[236:239], v[172:175], v[76:79]
  ds_read_b64_tr_b16 v[226:227], v20 offset:26624
  buffer_load_dwordx4 v[216:219], v11, s[64:67], s69 offen offset:0 sc1
  v_mfma_f32_16x16x32_bf16 v[72:75], v[236:239], v[164:167], v[72:75]
  ds_read_b64_tr_b16 v[228:229], v20 offset:28672
  v_mfma_f32_16x16x32_bf16 v[72:75], v[232:235], v[160:163], v[72:75]
  ds_read_b64_tr_b16 v[230:231], v20 offset:30720
  buffer_load_dwordx4 v[220:223], v11, s[64:67], s69 offen offset:1024 sc1
  s_waitcnt lgkmcnt(8)
  v_mfma_f32_16x16x32_bf16 v[80:83], v[240:243], v[160:163], v[80:83]
  ds_read_b64_tr_b16 v[232:233], v21 offset:24576
  v_mfma_f32_16x16x32_bf16 v[80:83], v[244:247], v[164:167], v[80:83]
  ds_read_b64_tr_b16 v[234:235], v21 offset:26624
  s_add_u32 m0, s10, 98304
  s_add_u32 s12, s22, 4325376
  buffer_load_dwordx4 v15, s[52:55], s12 offen lds
  v_mfma_f32_16x16x32_bf16 v[84:87], v[244:247], v[172:175], v[84:87]
  ds_read_b64_tr_b16 v[236:237], v21 offset:28672
  v_mfma_f32_16x16x32_bf16 v[84:87], v[240:243], v[168:171], v[84:87]
  ds_read_b64_tr_b16 v[238:239], v21 offset:30720
  s_add_u32 m0, s10, 102400
  s_add_u32 s12, s22, 4390912
  buffer_load_dwordx4 v15, s[52:55], s12 offen lds
  s_waitcnt lgkmcnt(8)
  v_mfma_f32_16x16x32_bf16 v[92:95], v[248:251], v[168:171], v[92:95]
  ds_read_b64_tr_b16 v[240:241], v22 offset:24576
  v_mfma_f32_16x16x32_bf16 v[92:95], v[252:255], v[172:175], v[92:95]
  ds_read_b64_tr_b16 v[242:243], v22 offset:26624
  s_add_u32 m0, s10, 106496
  s_add_u32 s12, s22, 4325376
  buffer_load_dwordx4 v13, s[52:55], s12 offen lds
  v_mfma_f32_16x16x32_bf16 v[88:91], v[252:255], v[164:167], v[88:91]
  ds_read_b64_tr_b16 v[244:245], v22 offset:28672
  v_mfma_f32_16x16x32_bf16 v[88:91], v[248:251], v[160:163], v[88:91]
  ds_read_b64_tr_b16 v[246:247], v22 offset:30720
  s_add_u32 m0, s10, 110592
  s_add_u32 s12, s22, 4390912
  buffer_load_dwordx4 v13, s[52:55], s12 offen lds
  s_waitcnt lgkmcnt(8)
  v_mfma_f32_16x16x32_bf16 v[96:99], v[224:227], v[160:163], v[96:99]
  ds_read_b64_tr_b16 v[248:249], v23 offset:24576
  v_mfma_f32_16x16x32_bf16 v[96:99], v[228:231], v[164:167], v[96:99]
  ds_read_b64_tr_b16 v[250:251], v23 offset:26624
  s_add_u32 m0, s10, 114688
  s_add_u32 s12, s22, 4456448
  buffer_load_dwordx4 v13, s[52:55], s12 offen lds
  v_mfma_f32_16x16x32_bf16 v[100:103], v[228:231], v[172:175], v[100:103]
  ds_read_b64_tr_b16 v[252:253], v23 offset:28672
  v_mfma_f32_16x16x32_bf16 v[100:103], v[224:227], v[168:171], v[100:103]
  ds_read_b64_tr_b16 v[254:255], v23 offset:30720
  s_add_u32 m0, s10, 118784
  s_add_u32 s12, s22, 4521984
  buffer_load_dwordx4 v13, s[52:55], s12 offen lds
  s_waitcnt lgkmcnt(8)
  v_mfma_f32_16x16x32_bf16 v[108:111], v[232:235], v[168:171], v[108:111]
  ds_read_b64_tr_b16 v[224:225], v20 offset:32768
  v_mfma_f32_16x16x32_bf16 v[108:111], v[236:239], v[172:175], v[108:111]
  ds_read_b64_tr_b16 v[226:227], v20 offset:34816
  s_add_u32 m0, s10, 122880
  s_add_u32 s12, s22, 4587520
  buffer_load_dwordx4 v13, s[52:55], s12 offen lds
  v_mfma_f32_16x16x32_bf16 v[104:107], v[236:239], v[164:167], v[104:107]
  ds_read_b64_tr_b16 v[228:229], v20 offset:36864
  v_mfma_f32_16x16x32_bf16 v[104:107], v[232:235], v[160:163], v[104:107]
  ds_read_b64_tr_b16 v[230:231], v20 offset:38912
  s_add_u32 m0, s10, 126976
  s_add_u32 s12, s22, 4653056
  buffer_load_dwordx4 v13, s[52:55], s12 offen lds
  s_waitcnt lgkmcnt(8)
  v_mfma_f32_16x16x32_bf16 v[112:115], v[240:243], v[160:163], v[112:115]
  ds_read_b64_tr_b16 v[232:233], v21 offset:32768
  v_mfma_f32_16x16x32_bf16 v[112:115], v[244:247], v[164:167], v[112:115]
  ds_read_b64_tr_b16 v[234:235], v21 offset:34816
  s_add_u32 s11, s5, 11
  s_and_b32 s11, s11, 15
  s_lshl_b32 s11, s11, 14
  s_add_u32 m0, s10, 16384
  s_add_u32 s12, s11, 27262976
  buffer_load_dwordx4 v14, s[64:67], s12 offen sc1 lds
  v_mfma_f32_16x16x32_bf16 v[116:119], v[244:247], v[172:175], v[116:119]
  ds_read_b64_tr_b16 v[236:237], v21 offset:36864
  v_mfma_f32_16x16x32_bf16 v[116:119], v[240:243], v[168:171], v[116:119]
  ds_read_b64_tr_b16 v[238:239], v21 offset:38912
  s_add_u32 m0, s10, 20480
  s_add_u32 s12, s11, 27267072
  buffer_load_dwordx4 v14, s[64:67], s12 offen sc1 lds
  s_waitcnt lgkmcnt(8)
  v_mfma_f32_16x16x32_bf16 v[124:127], v[248:251], v[168:171], v[124:127]
  ds_read_b64_tr_b16 v[240:241], v22 offset:32768
  v_mfma_f32_16x16x32_bf16 v[124:127], v[252:255], v[172:175], v[124:127]
  ds_read_b64_tr_b16 v[242:243], v22 offset:34816
  s_add_u32 m0, s10, 24576
  s_add_u32 s12, s11, 27271168
  buffer_load_dwordx4 v14, s[64:67], s12 offen sc1 lds
  v_mfma_f32_16x16x32_bf16 v[120:123], v[252:255], v[164:167], v[120:123]
  ds_read_b64_tr_b16 v[244:245], v22 offset:36864
  v_mfma_f32_16x16x32_bf16 v[120:123], v[248:251], v[160:163], v[120:123]
  ds_read_b64_tr_b16 v[246:247], v22 offset:38912
  s_add_u32 m0, s10, 28672
  s_add_u32 s12, s11, 27275264
  buffer_load_dwordx4 v14, s[64:67], s12 offen sc1 lds
  s_waitcnt vmcnt(32)
  s_waitcnt lgkmcnt(8)
  v_mfma_f32_16x16x32_bf16 v[64:67], v[224:227], v[176:179], v[64:67]
  ds_read_b64_tr_b16 v[248:249], v23 offset:32768
  v_mfma_f32_16x16x32_bf16 v[64:67], v[228:231], v[180:183], v[64:67]
  ds_read_b64_tr_b16 v[250:251], v23 offset:34816
  s_add_u32 s69, s18, 65536
  buffer_load_dwordx4 v[28:31], v10, s[64:67], s69 offen offset:0 sc1
  v_mfma_f32_16x16x32_bf16 v[68:71], v[228:231], v[188:191], v[68:71]
  ds_read_b64_tr_b16 v[252:253], v23 offset:36864
  v_mfma_f32_16x16x32_bf16 v[68:71], v[224:227], v[184:187], v[68:71]
  ds_read_b64_tr_b16 v[254:255], v23 offset:38912
  buffer_load_dwordx4 v[32:35], v10, s[64:67], s69 offen offset:1024 sc1
  s_waitcnt lgkmcnt(8)
  v_mfma_f32_16x16x32_bf16 v[76:79], v[232:235], v[184:187], v[76:79]
  ds_read_b64_tr_b16 v[224:225], v20 offset:40960
  v_mfma_f32_16x16x32_bf16 v[76:79], v[236:239], v[188:191], v[76:79]
  ds_read_b64_tr_b16 v[226:227], v20 offset:43008
  buffer_load_dwordx4 v[36:39], v11, s[64:67], s69 offen offset:0 sc1
  v_mfma_f32_16x16x32_bf16 v[72:75], v[236:239], v[180:183], v[72:75]
  ds_read_b64_tr_b16 v[228:229], v20 offset:45056
  v_mfma_f32_16x16x32_bf16 v[72:75], v[232:235], v[176:179], v[72:75]
  ds_read_b64_tr_b16 v[230:231], v20 offset:47104
  buffer_load_dwordx4 v[40:43], v11, s[64:67], s69 offen offset:1024 sc1
  s_waitcnt lgkmcnt(8)
  v_mfma_f32_16x16x32_bf16 v[80:83], v[240:243], v[176:179], v[80:83]
  ds_read_b64_tr_b16 v[232:233], v21 offset:40960
  v_mfma_f32_16x16x32_bf16 v[80:83], v[244:247], v[180:183], v[80:83]
  ds_read_b64_tr_b16 v[234:235], v21 offset:43008
  v_mfma_f32_16x16x32_bf16 v[84:87], v[244:247], v[188:191], v[84:87]
  ds_read_b64_tr_b16 v[236:237], v21 offset:45056
  v_mfma_f32_16x16x32_bf16 v[84:87], v[240:243], v[184:187], v[84:87]
  ds_read_b64_tr_b16 v[238:239], v21 offset:47104
  s_waitcnt lgkmcnt(8)
  v_mfma_f32_16x16x32_bf16 v[92:95], v[248:251], v[184:187], v[92:95]
  ds_read_b64_tr_b16 v[240:241], v22 offset:40960
  v_mfma_f32_16x16x32_bf16 v[92:95], v[252:255], v[188:191], v[92:95]
  ds_read_b64_tr_b16 v[242:243], v22 offset:43008
  v_mfma_f32_16x16x32_bf16 v[88:91], v[252:255], v[180:183], v[88:91]
  ds_read_b64_tr_b16 v[244:245], v22 offset:45056
  v_mfma_f32_16x16x32_bf16 v[88:91], v[248:251], v[176:179], v[88:91]
  ds_read_b64_tr_b16 v[246:247], v22 offset:47104
  s_waitcnt lgkmcnt(8)
  v_mfma_f32_16x16x32_bf16 v[96:99], v[224:227], v[176:179], v[96:99]
  ds_read_b64_tr_b16 v[248:249], v23 offset:40960
  v_mfma_f32_16x16x32_bf16 v[96:99], v[228:231], v[180:183], v[96:99]
  ds_read_b64_tr_b16 v[250:251], v23 offset:43008
  v_mfma_f32_16x16x32_bf16 v[100:103], v[228:231], v[188:191], v[100:103]
  ds_read_b64_tr_b16 v[252:253], v23 offset:45056
  v_mfma_f32_16x16x32_bf16 v[100:103], v[224:227], v[184:187], v[100:103]
  ds_read_b64_tr_b16 v[254:255], v23 offset:47104
  s_waitcnt lgkmcnt(8)
  v_mfma_f32_16x16x32_bf16 v[108:111], v[232:235], v[184:187], v[108:111]
  ds_read_b64_tr_b16 v[224:225], v16 offset:0
  v_mfma_f32_16x16x32_bf16 v[108:111], v[236:239], v[188:191], v[108:111]
  ds_read_b64_tr_b16 v[226:227], v16 offset:2048
  v_mfma_f32_16x16x32_bf16 v[104:107], v[236:239], v[180:183], v[104:107]
  ds_read_b64_tr_b16 v[228:229], v16 offset:4096
  v_mfma_f32_16x16x32_bf16 v[104:107], v[232:235], v[176:179], v[104:107]
  ds_read_b64_tr_b16 v[230:231], v16 offset:6144
  s_waitcnt lgkmcnt(8)
  v_mfma_f32_16x16x32_bf16 v[112:115], v[240:243], v[176:179], v[112:115]
  ds_read_b64_tr_b16 v[232:233], v17 offset:0
  v_mfma_f32_16x16x32_bf16 v[112:115], v[244:247], v[180:183], v[112:115]
  ds_read_b64_tr_b16 v[234:235], v17 offset:2048
  v_mfma_f32_16x16x32_bf16 v[116:119], v[244:247], v[188:191], v[116:119]
  ds_read_b64_tr_b16 v[236:237], v17 offset:4096
  v_mfma_f32_16x16x32_bf16 v[116:119], v[240:243], v[184:187], v[116:119]
  ds_read_b64_tr_b16 v[238:239], v17 offset:6144
  s_waitcnt lgkmcnt(8)
  v_mfma_f32_16x16x32_bf16 v[124:127], v[248:251], v[184:187], v[124:127]
  ds_read_b64_tr_b16 v[240:241], v18 offset:0
  v_mfma_f32_16x16x32_bf16 v[124:127], v[252:255], v[188:191], v[124:127]
  ds_read_b64_tr_b16 v[242:243], v18 offset:2048
  v_mfma_f32_16x16x32_bf16 v[120:123], v[252:255], v[180:183], v[120:123]
  ds_read_b64_tr_b16 v[244:245], v18 offset:4096
  v_mfma_f32_16x16x32_bf16 v[120:123], v[248:251], v[176:179], v[120:123]
  ds_read_b64_tr_b16 v[246:247], v18 offset:6144
  s_waitcnt vmcnt(20)
  s_waitcnt lgkmcnt(8)
  v_mfma_f32_16x16x32_bf16 v[64:67], v[224:227], v[192:195], v[64:67]
  ds_read_b64_tr_b16 v[248:249], v19 offset:0
  v_mfma_f32_16x16x32_bf16 v[64:67], v[228:231], v[196:199], v[64:67]
  ds_read_b64_tr_b16 v[250:251], v19 offset:2048
  s_add_u32 s69, s18, 67584
  buffer_load_dwordx4 v[44:47], v10, s[64:67], s69 offen offset:0 sc1
  v_mfma_f32_16x16x32_bf16 v[68:71], v[228:231], v[204:207], v[68:71]
  ds_read_b64_tr_b16 v[252:253], v19 offset:4096
  v_mfma_f32_16x16x32_bf16 v[68:71], v[224:227], v[200:203], v[68:71]
  ds_read_b64_tr_b16 v[254:255], v19 offset:6144
  buffer_load_dwordx4 v[48:51], v10, s[64:67], s69 offen offset:1024 sc1
  s_barrier
  s_waitcnt lgkmcnt(8)
  v_mfma_f32_16x16x32_bf16 v[76:79], v[232:235], v[200:203], v[76:79]
  ds_read_b64_tr_b16 v[224:225], v16 offset:8192
  v_mfma_f32_16x16x32_bf16 v[76:79], v[236:239], v[204:207], v[76:79]
  ds_read_b64_tr_b16 v[226:227], v16 offset:10240
  buffer_load_dwordx4 v[52:55], v11, s[64:67], s69 offen offset:0 sc1
  v_mfma_f32_16x16x32_bf16 v[72:75], v[236:239], v[196:199], v[72:75]
  ds_read_b64_tr_b16 v[228:229], v16 offset:12288
  v_mfma_f32_16x16x32_bf16 v[72:75], v[232:235], v[192:195], v[72:75]
  ds_read_b64_tr_b16 v[230:231], v16 offset:14336
  buffer_load_dwordx4 v[56:59], v11, s[64:67], s69 offen offset:1024 sc1
  s_waitcnt lgkmcnt(8)
  v_mfma_f32_16x16x32_bf16 v[80:83], v[240:243], v[192:195], v[80:83]
  ds_read_b64_tr_b16 v[232:233], v17 offset:8192
  v_mfma_f32_16x16x32_bf16 v[80:83], v[244:247], v[196:199], v[80:83]
  ds_read_b64_tr_b16 v[234:235], v17 offset:10240
  s_add_u32 m0, s10, 131072
  s_add_u32 s12, s23, 3932160
  buffer_load_dwordx4 v13, s[52:55], s12 offen lds
  v_mfma_f32_16x16x32_bf16 v[84:87], v[244:247], v[204:207], v[84:87]
  ds_read_b64_tr_b16 v[236:237], v17 offset:12288
  v_mfma_f32_16x16x32_bf16 v[84:87], v[240:243], v[200:203], v[84:87]
  ds_read_b64_tr_b16 v[238:239], v17 offset:14336
  s_add_u32 m0, s10, 135168
  s_add_u32 s12, s23, 3997696
  buffer_load_dwordx4 v13, s[52:55], s12 offen lds
  s_waitcnt lgkmcnt(8)
  v_mfma_f32_16x16x32_bf16 v[92:95], v[248:251], v[200:203], v[92:95]
  ds_read_b64_tr_b16 v[240:241], v18 offset:8192
  v_mfma_f32_16x16x32_bf16 v[92:95], v[252:255], v[204:207], v[92:95]
  ds_read_b64_tr_b16 v[242:243], v18 offset:10240
  s_add_u32 m0, s10, 139264
  s_add_u32 s12, s23, 4063232
  buffer_load_dwordx4 v13, s[52:55], s12 offen lds
  v_mfma_f32_16x16x32_bf16 v[88:91], v[252:255], v[196:199], v[88:91]
  ds_read_b64_tr_b16 v[244:245], v18 offset:12288
  v_mfma_f32_16x16x32_bf16 v[88:91], v[248:251], v[192:195], v[88:91]
  ds_read_b64_tr_b16 v[246:247], v18 offset:14336
  s_add_u32 m0, s10, 143360
  s_add_u32 s12, s23, 4128768
  buffer_load_dwordx4 v13, s[52:55], s12 offen lds
  s_waitcnt lgkmcnt(8)
  v_mfma_f32_16x16x32_bf16 v[96:99], v[224:227], v[192:195], v[96:99]
  ds_read_b64_tr_b16 v[248:249], v19 offset:8192
  v_mfma_f32_16x16x32_bf16 v[96:99], v[228:231], v[196:199], v[96:99]
  ds_read_b64_tr_b16 v[250:251], v19 offset:10240
  s_add_u32 m0, s10, 147456
  s_add_u32 s12, s23, 4194304
  buffer_load_dwordx4 v13, s[52:55], s12 offen lds
  v_mfma_f32_16x16x32_bf16 v[100:103], v[228:231], v[204:207], v[100:103]
  ds_read_b64_tr_b16 v[252:253], v19 offset:12288
  v_mfma_f32_16x16x32_bf16 v[100:103], v[224:227], v[200:203], v[100:103]
  ds_read_b64_tr_b16 v[254:255], v19 offset:14336
  s_add_u32 m0, s10, 151552
  s_add_u32 s12, s23, 4259840
  buffer_load_dwordx4 v13, s[52:55], s12 offen lds
  s_waitcnt lgkmcnt(8)
  v_mfma_f32_16x16x32_bf16 v[108:111], v[232:235], v[200:203], v[108:111]
  ds_read_b64_tr_b16 v[224:225], v16 offset:16384
  v_mfma_f32_16x16x32_bf16 v[108:111], v[236:239], v[204:207], v[108:111]
  ds_read_b64_tr_b16 v[226:227], v16 offset:18432
  s_add_u32 m0, s10, 155648
  s_add_u32 s12, s23, 4325376
  buffer_load_dwordx4 v13, s[52:55], s12 offen lds
  v_mfma_f32_16x16x32_bf16 v[104:107], v[236:239], v[196:199], v[104:107]
  ds_read_b64_tr_b16 v[228:229], v16 offset:20480
  v_mfma_f32_16x16x32_bf16 v[104:107], v[232:235], v[192:195], v[104:107]
  ds_read_b64_tr_b16 v[230:231], v16 offset:22528
  s_add_u32 m0, s10, 159744
  s_add_u32 s12, s23, 4390912
  buffer_load_dwordx4 v13, s[52:55], s12 offen lds
  s_waitcnt lgkmcnt(8)
  v_mfma_f32_16x16x32_bf16 v[112:115], v[240:243], v[192:195], v[112:115]
  ds_read_b64_tr_b16 v[232:233], v17 offset:16384
  v_mfma_f32_16x16x32_bf16 v[112:115], v[244:247], v[196:199], v[112:115]
  ds_read_b64_tr_b16 v[234:235], v17 offset:18432
  s_add_u32 s11, s5, 12
  s_and_b32 s11, s11, 15
  s_lshl_b32 s11, s11, 14
  s_add_u32 m0, s10, 0
  s_add_u32 s12, s11, 27262976
  buffer_load_dwordx4 v14, s[64:67], s12 offen sc1 lds
  v_mfma_f32_16x16x32_bf16 v[116:119], v[244:247], v[204:207], v[116:119]
  ds_read_b64_tr_b16 v[236:237], v17 offset:20480
  v_mfma_f32_16x16x32_bf16 v[116:119], v[240:243], v[200:203], v[116:119]
  ds_read_b64_tr_b16 v[238:239], v17 offset:22528
  s_add_u32 m0, s10, 4096
  s_add_u32 s12, s11, 27267072
  buffer_load_dwordx4 v14, s[64:67], s12 offen sc1 lds
  s_waitcnt lgkmcnt(8)
  v_mfma_f32_16x16x32_bf16 v[124:127], v[248:251], v[200:203], v[124:127]
  ds_read_b64_tr_b16 v[240:241], v18 offset:16384
  v_mfma_f32_16x16x32_bf16 v[124:127], v[252:255], v[204:207], v[124:127]
  ds_read_b64_tr_b16 v[242:243], v18 offset:18432
  s_add_u32 m0, s10, 8192
  s_add_u32 s12, s11, 27271168
  buffer_load_dwordx4 v14, s[64:67], s12 offen sc1 lds
  v_mfma_f32_16x16x32_bf16 v[120:123], v[252:255], v[196:199], v[120:123]
  ds_read_b64_tr_b16 v[244:245], v18 offset:20480
  v_mfma_f32_16x16x32_bf16 v[120:123], v[248:251], v[192:195], v[120:123]
  ds_read_b64_tr_b16 v[246:247], v18 offset:22528
  s_add_u32 m0, s10, 12288
  s_add_u32 s12, s11, 27275264
  buffer_load_dwordx4 v14, s[64:67], s12 offen sc1 lds
  s_waitcnt vmcnt(32)
  s_waitcnt lgkmcnt(8)
  v_mfma_f32_16x16x32_bf16 v[64:67], v[224:227], v[208:211], v[64:67]
  ds_read_b64_tr_b16 v[248:249], v19 offset:16384
  v_mfma_f32_16x16x32_bf16 v[64:67], v[228:231], v[212:215], v[64:67]
  ds_read_b64_tr_b16 v[250:251], v19 offset:18432
  s_add_u32 s69, s18, 69632
  buffer_load_dwordx4 v[128:131], v10, s[64:67], s69 offen offset:0 sc1
  v_mfma_f32_16x16x32_bf16 v[68:71], v[228:231], v[220:223], v[68:71]
  ds_read_b64_tr_b16 v[252:253], v19 offset:20480
  v_mfma_f32_16x16x32_bf16 v[68:71], v[224:227], v[216:219], v[68:71]
  ds_read_b64_tr_b16 v[254:255], v19 offset:22528
  buffer_load_dwordx4 v[132:135], v10, s[64:67], s69 offen offset:1024 sc1
  s_waitcnt lgkmcnt(8)
  v_mfma_f32_16x16x32_bf16 v[76:79], v[232:235], v[216:219], v[76:79]
  ds_read_b64_tr_b16 v[224:225], v16 offset:24576
  v_mfma_f32_16x16x32_bf16 v[76:79], v[236:239], v[220:223], v[76:79]
  ds_read_b64_tr_b16 v[226:227], v16 offset:26624
  buffer_load_dwordx4 v[136:139], v11, s[64:67], s69 offen offset:0 sc1
  v_mfma_f32_16x16x32_bf16 v[72:75], v[236:239], v[212:215], v[72:75]
  ds_read_b64_tr_b16 v[228:229], v16 offset:28672
  v_mfma_f32_16x16x32_bf16 v[72:75], v[232:235], v[208:211], v[72:75]
  ds_read_b64_tr_b16 v[230:231], v16 offset:30720
  buffer_load_dwordx4 v[140:143], v11, s[64:67], s69 offen offset:1024 sc1
  s_waitcnt lgkmcnt(8)
  v_mfma_f32_16x16x32_bf16 v[80:83], v[240:243], v[208:211], v[80:83]
  ds_read_b64_tr_b16 v[232:233], v17 offset:24576
  v_mfma_f32_16x16x32_bf16 v[80:83], v[244:247], v[212:215], v[80:83]
  ds_read_b64_tr_b16 v[234:235], v17 offset:26624
  v_mfma_f32_16x16x32_bf16 v[84:87], v[244:247], v[220:223], v[84:87]
  ds_read_b64_tr_b16 v[236:237], v17 offset:28672
  v_mfma_f32_16x16x32_bf16 v[84:87], v[240:243], v[216:219], v[84:87]
  ds_read_b64_tr_b16 v[238:239], v17 offset:30720
  s_waitcnt lgkmcnt(8)
  v_mfma_f32_16x16x32_bf16 v[92:95], v[248:251], v[216:219], v[92:95]
  ds_read_b64_tr_b16 v[240:241], v18 offset:24576
  v_mfma_f32_16x16x32_bf16 v[92:95], v[252:255], v[220:223], v[92:95]
  ds_read_b64_tr_b16 v[242:243], v18 offset:26624
  v_mfma_f32_16x16x32_bf16 v[88:91], v[252:255], v[212:215], v[88:91]
  ds_read_b64_tr_b16 v[244:245], v18 offset:28672
  v_mfma_f32_16x16x32_bf16 v[88:91], v[248:251], v[208:211], v[88:91]
  ds_read_b64_tr_b16 v[246:247], v18 offset:30720
  s_waitcnt lgkmcnt(8)
  v_mfma_f32_16x16x32_bf16 v[96:99], v[224:227], v[208:211], v[96:99]
  ds_read_b64_tr_b16 v[248:249], v19 offset:24576
  v_mfma_f32_16x16x32_bf16 v[96:99], v[228:231], v[212:215], v[96:99]
  ds_read_b64_tr_b16 v[250:251], v19 offset:26624
  s_add_u32 s69, s18, 71680
  buffer_load_dwordx4 v[144:147], v10, s[64:67], s69 offen offset:0 sc1
  v_mfma_f32_16x16x32_bf16 v[100:103], v[228:231], v[220:223], v[100:103]
  ds_read_b64_tr_b16 v[252:253], v19 offset:28672
  v_mfma_f32_16x16x32_bf16 v[100:103], v[224:227], v[216:219], v[100:103]
  ds_read_b64_tr_b16 v[254:255], v19 offset:30720
  buffer_load_dwordx4 v[148:151], v10, s[64:67], s69 offen offset:1024 sc1
  s_waitcnt lgkmcnt(8)
  v_mfma_f32_16x16x32_bf16 v[108:111], v[232:235], v[216:219], v[108:111]
  ds_read_b64_tr_b16 v[224:225], v16 offset:32768
  v_mfma_f32_16x16x32_bf16 v[108:111], v[236:239], v[220:223], v[108:111]
  ds_read_b64_tr_b16 v[226:227], v16 offset:34816
  buffer_load_dwordx4 v[152:155], v11, s[64:67], s69 offen offset:0 sc1
  v_mfma_f32_16x16x32_bf16 v[104:107], v[236:239], v[212:215], v[104:107]
  ds_read_b64_tr_b16 v[228:229], v16 offset:36864
  v_mfma_f32_16x16x32_bf16 v[104:107], v[232:235], v[208:211], v[104:107]
  ds_read_b64_tr_b16 v[230:231], v16 offset:38912
  buffer_load_dwordx4 v[156:159], v11, s[64:67], s69 offen offset:1024 sc1
  s_waitcnt lgkmcnt(8)
  v_mfma_f32_16x16x32_bf16 v[112:115], v[240:243], v[208:211], v[112:115]
  ds_read_b64_tr_b16 v[232:233], v17 offset:32768
  v_mfma_f32_16x16x32_bf16 v[112:115], v[244:247], v[212:215], v[112:115]
  ds_read_b64_tr_b16 v[234:235], v17 offset:34816
  v_mfma_f32_16x16x32_bf16 v[116:119], v[244:247], v[220:223], v[116:119]
  ds_read_b64_tr_b16 v[236:237], v17 offset:36864
  v_mfma_f32_16x16x32_bf16 v[116:119], v[240:243], v[216:219], v[116:119]
  ds_read_b64_tr_b16 v[238:239], v17 offset:38912
  s_waitcnt lgkmcnt(8)
  v_mfma_f32_16x16x32_bf16 v[124:127], v[248:251], v[216:219], v[124:127]
  ds_read_b64_tr_b16 v[240:241], v18 offset:32768
  v_mfma_f32_16x16x32_bf16 v[124:127], v[252:255], v[220:223], v[124:127]
  ds_read_b64_tr_b16 v[242:243], v18 offset:34816
  v_mfma_f32_16x16x32_bf16 v[120:123], v[252:255], v[212:215], v[120:123]
  ds_read_b64_tr_b16 v[244:245], v18 offset:36864
  v_mfma_f32_16x16x32_bf16 v[120:123], v[248:251], v[208:211], v[120:123]
  ds_read_b64_tr_b16 v[246:247], v18 offset:38912
  s_waitcnt vmcnt(24)
  s_waitcnt lgkmcnt(8)
  v_mfma_f32_16x16x32_bf16 v[64:67], v[224:227], v[28:31], v[64:67]
  ds_read_b64_tr_b16 v[248:249], v19 offset:32768
  v_mfma_f32_16x16x32_bf16 v[64:67], v[228:231], v[32:35], v[64:67]
  ds_read_b64_tr_b16 v[250:251], v19 offset:34816
  s_add_u32 s69, s19, 61440
  buffer_load_dwordx4 v[160:163], v10, s[64:67], s69 offen offset:0 sc1
  v_mfma_f32_16x16x32_bf16 v[68:71], v[228:231], v[40:43], v[68:71]
  ds_read_b64_tr_b16 v[252:253], v19 offset:36864
  v_mfma_f32_16x16x32_bf16 v[68:71], v[224:227], v[36:39], v[68:71]
  ds_read_b64_tr_b16 v[254:255], v19 offset:38912
  buffer_load_dwordx4 v[164:167], v10, s[64:67], s69 offen offset:1024 sc1
  s_waitcnt lgkmcnt(8)
  v_mfma_f32_16x16x32_bf16 v[76:79], v[232:235], v[36:39], v[76:79]
  ds_read_b64_tr_b16 v[224:225], v16 offset:40960
  v_mfma_f32_16x16x32_bf16 v[76:79], v[236:239], v[40:43], v[76:79]
  ds_read_b64_tr_b16 v[226:227], v16 offset:43008
  buffer_load_dwordx4 v[168:171], v11, s[64:67], s69 offen offset:0 sc1
  v_mfma_f32_16x16x32_bf16 v[72:75], v[236:239], v[32:35], v[72:75]
  ds_read_b64_tr_b16 v[228:229], v16 offset:45056
  v_mfma_f32_16x16x32_bf16 v[72:75], v[232:235], v[28:31], v[72:75]
  ds_read_b64_tr_b16 v[230:231], v16 offset:47104
  buffer_load_dwordx4 v[172:175], v11, s[64:67], s69 offen offset:1024 sc1
  s_barrier
  s_waitcnt lgkmcnt(8)
  v_mfma_f32_16x16x32_bf16 v[80:83], v[240:243], v[28:31], v[80:83]
  ds_read_b64_tr_b16 v[232:233], v17 offset:40960
  v_mfma_f32_16x16x32_bf16 v[80:83], v[244:247], v[32:35], v[80:83]
  ds_read_b64_tr_b16 v[234:235], v17 offset:43008
  s_add_u32 m0, s10, 49152
  s_add_u32 s12, s23, 4456448
  buffer_load_dwordx4 v13, s[52:55], s12 offen lds
  v_mfma_f32_16x16x32_bf16 v[84:87], v[244:247], v[40:43], v[84:87]
  ds_read_b64_tr_b16 v[236:237], v17 offset:45056
  v_mfma_f32_16x16x32_bf16 v[84:87], v[240:243], v[36:39], v[84:87]
  ds_read_b64_tr_b16 v[238:239], v17 offset:47104
  s_add_u32 m0, s10, 53248
  s_add_u32 s12, s23, 4521984
  buffer_load_dwordx4 v13, s[52:55], s12 offen lds
  s_waitcnt lgkmcnt(8)
  v_mfma_f32_16x16x32_bf16 v[92:95], v[248:251], v[36:39], v[92:95]
  ds_read_b64_tr_b16 v[240:241], v18 offset:40960
  v_mfma_f32_16x16x32_bf16 v[92:95], v[252:255], v[40:43], v[92:95]
  ds_read_b64_tr_b16 v[242:243], v18 offset:43008
  s_add_u32 m0, s10, 57344
  s_add_u32 s12, s23, 4587520
  buffer_load_dwordx4 v13, s[52:55], s12 offen lds
  v_mfma_f32_16x16x32_bf16 v[88:91], v[252:255], v[32:35], v[88:91]
  ds_read_b64_tr_b16 v[244:245], v18 offset:45056
  v_mfma_f32_16x16x32_bf16 v[88:91], v[248:251], v[28:31], v[88:91]
  ds_read_b64_tr_b16 v[246:247], v18 offset:47104
  s_add_u32 m0, s10, 61440
  s_add_u32 s12, s23, 4653056
  buffer_load_dwordx4 v13, s[52:55], s12 offen lds
  s_waitcnt lgkmcnt(8)
  v_mfma_f32_16x16x32_bf16 v[96:99], v[224:227], v[28:31], v[96:99]
  ds_read_b64_tr_b16 v[248:249], v19 offset:40960
  v_mfma_f32_16x16x32_bf16 v[96:99], v[228:231], v[32:35], v[96:99]
  ds_read_b64_tr_b16 v[250:251], v19 offset:43008
  s_add_u32 s69, s19, 63488
  buffer_load_dwordx4 v[176:179], v10, s[64:67], s69 offen offset:0 sc1
  v_mfma_f32_16x16x32_bf16 v[100:103], v[228:231], v[40:43], v[100:103]
  ds_read_b64_tr_b16 v[252:253], v19 offset:45056
  v_mfma_f32_16x16x32_bf16 v[100:103], v[224:227], v[36:39], v[100:103]
  ds_read_b64_tr_b16 v[254:255], v19 offset:47104
  buffer_load_dwordx4 v[180:183], v10, s[64:67], s69 offen offset:1024 sc1
  s_waitcnt lgkmcnt(8)
  v_mfma_f32_16x16x32_bf16 v[108:111], v[232:235], v[36:39], v[108:111]
  ds_read_b64_tr_b16 v[224:225], v16 offset:49152
  v_mfma_f32_16x16x32_bf16 v[108:111], v[236:239], v[40:43], v[108:111]
  ds_read_b64_tr_b16 v[226:227], v16 offset:51200
  buffer_load_dwordx4 v[184:187], v11, s[64:67], s69 offen offset:0 sc1
  v_mfma_f32_16x16x32_bf16 v[104:107], v[236:239], v[32:35], v[104:107]
  ds_read_b64_tr_b16 v[228:229], v16 offset:53248
  v_mfma_f32_16x16x32_bf16 v[104:107], v[232:235], v[28:31], v[104:107]
  ds_read_b64_tr_b16 v[230:231], v16 offset:55296
  buffer_load_dwordx4 v[188:191], v11, s[64:67], s69 offen offset:1024 sc1
  s_waitcnt lgkmcnt(8)
  v_mfma_f32_16x16x32_bf16 v[112:115], v[240:243], v[28:31], v[112:115]
  ds_read_b64_tr_b16 v[232:233], v17 offset:49152
  v_mfma_f32_16x16x32_bf16 v[112:115], v[244:247], v[32:35], v[112:115]
  ds_read_b64_tr_b16 v[234:235], v17 offset:51200
  s_add_u32 m0, s10, 65536
  s_mov_b32 s12, 7077888
  buffer_load_dwordx4 v13, s[52:55], s12 offen lds
  v_mfma_f32_16x16x32_bf16 v[116:119], v[244:247], v[40:43], v[116:119]
  ds_read_b64_tr_b16 v[236:237], v17 offset:53248
  v_mfma_f32_16x16x32_bf16 v[116:119], v[240:243], v[36:39], v[116:119]
  ds_read_b64_tr_b16 v[238:239], v17 offset:55296
  s_add_u32 m0, s10, 69632
  s_mov_b32 s12, 7143424
  buffer_load_dwordx4 v13, s[52:55], s12 offen lds
  s_waitcnt lgkmcnt(8)
  v_mfma_f32_16x16x32_bf16 v[124:127], v[248:251], v[36:39], v[124:127]
  ds_read_b64_tr_b16 v[240:241], v18 offset:49152
  v_mfma_f32_16x16x32_bf16 v[124:127], v[252:255], v[40:43], v[124:127]
  ds_read_b64_tr_b16 v[242:243], v18 offset:51200
  s_add_u32 m0, s10, 73728
  s_mov_b32 s12, 7208960
  buffer_load_dwordx4 v13, s[52:55], s12 offen lds
  v_mfma_f32_16x16x32_bf16 v[120:123], v[252:255], v[32:35], v[120:123]
  ds_read_b64_tr_b16 v[244:245], v18 offset:53248
  v_mfma_f32_16x16x32_bf16 v[120:123], v[248:251], v[28:31], v[120:123]
  ds_read_b64_tr_b16 v[246:247], v18 offset:55296
  s_add_u32 m0, s10, 77824
  s_mov_b32 s12, 7274496
  buffer_load_dwordx4 v13, s[52:55], s12 offen lds
  s_waitcnt vmcnt(36)
  s_waitcnt lgkmcnt(8)
  v_mfma_f32_16x16x32_bf16 v[64:67], v[224:227], v[44:47], v[64:67]
  ds_read_b64_tr_b16 v[248:249], v19 offset:49152
  v_mfma_f32_16x16x32_bf16 v[64:67], v[228:231], v[48:51], v[64:67]
  ds_read_b64_tr_b16 v[250:251], v19 offset:51200
  s_add_u32 s69, s19, 65536
  buffer_load_dwordx4 v[192:195], v10, s[64:67], s69 offen offset:0 sc1
  v_mfma_f32_16x16x32_bf16 v[68:71], v[228:231], v[56:59], v[68:71]
  ds_read_b64_tr_b16 v[252:253], v19 offset:53248
  v_mfma_f32_16x16x32_bf16 v[68:71], v[224:227], v[52:55], v[68:71]
  ds_read_b64_tr_b16 v[254:255], v19 offset:55296
  buffer_load_dwordx4 v[196:199], v10, s[64:67], s69 offen offset:1024 sc1
  s_waitcnt lgkmcnt(8)
  v_mfma_f32_16x16x32_bf16 v[76:79], v[232:235], v[52:55], v[76:79]
  ds_read_b64_tr_b16 v[224:225], v16 offset:57344
  v_mfma_f32_16x16x32_bf16 v[76:79], v[236:239], v[56:59], v[76:79]
  ds_read_b64_tr_b16 v[226:227], v16 offset:59392
  buffer_load_dwordx4 v[200:203], v11, s[64:67], s69 offen offset:0 sc1
  v_mfma_f32_16x16x32_bf16 v[72:75], v[236:239], v[48:51], v[72:75]
  ds_read_b64_tr_b16 v[228:229], v16 offset:61440
  v_mfma_f32_16x16x32_bf16 v[72:75], v[232:235], v[44:47], v[72:75]
  ds_read_b64_tr_b16 v[230:231], v16 offset:63488
  buffer_load_dwordx4 v[204:207], v11, s[64:67], s69 offen offset:1024 sc1
  s_waitcnt lgkmcnt(8)
  v_mfma_f32_16x16x32_bf16 v[80:83], v[240:243], v[44:47], v[80:83]
  ds_read_b64_tr_b16 v[232:233], v17 offset:57344
  v_mfma_f32_16x16x32_bf16 v[80:83], v[244:247], v[48:51], v[80:83]
  ds_read_b64_tr_b16 v[234:235], v17 offset:59392
  s_add_u32 s11, s5, 13
  s_and_b32 s11, s11, 15
  s_lshl_b32 s11, s11, 14
  s_add_u32 m0, s10, 32768
  s_add_u32 s12, s11, 27262976
  buffer_load_dwordx4 v14, s[64:67], s12 offen sc1 lds
  v_mfma_f32_16x16x32_bf16 v[84:87], v[244:247], v[56:59], v[84:87]
  ds_read_b64_tr_b16 v[236:237], v17 offset:61440
  v_mfma_f32_16x16x32_bf16 v[84:87], v[240:243], v[52:55], v[84:87]
  ds_read_b64_tr_b16 v[238:239], v17 offset:63488
  s_add_u32 m0, s10, 36864
  s_add_u32 s12, s11, 27267072
  buffer_load_dwordx4 v14, s[64:67], s12 offen sc1 lds
  s_waitcnt lgkmcnt(8)
  v_mfma_f32_16x16x32_bf16 v[92:95], v[248:251], v[52:55], v[92:95]
  ds_read_b64_tr_b16 v[240:241], v18 offset:57344
  v_mfma_f32_16x16x32_bf16 v[92:95], v[252:255], v[56:59], v[92:95]
  ds_read_b64_tr_b16 v[242:243], v18 offset:59392
  s_add_u32 m0, s10, 40960
  s_add_u32 s12, s11, 27271168
  buffer_load_dwordx4 v14, s[64:67], s12 offen sc1 lds
  v_mfma_f32_16x16x32_bf16 v[88:91], v[252:255], v[48:51], v[88:91]
  ds_read_b64_tr_b16 v[244:245], v18 offset:61440
  v_mfma_f32_16x16x32_bf16 v[88:91], v[248:251], v[44:47], v[88:91]
  ds_read_b64_tr_b16 v[246:247], v18 offset:63488
  s_add_u32 m0, s10, 45056
  s_add_u32 s12, s11, 27275264
  buffer_load_dwordx4 v14, s[64:67], s12 offen sc1 lds
  s_waitcnt lgkmcnt(8)
  v_mfma_f32_16x16x32_bf16 v[96:99], v[224:227], v[44:47], v[96:99]
  ds_read_b64_tr_b16 v[248:249], v19 offset:57344
  v_mfma_f32_16x16x32_bf16 v[96:99], v[228:231], v[48:51], v[96:99]
  ds_read_b64_tr_b16 v[250:251], v19 offset:59392
  s_add_u32 s69, s19, 67584
  buffer_load_dwordx4 v[208:211], v10, s[64:67], s69 offen offset:0 sc1
  v_mfma_f32_16x16x32_bf16 v[100:103], v[228:231], v[56:59], v[100:103]
  ds_read_b64_tr_b16 v[252:253], v19 offset:61440
  v_mfma_f32_16x16x32_bf16 v[100:103], v[224:227], v[52:55], v[100:103]
  ds_read_b64_tr_b16 v[254:255], v19 offset:63488
  buffer_load_dwordx4 v[212:215], v10, s[64:67], s69 offen offset:1024 sc1
  s_waitcnt lgkmcnt(8)
  v_mfma_f32_16x16x32_bf16 v[108:111], v[232:235], v[52:55], v[108:111]
  ds_read_b64_tr_b16 v[224:225], v20 offset:0
  v_mfma_f32_16x16x32_bf16 v[108:111], v[236:239], v[56:59], v[108:111]
  ds_read_b64_tr_b16 v[226:227], v20 offset:2048
  buffer_load_dwordx4 v[216:219], v11, s[64:67], s69 offen offset:0 sc1
  v_mfma_f32_16x16x32_bf16 v[104:107], v[236:239], v[48:51], v[104:107]
  ds_read_b64_tr_b16 v[228:229], v20 offset:4096
  v_mfma_f32_16x16x32_bf16 v[104:107], v[232:235], v[44:47], v[104:107]
  ds_read_b64_tr_b16 v[230:231], v20 offset:6144
  buffer_load_dwordx4 v[220:223], v11, s[64:67], s69 offen offset:1024 sc1
  s_waitcnt lgkmcnt(8)
  v_mfma_f32_16x16x32_bf16 v[112:115], v[240:243], v[44:47], v[112:115]
  ds_read_b64_tr_b16 v[232:233], v21 offset:0
  v_mfma_f32_16x16x32_bf16 v[112:115], v[244:247], v[48:51], v[112:115]
  ds_read_b64_tr_b16 v[234:235], v21 offset:2048
  v_mfma_f32_16x16x32_bf16 v[116:119], v[244:247], v[56:59], v[116:119]
  ds_read_b64_tr_b16 v[236:237], v21 offset:4096
  v_mfma_f32_16x16x32_bf16 v[116:119], v[240:243], v[52:55], v[116:119]
  ds_read_b64_tr_b16 v[238:239], v21 offset:6144
  s_waitcnt lgkmcnt(8)
  v_mfma_f32_16x16x32_bf16 v[124:127], v[248:251], v[52:55], v[124:127]
  ds_read_b64_tr_b16 v[240:241], v22 offset:0
  v_mfma_f32_16x16x32_bf16 v[124:127], v[252:255], v[56:59], v[124:127]
  ds_read_b64_tr_b16 v[242:243], v22 offset:2048
  v_mfma_f32_16x16x32_bf16 v[120:123], v[252:255], v[48:51], v[120:123]
  ds_read_b64_tr_b16 v[244:245], v22 offset:4096
  v_mfma_f32_16x16x32_bf16 v[120:123], v[248:251], v[44:47], v[120:123]
  ds_read_b64_tr_b16 v[246:247], v22 offset:6144
  s_waitcnt vmcnt(32)
  s_waitcnt lgkmcnt(8)
  v_mfma_f32_16x16x32_bf16 v[96:99], v[224:227], v[128:131], v[96:99]
  ds_read_b64_tr_b16 v[248:249], v23 offset:0
  v_mfma_f32_16x16x32_bf16 v[96:99], v[228:231], v[132:135], v[96:99]
  ds_read_b64_tr_b16 v[250:251], v23 offset:2048
  s_add_u32 s69, s19, 69632
  buffer_load_dwordx4 v[28:31], v10, s[64:67], s69 offen offset:0 sc1
  v_mfma_f32_16x16x32_bf16 v[100:103], v[228:231], v[140:143], v[100:103]
  ds_read_b64_tr_b16 v[252:253], v23 offset:4096
  v_mfma_f32_16x16x32_bf16 v[100:103], v[224:227], v[136:139], v[100:103]
  ds_read_b64_tr_b16 v[254:255], v23 offset:6144
  buffer_load_dwordx4 v[32:35], v10, s[64:67], s69 offen offset:1024 sc1
  s_waitcnt lgkmcnt(8)
  v_mfma_f32_16x16x32_bf16 v[108:111], v[232:235], v[136:139], v[108:111]
  ds_read_b64_tr_b16 v[224:225], v20 offset:8192
  v_mfma_f32_16x16x32_bf16 v[108:111], v[236:239], v[140:143], v[108:111]
  ds_read_b64_tr_b16 v[226:227], v20 offset:10240
  buffer_load_dwordx4 v[36:39], v11, s[64:67], s69 offen offset:0 sc1
  v_mfma_f32_16x16x32_bf16 v[104:107], v[236:239], v[132:135], v[104:107]
  ds_read_b64_tr_b16 v[228:229], v20 offset:12288
  v_mfma_f32_16x16x32_bf16 v[104:107], v[232:235], v[128:131], v[104:107]
  ds_read_b64_tr_b16 v[230:231], v20 offset:14336
  buffer_load_dwordx4 v[40:43], v11, s[64:67], s69 offen offset:1024 sc1
  s_barrier
  s_waitcnt lgkmcnt(8)
  v_mfma_f32_16x16x32_bf16 v[112:115], v[240:243], v[128:131], v[112:115]
  ds_read_b64_tr_b16 v[232:233], v21 offset:8192
  v_mfma_f32_16x16x32_bf16 v[112:115], v[244:247], v[132:135], v[112:115]
  ds_read_b64_tr_b16 v[234:235], v21 offset:10240
  s_add_u32 m0, s10, 81920
  s_mov_b32 s12, 7208960
  buffer_load_dwordx4 v15, s[52:55], s12 offen lds
  v_mfma_f32_16x16x32_bf16 v[116:119], v[244:247], v[140:143], v[116:119]
  ds_read_b64_tr_b16 v[236:237], v21 offset:12288
  v_mfma_f32_16x16x32_bf16 v[116:119], v[240:243], v[136:139], v[116:119]
  ds_read_b64_tr_b16 v[238:239], v21 offset:14336
  s_add_u32 m0, s10, 86016
  s_mov_b32 s12, 7274496
  buffer_load_dwordx4 v15, s[52:55], s12 offen lds
  s_waitcnt lgkmcnt(8)
  v_mfma_f32_16x16x32_bf16 v[124:127], v[248:251], v[136:139], v[124:127]
  ds_read_b64_tr_b16 v[240:241], v22 offset:8192
  v_mfma_f32_16x16x32_bf16 v[124:127], v[252:255], v[140:143], v[124:127]
  ds_read_b64_tr_b16 v[242:243], v22 offset:10240
  s_add_u32 m0, s10, 90112
  s_mov_b32 s12, 7077888
  buffer_load_dwordx4 v15, s[52:55], s12 offen lds
  v_mfma_f32_16x16x32_bf16 v[120:123], v[252:255], v[132:135], v[120:123]
  ds_read_b64_tr_b16 v[244:245], v22 offset:12288
  v_mfma_f32_16x16x32_bf16 v[120:123], v[248:251], v[128:131], v[120:123]
  ds_read_b64_tr_b16 v[246:247], v22 offset:14336
  s_add_u32 m0, s10, 94208
  s_mov_b32 s12, 7143424
  buffer_load_dwordx4 v15, s[52:55], s12 offen lds
  s_waitcnt vmcnt(36)
  s_waitcnt lgkmcnt(8)
  v_mfma_f32_16x16x32_bf16 v[96:99], v[224:227], v[144:147], v[96:99]
  ds_read_b64_tr_b16 v[248:249], v23 offset:8192
  v_mfma_f32_16x16x32_bf16 v[96:99], v[228:231], v[148:151], v[96:99]
  ds_read_b64_tr_b16 v[250:251], v23 offset:10240
  s_add_u32 s69, s19, 71680
  buffer_load_dwordx4 v[44:47], v10, s[64:67], s69 offen offset:0 sc1
  v_mfma_f32_16x16x32_bf16 v[100:103], v[228:231], v[156:159], v[100:103]
  ds_read_b64_tr_b16 v[252:253], v23 offset:12288
  v_mfma_f32_16x16x32_bf16 v[100:103], v[224:227], v[152:155], v[100:103]
  ds_read_b64_tr_b16 v[254:255], v23 offset:14336
  buffer_load_dwordx4 v[48:51], v10, s[64:67], s69 offen offset:1024 sc1
  s_waitcnt lgkmcnt(8)
  v_mfma_f32_16x16x32_bf16 v[108:111], v[232:235], v[152:155], v[108:111]
  ds_read_b64_tr_b16 v[224:225], v20 offset:16384
  v_mfma_f32_16x16x32_bf16 v[108:111], v[236:239], v[156:159], v[108:111]
  ds_read_b64_tr_b16 v[226:227], v20 offset:18432
  buffer_load_dwordx4 v[52:55], v11, s[64:67], s69 offen offset:0 sc1
  v_mfma_f32_16x16x32_bf16 v[104:107], v[236:239], v[148:151], v[104:107]
  ds_read_b64_tr_b16 v[228:229], v20 offset:20480
  v_mfma_f32_16x16x32_bf16 v[104:107], v[232:235], v[144:147], v[104:107]
  ds_read_b64_tr_b16 v[230:231], v20 offset:22528
  buffer_load_dwordx4 v[56:59], v11, s[64:67], s69 offen offset:1024 sc1
  s_waitcnt lgkmcnt(8)
  v_mfma_f32_16x16x32_bf16 v[112:115], v[240:243], v[144:147], v[112:115]
  ds_read_b64_tr_b16 v[232:233], v21 offset:16384
  v_mfma_f32_16x16x32_bf16 v[112:115], v[244:247], v[148:151], v[112:115]
  ds_read_b64_tr_b16 v[234:235], v21 offset:18432
  s_add_u32 m0, s10, 98304
  s_add_u32 s12, s23, 4587520
  buffer_load_dwordx4 v15, s[52:55], s12 offen lds
  v_mfma_f32_16x16x32_bf16 v[116:119], v[244:247], v[156:159], v[116:119]
  ds_read_b64_tr_b16 v[236:237], v21 offset:20480
  v_mfma_f32_16x16x32_bf16 v[116:119], v[240:243], v[152:155], v[116:119]
  ds_read_b64_tr_b16 v[238:239], v21 offset:22528
  s_add_u32 m0, s10, 102400
  s_add_u32 s12, s23, 4653056
  buffer_load_dwordx4 v15, s[52:55], s12 offen lds
  s_waitcnt lgkmcnt(8)
  v_mfma_f32_16x16x32_bf16 v[124:127], v[248:251], v[152:155], v[124:127]
  ds_read_b64_tr_b16 v[240:241], v22 offset:16384
  v_mfma_f32_16x16x32_bf16 v[124:127], v[252:255], v[156:159], v[124:127]
  ds_read_b64_tr_b16 v[242:243], v22 offset:18432
  s_add_u32 m0, s10, 106496
  s_add_u32 s12, s23, 4456448
  buffer_load_dwordx4 v15, s[52:55], s12 offen lds
  v_mfma_f32_16x16x32_bf16 v[120:123], v[252:255], v[148:151], v[120:123]
  ds_read_b64_tr_b16 v[244:245], v22 offset:20480
  v_mfma_f32_16x16x32_bf16 v[120:123], v[248:251], v[144:147], v[120:123]
  ds_read_b64_tr_b16 v[246:247], v22 offset:22528
  s_add_u32 m0, s10, 110592
  s_add_u32 s12, s23, 4521984
  buffer_load_dwordx4 v15, s[52:55], s12 offen lds
  s_waitcnt vmcnt(40)
  s_waitcnt lgkmcnt(8)
  v_mfma_f32_16x16x32_bf16 v[96:99], v[224:227], v[160:163], v[96:99]
  ds_read_b64_tr_b16 v[248:249], v23 offset:16384
  v_mfma_f32_16x16x32_bf16 v[96:99], v[228:231], v[164:167], v[96:99]
  ds_read_b64_tr_b16 v[250:251], v23 offset:18432
  s_add_u32 s69, s28, 110592
  buffer_load_dwordx4 v[128:131], v10, s[64:67], s69 offen offset:0 sc1
  v_mfma_f32_16x16x32_bf16 v[100:103], v[228:231], v[172:175], v[100:103]
  ds_read_b64_tr_b16 v[252:253], v23 offset:20480
  v_mfma_f32_16x16x32_bf16 v[100:103], v[224:227], v[168:171], v[100:103]
  ds_read_b64_tr_b16 v[254:255], v23 offset:22528
  buffer_load_dwordx4 v[132:135], v10, s[64:67], s69 offen offset:1024 sc1
  s_waitcnt lgkmcnt(8)
  v_mfma_f32_16x16x32_bf16 v[108:111], v[232:235], v[168:171], v[108:111]
  ds_read_b64_tr_b16 v[224:225], v20 offset:24576
  v_mfma_f32_16x16x32_bf16 v[108:111], v[236:239], v[172:175], v[108:111]
  ds_read_b64_tr_b16 v[226:227], v20 offset:26624
  buffer_load_dwordx4 v[136:139], v11, s[64:67], s69 offen offset:0 sc1
  v_mfma_f32_16x16x32_bf16 v[104:107], v[236:239], v[164:167], v[104:107]
  ds_read_b64_tr_b16 v[228:229], v20 offset:28672
  v_mfma_f32_16x16x32_bf16 v[104:107], v[232:235], v[160:163], v[104:107]
  ds_read_b64_tr_b16 v[230:231], v20 offset:30720
  buffer_load_dwordx4 v[140:143], v11, s[64:67], s69 offen offset:1024 sc1
  s_waitcnt lgkmcnt(8)
  v_mfma_f32_16x16x32_bf16 v[112:115], v[240:243], v[160:163], v[112:115]
  ds_read_b64_tr_b16 v[232:233], v21 offset:24576
  v_mfma_f32_16x16x32_bf16 v[112:115], v[244:247], v[164:167], v[112:115]
  ds_read_b64_tr_b16 v[234:235], v21 offset:26624
  s_add_u32 s11, s5, 14
  s_and_b32 s11, s11, 15
  s_lshl_b32 s11, s11, 14
  s_add_u32 m0, s10, 16384
  s_add_u32 s12, s11, 27262976
  buffer_load_dwordx4 v14, s[64:67], s12 offen sc1 lds
  v_mfma_f32_16x16x32_bf16 v[116:119], v[244:247], v[172:175], v[116:119]
  ds_read_b64_tr_b16 v[236:237], v21 offset:28672
  v_mfma_f32_16x16x32_bf16 v[116:119], v[240:243], v[168:171], v[116:119]
  ds_read_b64_tr_b16 v[238:239], v21 offset:30720
  s_add_u32 m0, s10, 20480
  s_add_u32 s12, s11, 27267072
  buffer_load_dwordx4 v14, s[64:67], s12 offen sc1 lds
  s_waitcnt lgkmcnt(8)
  v_mfma_f32_16x16x32_bf16 v[124:127], v[248:251], v[168:171], v[124:127]
  ds_read_b64_tr_b16 v[240:241], v22 offset:24576
  v_mfma_f32_16x16x32_bf16 v[124:127], v[252:255], v[172:175], v[124:127]
  ds_read_b64_tr_b16 v[242:243], v22 offset:26624
  s_add_u32 m0, s10, 24576
  s_add_u32 s12, s11, 27271168
  buffer_load_dwordx4 v14, s[64:67], s12 offen sc1 lds
  v_mfma_f32_16x16x32_bf16 v[120:123], v[252:255], v[164:167], v[120:123]
  ds_read_b64_tr_b16 v[244:245], v22 offset:28672
  v_mfma_f32_16x16x32_bf16 v[120:123], v[248:251], v[160:163], v[120:123]
  ds_read_b64_tr_b16 v[246:247], v22 offset:30720
  s_add_u32 m0, s10, 28672
  s_add_u32 s12, s11, 27275264
  buffer_load_dwordx4 v14, s[64:67], s12 offen sc1 lds
  s_waitcnt vmcnt(40)
  s_waitcnt lgkmcnt(8)
  v_mfma_f32_16x16x32_bf16 v[96:99], v[224:227], v[176:179], v[96:99]
  ds_read_b64_tr_b16 v[248:249], v23 offset:24576
  v_mfma_f32_16x16x32_bf16 v[96:99], v[228:231], v[180:183], v[96:99]
  ds_read_b64_tr_b16 v[250:251], v23 offset:26624
  s_add_u32 s69, s28, 112640
  buffer_load_dwordx4 v[144:147], v10, s[64:67], s69 offen offset:0 sc1
  v_mfma_f32_16x16x32_bf16 v[100:103], v[228:231], v[188:191], v[100:103]
  ds_read_b64_tr_b16 v[252:253], v23 offset:28672
  v_mfma_f32_16x16x32_bf16 v[100:103], v[224:227], v[184:187], v[100:103]
  ds_read_b64_tr_b16 v[254:255], v23 offset:30720
  buffer_load_dwordx4 v[148:151], v10, s[64:67], s69 offen offset:1024 sc1
  s_waitcnt lgkmcnt(8)
  v_mfma_f32_16x16x32_bf16 v[108:111], v[232:235], v[184:187], v[108:111]
  ds_read_b64_tr_b16 v[224:225], v20 offset:32768
  v_mfma_f32_16x16x32_bf16 v[108:111], v[236:239], v[188:191], v[108:111]
  ds_read_b64_tr_b16 v[226:227], v20 offset:34816
  buffer_load_dwordx4 v[152:155], v11, s[64:67], s69 offen offset:0 sc1
  v_mfma_f32_16x16x32_bf16 v[104:107], v[236:239], v[180:183], v[104:107]
  ds_read_b64_tr_b16 v[228:229], v20 offset:36864
  v_mfma_f32_16x16x32_bf16 v[104:107], v[232:235], v[176:179], v[104:107]
  ds_read_b64_tr_b16 v[230:231], v20 offset:38912
  buffer_load_dwordx4 v[156:159], v11, s[64:67], s69 offen offset:1024 sc1
  s_waitcnt lgkmcnt(8)
  v_mfma_f32_16x16x32_bf16 v[112:115], v[240:243], v[176:179], v[112:115]
  ds_read_b64_tr_b16 v[232:233], v21 offset:32768
  v_mfma_f32_16x16x32_bf16 v[112:115], v[244:247], v[180:183], v[112:115]
  ds_read_b64_tr_b16 v[234:235], v21 offset:34816
  v_mfma_f32_16x16x32_bf16 v[116:119], v[244:247], v[188:191], v[116:119]
  ds_read_b64_tr_b16 v[236:237], v21 offset:36864
  v_mfma_f32_16x16x32_bf16 v[116:119], v[240:243], v[184:187], v[116:119]
  ds_read_b64_tr_b16 v[238:239], v21 offset:38912
  s_waitcnt lgkmcnt(8)
  v_mfma_f32_16x16x32_bf16 v[124:127], v[248:251], v[184:187], v[124:127]
  ds_read_b64_tr_b16 v[240:241], v22 offset:32768
  v_mfma_f32_16x16x32_bf16 v[124:127], v[252:255], v[188:191], v[124:127]
  ds_read_b64_tr_b16 v[242:243], v22 offset:34816
  v_mfma_f32_16x16x32_bf16 v[120:123], v[252:255], v[180:183], v[120:123]
  ds_read_b64_tr_b16 v[244:245], v22 offset:36864
  v_mfma_f32_16x16x32_bf16 v[120:123], v[248:251], v[176:179], v[120:123]
  ds_read_b64_tr_b16 v[246:247], v22 offset:38912
  s_waitcnt vmcnt(36)
  s_waitcnt lgkmcnt(8)
  v_mfma_f32_16x16x32_bf16 v[96:99], v[224:227], v[192:195], v[96:99]
  ds_read_b64_tr_b16 v[248:249], v23 offset:32768
  v_mfma_f32_16x16x32_bf16 v[96:99], v[228:231], v[196:199], v[96:99]
  ds_read_b64_tr_b16 v[250:251], v23 offset:34816
  v_mfma_f32_16x16x32_bf16 v[100:103], v[228:231], v[204:207], v[100:103]
  ds_read_b64_tr_b16 v[252:253], v23 offset:36864
  v_mfma_f32_16x16x32_bf16 v[100:103], v[224:227], v[200:203], v[100:103]
  ds_read_b64_tr_b16 v[254:255], v23 offset:38912
  s_waitcnt lgkmcnt(8)
  v_mfma_f32_16x16x32_bf16 v[108:111], v[232:235], v[200:203], v[108:111]
  ds_read_b64_tr_b16 v[224:225], v20 offset:40960
  v_mfma_f32_16x16x32_bf16 v[108:111], v[236:239], v[204:207], v[108:111]
  ds_read_b64_tr_b16 v[226:227], v20 offset:43008
  v_mfma_f32_16x16x32_bf16 v[104:107], v[236:239], v[196:199], v[104:107]
  ds_read_b64_tr_b16 v[228:229], v20 offset:45056
  v_mfma_f32_16x16x32_bf16 v[104:107], v[232:235], v[192:195], v[104:107]
  ds_read_b64_tr_b16 v[230:231], v20 offset:47104
  s_waitcnt vmcnt(32)
  s_barrier
  s_waitcnt lgkmcnt(8)
  v_mfma_f32_16x16x32_bf16 v[112:115], v[240:243], v[192:195], v[112:115]
  ds_read_b64_tr_b16 v[232:233], v21 offset:40960
  v_mfma_f32_16x16x32_bf16 v[112:115], v[244:247], v[196:199], v[112:115]
  ds_read_b64_tr_b16 v[234:235], v21 offset:43008
  s_add_u32 s11, s5, 15
  s_and_b32 s11, s11, 15
  s_lshl_b32 s11, s11, 14
  s_add_u32 m0, s10, 0
  s_add_u32 s12, s11, 27262976
  buffer_load_dwordx4 v14, s[64:67], s12 offen sc1 lds
  v_mfma_f32_16x16x32_bf16 v[116:119], v[244:247], v[204:207], v[116:119]
  ds_read_b64_tr_b16 v[236:237], v21 offset:45056
  v_mfma_f32_16x16x32_bf16 v[116:119], v[240:243], v[200:203], v[116:119]
  ds_read_b64_tr_b16 v[238:239], v21 offset:47104
  s_add_u32 m0, s10, 4096
  s_add_u32 s12, s11, 27267072
  buffer_load_dwordx4 v14, s[64:67], s12 offen sc1 lds
  s_waitcnt lgkmcnt(8)
  v_mfma_f32_16x16x32_bf16 v[124:127], v[248:251], v[200:203], v[124:127]
  ds_read_b64_tr_b16 v[240:241], v22 offset:40960
  v_mfma_f32_16x16x32_bf16 v[124:127], v[252:255], v[204:207], v[124:127]
  ds_read_b64_tr_b16 v[242:243], v22 offset:43008
  s_add_u32 m0, s10, 8192
  s_add_u32 s12, s11, 27271168
  buffer_load_dwordx4 v14, s[64:67], s12 offen sc1 lds
  v_mfma_f32_16x16x32_bf16 v[120:123], v[252:255], v[196:199], v[120:123]
  ds_read_b64_tr_b16 v[244:245], v22 offset:45056
  v_mfma_f32_16x16x32_bf16 v[120:123], v[248:251], v[192:195], v[120:123]
  ds_read_b64_tr_b16 v[246:247], v22 offset:47104
  s_add_u32 m0, s10, 12288
  s_add_u32 s12, s11, 27275264
  buffer_load_dwordx4 v14, s[64:67], s12 offen sc1 lds
  s_waitcnt vmcnt(32)
  s_waitcnt lgkmcnt(8)
  v_mfma_f32_16x16x32_bf16 v[96:99], v[224:227], v[208:211], v[96:99]
  ds_read_b64_tr_b16 v[248:249], v23 offset:40960
  v_mfma_f32_16x16x32_bf16 v[96:99], v[228:231], v[212:215], v[96:99]
  ds_read_b64_tr_b16 v[250:251], v23 offset:43008
  s_add_u32 m0, s10, 114688
  s_add_u32 s12, s23, 4325376
  buffer_load_dwordx4 v15, s[52:55], s12 offen lds
  v_mfma_f32_16x16x32_bf16 v[100:103], v[228:231], v[220:223], v[100:103]
  ds_read_b64_tr_b16 v[252:253], v23 offset:45056
  v_mfma_f32_16x16x32_bf16 v[100:103], v[224:227], v[216:219], v[100:103]
  ds_read_b64_tr_b16 v[254:255], v23 offset:47104
  s_add_u32 m0, s10, 118784
  s_add_u32 s12, s23, 4390912
  buffer_load_dwordx4 v15, s[52:55], s12 offen lds
  s_waitcnt lgkmcnt(8)
  v_mfma_f32_16x16x32_bf16 v[108:111], v[232:235], v[216:219], v[108:111]
  ds_read_b64_tr_b16 v[224:225], v16 offset:0
  v_mfma_f32_16x16x32_bf16 v[108:111], v[236:239], v[220:223], v[108:111]
  ds_read_b64_tr_b16 v[226:227], v16 offset:2048
  s_add_u32 m0, s10, 122880
  s_add_u32 s12, s23, 4194304
  buffer_load_dwordx4 v15, s[52:55], s12 offen lds
  v_mfma_f32_16x16x32_bf16 v[104:107], v[236:239], v[212:215], v[104:107]
  ds_read_b64_tr_b16 v[228:229], v16 offset:4096
  v_mfma_f32_16x16x32_bf16 v[104:107], v[232:235], v[208:211], v[104:107]
  ds_read_b64_tr_b16 v[230:231], v16 offset:6144
  s_add_u32 m0, s10, 126976
  s_add_u32 s12, s23, 4259840
  buffer_load_dwordx4 v15, s[52:55], s12 offen lds
  s_waitcnt lgkmcnt(8)
  v_mfma_f32_16x16x32_bf16 v[112:115], v[240:243], v[208:211], v[112:115]
  ds_read_b64_tr_b16 v[232:233], v17 offset:0
  v_mfma_f32_16x16x32_bf16 v[112:115], v[244:247], v[212:215], v[112:115]
  ds_read_b64_tr_b16 v[234:235], v17 offset:2048
  s_add_u32 m0, s10, 131072
  s_add_u32 s12, s23, 4063232
  buffer_load_dwordx4 v15, s[52:55], s12 offen lds
  v_mfma_f32_16x16x32_bf16 v[116:119], v[244:247], v[220:223], v[116:119]
  ds_read_b64_tr_b16 v[236:237], v17 offset:4096
  v_mfma_f32_16x16x32_bf16 v[116:119], v[240:243], v[216:219], v[116:119]
  ds_read_b64_tr_b16 v[238:239], v17 offset:6144
  s_add_u32 m0, s10, 135168
  s_add_u32 s12, s23, 4128768
  buffer_load_dwordx4 v15, s[52:55], s12 offen lds
  s_waitcnt lgkmcnt(8)
  v_mfma_f32_16x16x32_bf16 v[124:127], v[248:251], v[216:219], v[124:127]
  ds_read_b64_tr_b16 v[240:241], v18 offset:0
  v_mfma_f32_16x16x32_bf16 v[124:127], v[252:255], v[220:223], v[124:127]
  ds_read_b64_tr_b16 v[242:243], v18 offset:2048
  s_add_u32 m0, s10, 139264
  s_add_u32 s12, s23, 3932160
  buffer_load_dwordx4 v15, s[52:55], s12 offen lds
  v_mfma_f32_16x16x32_bf16 v[120:123], v[252:255], v[212:215], v[120:123]
  ds_read_b64_tr_b16 v[244:245], v18 offset:4096
  v_mfma_f32_16x16x32_bf16 v[120:123], v[248:251], v[208:211], v[120:123]
  ds_read_b64_tr_b16 v[246:247], v18 offset:6144
  s_add_u32 m0, s10, 143360
  s_add_u32 s12, s23, 3997696
  buffer_load_dwordx4 v15, s[52:55], s12 offen lds
  s_waitcnt vmcnt(36)
  s_waitcnt lgkmcnt(8)
  v_mfma_f32_16x16x32_bf16 v[96:99], v[224:227], v[28:31], v[96:99]
  ds_read_b64_tr_b16 v[248:249], v19 offset:0
  v_mfma_f32_16x16x32_bf16 v[96:99], v[228:231], v[32:35], v[96:99]
  ds_read_b64_tr_b16 v[250:251], v19 offset:2048
  v_mfma_f32_16x16x32_bf16 v[100:103], v[228:231], v[40:43], v[100:103]
  ds_read_b64_tr_b16 v[252:253], v19 offset:4096
  v_mfma_f32_16x16x32_bf16 v[100:103], v[224:227], v[36:39], v[100:103]
  ds_read_b64_tr_b16 v[254:255], v19 offset:6144
  s_waitcnt lgkmcnt(8)
  v_mfma_f32_16x16x32_bf16 v[108:111], v[232:235], v[36:39], v[108:111]
  ds_read_b64_tr_b16 v[224:225], v16 offset:8192
  v_mfma_f32_16x16x32_bf16 v[108:111], v[236:239], v[40:43], v[108:111]
  ds_read_b64_tr_b16 v[226:227], v16 offset:10240
  v_mfma_f32_16x16x32_bf16 v[104:107], v[236:239], v[32:35], v[104:107]
  ds_read_b64_tr_b16 v[228:229], v16 offset:12288
  v_mfma_f32_16x16x32_bf16 v[104:107], v[232:235], v[28:31], v[104:107]
  ds_read_b64_tr_b16 v[230:231], v16 offset:14336
  s_waitcnt lgkmcnt(8)
  v_mfma_f32_16x16x32_bf16 v[112:115], v[240:243], v[28:31], v[112:115]
  ds_read_b64_tr_b16 v[232:233], v17 offset:8192
  v_mfma_f32_16x16x32_bf16 v[112:115], v[244:247], v[32:35], v[112:115]
  ds_read_b64_tr_b16 v[234:235], v17 offset:10240
  v_mfma_f32_16x16x32_bf16 v[116:119], v[244:247], v[40:43], v[116:119]
  ds_read_b64_tr_b16 v[236:237], v17 offset:12288
  v_mfma_f32_16x16x32_bf16 v[116:119], v[240:243], v[36:39], v[116:119]
  ds_read_b64_tr_b16 v[238:239], v17 offset:14336
  s_waitcnt lgkmcnt(8)
  v_mfma_f32_16x16x32_bf16 v[124:127], v[248:251], v[36:39], v[124:127]
  ds_read_b64_tr_b16 v[240:241], v18 offset:8192
  v_mfma_f32_16x16x32_bf16 v[124:127], v[252:255], v[40:43], v[124:127]
  ds_read_b64_tr_b16 v[242:243], v18 offset:10240
  v_mfma_f32_16x16x32_bf16 v[120:123], v[252:255], v[32:35], v[120:123]
  ds_read_b64_tr_b16 v[244:245], v18 offset:12288
  v_mfma_f32_16x16x32_bf16 v[120:123], v[248:251], v[28:31], v[120:123]
  ds_read_b64_tr_b16 v[246:247], v18 offset:14336
  s_waitcnt vmcnt(28)
  s_waitcnt lgkmcnt(8)
  v_mfma_f32_16x16x32_bf16 v[96:99], v[224:227], v[44:47], v[96:99]
  ds_read_b64_tr_b16 v[248:249], v19 offset:8192
  v_mfma_f32_16x16x32_bf16 v[96:99], v[228:231], v[48:51], v[96:99]
  ds_read_b64_tr_b16 v[250:251], v19 offset:10240
  v_mfma_f32_16x16x32_bf16 v[100:103], v[228:231], v[56:59], v[100:103]
  ds_read_b64_tr_b16 v[252:253], v19 offset:12288
  v_mfma_f32_16x16x32_bf16 v[100:103], v[224:227], v[52:55], v[100:103]
  ds_read_b64_tr_b16 v[254:255], v19 offset:14336
  s_waitcnt lgkmcnt(8)
  v_mfma_f32_16x16x32_bf16 v[108:111], v[232:235], v[52:55], v[108:111]
  ds_read_b64_tr_b16 v[224:225], v16 offset:16384
  v_mfma_f32_16x16x32_bf16 v[108:111], v[236:239], v[56:59], v[108:111]
  ds_read_b64_tr_b16 v[226:227], v16 offset:18432
  v_mfma_f32_16x16x32_bf16 v[104:107], v[236:239], v[48:51], v[104:107]
  ds_read_b64_tr_b16 v[228:229], v16 offset:20480
  v_mfma_f32_16x16x32_bf16 v[104:107], v[232:235], v[44:47], v[104:107]
  ds_read_b64_tr_b16 v[230:231], v16 offset:22528
  s_waitcnt lgkmcnt(8)
  v_mfma_f32_16x16x32_bf16 v[112:115], v[240:243], v[44:47], v[112:115]
  ds_read_b64_tr_b16 v[232:233], v17 offset:16384
  v_mfma_f32_16x16x32_bf16 v[112:115], v[244:247], v[48:51], v[112:115]
  ds_read_b64_tr_b16 v[234:235], v17 offset:18432
  v_mfma_f32_16x16x32_bf16 v[116:119], v[244:247], v[56:59], v[116:119]
  ds_read_b64_tr_b16 v[236:237], v17 offset:20480
  v_mfma_f32_16x16x32_bf16 v[116:119], v[240:243], v[52:55], v[116:119]
  ds_read_b64_tr_b16 v[238:239], v17 offset:22528
  s_waitcnt vmcnt(16)
  s_barrier
  s_waitcnt lgkmcnt(8)
  v_mfma_f32_16x16x32_bf16 v[124:127], v[248:251], v[52:55], v[124:127]
  ds_read_b64_tr_b16 v[240:241], v18 offset:16384
  v_mfma_f32_16x16x32_bf16 v[124:127], v[252:255], v[56:59], v[124:127]
  ds_read_b64_tr_b16 v[242:243], v18 offset:18432
  s_add_u32 m0, s10, 147456
  s_add_u32 s12, s22, 4587520
  buffer_load_dwordx4 v15, s[52:55], s12 offen lds
  v_mfma_f32_16x16x32_bf16 v[120:123], v[252:255], v[48:51], v[120:123]
  ds_read_b64_tr_b16 v[244:245], v18 offset:20480
  v_mfma_f32_16x16x32_bf16 v[120:123], v[248:251], v[44:47], v[120:123]
  ds_read_b64_tr_b16 v[246:247], v18 offset:22528
  s_add_u32 m0, s10, 151552
  s_add_u32 s12, s22, 4653056
  buffer_load_dwordx4 v15, s[52:55], s12 offen lds
  s_waitcnt lgkmcnt(8)
  v_mfma_f32_16x16x32_bf16 v[96:99], v[224:227], v[128:131], v[96:99]
  ds_read_b64_tr_b16 v[248:249], v19 offset:16384
  v_mfma_f32_16x16x32_bf16 v[96:99], v[228:231], v[132:135], v[96:99]
  ds_read_b64_tr_b16 v[250:251], v19 offset:18432
  s_add_u32 m0, s10, 155648
  s_add_u32 s12, s22, 4456448
  buffer_load_dwordx4 v15, s[52:55], s12 offen lds
  v_mfma_f32_16x16x32_bf16 v[100:103], v[228:231], v[140:143], v[100:103]
  ds_read_b64_tr_b16 v[252:253], v19 offset:20480
  v_mfma_f32_16x16x32_bf16 v[100:103], v[224:227], v[136:139], v[100:103]
  ds_read_b64_tr_b16 v[254:255], v19 offset:22528
  s_add_u32 m0, s10, 159744
  s_add_u32 s12, s22, 4521984
  buffer_load_dwordx4 v15, s[52:55], s12 offen lds
  s_waitcnt lgkmcnt(8)
  v_mfma_f32_16x16x32_bf16 v[108:111], v[232:235], v[136:139], v[108:111]
  ds_read_b64_tr_b16 v[224:225], v16 offset:24576
  v_mfma_f32_16x16x32_bf16 v[108:111], v[236:239], v[140:143], v[108:111]
  ds_read_b64_tr_b16 v[226:227], v16 offset:26624
  v_mfma_f32_16x16x32_bf16 v[104:107], v[236:239], v[132:135], v[104:107]
  ds_read_b64_tr_b16 v[228:229], v16 offset:28672
  v_mfma_f32_16x16x32_bf16 v[104:107], v[232:235], v[128:131], v[104:107]
  ds_read_b64_tr_b16 v[230:231], v16 offset:30720
  s_waitcnt lgkmcnt(8)
  v_mfma_f32_16x16x32_bf16 v[112:115], v[240:243], v[128:131], v[112:115]
  ds_read_b64_tr_b16 v[232:233], v17 offset:24576
  v_mfma_f32_16x16x32_bf16 v[112:115], v[244:247], v[132:135], v[112:115]
  ds_read_b64_tr_b16 v[234:235], v17 offset:26624
  v_mfma_f32_16x16x32_bf16 v[116:119], v[244:247], v[140:143], v[116:119]
  ds_read_b64_tr_b16 v[236:237], v17 offset:28672
  v_mfma_f32_16x16x32_bf16 v[116:119], v[240:243], v[136:139], v[116:119]
  ds_read_b64_tr_b16 v[238:239], v17 offset:30720
  s_waitcnt lgkmcnt(8)
  v_mfma_f32_16x16x32_bf16 v[124:127], v[248:251], v[136:139], v[124:127]
  ds_read_b64_tr_b16 v[240:241], v18 offset:24576
  v_mfma_f32_16x16x32_bf16 v[124:127], v[252:255], v[140:143], v[124:127]
  ds_read_b64_tr_b16 v[242:243], v18 offset:26624
  v_mfma_f32_16x16x32_bf16 v[120:123], v[252:255], v[132:135], v[120:123]
  ds_read_b64_tr_b16 v[244:245], v18 offset:28672
  v_mfma_f32_16x16x32_bf16 v[120:123], v[248:251], v[128:131], v[120:123]
  ds_read_b64_tr_b16 v[246:247], v18 offset:30720
  s_waitcnt vmcnt(16)
  s_waitcnt lgkmcnt(8)
  v_mfma_f32_16x16x32_bf16 v[96:99], v[224:227], v[144:147], v[96:99]
  ds_read_b64_tr_b16 v[248:249], v19 offset:24576
  v_mfma_f32_16x16x32_bf16 v[96:99], v[228:231], v[148:151], v[96:99]
  ds_read_b64_tr_b16 v[250:251], v19 offset:26624
  v_mfma_f32_16x16x32_bf16 v[100:103], v[228:231], v[156:159], v[100:103]
  ds_read_b64_tr_b16 v[252:253], v19 offset:28672
  v_mfma_f32_16x16x32_bf16 v[100:103], v[224:227], v[152:155], v[100:103]
  ds_read_b64_tr_b16 v[254:255], v19 offset:30720
  s_waitcnt lgkmcnt(8)
  v_mfma_f32_16x16x32_bf16 v[108:111], v[232:235], v[152:155], v[108:111]
  ds_read_b64_tr_b16 v[224:225], v16 offset:32768
  v_mfma_f32_16x16x32_bf16 v[108:111], v[236:239], v[156:159], v[108:111]
  ds_read_b64_tr_b16 v[226:227], v16 offset:34816
  v_mfma_f32_16x16x32_bf16 v[104:107], v[236:239], v[148:151], v[104:107]
  ds_read_b64_tr_b16 v[228:229], v16 offset:36864
  v_mfma_f32_16x16x32_bf16 v[104:107], v[232:235], v[144:147], v[104:107]
  ds_read_b64_tr_b16 v[230:231], v16 offset:38912
  s_waitcnt lgkmcnt(8)
  v_mfma_f32_16x16x32_bf16 v[112:115], v[240:243], v[144:147], v[112:115]
  ds_read_b64_tr_b16 v[232:233], v17 offset:32768
  v_mfma_f32_16x16x32_bf16 v[112:115], v[244:247], v[148:151], v[112:115]
  ds_read_b64_tr_b16 v[234:235], v17 offset:34816
  v_mfma_f32_16x16x32_bf16 v[116:119], v[244:247], v[156:159], v[116:119]
  ds_read_b64_tr_b16 v[236:237], v17 offset:36864
  v_mfma_f32_16x16x32_bf16 v[116:119], v[240:243], v[152:155], v[116:119]
  ds_read_b64_tr_b16 v[238:239], v17 offset:38912
  s_waitcnt vmcnt(8)
  s_barrier
  s_waitcnt lgkmcnt(8)
  v_mfma_f32_16x16x32_bf16 v[124:127], v[248:251], v[152:155], v[124:127]
  ds_read_b64_tr_b16 v[240:241], v18 offset:32768
  v_mfma_f32_16x16x32_bf16 v[124:127], v[252:255], v[156:159], v[124:127]
  ds_read_b64_tr_b16 v[242:243], v18 offset:34816
  s_add_u32 m0, s10, 49152
  s_mov_b32 s12, 786432
  buffer_load_dwordx4 v15, s[48:51], s12 offen lds
  v_mfma_f32_16x16x32_bf16 v[120:123], v[252:255], v[148:151], v[120:123]
  ds_read_b64_tr_b16 v[244:245], v18 offset:36864
  v_mfma_f32_16x16x32_bf16 v[120:123], v[248:251], v[144:147], v[120:123]
  ds_read_b64_tr_b16 v[246:247], v18 offset:38912
  s_add_u32 m0, s10, 53248
  s_mov_b32 s12, 851968
  buffer_load_dwordx4 v15, s[48:51], s12 offen lds
  s_waitcnt lgkmcnt(8)
  v_mfma_f32_16x16x32_bf16 v[64:67], v[224:227], v[144:147], v[64:67]
  ds_read_b64_tr_b16 v[248:249], v19 offset:32768
  v_mfma_f32_16x16x32_bf16 v[64:67], v[228:231], v[148:151], v[64:67]
  ds_read_b64_tr_b16 v[250:251], v19 offset:34816
  s_add_u32 m0, s10, 57344
  s_mov_b32 s12, 917504
  buffer_load_dwordx4 v15, s[48:51], s12 offen lds
  v_mfma_f32_16x16x32_bf16 v[68:71], v[228:231], v[156:159], v[68:71]
  ds_read_b64_tr_b16 v[252:253], v19 offset:36864
  v_mfma_f32_16x16x32_bf16 v[68:71], v[224:227], v[152:155], v[68:71]
  ds_read_b64_tr_b16 v[254:255], v19 offset:38912
  s_add_u32 m0, s10, 61440
  s_mov_b32 s12, 983040
  buffer_load_dwordx4 v15, s[48:51], s12 offen lds
  s_waitcnt lgkmcnt(8)
  v_mfma_f32_16x16x32_bf16 v[76:79], v[232:235], v[152:155], v[76:79]
  ds_read_b64_tr_b16 v[224:225], v16 offset:40960
  v_mfma_f32_16x16x32_bf16 v[76:79], v[236:239], v[156:159], v[76:79]
  ds_read_b64_tr_b16 v[226:227], v16 offset:43008
  v_mfma_f32_16x16x32_bf16 v[72:75], v[236:239], v[148:151], v[72:75]
  ds_read_b64_tr_b16 v[228:229], v16 offset:45056
  v_mfma_f32_16x16x32_bf16 v[72:75], v[232:235], v[144:147], v[72:75]
  ds_read_b64_tr_b16 v[230:231], v16 offset:47104
  s_waitcnt lgkmcnt(8)
  v_mfma_f32_16x16x32_bf16 v[80:83], v[240:243], v[144:147], v[80:83]
  ds_read_b64_tr_b16 v[232:233], v17 offset:40960
  v_mfma_f32_16x16x32_bf16 v[80:83], v[244:247], v[148:151], v[80:83]
  ds_read_b64_tr_b16 v[234:235], v17 offset:43008
  v_cvt_pk_bf16_f32 v96, v96, v97
  v_cvt_pk_bf16_f32 v97, v98, v99
  v_cvt_pk_bf16_f32 v98, v100, v101
  v_cvt_pk_bf16_f32 v99, v102, v103
  buffer_store_dwordx4 v[96:99], v10, s[64:67], s71 offen offset:0 sc1
  v_mfma_f32_16x16x32_bf16 v[84:87], v[244:247], v[156:159], v[84:87]
  ds_read_b64_tr_b16 v[236:237], v17 offset:45056
  v_mfma_f32_16x16x32_bf16 v[84:87], v[240:243], v[152:155], v[84:87]
  ds_read_b64_tr_b16 v[238:239], v17 offset:47104
  s_waitcnt lgkmcnt(8)
  v_mfma_f32_16x16x32_bf16 v[92:95], v[248:251], v[152:155], v[92:95]
  ds_read_b64_tr_b16 v[240:241], v18 offset:40960
  v_mfma_f32_16x16x32_bf16 v[92:95], v[252:255], v[156:159], v[92:95]
  ds_read_b64_tr_b16 v[242:243], v18 offset:43008
  v_cvt_pk_bf16_f32 v104, v104, v105
  v_cvt_pk_bf16_f32 v105, v106, v107
  v_cvt_pk_bf16_f32 v106, v108, v109
  v_cvt_pk_bf16_f32 v107, v110, v111
  buffer_store_dwordx4 v[104:107], v10, s[64:67], s71 offen offset:1024 sc1
  v_mfma_f32_16x16x32_bf16 v[88:91], v[252:255], v[148:151], v[88:91]
  ds_read_b64_tr_b16 v[244:245], v18 offset:45056
  v_mfma_f32_16x16x32_bf16 v[88:91], v[248:251], v[144:147], v[88:91]
  ds_read_b64_tr_b16 v[246:247], v18 offset:47104
  s_waitcnt lgkmcnt(8)
  v_mfma_f32_16x16x32_bf16 v[64:67], v[224:227], v[128:131], v[64:67]
  ds_read_b64_tr_b16 v[248:249], v19 offset:40960
  v_mfma_f32_16x16x32_bf16 v[64:67], v[228:231], v[132:135], v[64:67]
  ds_read_b64_tr_b16 v[250:251], v19 offset:43008
  v_cvt_pk_bf16_f32 v112, v112, v113
  v_cvt_pk_bf16_f32 v113, v114, v115
  v_cvt_pk_bf16_f32 v114, v116, v117
  v_cvt_pk_bf16_f32 v115, v118, v119
  buffer_store_dwordx4 v[112:115], v10, s[64:67], s71 offen offset:2048 sc1
  v_mfma_f32_16x16x32_bf16 v[68:71], v[228:231], v[140:143], v[68:71]
  ds_read_b64_tr_b16 v[252:253], v19 offset:45056
  v_mfma_f32_16x16x32_bf16 v[68:71], v[224:227], v[136:139], v[68:71]
  ds_read_b64_tr_b16 v[254:255], v19 offset:47104
  s_waitcnt lgkmcnt(8)
  v_mfma_f32_16x16x32_bf16 v[76:79], v[232:235], v[136:139], v[76:79]
  ds_read_b64_tr_b16 v[224:225], v16 offset:49152
  v_mfma_f32_16x16x32_bf16 v[76:79], v[236:239], v[140:143], v[76:79]
  ds_read_b64_tr_b16 v[226:227], v16 offset:51200
  v_cvt_pk_bf16_f32 v120, v120, v121
  v_cvt_pk_bf16_f32 v121, v122, v123
  v_cvt_pk_bf16_f32 v122, v124, v125
  v_cvt_pk_bf16_f32 v123, v126, v127
  buffer_store_dwordx4 v[120:123], v10, s[64:67], s71 offen offset:3072 sc1
  v_mfma_f32_16x16x32_bf16 v[72:75], v[236:239], v[132:135], v[72:75]
  ds_read_b64_tr_b16 v[228:229], v16 offset:53248
  v_mfma_f32_16x16x32_bf16 v[72:75], v[232:235], v[128:131], v[72:75]
  ds_read_b64_tr_b16 v[230:231], v16 offset:55296
  s_waitcnt lgkmcnt(8)
  v_mfma_f32_16x16x32_bf16 v[80:83], v[240:243], v[128:131], v[80:83]
  ds_read_b64_tr_b16 v[232:233], v17 offset:49152
  v_mfma_f32_16x16x32_bf16 v[80:83], v[244:247], v[132:135], v[80:83]
  ds_read_b64_tr_b16 v[234:235], v17 offset:51200
  v_mfma_f32_16x16x32_bf16 v[84:87], v[244:247], v[140:143], v[84:87]
  ds_read_b64_tr_b16 v[236:237], v17 offset:53248
  v_mfma_f32_16x16x32_bf16 v[84:87], v[240:243], v[136:139], v[84:87]
  ds_read_b64_tr_b16 v[238:239], v17 offset:55296
  s_waitcnt lgkmcnt(8)
  v_mfma_f32_16x16x32_bf16 v[92:95], v[248:251], v[136:139], v[92:95]
  ds_read_b64_tr_b16 v[240:241], v18 offset:49152
  v_mfma_f32_16x16x32_bf16 v[92:95], v[252:255], v[140:143], v[92:95]
  ds_read_b64_tr_b16 v[242:243], v18 offset:51200
  v_mfma_f32_16x16x32_bf16 v[88:91], v[252:255], v[132:135], v[88:91]
  ds_read_b64_tr_b16 v[244:245], v18 offset:53248
  v_mfma_f32_16x16x32_bf16 v[88:91], v[248:251], v[128:131], v[88:91]
  ds_read_b64_tr_b16 v[246:247], v18 offset:55296
  s_waitcnt lgkmcnt(8)
  v_mfma_f32_16x16x32_bf16 v[64:67], v[224:227], v[44:47], v[64:67]
  ds_read_b64_tr_b16 v[248:249], v19 offset:49152
  v_mfma_f32_16x16x32_bf16 v[64:67], v[228:231], v[48:51], v[64:67]
  ds_read_b64_tr_b16 v[250:251], v19 offset:51200
  s_add_u32 s69, s18, 71680
  buffer_load_dwordx4 v[144:147], v10, s[64:67], s69 offen offset:0 sc1
  v_mfma_f32_16x16x32_bf16 v[68:71], v[228:231], v[56:59], v[68:71]
  ds_read_b64_tr_b16 v[252:253], v19 offset:53248
  v_mfma_f32_16x16x32_bf16 v[68:71], v[224:227], v[52:55], v[68:71]
  ds_read_b64_tr_b16 v[254:255], v19 offset:55296
  buffer_load_dwordx4 v[148:151], v10, s[64:67], s69 offen offset:1024 sc1
  s_waitcnt lgkmcnt(8)
  v_mfma_f32_16x16x32_bf16 v[76:79], v[232:235], v[52:55], v[76:79]
  ds_read_b64_tr_b16 v[224:225], v16 offset:57344
  v_mfma_f32_16x16x32_bf16 v[76:79], v[236:239], v[56:59], v[76:79]
  ds_read_b64_tr_b16 v[226:227], v16 offset:59392
  buffer_load_dwordx4 v[152:155], v11, s[64:67], s69 offen offset:0 sc1
  v_mfma_f32_16x16x32_bf16 v[72:75], v[236:239], v[48:51], v[72:75]
  ds_read_b64_tr_b16 v[228:229], v16 offset:61440
  v_mfma_f32_16x16x32_bf16 v[72:75], v[232:235], v[44:47], v[72:75]
  ds_read_b64_tr_b16 v[230:231], v16 offset:63488
  buffer_load_dwordx4 v[156:159], v11, s[64:67], s69 offen offset:1024 sc1
  s_waitcnt lgkmcnt(8)
  v_mfma_f32_16x16x32_bf16 v[80:83], v[240:243], v[44:47], v[80:83]
  ds_read_b64_tr_b16 v[232:233], v17 offset:57344
  v_mfma_f32_16x16x32_bf16 v[80:83], v[244:247], v[48:51], v[80:83]
  ds_read_b64_tr_b16 v[234:235], v17 offset:59392
  v_mfma_f32_16x16x32_bf16 v[84:87], v[244:247], v[56:59], v[84:87]
  ds_read_b64_tr_b16 v[236:237], v17 offset:61440
  v_mfma_f32_16x16x32_bf16 v[84:87], v[240:243], v[52:55], v[84:87]
  ds_read_b64_tr_b16 v[238:239], v17 offset:63488
  s_waitcnt lgkmcnt(8)
  v_mfma_f32_16x16x32_bf16 v[92:95], v[248:251], v[52:55], v[92:95]
  ds_read_b64_tr_b16 v[240:241], v18 offset:57344
  v_mfma_f32_16x16x32_bf16 v[92:95], v[252:255], v[56:59], v[92:95]
  ds_read_b64_tr_b16 v[242:243], v18 offset:59392
  v_mfma_f32_16x16x32_bf16 v[88:91], v[252:255], v[48:51], v[88:91]
  ds_read_b64_tr_b16 v[244:245], v18 offset:61440
  v_mfma_f32_16x16x32_bf16 v[88:91], v[248:251], v[44:47], v[88:91]
  ds_read_b64_tr_b16 v[246:247], v18 offset:63488
  s_waitcnt lgkmcnt(8)
  v_mfma_f32_16x16x32_bf16 v[64:67], v[224:227], v[28:31], v[64:67]
  ds_read_b64_tr_b16 v[248:249], v19 offset:57344
  v_mfma_f32_16x16x32_bf16 v[64:67], v[228:231], v[32:35], v[64:67]
  ds_read_b64_tr_b16 v[250:251], v19 offset:59392
  s_add_u32 s69, s18, 69632
  buffer_load_dwordx4 v[128:131], v10, s[64:67], s69 offen offset:0 sc1
  v_mfma_f32_16x16x32_bf16 v[68:71], v[228:231], v[40:43], v[68:71]
  ds_read_b64_tr_b16 v[252:253], v19 offset:61440
  v_mfma_f32_16x16x32_bf16 v[68:71], v[224:227], v[36:39], v[68:71]
  ds_read_b64_tr_b16 v[254:255], v19 offset:63488
  buffer_load_dwordx4 v[132:135], v10, s[64:67], s69 offen offset:1024 sc1
  s_waitcnt lgkmcnt(8)
  v_mfma_f32_16x16x32_bf16 v[76:79], v[232:235], v[36:39], v[76:79]
  ds_read_b64_tr_b16 v[224:225], v20 offset:0
  v_mfma_f32_16x16x32_bf16 v[76:79], v[236:239], v[40:43], v[76:79]
  ds_read_b64_tr_b16 v[226:227], v20 offset:2048
  buffer_load_dwordx4 v[136:139], v11, s[64:67], s69 offen offset:0 sc1
  v_mfma_f32_16x16x32_bf16 v[72:75], v[236:239], v[32:35], v[72:75]
  ds_read_b64_tr_b16 v[228:229], v20 offset:4096
  v_mfma_f32_16x16x32_bf16 v[72:75], v[232:235], v[28:31], v[72:75]
  ds_read_b64_tr_b16 v[230:231], v20 offset:6144
  buffer_load_dwordx4 v[140:143], v11, s[64:67], s69 offen offset:1024 sc1
  s_waitcnt vmcnt(8)
  s_mov_b64 exec, 1
  v_mov_b32 v2, 0
  v_mov_b32 v3, 1
  buffer_store_dword v3, v2, s[64:67], s72 offen offset:8 sc1
  s_mov_b64 exec, -1
  s_nop 3
  s_waitcnt lgkmcnt(8)
  v_mfma_f32_16x16x32_bf16 v[80:83], v[240:243], v[28:31], v[80:83]
  ds_read_b64_tr_b16 v[232:233], v21 offset:0
  v_mfma_f32_16x16x32_bf16 v[80:83], v[244:247], v[32:35], v[80:83]
  ds_read_b64_tr_b16 v[234:235], v21 offset:2048
  v_mfma_f32_16x16x32_bf16 v[84:87], v[244:247], v[40:43], v[84:87]
  ds_read_b64_tr_b16 v[236:237], v21 offset:4096
  v_mfma_f32_16x16x32_bf16 v[84:87], v[240:243], v[36:39], v[84:87]
  ds_read_b64_tr_b16 v[238:239], v21 offset:6144
  s_barrier
  s_waitcnt lgkmcnt(8)
  v_mfma_f32_16x16x32_bf16 v[92:95], v[248:251], v[36:39], v[92:95]
  ds_read_b64_tr_b16 v[240:241], v22 offset:0
  v_mfma_f32_16x16x32_bf16 v[92:95], v[252:255], v[40:43], v[92:95]
  ds_read_b64_tr_b16 v[242:243], v22 offset:2048
  s_add_u32 m0, s10, 32768
  s_mov_b32 s12, 524288
  buffer_load_dwordx4 v15, s[48:51], s12 offen lds
  v_mfma_f32_16x16x32_bf16 v[88:91], v[252:255], v[32:35], v[88:91]
  ds_read_b64_tr_b16 v[244:245], v22 offset:4096
  v_mfma_f32_16x16x32_bf16 v[88:91], v[248:251], v[28:31], v[88:91]
  ds_read_b64_tr_b16 v[246:247], v22 offset:6144
  s_add_u32 m0, s10, 36864
  s_mov_b32 s12, 589824
  buffer_load_dwordx4 v15, s[48:51], s12 offen lds
  s_waitcnt lgkmcnt(8)
  v_mfma_f32_16x16x32_bf16 v[64:67], v[224:227], v[208:211], v[64:67]
  ds_read_b64_tr_b16 v[248:249], v23 offset:0
  v_mfma_f32_16x16x32_bf16 v[64:67], v[228:231], v[212:215], v[64:67]
  ds_read_b64_tr_b16 v[250:251], v23 offset:2048
  s_add_u32 m0, s10, 40960
  s_mov_b32 s12, 655360
  buffer_load_dwordx4 v15, s[48:51], s12 offen lds
  v_mfma_f32_16x16x32_bf16 v[68:71], v[228:231], v[220:223], v[68:71]
  ds_read_b64_tr_b16 v[252:253], v23 offset:4096
  v_mfma_f32_16x16x32_bf16 v[68:71], v[224:227], v[216:219], v[68:71]
  ds_read_b64_tr_b16 v[254:255], v23 offset:6144
  s_add_u32 m0, s10, 45056
  s_mov_b32 s12, 720896
  buffer_load_dwordx4 v15, s[48:51], s12 offen lds
  s_waitcnt lgkmcnt(8)
  v_mfma_f32_16x16x32_bf16 v[76:79], v[232:235], v[216:219], v[76:79]
  ds_read_b64_tr_b16 v[224:225], v20 offset:8192
  v_mfma_f32_16x16x32_bf16 v[76:79], v[236:239], v[220:223], v[76:79]
  ds_read_b64_tr_b16 v[226:227], v20 offset:10240
  s_add_u32 m0, s10, 65536
  s_mov_b32 s12, 1048576
  buffer_load_dwordx4 v15, s[48:51], s12 offen lds
  v_mfma_f32_16x16x32_bf16 v[72:75], v[236:239], v[212:215], v[72:75]
  ds_read_b64_tr_b16 v[228:229], v20 offset:12288
  v_mfma_f32_16x16x32_bf16 v[72:75], v[232:235], v[208:211], v[72:75]
  ds_read_b64_tr_b16 v[230:231], v20 offset:14336
  s_add_u32 m0, s10, 69632
  s_mov_b32 s12, 1114112
  buffer_load_dwordx4 v15, s[48:51], s12 offen lds
  s_waitcnt lgkmcnt(8)
  v_mfma_f32_16x16x32_bf16 v[80:83], v[240:243], v[208:211], v[80:83]
  ds_read_b64_tr_b16 v[232:233], v21 offset:8192
  v_mfma_f32_16x16x32_bf16 v[80:83], v[244:247], v[212:215], v[80:83]
  ds_read_b64_tr_b16 v[234:235], v21 offset:10240
  s_add_u32 m0, s10, 73728
  s_mov_b32 s12, 1179648
  buffer_load_dwordx4 v15, s[48:51], s12 offen lds
  v_mfma_f32_16x16x32_bf16 v[84:87], v[244:247], v[220:223], v[84:87]
  ds_read_b64_tr_b16 v[236:237], v21 offset:12288
  v_mfma_f32_16x16x32_bf16 v[84:87], v[240:243], v[216:219], v[84:87]
  ds_read_b64_tr_b16 v[238:239], v21 offset:14336
  s_add_u32 m0, s10, 77824
  s_mov_b32 s12, 1245184
  buffer_load_dwordx4 v15, s[48:51], s12 offen lds
  s_waitcnt lgkmcnt(8)
  v_mfma_f32_16x16x32_bf16 v[92:95], v[248:251], v[216:219], v[92:95]
  ds_read_b64_tr_b16 v[240:241], v22 offset:8192
  v_mfma_f32_16x16x32_bf16 v[92:95], v[252:255], v[220:223], v[92:95]
  ds_read_b64_tr_b16 v[242:243], v22 offset:10240
  s_add_u32 m0, s10, 81920
  s_mov_b32 s12, 1310720
  buffer_load_dwordx4 v15, s[48:51], s12 offen lds
  v_mfma_f32_16x16x32_bf16 v[88:91], v[252:255], v[212:215], v[88:91]
  ds_read_b64_tr_b16 v[244:245], v22 offset:12288
  v_mfma_f32_16x16x32_bf16 v[88:91], v[248:251], v[208:211], v[88:91]
  ds_read_b64_tr_b16 v[246:247], v22 offset:14336
  s_add_u32 m0, s10, 86016
  s_mov_b32 s12, 1376256
  buffer_load_dwordx4 v15, s[48:51], s12 offen lds
  s_waitcnt lgkmcnt(8)
  v_mfma_f32_16x16x32_bf16 v[64:67], v[224:227], v[192:195], v[64:67]
  ds_read_b64_tr_b16 v[248:249], v23 offset:8192
  v_mfma_f32_16x16x32_bf16 v[64:67], v[228:231], v[196:199], v[64:67]
  ds_read_b64_tr_b16 v[250:251], v23 offset:10240
  s_add_u32 m0, s10, 90112
  s_mov_b32 s12, 1441792
  buffer_load_dwordx4 v15, s[48:51], s12 offen lds
  v_mfma_f32_16x16x32_bf16 v[68:71], v[228:231], v[204:207], v[68:71]
  ds_read_b64_tr_b16 v[252:253], v23 offset:12288
  v_mfma_f32_16x16x32_bf16 v[68:71], v[224:227], v[200:203], v[68:71]
  ds_read_b64_tr_b16 v[254:255], v23 offset:14336
  s_add_u32 m0, s10, 94208
  s_mov_b32 s12, 1507328
  buffer_load_dwordx4 v15, s[48:51], s12 offen lds
  s_waitcnt lgkmcnt(8)
  v_mfma_f32_16x16x32_bf16 v[76:79], v[232:235], v[200:203], v[76:79]
  ds_read_b64_tr_b16 v[224:225], v20 offset:16384
  v_mfma_f32_16x16x32_bf16 v[76:79], v[236:239], v[204:207], v[76:79]
  ds_read_b64_tr_b16 v[226:227], v20 offset:18432
  v_mfma_f32_16x16x32_bf16 v[72:75], v[236:239], v[196:199], v[72:75]
  ds_read_b64_tr_b16 v[228:229], v20 offset:20480
  v_mfma_f32_16x16x32_bf16 v[72:75], v[232:235], v[192:195], v[72:75]
  ds_read_b64_tr_b16 v[230:231], v20 offset:22528
  s_waitcnt lgkmcnt(8)
  v_mfma_f32_16x16x32_bf16 v[80:83], v[240:243], v[192:195], v[80:83]
  ds_read_b64_tr_b16 v[232:233], v21 offset:16384
  v_mfma_f32_16x16x32_bf16 v[80:83], v[244:247], v[196:199], v[80:83]
  ds_read_b64_tr_b16 v[234:235], v21 offset:18432
  s_xor_b32 s14, s72, 512
  v_mov_b32 v5, 0
  buffer_load_dword v9, v5, s[64:67], s14 offen offset:8 sc1
  v_mfma_f32_16x16x32_bf16 v[84:87], v[244:247], v[204:207], v[84:87]
  ds_read_b64_tr_b16 v[236:237], v21 offset:20480
  v_mfma_f32_16x16x32_bf16 v[84:87], v[240:243], v[200:203], v[84:87]
  ds_read_b64_tr_b16 v[238:239], v21 offset:22528
  s_barrier
  s_waitcnt lgkmcnt(8)
  v_mfma_f32_16x16x32_bf16 v[92:95], v[248:251], v[200:203], v[92:95]
  ds_read_b64_tr_b16 v[240:241], v22 offset:16384
  v_mfma_f32_16x16x32_bf16 v[92:95], v[252:255], v[204:207], v[92:95]
  ds_read_b64_tr_b16 v[242:243], v22 offset:18432
  s_add_u32 m0, s10, 16384
  s_mov_b32 s12, 262144
  buffer_load_dwordx4 v15, s[48:51], s12 offen lds
  v_mfma_f32_16x16x32_bf16 v[88:91], v[252:255], v[196:199], v[88:91]
  ds_read_b64_tr_b16 v[244:245], v22 offset:20480
  v_mfma_f32_16x16x32_bf16 v[88:91], v[248:251], v[192:195], v[88:91]
  ds_read_b64_tr_b16 v[246:247], v22 offset:22528
  s_add_u32 m0, s10, 20480
  s_mov_b32 s12, 327680
  buffer_load_dwordx4 v15, s[48:51], s12 offen lds
  s_waitcnt lgkmcnt(8)
  v_mfma_f32_16x16x32_bf16 v[64:67], v[224:227], v[176:179], v[64:67]
  ds_read_b64_tr_b16 v[248:249], v23 offset:16384
  v_mfma_f32_16x16x32_bf16 v[64:67], v[228:231], v[180:183], v[64:67]
  ds_read_b64_tr_b16 v[250:251], v23 offset:18432
  s_add_u32 m0, s10, 24576
  s_mov_b32 s12, 393216
  buffer_load_dwordx4 v15, s[48:51], s12 offen lds
  v_mfma_f32_16x16x32_bf16 v[68:71], v[228:231], v[188:191], v[68:71]
  ds_read_b64_tr_b16 v[252:253], v23 offset:20480
  v_mfma_f32_16x16x32_bf16 v[68:71], v[224:227], v[184:187], v[68:71]
  ds_read_b64_tr_b16 v[254:255], v23 offset:22528
  s_add_u32 m0, s10, 28672
  s_mov_b32 s12, 458752
  buffer_load_dwordx4 v15, s[48:51], s12 offen lds
  s_waitcnt lgkmcnt(8)
  v_mfma_f32_16x16x32_bf16 v[76:79], v[232:235], v[184:187], v[76:79]
  ds_read_b64_tr_b16 v[224:225], v20 offset:24576
  v_mfma_f32_16x16x32_bf16 v[76:79], v[236:239], v[188:191], v[76:79]
  ds_read_b64_tr_b16 v[226:227], v20 offset:26624
  s_add_u32 m0, s10, 98304
  s_mov_b32 s12, 1572864
  buffer_load_dwordx4 v15, s[48:51], s12 offen lds
  v_mfma_f32_16x16x32_bf16 v[72:75], v[236:239], v[180:183], v[72:75]
  ds_read_b64_tr_b16 v[228:229], v20 offset:28672
  v_mfma_f32_16x16x32_bf16 v[72:75], v[232:235], v[176:179], v[72:75]
  ds_read_b64_tr_b16 v[230:231], v20 offset:30720
  s_add_u32 m0, s10, 102400
  s_mov_b32 s12, 1638400
  buffer_load_dwordx4 v15, s[48:51], s12 offen lds
  s_waitcnt lgkmcnt(8)
  v_mfma_f32_16x16x32_bf16 v[80:83], v[240:243], v[176:179], v[80:83]
  ds_read_b64_tr_b16 v[232:233], v21 offset:24576
  v_mfma_f32_16x16x32_bf16 v[80:83], v[244:247], v[180:183], v[80:83]
  ds_read_b64_tr_b16 v[234:235], v21 offset:26624
  s_add_u32 m0, s10, 106496
  s_mov_b32 s12, 1703936
  buffer_load_dwordx4 v15, s[48:51], s12 offen lds
  v_mfma_f32_16x16x32_bf16 v[84:87], v[244:247], v[188:191], v[84:87]
  ds_read_b64_tr_b16 v[236:237], v21 offset:28672
  v_mfma_f32_16x16x32_bf16 v[84:87], v[240:243], v[184:187], v[84:87]
  ds_read_b64_tr_b16 v[238:239], v21 offset:30720
  s_add_u32 m0, s10, 110592
  s_mov_b32 s12, 1769472
  buffer_load_dwordx4 v15, s[48:51], s12 offen lds
  s_waitcnt lgkmcnt(8)
  v_mfma_f32_16x16x32_bf16 v[92:95], v[248:251], v[184:187], v[92:95]
  ds_read_b64_tr_b16 v[240:241], v22 offset:24576
  v_mfma_f32_16x16x32_bf16 v[92:95], v[252:255], v[188:191], v[92:95]
  ds_read_b64_tr_b16 v[242:243], v22 offset:26624
  v_mfma_f32_16x16x32_bf16 v[88:91], v[252:255], v[180:183], v[88:91]
  ds_read_b64_tr_b16 v[244:245], v22 offset:28672
  v_mfma_f32_16x16x32_bf16 v[88:91], v[248:251], v[176:179], v[88:91]
  ds_read_b64_tr_b16 v[246:247], v22 offset:30720
  s_waitcnt vmcnt(8)
  v_cmp_eq_u32 vcc, 1, v9
  s_xor_b32 s71, s71, 32768
  s_mov_b32 s70, 0
  s_cmp_eq_u64 vcc, exec
  s_cbranch_scc0 L_g_npo
  s_mov_b32 s70, 1
  buffer_load_dwordx4 v[96:99], v10, s[64:67], s71 offen offset:0 sc1
  buffer_load_dwordx4 v[100:103], v10, s[64:67], s71 offen offset:1024 sc1
  buffer_load_dwordx4 v[104:107], v10, s[64:67], s71 offen offset:2048 sc1
  buffer_load_dwordx4 v[108:111], v10, s[64:67], s71 offen offset:3072 sc1
L_g_npo:
  s_waitcnt lgkmcnt(8)
  v_mfma_f32_16x16x32_bf16 v[64:67], v[224:227], v[160:163], v[64:67]
  ds_read_b64_tr_b16 v[248:249], v23 offset:24576
  v_mfma_f32_16x16x32_bf16 v[64:67], v[228:231], v[164:167], v[64:67]
  ds_read_b64_tr_b16 v[250:251], v23 offset:26624
  v_mfma_f32_16x16x32_bf16 v[68:71], v[228:231], v[172:175], v[68:71]
  ds_read_b64_tr_b16 v[252:253], v23 offset:28672
  v_mfma_f32_16x16x32_bf16 v[68:71], v[224:227], v[168:171], v[68:71]
  ds_read_b64_tr_b16 v[254:255], v23 offset:30720
  s_waitcnt lgkmcnt(8)
  v_mfma_f32_16x16x32_bf16 v[76:79], v[232:235], v[168:171], v[76:79]
  ds_read_b64_tr_b16 v[224:225], v20 offset:32768
  v_mfma_f32_16x16x32_bf16 v[76:79], v[236:239], v[172:175], v[76:79]
  ds_read_b64_tr_b16 v[226:227], v20 offset:34816
  v_mfma_f32_16x16x32_bf16 v[72:75], v[236:239], v[164:167], v[72:75]
  ds_read_b64_tr_b16 v[228:229], v20 offset:36864
  v_mfma_f32_16x16x32_bf16 v[72:75], v[232:235], v[160:163], v[72:75]
  ds_read_b64_tr_b16 v[230:231], v20 offset:38912
  s_waitcnt lgkmcnt(8)
  v_mfma_f32_16x16x32_bf16 v[80:83], v[240:243], v[160:163], v[80:83]
  ds_read_b64_tr_b16 v[232:233], v21 offset:32768
  v_mfma_f32_16x16x32_bf16 v[80:83], v[244:247], v[164:167], v[80:83]
  ds_read_b64_tr_b16 v[234:235], v21 offset:34816
  v_mfma_f32_16x16x32_bf16 v[84:87], v[244:247], v[172:175], v[84:87]
  ds_read_b64_tr_b16 v[236:237], v21 offset:36864
  v_mfma_f32_16x16x32_bf16 v[84:87], v[240:243], v[168:171], v[84:87]
  ds_read_b64_tr_b16 v[238:239], v21 offset:38912
  s_waitcnt lgkmcnt(8)
  v_mfma_f32_16x16x32_bf16 v[92:95], v[248:251], v[168:171], v[92:95]
  ds_read_b64_tr_b16 v[240:241], v22 offset:32768
  v_mfma_f32_16x16x32_bf16 v[92:95], v[252:255], v[172:175], v[92:95]
  ds_read_b64_tr_b16 v[242:243], v22 offset:34816
  v_mfma_f32_16x16x32_bf16 v[88:91], v[252:255], v[164:167], v[88:91]
  ds_read_b64_tr_b16 v[244:245], v22 offset:36864
  v_mfma_f32_16x16x32_bf16 v[88:91], v[248:251], v[160:163], v[88:91]
  ds_read_b64_tr_b16 v[246:247], v22 offset:38912
  s_barrier
  s_add_u32 m0, s10, 114688
  s_mov_b32 s12, 1835008
  buffer_load_dwordx4 v15, s[48:51], s12 offen lds
  s_add_u32 m0, s10, 118784
  s_mov_b32 s12, 1900544
  buffer_load_dwordx4 v15, s[48:51], s12 offen lds
  s_add_u32 m0, s10, 122880
  s_mov_b32 s12, 1966080
  buffer_load_dwordx4 v15, s[48:51], s12 offen lds
  s_add_u32 m0, s10, 126976
  s_mov_b32 s12, 2031616
  buffer_load_dwordx4 v15, s[48:51], s12 offen lds
  s_add_u32 m0, s10, 0
  s_mov_b32 s12, 0
  buffer_load_dwordx4 v15, s[48:51], s12 offen lds
  s_add_u32 m0, s10, 4096
  s_mov_b32 s12, 65536
  buffer_load_dwordx4 v15, s[48:51], s12 offen lds
  s_add_u32 m0, s10, 8192
  s_mov_b32 s12, 131072
  buffer_load_dwordx4 v15, s[48:51], s12 offen lds
  s_add_u32 m0, s10, 12288
  s_mov_b32 s12, 196608
  buffer_load_dwordx4 v15, s[48:51], s12 offen lds
  s_waitcnt lgkmcnt(8)
  v_mfma_f32_16x16x32_bf16 v[64:67], v[224:227], v[144:147], v[64:67]
  ds_read_b64_tr_b16 v[248:249], v23 offset:32768
  v_mfma_f32_16x16x32_bf16 v[64:67], v[228:231], v[148:151], v[64:67]
  ds_read_b64_tr_b16 v[250:251], v23 offset:34816
  v_mfma_f32_16x16x32_bf16 v[68:71], v[228:231], v[156:159], v[68:71]
  ds_read_b64_tr_b16 v[252:253], v23 offset:36864
  v_mfma_f32_16x16x32_bf16 v[68:71], v[224:227], v[152:155], v[68:71]
  ds_read_b64_tr_b16 v[254:255], v23 offset:38912
  s_waitcnt lgkmcnt(8)
  v_mfma_f32_16x16x32_bf16 v[76:79], v[232:235], v[152:155], v[76:79]
  ds_read_b64_tr_b16 v[224:225], v20 offset:40960
  v_mfma_f32_16x16x32_bf16 v[76:79], v[236:239], v[156:159], v[76:79]
  ds_read_b64_tr_b16 v[226:227], v20 offset:43008
  v_mfma_f32_16x16x32_bf16 v[72:75], v[236:239], v[148:151], v[72:75]
  ds_read_b64_tr_b16 v[228:229], v20 offset:45056
  v_mfma_f32_16x16x32_bf16 v[72:75], v[232:235], v[144:147], v[72:75]
  ds_read_b64_tr_b16 v[230:231], v20 offset:47104
  s_waitcnt lgkmcnt(8)
  v_mfma_f32_16x16x32_bf16 v[80:83], v[240:243], v[144:147], v[80:83]
  ds_read_b64_tr_b16 v[232:233], v21 offset:40960
  v_mfma_f32_16x16x32_bf16 v[80:83], v[244:247], v[148:151], v[80:83]
  ds_read_b64_tr_b16 v[234:235], v21 offset:43008
  v_mfma_f32_16x16x32_bf16 v[84:87], v[244:247], v[156:159], v[84:87]
  ds_read_b64_tr_b16 v[236:237], v21 offset:45056
  v_mfma_f32_16x16x32_bf16 v[84:87], v[240:243], v[152:155], v[84:87]
  ds_read_b64_tr_b16 v[238:239], v21 offset:47104
  s_waitcnt lgkmcnt(8)
  v_mfma_f32_16x16x32_bf16 v[92:95], v[248:251], v[152:155], v[92:95]
  ds_read_b64_tr_b16 v[240:241], v22 offset:40960
  v_mfma_f32_16x16x32_bf16 v[92:95], v[252:255], v[156:159], v[92:95]
  ds_read_b64_tr_b16 v[242:243], v22 offset:43008
  v_mfma_f32_16x16x32_bf16 v[88:91], v[252:255], v[148:151], v[88:91]
  ds_read_b64_tr_b16 v[244:245], v22 offset:45056
  v_mfma_f32_16x16x32_bf16 v[88:91], v[248:251], v[144:147], v[88:91]
  ds_read_b64_tr_b16 v[246:247], v22 offset:47104
  s_waitcnt lgkmcnt(8)
  v_mfma_f32_16x16x32_bf16 v[64:67], v[224:227], v[128:131], v[64:67]
  ds_read_b64_tr_b16 v[248:249], v23 offset:40960
  v_mfma_f32_16x16x32_bf16 v[64:67], v[228:231], v[132:135], v[64:67]
  ds_read_b64_tr_b16 v[250:251], v23 offset:43008
  v_mfma_f32_16x16x32_bf16 v[68:71], v[228:231], v[140:143], v[68:71]
  ds_read_b64_tr_b16 v[252:253], v23 offset:45056
  v_mfma_f32_16x16x32_bf16 v[68:71], v[224:227], v[136:139], v[68:71]
  ds_read_b64_tr_b16 v[254:255], v23 offset:47104
  s_waitcnt lgkmcnt(8)
  v_mfma_f32_16x16x32_bf16 v[76:79], v[232:235], v[136:139], v[76:79]
  v_mfma_f32_16x16x32_bf16 v[76:79], v[236:239], v[140:143], v[76:79]
  v_mfma_f32_16x16x32_bf16 v[72:75], v[236:239], v[132:135], v[72:75]
  v_mfma_f32_16x16x32_bf16 v[72:75], v[232:235], v[128:131], v[72:75]
  s_waitcnt lgkmcnt(6)
  v_mfma_f32_16x16x32_bf16 v[80:83], v[240:243], v[128:131], v[80:83]
  s_waitcnt lgkmcnt(4)
  v_mfma_f32_16x16x32_bf16 v[80:83], v[244:247], v[132:135], v[80:83]
  v_mfma_f32_16x16x32_bf16 v[84:87], v[244:247], v[140:143], v[84:87]
  v_mfma_f32_16x16x32_bf16 v[84:87], v[240:243], v[136:139], v[84:87]
  s_waitcnt lgkmcnt(2)
  v_mfma_f32_16x16x32_bf16 v[92:95], v[248:251], v[136:139], v[92:95]
  s_waitcnt lgkmcnt(0)
  v_mfma_f32_16x16x32_bf16 v[92:95], v[252:255], v[140:143], v[92:95]
  v_mfma_f32_16x16x32_bf16 v[88:91], v[252:255], v[132:135], v[88:91]
  v_mfma_f32_16x16x32_bf16 v[88:91], v[248:251], v[128:131], v[88:91]
  s_waitcnt vmcnt(8)
  s_waitcnt lgkmcnt(0)
  s_branch L_g_tail
.fill 3, 4, 0xbf800000
L_g_tail:
L_pad_850:
  s_cbranch_execz L_pad_1122
  s_nop 0
  v_sub_f32 v60, 1.0, v60
  v_sub_f32 v61, 1.0, v61
  s_lshl_b32 s12, s4, 13
  s_add_u32 s12, s12, 131072
  v_add_u32 v6, s12, v10
  s_cmp_eq_u32 s70, 1
  s_cbranch_scc1 L_g_got
  s_mov_b32 s15, 1048576
L_poll_42:
  buffer_load_dword v4, v5, s[64:67], s14 offen offset:8 sc1
  s_waitcnt vmcnt(0)
  v_cmp_eq_u32 vcc, 1, v4
  s_nop 1
  s_cmp_eq_u64 vcc, exec
  s_cbranch_scc1 L_pdone_43
  s_sleep 2
  s_sub_u32 s15, s15, 1
  s_cmp_lg_u32 s15, 0
  s_cbranch_scc1 L_poll_42
L_pdone_43:
  buffer_load_dwordx4 v[96:99], v10, s[64:67], s71 offen offset:0 sc1
  buffer_load_dwordx4 v[100:103], v10, s[64:67], s71 offen offset:1024 sc1
  buffer_load_dwordx4 v[104:107], v10, s[64:67], s71 offen offset:2048 sc1
  buffer_load_dwordx4 v[108:111], v10, s[64:67], s71 offen offset:3072 sc1
  s_waitcnt vmcnt(0)
L_g_got:
  v_lshlrev_b32 v112, 16, v96
  v_and_b32 v113, 0xffff0000, v96
  v_lshlrev_b32 v114, 16, v97
  v_and_b32 v115, 0xffff0000, v97
  v_add_f32 v64, v64, v112
  v_mul_f32 v64, v60, v64
  v_add_f32 v65, v65, v113
  v_mul_f32 v65, v60, v65
  v_add_f32 v66, v66, v114
  v_mul_f32 v66, v60, v66
  v_add_f32 v67, v67, v115
  v_mul_f32 v67, v60, v67
  v_lshlrev_b32 v112, 16, v98
  v_and_b32 v113, 0xffff0000, v98
  v_lshlrev_b32 v114, 16, v99
  v_and_b32 v115, 0xffff0000, v99
  v_add_f32 v68, v68, v112
  v_mul_f32 v68, v61, v68
  v_add_f32 v69, v69, v113
  v_mul_f32 v69, v61, v69
  v_add_f32 v70, v70, v114
  v_mul_f32 v70, v61, v70
  v_add_f32 v71, v71, v115
  v_mul_f32 v71, v61, v71
  v_lshlrev_b32 v112, 16, v100
  v_and_b32 v113, 0xffff0000, v100
  v_lshlrev_b32 v114, 16, v101
  v_and_b32 v115, 0xffff0000, v101
  v_add_f32 v72, v72, v112
  v_mul_f32 v72, v60, v72
  v_add_f32 v73, v73, v113
  v_mul_f32 v73, v60, v73
  v_add_f32 v74, v74, v114
  v_mul_f32 v74, v60, v74
  v_add_f32 v75, v75, v115
  v_mul_f32 v75, v60, v75
  v_lshlrev_b32 v112, 16, v102
  v_and_b32 v113, 0xffff0000, v102
  v_lshlrev_b32 v114, 16, v103
  v_and_b32 v115, 0xffff0000, v103
  v_add_f32 v76, v76, v112
  v_mul_f32 v76, v61, v76
  v_add_f32 v77, v77, v113
  v_mul_f32 v77, v61, v77
  v_add_f32 v78, v78, v114
  v_mul_f32 v78, v61, v78
  v_add_f32 v79, v79, v115
  v_mul_f32 v79, v61, v79
  v_lshlrev_b32 v112, 16, v104
  v_and_b32 v113, 0xffff0000, v104
  v_lshlrev_b32 v114, 16, v105
  v_and_b32 v115, 0xffff0000, v105
  v_add_f32 v80, v80, v112
  v_mul_f32 v80, v60, v80
  v_add_f32 v81, v81, v113
  v_mul_f32 v81, v60, v81
  v_add_f32 v82, v82, v114
  v_mul_f32 v82, v60, v82
  v_add_f32 v83, v83, v115
  v_mul_f32 v83, v60, v83
  v_lshlrev_b32 v112, 16, v106
  v_and_b32 v113, 0xffff0000, v106
  v_lshlrev_b32 v114, 16, v107
  v_and_b32 v115, 0xffff0000, v107
  v_add_f32 v84, v84, v112
  v_mul_f32 v84, v61, v84
  v_add_f32 v85, v85, v113
  v_mul_f32 v85, v61, v85
  v_add_f32 v86, v86, v114
  v_mul_f32 v86, v61, v86
  v_add_f32 v87, v87, v115
  v_mul_f32 v87, v61, v87
  v_lshlrev_b32 v112, 16, v108
  v_and_b32 v113, 0xffff0000, v108
  v_lshlrev_b32 v114, 16, v109
  v_and_b32 v115, 0xffff0000, v109
  v_add_f32 v88, v88, v112
  v_mul_f32 v88, v60, v88
  v_add_f32 v89, v89, v113
  v_mul_f32 v89, v60, v89
  v_add_f32 v90, v90, v114
  v_mul_f32 v90, v60, v90
  v_add_f32 v91, v91, v115
  v_mul_f32 v91, v60, v91
  v_lshlrev_b32 v112, 16, v110
  v_and_b32 v113, 0xffff0000, v110
  v_lshlrev_b32 v114, 16, v111
  v_and_b32 v115, 0xffff0000, v111
  v_add_f32 v92, v92, v112
  v_mul_f32 v92, v61, v92
  v_add_f32 v93, v93, v113
  v_mul_f32 v93, v61, v93
  v_add_f32 v94, v94, v114
  v_mul_f32 v94, v61, v94
  v_add_f32 v95, v95, v115
  v_mul_f32 v95, v61, v95
  s_barrier
  ds_write_b128 v6, v[64:67] offset:0
  ds_write_b128 v6, v[68:71] offset:1024
  ds_write_b128 v6, v[72:75] offset:2048
  ds_write_b128 v6, v[76:79] offset:3072
  ds_write_b128 v6, v[80:83] offset:4096
  ds_write_b128 v6, v[84:87] offset:5120
  ds_write_b128 v6, v[88:91] offset:6144
  ds_write_b128 v6, v[92:95] offset:7168
  s_waitcnt vmcnt(0) lgkmcnt(0)
  s_lshl_b32 s12, s5, 4
  s_add_u32 s12, s12, s6
  s_lshl_b32 s12, s12, 2
  s_add_u32 s12, s12, s4
  s_lshl_b32 s12, s12, 7
  s_add_u32 s12, s12, 27656192
  v_mov_b32 v2, 0
  v_mov_b32 v3, 2
  s_mov_b64 exec, 1
  s_setprio 3
  s_barrier
  buffer_store_dword v3, v2, s[64:67], s12 offen offset:4 sc1
  s_endpgm
.fill 95, 4, 0xbf800000
L_crole:
  s_mov_b64 exec, -1
  s_waitcnt lgkmcnt(0)
  s_mov_b32 s64, s42
  s_mov_b32 s65, s43
  s_mov_b32 s66, 28311552
  s_mov_b32 s67, 0x20000
  s_setprio 2
  s_and_b32 s70, s4, 1
  s_mov_b32 s71, s4
  s_xor_b32 s72, s4, 1
  s_mov_b32 s44, s30
  s_mov_b32 s45, s31
  s_mov_b32 s46, 7168
  s_mov_b32 s47, 0x20000
  v_lshrrev_b32 v2, 4, v0
  v_lshlrev_b32 v3, 3, v2
  s_mul_i32 s12, s6, 448
  s_mul_i32 s13, s70, 192
  s_add_u32 s13, s13, s12
  buffer_load_dwordx2 v[192:193], v3, s[44:47], s13 offen offset:0
  buffer_load_dwordx2 v[194:195], v3, s[44:47], s13 offen offset:32
  buffer_load_dwordx2 v[196:197], v3, s[44:47], s13 offen offset:64
  buffer_load_dwordx2 v[198:199], v3, s[44:47], s13 offen offset:96
  buffer_load_dwordx2 v[200:201], v3, s[44:47], s13 offen offset:128
  buffer_load_dwordx2 v[202:203], v3, s[44:47], s13 offen offset:160
  buffer_load_dwordx2 v[204:205], v3, s[44:47], s12 offen offset:384
  buffer_load_dwordx2 v[206:207], v3, s[44:47], s12 offen offset:416
  s_lshl_b32 s15, s2, 2
  s_add_u32 s15, s15, s4
  s_lshr_b32 s12, s2, 3
  s_lshl_b32 s12, s12, 2
  s_add_u32 s12, s12, s4
  s_bitcmp1_b32 s12, 6
  s_cselect_b32 s20, s22, s20
  s_cselect_b32 s21, s23, s21
  s_and_b32 s12, s12, 63
  s_lshl_b32 s12, s12, 10
  s_add_u32 s20, s20, s12
  s_addc_u32 s21, s21, 0
  s_load_dword s0, s[20:21], 0
  s_load_dword s0, s[20:21], 64
  s_load_dword s0, s[20:21], 128
  s_load_dword s0, s[20:21], 192
  s_load_dword s0, s[20:21], 256
  s_load_dword s0, s[20:21], 320
  s_load_dword s0, s[20:21], 384
  s_load_dword s0, s[20:21], 448
  s_load_dword s0, s[20:21], 512
  s_load_dword s0, s[20:21], 576
  s_load_dword s0, s[20:21], 640
  s_load_dword s0, s[20:21], 704
  s_load_dword s0, s[20:21], 768
  s_load_dword s0, s[20:21], 832
  s_mov_b32 s48, s40
  s_mov_b32 s49, s41
  s_mov_b32 s50, 256
  s_mov_b32 s51, 0x20000
  s_lshr_b32 s12, s2, 4
  s_or_b32 s69, s12, s4
  s_cmp_lg_u32 s69, 0
  s_cbranch_scc1 L_noz_1
  v_lshlrev_b32 v4, 7, v0
  s_lshl_b32 s12, s2, 13
  s_add_u32 s12, s12, 27656192
  v_mov_b32 v224, 0
  v_mov_b32 v225, 0
  v_mov_b32 v226, 0
  v_mov_b32 v227, 0
  buffer_store_dwordx4 v[224:227], v4, s[64:67], s12 offen sc1
L_noz_1:
  v_and_b32 v3, 15, v0
  v_lshrrev_b32 v4, 1, v3
  v_xor_b32 v4, v4, v2
  v_lshlrev_b32 v4, 4, v4
  v_lshl_add_u32 v4, v3, 7, v4
  v_xor_b32 v5, 64, v4
  s_lshl_b32 s12, s71, 12
  s_lshl_b32 s13, s72, 12
  s_add_u32 s12, s12, 90112
  s_add_u32 s13, s13, 90112
  v_add_u32 v6, s12, v4
  v_add_u32 v7, s12, v5
  v_add_u32 v8, s13, v4
  v_add_u32 v9, s13, v5
  v_bfe_u32 v3, v0, 2, 2
  v_lshl_add_u32 v4, v2, 3, v3
  v_and_b32 v5, 3, v0
  v_lshlrev_b32 v5, 3, v5
  v_and_b32 v2, 1, v2
  v_mul_u32_u24 v1, 448, v4
  v_add_u32 v1, v1, v5
  v_lshl_add_u32 v14, v2, 5, v1
  v_xor_b32 v15, 1, v2
  v_lshl_add_u32 v15, v15, 5, v1
  s_mul_i32 s12, s70, 192
  s_add_u32 s12, s12, 106496
  v_add_u32 v12, s12, v14
  v_add_u32 v13, s12, v15
  v_add_u32 v14, 106880, v14
  v_add_u32 v15, 106880, v15
  v_lshrrev_b32 v3, 1, v3
  v_xor_b32 v2, s70, v2
  v_lshl_add_u32 v3, v2, 1, v3
  v_lshl_add_u32 v5, v3, 5, v5
  v_lshl_add_u32 v5, v4, 7, v5
  v_add_u32 v10, 135168, v5
  v_xor_b32 v11, 32, v10
  v_mov_b32 v16, 0
  v_mov_b32 v17, 0
  v_mov_b32 v18, 0
  v_mov_b32 v19, 0
  v_mov_b32 v20, 0
  v_mov_b32 v21, 0
  v_mov_b32 v22, 0
  v_mov_b32 v23, 0
  v_mov_b32 v24, 0
  v_mov_b32 v25, 0
  v_mov_b32 v26, 0
  v_mov_b32 v27, 0
  v_mov_b32 v28, 0
  v_mov_b32 v29, 0
  v_mov_b32 v30, 0
  v_mov_b32 v31, 0
  v_mov_b32 v32, 0
  v_mov_b32 v33, 0
  v_mov_b32 v34, 0
  v_mov_b32 v35, 0
  v_mov_b32 v36, 0
  v_mov_b32 v37, 0
  v_mov_b32 v38, 0
  v_mov_b32 v39, 0
  v_mov_b32 v40, 0
  v_mov_b32 v41, 0
  v_mov_b32 v42, 0
  v_mov_b32 v43, 0
  v_mov_b32 v44, 0
  v_mov_b32 v45, 0
  v_mov_b32 v46, 0
  v_mov_b32 v47, 0
  s_mov_b64 exec, 0
  s_cmp_eq_u32 s4, 0
  s_cbranch_scc1 L_pad_901
  s_cmp_eq_u32 s4, 1
  s_cbranch_scc1 L_pad_918
  s_cmp_eq_u32 s4, 2
  s_cbranch_scc1 L_pad_51
  s_branch L_pad_68
L_ret_s2:
  s_mov_b64 exec, -1
  s_waitcnt vmcnt(0)
  s_cmp_lg_u32 s69, 0
  s_cbranch_scc1 L_noz2_2
  s_lshl_b32 s12, s2, 2
  s_mov_b64 exec, 1
  v_mov_b32 v2, 0
  v_mov_b32 v3, 1
  buffer_store_dword v3, v2, s[48:51], s12 offen offset:0 sc1
  s_mov_b64 exec, -1
L_noz2_2:
  s_load_dword s0, s[20:21], 896
  s_load_dword s0, s[20:21], 960
  v_lshlrev_b32 v48, 16, v192
  v_and_b32 v49, 0xffff0000, v192
  v_lshlrev_b32 v50, 16, v193
  v_and_b32 v51, 0xffff0000, v193
  v_lshlrev_b32 v52, 16, v192
  v_and_b32 v53, 0xffff0000, v192
  v_lshlrev_b32 v54, 16, v193
  v_and_b32 v55, 0xffff0000, v193
  v_lshlrev_b32 v56, 16, v192
  v_and_b32 v57, 0xffff0000, v192
  v_lshlrev_b32 v58, 16, v193
  v_and_b32 v59, 0xffff0000, v193
  v_lshlrev_b32 v60, 16, v192
  v_and_b32 v61, 0xffff0000, v192
  v_lshlrev_b32 v62, 16, v193
  v_and_b32 v63, 0xffff0000, v193
  v_lshlrev_b32 v64, 16, v194
  v_and_b32 v65, 0xffff0000, v194
  v_lshlrev_b32 v66, 16, v195
  v_and_b32 v67, 0xffff0000, v195
  v_lshlrev_b32 v68, 16, v194
  v_and_b32 v69, 0xffff0000, v194
  v_lshlrev_b32 v70, 16, v195
  v_and_b32 v71, 0xffff0000, v195
  v_lshlrev_b32 v72, 16, v194
  v_and_b32 v73, 0xffff0000, v194
  v_lshlrev_b32 v74, 16, v195
  v_and_b32 v75, 0xffff0000, v195
  v_lshlrev_b32 v76, 16, v194
  v_and_b32 v77, 0xffff0000, v194
  v_lshlrev_b32 v78, 16, v195
  v_and_b32 v79, 0xffff0000, v195
  v_lshlrev_b32 v80, 16, v196
  v_and_b32 v81, 0xffff0000, v196
  v_lshlrev_b32 v82, 16, v197
  v_and_b32 v83, 0xffff0000, v197
  v_lshlrev_b32 v84, 16, v196
  v_and_b32 v85, 0xffff0000, v196
  v_lshlrev_b32 v86, 16, v197
  v_and_b32 v87, 0xffff0000, v197
  v_lshlrev_b32 v88, 16, v196
  v_and_b32 v89, 0xffff0000, v196
L_pad_884:
  s_cbranch_execz L_crole
  v_lshlrev_b32 v90, 16, v197
  v_and_b32 v91, 0xffff0000, v197
  v_lshlrev_b32 v92, 16, v196
  v_and_b32 v93, 0xffff0000, v196
  v_lshlrev_b32 v94, 16, v197
  v_and_b32 v95, 0xffff0000, v197
  v_lshlrev_b32 v96, 16, v198
  v_and_b32 v97, 0xffff0000, v198
  v_lshlrev_b32 v98, 16, v199
  v_and_b32 v99, 0xffff0000, v199
  v_lshlrev_b32 v100, 16, v198
  v_and_b32 v101, 0xffff0000, v198
  v_lshlrev_b32 v102, 16, v199
  v_and_b32 v103, 0xffff0000, v199
  v_lshlrev_b32 v104, 16, v198
  v_and_b32 v105, 0xffff0000, v198
  v_lshlrev_b32 v106, 16, v199
  v_and_b32 v107, 0xffff0000, v199
  v_lshlrev_b32 v108, 16, v198
  v_and_b32 v109, 0xffff0000, v198
  v_lshlrev_b32 v110, 16, v199
  v_and_b32 v111, 0xffff0000, v199
  v_lshlrev_b32 v112, 16, v200
  v_and_b32 v113, 0xffff0000, v200
  v_lshlrev_b32 v114, 16, v201
  v_and_b32 v115, 0xffff0000, v201
  v_lshlrev_b32 v116, 16, v200
  v_and_b32 v117, 0xffff0000, v200
  v_lshlrev_b32 v118, 16, v201
  v_and_b32 v119, 0xffff0000, v201
  v_lshlrev_b32 v120, 16, v200
  v_and_b32 v121, 0xffff0000, v200
  v_lshlrev_b32 v122, 16, v201
  v_and_b32 v123, 0xffff0000, v201
  v_lshlrev_b32 v124, 16, v200
  v_and_b32 v125, 0xffff0000, v200
  v_lshlrev_b32 v126, 16, v201
  v_and_b32 v127, 0xffff0000, v201
  v_lshlrev_b32 v128, 16, v202
  v_and_b32 v129, 0xffff0000, v202
  v_lshlrev_b32 v130, 16, v203
  v_and_b32 v131, 0xffff0000, v203
  v_lshlrev_b32 v132, 16, v202
  v_and_b32 v133, 0xffff0000, v202
  v_lshlrev_b32 v134, 16, v203
  v_and_b32 v135, 0xffff0000, v203
  v_lshlrev_b32 v136, 16, v202
  v_and_b32 v137, 0xffff0000, v202
  v_lshlrev_b32 v138, 16, v203
  v_and_b32 v139, 0xffff0000, v203
  v_lshlrev_b32 v140, 16, v202
  v_and_b32 v141, 0xffff0000, v202
  v_lshlrev_b32 v142, 16, v203
  v_and_b32 v143, 0xffff0000, v203
  v_lshlrev_b32 v144, 16, v204
  v_and_b32 v145, 0xffff0000, v204
  v_lshlrev_b32 v146, 16, v205
  v_and_b32 v147, 0xffff0000, v205
  v_lshlrev_b32 v148, 16, v204
  v_and_b32 v149, 0xffff0000, v204
  v_lshlrev_b32 v150, 16, v205
  v_and_b32 v151, 0xffff0000, v205
  v_lshlrev_b32 v152, 16, v206
  v_and_b32 v153, 0xffff0000, v206
  v_lshlrev_b32 v154, 16, v207
  v_and_b32 v155, 0xffff0000, v207
  v_lshlrev_b32 v156, 16, v206
  v_and_b32 v157, 0xffff0000, v206
  v_lshlrev_b32 v158, 16, v207
  v_and_b32 v159, 0xffff0000, v207
  s_mov_b32 s44, s38
  s_mov_b32 s45, s39
  s_mov_b32 s46, 4194304
  s_mov_b32 s47, 0x20000
  s_lshl_b32 s19, s7, 13
  s_add_u32 s19, s19, 27656192
  s_mov_b32 s28, 562036736
  s_mov_b32 s29, 1568669696
  s_mov_b32 s31, 1048576
  s_lshl_b32 s12, s7, 7
  s_lshl_b32 s13, s4, 5
  s_add_u32 s13, s12, s13
  s_lshl_b32 s32, s13, 2
  s_add_u32 s32, s32, 27525120
  s_lshl_b32 s20, s13, 11
  s_add_u32 s18, s20, 14680064
  s_lshl_b32 s12, s9, 8
  s_add_u32 s20, s20, s12
  s_lshl_b32 s12, s8, 7
  s_add_u32 s20, s20, s12
  s_lshl_b32 s12, s5, 2
  s_add_u32 s17, s12, s72
  s_add_u32 s16, s12, s71
  s_lshl_b32 s16, s16, 16
  s_lshl_b32 s17, s17, 16
  s_lshl_b32 s12, s6, 1
  s_add_u32 s12, s12, s70
  s_lshl_b32 s12, s12, 10
  s_add_u32 s12, s12, 14680064
  s_add_u32 s16, s16, s12
  s_add_u32 s17, s17, s12
  s_mov_b32 s21, 0x1001
  s_and_b32 s36, s9, 1
  s_mul_i32 s36, s36, 12
  s_xor_b32 s12, s36, 4
  s_lshl1_add_u32 s48, s12, s70
  s_xor_b32 s12, s36, 8
  s_lshl1_add_u32 s49, s12, s70
  s_sub_u32 s37, s49, s48
  s_lshl_b32 s37, s37, 10
  s_mov_b32 s52, 0xf00000
  s_mov_b32 s53, 0xf000000
  s_lshl_b32 s22, s48, 10
  s_add_u32 s22, s22, s18
  s_lshl_b32 s23, s49, 12
  s_mov_b32 s24, 1
  s_lshl_b32 s33, s4, 13
  s_add_u32 s33, s33, 131072
  s_lshl_b32 s35, s48, 12
  s_mov_b32 s68, 8
  s_mov_b32 s74, 2
  s_mov_b32 s75, 4294877184
  s_mov_b32 s14, 45056
  s_barrier
  ds_read_b128 v[160:163], v6 offset:0
  ds_read_b128 v[164:167], v7 offset:0
  ds_read_b64_tr_b16 v[224:225], v10 offset:0
  ds_read_b64_tr_b16 v[226:227], v10 offset:512
  ds_read_b64_tr_b16 v[228:229], v10 offset:4096
  ds_read_b64_tr_b16 v[230:231], v10 offset:4608
  ds_read_b128 v[168:171], v6 offset:2048
  ds_read_b128 v[172:175], v7 offset:2048
  ds_read_b128 v[176:179], v8 offset:0
  ds_read_b128 v[180:183], v9 offset:0
  ds_read_b128 v[184:187], v8 offset:2048
  ds_read_b128 v[188:191], v9 offset:2048
  s_waitcnt lgkmcnt(4)
  ds_read_b64_tr_b16 v[232:233], v11 offset:0
  ds_read_b64_tr_b16 v[234:235], v11 offset:512
  ds_read_b64_tr_b16 v[236:237], v11 offset:4096
  ds_read_b64_tr_b16 v[238:239], v11 offset:4608
  ds_read_b64_tr_b16 v[240:241], v12 offset:0
  ds_read_b64_tr_b16 v[242:243], v12 offset:1792
  ds_read_b64_tr_b16 v[244:245], v12 offset:14336
  ds_read_b64_tr_b16 v[246:247], v12 offset:16128
  s_waitcnt lgkmcnt(0)
.p2align 6
L_c_loop:
  s_waitcnt lgkmcnt(8)
  v_mfma_f32_16x16x32_bf16 v[16:19], v[224:227], v[160:163], v[16:19]
  ds_read_b64_tr_b16 v[248:249], v14 offset:0
  v_mfma_f32_16x16x32_bf16 v[16:19], v[228:231], v[164:167], v[16:19]
  ds_read_b64_tr_b16 v[250:251], v14 offset:1792
  v_mfma_f32_16x16x32_bf16 v[20:23], v[228:231], v[172:175], v[20:23]
  ds_read_b64_tr_b16 v[252:253], v14 offset:14336
  v_mfma_f32_16x16x32_bf16 v[20:23], v[224:227], v[168:171], v[20:23]
  ds_read_b64_tr_b16 v[254:255], v14 offset:16128
  s_waitcnt lgkmcnt(8)
  v_mfma_f32_16x16x32_bf16 v[24:27], v[224:227], v[176:179], v[24:27]
  s_add_u32 s74, s74, 1
  s_cmp_eq_u32 s74, 3
  v_mfma_f32_16x16x32_bf16 v[24:27], v[228:231], v[180:183], v[24:27]
  s_cselect_b32 s74, 0, s74
  s_cselect_b32 s73, s75, s14
  s_waitcnt lgkmcnt(4)
  v_mfma_f32_16x16x32_bf16 v[28:31], v[228:231], v[188:191], v[28:31]
  v_mfma_f32_16x16x32_bf16 v[28:31], v[224:227], v[184:187], v[28:31]
  v_mfma_f32_16x16x32_bf16 v[44:47], v[232:235], v[184:187], v[44:47]
  ds_read_b64_tr_b16 v[224:225], v15 offset:0
  v_mfma_f32_16x16x32_bf16 v[44:47], v[236:239], v[188:191], v[44:47]
  ds_read_b64_tr_b16 v[226:227], v15 offset:1792
  v_mfma_f32_16x16x32_bf16 v[40:43], v[236:239], v[180:183], v[40:43]
  ds_read_b64_tr_b16 v[228:229], v15 offset:14336
  v_mfma_f32_16x16x32_bf16 v[40:43], v[232:235], v[176:179], v[40:43]
  ds_read_b64_tr_b16 v[230:231], v15 offset:16128
  v_mfma_f32_16x16x32_bf16 v[36:39], v[232:235], v[168:171], v[36:39]
L_pad_901:
  s_cbranch_execz L_pad_85
  v_mfma_f32_16x16x32_bf16 v[36:39], v[236:239], v[172:175], v[36:39]
  v_mfma_f32_16x16x32_bf16 v[32:35], v[236:239], v[164:167], v[32:35]
  v_add_u32 v14, s73, v14
  v_mfma_f32_16x16x32_bf16 v[32:35], v[232:235], v[160:163], v[32:35]
  v_add_u32 v15, s73, v15
  v_mfma_f32_16x16x32_bf16 v[48:51], v[240:243], v[160:163], v[48:51]
  ds_read_b64_tr_b16 v[232:233], v13 offset:0
  v_mfma_f32_16x16x32_bf16 v[48:51], v[244:247], v[164:167], v[48:51]
  ds_read_b64_tr_b16 v[234:235], v13 offset:1792
  v_mfma_f32_16x16x32_bf16 v[52:55], v[244:247], v[172:175], v[52:55]
  ds_read_b64_tr_b16 v[236:237], v13 offset:14336
  v_mfma_f32_16x16x32_bf16 v[52:55], v[240:243], v[168:171], v[52:55]
  ds_read_b64_tr_b16 v[238:239], v13 offset:16128
  v_mfma_f32_16x16x32_bf16 v[56:59], v[240:243], v[176:179], v[56:59]
  v_add_u32 v6, s73, v6
  v_mfma_f32_16x16x32_bf16 v[56:59], v[244:247], v[180:183], v[56:59]
  v_add_u32 v7, s73, v7
  v_mfma_f32_16x16x32_bf16 v[60:63], v[244:247], v[188:191], v[60:63]
  v_add_u32 v8, s73, v8
  v_mfma_f32_16x16x32_bf16 v[60:63], v[240:243], v[184:187], v[60:63]
  v_add_u32 v9, s73, v9
  s_waitcnt lgkmcnt(8)
  v_mfma_f32_16x16x32_bf16 v[148:151], v[248:251], v[168:171], v[148:151]
  ds_read_b64_tr_b16 v[240:241], v12 offset:64
  v_mfma_f32_16x16x32_bf16 v[148:151], v[252:255], v[172:175], v[148:151]
  ds_read_b64_tr_b16 v[242:243], v12 offset:1856
  v_mfma_f32_16x16x32_bf16 v[144:147], v[252:255], v[164:167], v[144:147]
  ds_read_b64_tr_b16 v[244:245], v12 offset:14400
  v_mfma_f32_16x16x32_bf16 v[144:147], v[248:251], v[160:163], v[144:147]
  ds_read_b64_tr_b16 v[246:247], v12 offset:16192
  s_waitcnt lgkmcnt(8)
  v_mfma_f32_16x16x32_bf16 v[152:155], v[224:227], v[160:163], v[152:155]
  ds_read_b64_tr_b16 v[248:249], v13 offset:64
  v_mfma_f32_16x16x32_bf16 v[152:155], v[228:231], v[164:167], v[152:155]
  ds_read_b64_tr_b16 v[250:251], v13 offset:1856
  v_mfma_f32_16x16x32_bf16 v[156:159], v[228:231], v[172:175], v[156:159]
  ds_read_b64_tr_b16 v[252:253], v13 offset:14400
  v_mfma_f32_16x16x32_bf16 v[156:159], v[224:227], v[168:171], v[156:159]
  ds_read_b64_tr_b16 v[254:255], v13 offset:16192
  s_waitcnt lgkmcnt(8)
  v_mfma_f32_16x16x32_bf16 v[64:67], v[232:235], v[160:163], v[64:67]
  ds_read_b64_tr_b16 v[224:225], v12 offset:128
  v_mfma_f32_16x16x32_bf16 v[64:67], v[236:239], v[164:167], v[64:67]
  ds_read_b64_tr_b16 v[226:227], v12 offset:1920
  v_mfma_f32_16x16x32_bf16 v[68:71], v[236:239], v[172:175], v[68:71]
  ds_read_b64_tr_b16 v[228:229], v12 offset:14464
  v_mfma_f32_16x16x32_bf16 v[68:71], v[232:235], v[168:171], v[68:71]
  ds_read_b64_tr_b16 v[230:231], v12 offset:16256
  v_mfma_f32_16x16x32_bf16 v[72:75], v[232:235], v[176:179], v[72:75]
  v_mfma_f32_16x16x32_bf16 v[72:75], v[236:239], v[180:183], v[72:75]
  v_mfma_f32_16x16x32_bf16 v[76:79], v[236:239], v[188:191], v[76:79]
  v_mfma_f32_16x16x32_bf16 v[76:79], v[232:235], v[184:187], v[76:79]
  s_waitcnt lgkmcnt(8)
  v_mfma_f32_16x16x32_bf16 v[92:95], v[240:243], v[184:187], v[92:95]
  ds_read_b64_tr_b16 v[232:233], v13 offset:128
  v_mfma_f32_16x16x32_bf16 v[92:95], v[244:247], v[188:191], v[92:95]
  ds_read_b64_tr_b16 v[234:235], v13 offset:1920
  v_mfma_f32_16x16x32_bf16 v[88:91], v[244:247], v[180:183], v[88:91]
  ds_read_b64_tr_b16 v[236:237], v13 offset:14464
  v_mfma_f32_16x16x32_bf16 v[88:91], v[240:243], v[176:179], v[88:91]
  ds_read_b64_tr_b16 v[238:239], v13 offset:16256
  v_mfma_f32_16x16x32_bf16 v[84:87], v[240:243], v[168:171], v[84:87]
  v_mfma_f32_16x16x32_bf16 v[84:87], v[244:247], v[172:175], v[84:87]
  v_mfma_f32_16x16x32_bf16 v[80:83], v[244:247], v[164:167], v[80:83]
  v_add_u32 v12, s73, v12
  v_mfma_f32_16x16x32_bf16 v[80:83], v[240:243], v[160:163], v[80:83]
  v_add_u32 v13, s73, v13
  s_waitcnt lgkmcnt(8)
  v_mfma_f32_16x16x32_bf16 v[96:99], v[248:251], v[160:163], v[96:99]
  v_mfma_f32_16x16x32_bf16 v[96:99], v[252:255], v[164:167], v[96:99]
  s_waitcnt lgkmcnt(0)
  s_barrier
  v_mfma_f32_16x16x32_bf16 v[100:103], v[252:255], v[172:175], v[100:103]
  ds_read_b128 v[192:195], v6 offset:0
  v_mfma_f32_16x16x32_bf16 v[100:103], v[248:251], v[168:171], v[100:103]
  ds_read_b128 v[196:199], v7 offset:0
  v_mfma_f32_16x16x32_bf16 v[104:107], v[248:251], v[176:179], v[104:107]
  ds_read_b64_tr_b16 v[240:241], v10 offset:8192
  v_mfma_f32_16x16x32_bf16 v[104:107], v[252:255], v[180:183], v[104:107]
  ds_read_b64_tr_b16 v[242:243], v10 offset:8704
  v_mfma_f32_16x16x32_bf16 v[108:111], v[252:255], v[188:191], v[108:111]
  ds_read_b64_tr_b16 v[244:245], v10 offset:12288
  v_mfma_f32_16x16x32_bf16 v[108:111], v[248:251], v[184:187], v[108:111]
  ds_read_b64_tr_b16 v[246:247], v10 offset:12800
  v_mfma_f32_16x16x32_bf16 v[124:127], v[224:227], v[184:187], v[124:127]
  ds_read_b64_tr_b16 v[248:249], v11 offset:8192
  v_mfma_f32_16x16x32_bf16 v[124:127], v[228:231], v[188:191], v[124:127]
  ds_read_b64_tr_b16 v[250:251], v11 offset:8704
  v_mfma_f32_16x16x32_bf16 v[120:123], v[228:231], v[180:183], v[120:123]
  ds_read_b64_tr_b16 v[252:253], v11 offset:12288
  v_mfma_f32_16x16x32_bf16 v[120:123], v[224:227], v[176:179], v[120:123]
  ds_read_b64_tr_b16 v[254:255], v11 offset:12800
  v_mfma_f32_16x16x32_bf16 v[116:119], v[224:227], v[168:171], v[116:119]
  ds_read_b128 v[200:203], v6 offset:2048
  v_mfma_f32_16x16x32_bf16 v[116:119], v[228:231], v[172:175], v[116:119]
  ds_read_b128 v[204:207], v7 offset:2048
  v_mfma_f32_16x16x32_bf16 v[112:115], v[228:231], v[164:167], v[112:115]
  ds_read_b128 v[208:211], v8 offset:0
  v_mfma_f32_16x16x32_bf16 v[112:115], v[224:227], v[160:163], v[112:115]
  ds_read_b128 v[212:215], v9 offset:0
  v_mfma_f32_16x16x32_bf16 v[128:131], v[232:235], v[160:163], v[128:131]
  ds_read_b64_tr_b16 v[224:225], v12 offset:0
  v_mfma_f32_16x16x32_bf16 v[128:131], v[236:239], v[164:167], v[128:131]
  ds_read_b64_tr_b16 v[226:227], v12 offset:1792
  v_mfma_f32_16x16x32_bf16 v[132:135], v[236:239], v[172:175], v[132:135]
  ds_read_b64_tr_b16 v[228:229], v12 offset:14336
  v_mfma_f32_16x16x32_bf16 v[132:135], v[232:235], v[168:171], v[132:135]
  ds_read_b64_tr_b16 v[230:231], v12 offset:16128
  v_mfma_f32_16x16x32_bf16 v[136:139], v[232:235], v[176:179], v[136:139]
  ds_read_b128 v[216:219], v8 offset:2048
  v_mfma_f32_16x16x32_bf16 v[136:139], v[236:239], v[180:183], v[136:139]
  ds_read_b128 v[220:223], v9 offset:2048
  v_mfma_f32_16x16x32_bf16 v[140:143], v[236:239], v[188:191], v[140:143]
  s_sub_u32 s68, s68, 1
  s_cmp_eq_u32 s68, 0
  v_mfma_f32_16x16x32_bf16 v[140:143], v[232:235], v[184:187], v[140:143]
  s_cbranch_scc1 L_c_last
  s_waitcnt lgkmcnt(8)
  v_mfma_f32_16x16x32_bf16 v[16:19], v[240:243], v[192:195], v[16:19]
  ds_read_b64_tr_b16 v[232:233], v14 offset:0
  v_mfma_f32_16x16x32_bf16 v[16:19], v[244:247], v[196:199], v[16:19]
  ds_read_b64_tr_b16 v[234:235], v14 offset:1792
  v_mfma_f32_16x16x32_bf16 v[20:23], v[244:247], v[204:207], v[20:23]
  ds_read_b64_tr_b16 v[236:237], v14 offset:14336
  v_mfma_f32_16x16x32_bf16 v[20:23], v[240:243], v[200:203], v[20:23]
  ds_read_b64_tr_b16 v[238:239], v14 offset:16128
  s_waitcnt lgkmcnt(8)
  v_mfma_f32_16x16x32_bf16 v[24:27], v[240:243], v[208:211], v[24:27]
  s_add_u32 s74, s74, 1
  s_cmp_eq_u32 s74, 3
  v_mfma_f32_16x16x32_bf16 v[24:27], v[244:247], v[212:215], v[24:27]
  s_cselect_b32 s74, 0, s74
  s_cselect_b32 s73, s75, s14
  s_waitcnt lgkmcnt(4)
  v_mfma_f32_16x16x32_bf16 v[28:31], v[244:247], v[220:223], v[28:31]
  v_mfma_f32_16x16x32_bf16 v[28:31], v[240:243], v[216:219], v[28:31]
  v_mfma_f32_16x16x32_bf16 v[44:47], v[248:251], v[216:219], v[44:47]
  ds_read_b64_tr_b16 v[240:241], v15 offset:0
  v_mfma_f32_16x16x32_bf16 v[44:47], v[252:255], v[220:223], v[44:47]
  ds_read_b64_tr_b16 v[242:243], v15 offset:1792
  v_mfma_f32_16x16x32_bf16 v[40:43], v[252:255], v[212:215], v[40:43]
  ds_read_b64_tr_b16 v[244:245], v15 offset:14336
  v_mfma_f32_16x16x32_bf16 v[40:43], v[248:251], v[208:211], v[40:43]
  ds_read_b64_tr_b16 v[246:247], v15 offset:16128
  v_mfma_f32_16x16x32_bf16 v[36:39], v[248:251], v[200:203], v[36:39]
  v_mfma_f32_16x16x32_bf16 v[36:39], v[252:255], v[204:207], v[36:39]
  v_mfma_f32_16x16x32_bf16 v[32:35], v[252:255], v[196:199], v[32:35]
  v_add_u32 v14, s73, v14
L_pad_918:
  s_cbranch_execz L_pad_102
  v_mfma_f32_16x16x32_bf16 v[32:35], v[248:251], v[192:195], v[32:35]
  v_add_u32 v15, s73, v15
  v_mfma_f32_16x16x32_bf16 v[48:51], v[224:227], v[192:195], v[48:51]
  ds_read_b64_tr_b16 v[248:249], v13 offset:0
  v_mfma_f32_16x16x32_bf16 v[48:51], v[228:231], v[196:199], v[48:51]
  ds_read_b64_tr_b16 v[250:251], v13 offset:1792
  v_mfma_f32_16x16x32_bf16 v[52:55], v[228:231], v[204:207], v[52:55]
  ds_read_b64_tr_b16 v[252:253], v13 offset:14336
  v_mfma_f32_16x16x32_bf16 v[52:55], v[224:227], v[200:203], v[52:55]
  ds_read_b64_tr_b16 v[254:255], v13 offset:16128
  v_mfma_f32_16x16x32_bf16 v[56:59], v[224:227], v[208:211], v[56:59]
  v_add_u32 v6, s73, v6
  v_mfma_f32_16x16x32_bf16 v[56:59], v[228:231], v[212:215], v[56:59]
  v_add_u32 v7, s73, v7
  v_mfma_f32_16x16x32_bf16 v[60:63], v[228:231], v[220:223], v[60:63]
  v_add_u32 v8, s73, v8
  v_mfma_f32_16x16x32_bf16 v[60:63], v[224:227], v[216:219], v[60:63]
  v_add_u32 v9, s73, v9
  s_waitcnt lgkmcnt(8)
  v_mfma_f32_16x16x32_bf16 v[148:151], v[232:235], v[200:203], v[148:151]
  ds_read_b64_tr_b16 v[224:225], v12 offset:64
  v_mfma_f32_16x16x32_bf16 v[148:151], v[236:239], v[204:207], v[148:151]
  ds_read_b64_tr_b16 v[226:227], v12 offset:1856
  v_mfma_f32_16x16x32_bf16 v[144:147], v[236:239], v[196:199], v[144:147]
  ds_read_b64_tr_b16 v[228:229], v12 offset:14400
  v_mfma_f32_16x16x32_bf16 v[144:147], v[232:235], v[192:195], v[144:147]
  ds_read_b64_tr_b16 v[230:231], v12 offset:16192
  s_waitcnt lgkmcnt(8)
  v_mfma_f32_16x16x32_bf16 v[152:155], v[240:243], v[192:195], v[152:155]
  ds_read_b64_tr_b16 v[232:233], v13 offset:64
  v_mfma_f32_16x16x32_bf16 v[152:155], v[244:247], v[196:199], v[152:155]
  ds_read_b64_tr_b16 v[234:235], v13 offset:1856
  v_mfma_f32_16x16x32_bf16 v[156:159], v[244:247], v[204:207], v[156:159]
  ds_read_b64_tr_b16 v[236:237], v13 offset:14400
  v_mfma_f32_16x16x32_bf16 v[156:159], v[240:243], v[200:203], v[156:159]
  ds_read_b64_tr_b16 v[238:239], v13 offset:16192
  s_waitcnt lgkmcnt(8)
  v_mfma_f32_16x16x32_bf16 v[64:67], v[248:251], v[192:195], v[64:67]
  ds_read_b64_tr_b16 v[240:241], v12 offset:128
  v_mfma_f32_16x16x32_bf16 v[64:67], v[252:255], v[196:199], v[64:67]
  ds_read_b64_tr_b16 v[242:243], v12 offset:1920
  v_mfma_f32_16x16x32_bf16 v[68:71], v[252:255], v[204:207], v[68:71]
  ds_read_b64_tr_b16 v[244:245], v12 offset:14464
  v_mfma_f32_16x16x32_bf16 v[68:71], v[248:251], v[200:203], v[68:71]
  ds_read_b64_tr_b16 v[246:247], v12 offset:16256
  v_mfma_f32_16x16x32_bf16 v[72:75], v[248:251], v[208:211], v[72:75]
  v_mfma_f32_16x16x32_bf16 v[72:75], v[252:255], v[212:215], v[72:75]
  v_mfma_f32_16x16x32_bf16 v[76:79], v[252:255], v[220:223], v[76:79]
  v_mfma_f32_16x16x32_bf16 v[76:79], v[248:251], v[216:219], v[76:79]
  s_waitcnt lgkmcnt(8)
  v_mfma_f32_16x16x32_bf16 v[92:95], v[224:227], v[216:219], v[92:95]
  ds_read_b64_tr_b16 v[248:249], v13 offset:128
  v_mfma_f32_16x16x32_bf16 v[92:95], v[228:231], v[220:223], v[92:95]
  ds_read_b64_tr_b16 v[250:251], v13 offset:1920
  v_mfma_f32_16x16x32_bf16 v[88:91], v[228:231], v[212:215], v[88:91]
  ds_read_b64_tr_b16 v[252:253], v13 offset:14464
  v_mfma_f32_16x16x32_bf16 v[88:91], v[224:227], v[208:211], v[88:91]
  ds_read_b64_tr_b16 v[254:255], v13 offset:16256
  v_mfma_f32_16x16x32_bf16 v[84:87], v[224:227], v[200:203], v[84:87]
  v_mfma_f32_16x16x32_bf16 v[84:87], v[228:231], v[204:207], v[84:87]
  v_mfma_f32_16x16x32_bf16 v[80:83], v[228:231], v[196:199], v[80:83]
  v_add_u32 v12, s73, v12
  v_mfma_f32_16x16x32_bf16 v[80:83], v[224:227], v[192:195], v[80:83]
  v_add_u32 v13, s73, v13
  s_waitcnt lgkmcnt(8)
  v_mfma_f32_16x16x32_bf16 v[96:99], v[232:235], v[192:195], v[96:99]
  v_mfma_f32_16x16x32_bf16 v[96:99], v[236:239], v[196:199], v[96:99]
  s_waitcnt lgkmcnt(0)
  s_barrier
  v_mfma_f32_16x16x32_bf16 v[100:103], v[236:239], v[204:207], v[100:103]
  ds_read_b128 v[160:163], v6 offset:0
  v_mfma_f32_16x16x32_bf16 v[100:103], v[232:235], v[200:203], v[100:103]
  ds_read_b128 v[164:167], v7 offset:0
  v_mfma_f32_16x16x32_bf16 v[104:107], v[232:235], v[208:211], v[104:107]
  ds_read_b64_tr_b16 v[224:225], v10 offset:0
  v_mfma_f32_16x16x32_bf16 v[104:107], v[236:239], v[212:215], v[104:107]
  ds_read_b64_tr_b16 v[226:227], v10 offset:512
  v_mfma_f32_16x16x32_bf16 v[108:111], v[236:239], v[220:223], v[108:111]
  ds_read_b64_tr_b16 v[228:229], v10 offset:4096
  v_mfma_f32_16x16x32_bf16 v[108:111], v[232:235], v[216:219], v[108:111]
  ds_read_b64_tr_b16 v[230:231], v10 offset:4608
  v_mfma_f32_16x16x32_bf16 v[124:127], v[240:243], v[216:219], v[124:127]
  ds_read_b64_tr_b16 v[232:233], v11 offset:0
  v_mfma_f32_16x16x32_bf16 v[124:127], v[244:247], v[220:223], v[124:127]
  ds_read_b64_tr_b16 v[234:235], v11 offset:512
  v_mfma_f32_16x16x32_bf16 v[120:123], v[244:247], v[212:215], v[120:123]
  ds_read_b64_tr_b16 v[236:237], v11 offset:4096
  v_mfma_f32_16x16x32_bf16 v[120:123], v[240:243], v[208:211], v[120:123]
  ds_read_b64_tr_b16 v[238:239], v11 offset:4608
  v_mfma_f32_16x16x32_bf16 v[116:119], v[240:243], v[200:203], v[116:119]
  ds_read_b128 v[168:171], v6 offset:2048
  v_mfma_f32_16x16x32_bf16 v[116:119], v[244:247], v[204:207], v[116:119]
  ds_read_b128 v[172:175], v7 offset:2048
  v_mfma_f32_16x16x32_bf16 v[112:115], v[244:247], v[196:199], v[112:115]
  ds_read_b128 v[176:179], v8 offset:0
  v_mfma_f32_16x16x32_bf16 v[112:115], v[240:243], v[192:195], v[112:115]
  ds_read_b128 v[180:183], v9 offset:0
  v_mfma_f32_16x16x32_bf16 v[128:131], v[248:251], v[192:195], v[128:131]
  ds_read_b64_tr_b16 v[240:241], v12 offset:0
  v_mfma_f32_16x16x32_bf16 v[128:131], v[252:255], v[196:199], v[128:131]
  ds_read_b64_tr_b16 v[242:243], v12 offset:1792
  v_mfma_f32_16x16x32_bf16 v[132:135], v[252:255], v[204:207], v[132:135]
  ds_read_b64_tr_b16 v[244:245], v12 offset:14336
  v_mfma_f32_16x16x32_bf16 v[132:135], v[248:251], v[200:203], v[132:135]
  ds_read_b64_tr_b16 v[246:247], v12 offset:16128
  v_mfma_f32_16x16x32_bf16 v[136:139], v[248:251], v[208:211], v[136:139]
  ds_read_b128 v[184:187], v8 offset:2048
  v_mfma_f32_16x16x32_bf16 v[136:139], v[252:255], v[212:215], v[136:139]
  ds_read_b128 v[188:191], v9 offset:2048
  v_mfma_f32_16x16x32_bf16 v[140:143], v[252:255], v[220:223], v[140:143]
  v_mfma_f32_16x16x32_bf16 v[140:143], v[248:251], v[216:219], v[140:143]
  s_branch L_c_loop
L_c_last:
  s_waitcnt lgkmcnt(8)
  v_mfma_f32_16x16x32_bf16 v[16:19], v[240:243], v[192:195], v[16:19]
  ds_read_b64_tr_b16 v[232:233], v14 offset:0
  s_lshl_b32 s12, s5, 2
  v_mfma_f32_16x16x32_bf16 v[16:19], v[244:247], v[196:199], v[16:19]
  ds_read_b64_tr_b16 v[234:235], v14 offset:1792
  s_add_u32 s13, s12, s71
  v_mfma_f32_16x16x32_bf16 v[20:23], v[244:247], v[204:207], v[20:23]
  ds_read_b64_tr_b16 v[236:237], v14 offset:14336
  s_add_u32 s12, s12, s72
  v_mfma_f32_16x16x32_bf16 v[20:23], v[240:243], v[200:203], v[20:23]
  ds_read_b64_tr_b16 v[238:239], v14 offset:16128
  s_mul_i32 s13, s13, 224
  s_waitcnt lgkmcnt(8)
  v_mfma_f32_16x16x32_bf16 v[24:27], v[240:243], v[208:211], v[24:27]
  s_mul_i32 s12, s12, 224
  v_mfma_f32_16x16x32_bf16 v[24:27], v[244:247], v[212:215], v[24:27]
  s_mul_i32 s14, s6, 7
  s_waitcnt lgkmcnt(4)
  v_mfma_f32_16x16x32_bf16 v[28:31], v[244:247], v[220:223], v[28:31]
  s_add_u32 s13, s13, s14
  v_mfma_f32_16x16x32_bf16 v[28:31], v[240:243], v[216:219], v[28:31]
  s_add_u32 s12, s12, s14
  v_mfma_f32_16x16x32_bf16 v[44:47], v[248:251], v[216:219], v[44:47]
  ds_read_b64_tr_b16 v[240:241], v15 offset:0
  s_add_u32 s75, s13, 6
  v_mfma_f32_16x16x32_bf16 v[44:47], v[252:255], v[220:223], v[44:47]
  ds_read_b64_tr_b16 v[242:243], v15 offset:1792
  s_mul_i32 s14, s70, 3
  v_mfma_f32_16x16x32_bf16 v[40:43], v[252:255], v[212:215], v[40:43]
  ds_read_b64_tr_b16 v[244:245], v15 offset:14336
  s_add_u32 s73, s13, s14
  v_mfma_f32_16x16x32_bf16 v[40:43], v[248:251], v[208:211], v[40:43]
  ds_read_b64_tr_b16 v[246:247], v15 offset:16128
  s_add_u32 s74, s12, s14
  v_mfma_f32_16x16x32_bf16 v[36:39], v[248:251], v[200:203], v[36:39]
  s_lshl_b32 s73, s73, 10
  v_mfma_f32_16x16x32_bf16 v[36:39], v[252:255], v[204:207], v[36:39]
L_pad_935:
  s_cbranch_execz L_pad_1003
  s_lshl_b32 s74, s74, 10
  v_mfma_f32_16x16x32_bf16 v[32:35], v[252:255], v[196:199], v[32:35]
  s_lshl_b32 s75, s75, 10
  v_mfma_f32_16x16x32_bf16 v[32:35], v[248:251], v[192:195], v[32:35]
  s_lshl_b32 s12, s5, 4
  v_mfma_f32_16x16x32_bf16 v[48:51], v[224:227], v[192:195], v[48:51]
  ds_read_b64_tr_b16 v[248:249], v13 offset:0
  s_add_u32 s12, s12, s6
  v_mfma_f32_16x16x32_bf16 v[48:51], v[228:231], v[196:199], v[48:51]
  ds_read_b64_tr_b16 v[250:251], v13 offset:1792
  s_lshl_b32 s12, s12, 2
  v_mfma_f32_16x16x32_bf16 v[52:55], v[228:231], v[204:207], v[52:55]
  ds_read_b64_tr_b16 v[252:253], v13 offset:14336
  s_add_u32 s12, s12, s4
  v_mfma_f32_16x16x32_bf16 v[52:55], v[224:227], v[200:203], v[52:55]
  ds_read_b64_tr_b16 v[254:255], v13 offset:16128
  s_lshl_b32 s12, s12, 7
  v_mfma_f32_16x16x32_bf16 v[56:59], v[224:227], v[208:211], v[56:59]
  s_add_u32 s69, s12, 27656192
  v_mfma_f32_16x16x32_bf16 v[56:59], v[228:231], v[212:215], v[56:59]
  v_lshlrev_b32 v10, 4, v0
  v_mfma_f32_16x16x32_bf16 v[60:63], v[228:231], v[220:223], v[60:63]
  v_add_u32 v11, 114688, v10
  v_mfma_f32_16x16x32_bf16 v[60:63], v[224:227], v[216:219], v[60:63]
  v_cvt_pk_bf16_f32 v160, v16, v17
  s_waitcnt lgkmcnt(8)
  v_mfma_f32_16x16x32_bf16 v[148:151], v[232:235], v[200:203], v[148:151]
  ds_read_b64_tr_b16 v[224:225], v12 offset:64
  v_cvt_pk_bf16_f32 v161, v18, v19
  v_mfma_f32_16x16x32_bf16 v[148:151], v[236:239], v[204:207], v[148:151]
  ds_read_b64_tr_b16 v[226:227], v12 offset:1856
  v_cvt_pk_bf16_f32 v164, v20, v21
  v_mfma_f32_16x16x32_bf16 v[144:147], v[236:239], v[196:199], v[144:147]
  ds_read_b64_tr_b16 v[228:229], v12 offset:14400
  v_cvt_pk_bf16_f32 v165, v22, v23
  v_mfma_f32_16x16x32_bf16 v[144:147], v[232:235], v[192:195], v[144:147]
  ds_read_b64_tr_b16 v[230:231], v12 offset:16192
  v_cvt_pk_bf16_f32 v168, v24, v25
  s_waitcnt lgkmcnt(8)
  v_mfma_f32_16x16x32_bf16 v[152:155], v[240:243], v[192:195], v[152:155]
  ds_read_b64_tr_b16 v[232:233], v13 offset:64
  v_cvt_pk_bf16_f32 v169, v26, v27
  v_mfma_f32_16x16x32_bf16 v[152:155], v[244:247], v[196:199], v[152:155]
  ds_read_b64_tr_b16 v[234:235], v13 offset:1856
  v_cvt_pk_bf16_f32 v172, v28, v29
  v_mfma_f32_16x16x32_bf16 v[156:159], v[244:247], v[204:207], v[156:159]
  ds_read_b64_tr_b16 v[236:237], v13 offset:14400
  v_cvt_pk_bf16_f32 v173, v30, v31
  v_mfma_f32_16x16x32_bf16 v[156:159], v[240:243], v[200:203], v[156:159]
  ds_read_b64_tr_b16 v[238:239], v13 offset:16192
  v_cvt_pk_bf16_f32 v174, v44, v45
  s_waitcnt lgkmcnt(8)
  v_mfma_f32_16x16x32_bf16 v[64:67], v[248:251], v[192:195], v[64:67]
  ds_read_b64_tr_b16 v[240:241], v12 offset:128
  v_cvt_pk_bf16_f32 v175, v46, v47
  v_mfma_f32_16x16x32_bf16 v[64:67], v[252:255], v[196:199], v[64:67]
  ds_read_b64_tr_b16 v[242:243], v12 offset:1920
  v_cvt_pk_bf16_f32 v170, v40, v41
  v_mfma_f32_16x16x32_bf16 v[68:71], v[252:255], v[204:207], v[68:71]
  ds_read_b64_tr_b16 v[244:245], v12 offset:14464
  v_cvt_pk_bf16_f32 v171, v42, v43
  v_mfma_f32_16x16x32_bf16 v[68:71], v[248:251], v[200:203], v[68:71]
  ds_read_b64_tr_b16 v[246:247], v12 offset:16256
  v_cvt_pk_bf16_f32 v166, v36, v37
  v_mfma_f32_16x16x32_bf16 v[72:75], v[248:251], v[208:211], v[72:75]
  v_cvt_pk_bf16_f32 v167, v38, v39
  v_mfma_f32_16x16x32_bf16 v[72:75], v[252:255], v[212:215], v[72:75]
  v_cvt_pk_bf16_f32 v162, v32, v33
  v_mfma_f32_16x16x32_bf16 v[76:79], v[252:255], v[220:223], v[76:79]
  v_cvt_pk_bf16_f32 v163, v34, v35
  v_mfma_f32_16x16x32_bf16 v[76:79], v[248:251], v[216:219], v[76:79]
  v_mul_f32 v144, v144, abs(v144)
  s_waitcnt lgkmcnt(8)
  v_mfma_f32_16x16x32_bf16 v[92:95], v[224:227], v[216:219], v[92:95]
  ds_read_b64_tr_b16 v[248:249], v13 offset:128
  v_mul_f32 v145, v145, abs(v145)
  v_mfma_f32_16x16x32_bf16 v[92:95], v[228:231], v[220:223], v[92:95]
  ds_read_b64_tr_b16 v[250:251], v13 offset:1920
  v_mul_f32 v146, v146, abs(v146)
  v_mfma_f32_16x16x32_bf16 v[88:91], v[228:231], v[212:215], v[88:91]
  ds_read_b64_tr_b16 v[252:253], v13 offset:14464
  v_mul_f32 v147, v147, abs(v147)
  v_mfma_f32_16x16x32_bf16 v[88:91], v[224:227], v[208:211], v[88:91]
  ds_read_b64_tr_b16 v[254:255], v13 offset:16256
  v_mul_f32 v152, v152, abs(v152)
  v_mfma_f32_16x16x32_bf16 v[84:87], v[224:227], v[200:203], v[84:87]
  v_mul_f32 v153, v153, abs(v153)
  v_mfma_f32_16x16x32_bf16 v[84:87], v[228:231], v[204:207], v[84:87]
  v_mul_f32 v154, v154, abs(v154)
  v_mfma_f32_16x16x32_bf16 v[80:83], v[228:231], v[196:199], v[80:83]
  v_mul_f32 v155, v155, abs(v155)
  v_mfma_f32_16x16x32_bf16 v[80:83], v[224:227], v[192:195], v[80:83]
  v_cvt_pk_bf16_f32 v144, v144, v145
  s_waitcnt lgkmcnt(8)
  v_mfma_f32_16x16x32_bf16 v[96:99], v[232:235], v[192:195], v[96:99]
  v_cvt_pk_bf16_f32 v145, v146, v147
  v_mfma_f32_16x16x32_bf16 v[96:99], v[236:239], v[196:199], v[96:99]
  s_waitcnt lgkmcnt(0)
  s_barrier
  v_cvt_pk_bf16_f32 v146, v152, v153
  v_mfma_f32_16x16x32_bf16 v[100:103], v[236:239], v[204:207], v[100:103]
  v_cvt_pk_bf16_f32 v147, v154, v155
  v_mfma_f32_16x16x32_bf16 v[100:103], v[232:235], v[200:203], v[100:103]
  v_pk_max_i16 v144, v144, 0
  v_mfma_f32_16x16x32_bf16 v[104:107], v[232:235], v[208:211], v[104:107]
  v_pk_max_i16 v145, v145, 0
  v_mfma_f32_16x16x32_bf16 v[104:107], v[236:239], v[212:215], v[104:107]
  v_pk_max_i16 v146, v146, 0
  v_mfma_f32_16x16x32_bf16 v[108:111], v[236:239], v[220:223], v[108:111]
  v_pk_max_i16 v147, v147, 0
  v_mfma_f32_16x16x32_bf16 v[108:111], v[232:235], v[216:219], v[108:111]
  v_mul_f32 v148, v148, abs(v148)
  v_mfma_f32_16x16x32_bf16 v[124:127], v[240:243], v[216:219], v[124:127]
  v_mul_f32 v149, v149, abs(v149)
  v_mfma_f32_16x16x32_bf16 v[124:127], v[244:247], v[220:223], v[124:127]
  v_mul_f32 v150, v150, abs(v150)
  v_mfma_f32_16x16x32_bf16 v[120:123], v[244:247], v[212:215], v[120:123]
  v_mul_f32 v151, v151, abs(v151)
  v_mfma_f32_16x16x32_bf16 v[120:123], v[240:243], v[208:211], v[120:123]
  v_mul_f32 v156, v156, abs(v156)
  v_mfma_f32_16x16x32_bf16 v[116:119], v[240:243], v[200:203], v[116:119]
  v_mul_f32 v157, v157, abs(v157)
  v_mfma_f32_16x16x32_bf16 v[116:119], v[244:247], v[204:207], v[116:119]
  v_mul_f32 v158, v158, abs(v158)
  v_mfma_f32_16x16x32_bf16 v[112:115], v[244:247], v[196:199], v[112:115]
  v_mul_f32 v159, v159, abs(v159)
  v_mfma_f32_16x16x32_bf16 v[112:115], v[240:243], v[192:195], v[112:115]
  v_cvt_pk_bf16_f32 v148, v148, v149
  v_mfma_f32_16x16x32_bf16 v[128:131], v[248:251], v[192:195], v[128:131]
  v_cvt_pk_bf16_f32 v149, v150, v151
  v_mfma_f32_16x16x32_bf16 v[128:131], v[252:255], v[196:199], v[128:131]
  v_cvt_pk_bf16_f32 v150, v156, v157
  v_mfma_f32_16x16x32_bf16 v[132:135], v[252:255], v[204:207], v[132:135]
  v_cvt_pk_bf16_f32 v151, v158, v159
  v_mfma_f32_16x16x32_bf16 v[132:135], v[248:251], v[200:203], v[132:135]
  v_pk_max_i16 v148, v148, 0
  v_mfma_f32_16x16x32_bf16 v[136:139], v[248:251], v[208:211], v[136:139]
  v_pk_max_i16 v149, v149, 0
  v_mfma_f32_16x16x32_bf16 v[136:139], v[252:255], v[212:215], v[136:139]
  v_pk_max_i16 v150, v150, 0
  v_mfma_f32_16x16x32_bf16 v[140:143], v[252:255], v[220:223], v[140:143]
  v_pk_max_i16 v151, v151, 0
  v_mfma_f32_16x16x32_bf16 v[140:143], v[248:251], v[216:219], v[140:143]
L_pad_952:
  s_cbranch_execz L_pad_1020
  v_mul_f32 v48, v48, abs(v48)
  ds_read_b128 v[192:195], v10 offset:0
  ds_read_b128 v[196:199], v10 offset:1024
  ds_read_b128 v[200:203], v10 offset:2048
  ds_read_b128 v[204:207], v10 offset:3072
  ds_read_b128 v[208:211], v10 offset:4096
  ds_read_b128 v[212:215], v10 offset:5120
  ds_read_b128 v[216:219], v10 offset:6144
  ds_read_b128 v[220:223], v10 offset:7168
  buffer_store_dwordx4 v[144:147], v10, s[64:67], s75 offen offset:0 sc1
  v_mul_f32 v49, v49, abs(v49)
  v_mul_f32 v50, v50, abs(v50)
  v_mul_f32 v51, v51, abs(v51)
  v_mul_f32 v64, v64, abs(v64)
  v_mul_f32 v65, v65, abs(v65)
  v_mul_f32 v66, v66, abs(v66)
  v_mul_f32 v67, v67, abs(v67)
  v_cvt_pk_bf16_f32 v48, v48, v49
  v_cvt_pk_bf16_f32 v49, v50, v51
  v_cvt_pk_bf16_f32 v50, v64, v65
  v_cvt_pk_bf16_f32 v51, v66, v67
  v_pk_max_i16 v48, v48, 0
  buffer_store_dwordx4 v[148:151], v11, s[64:67], s75 offen offset:0 sc1
  v_pk_max_i16 v49, v49, 0
  v_pk_max_i16 v50, v50, 0
  v_pk_max_i16 v51, v51, 0
  v_mul_f32 v52, v52, abs(v52)
  v_mul_f32 v53, v53, abs(v53)
  v_mul_f32 v54, v54, abs(v54)
  v_mul_f32 v55, v55, abs(v55)
  v_mul_f32 v68, v68, abs(v68)
  v_mul_f32 v69, v69, abs(v69)
  v_mul_f32 v70, v70, abs(v70)
  v_mul_f32 v71, v71, abs(v71)
  v_cvt_pk_bf16_f32 v52, v52, v53
  buffer_store_dwordx4 v[48:51], v10, s[64:67], s73 offen offset:0 sc1
  v_cvt_pk_bf16_f32 v53, v54, v55
  v_cvt_pk_bf16_f32 v54, v68, v69
  v_cvt_pk_bf16_f32 v55, v70, v71
  v_pk_max_i16 v52, v52, 0
  v_pk_max_i16 v53, v53, 0
  v_pk_max_i16 v54, v54, 0
  v_pk_max_i16 v55, v55, 0
  v_mul_f32 v56, v56, abs(v56)
  v_mul_f32 v57, v57, abs(v57)
  v_mul_f32 v58, v58, abs(v58)
  v_mul_f32 v59, v59, abs(v59)
  v_mul_f32 v72, v72, abs(v72)
  buffer_store_dwordx4 v[52:55], v11, s[64:67], s73 offen offset:0 sc1
  v_mul_f32 v73, v73, abs(v73)
  v_mul_f32 v74, v74, abs(v74)
  v_mul_f32 v75, v75, abs(v75)
  v_cvt_pk_bf16_f32 v56, v56, v57
  v_cvt_pk_bf16_f32 v57, v58, v59
  v_cvt_pk_bf16_f32 v58, v72, v73
  v_cvt_pk_bf16_f32 v59, v74, v75
  v_pk_max_i16 v56, v56, 0
  v_pk_max_i16 v57, v57, 0
  v_pk_max_i16 v58, v58, 0
  v_pk_max_i16 v59, v59, 0
  v_mul_f32 v60, v60, abs(v60)
  buffer_store_dwordx4 v[56:59], v10, s[64:67], s74 offen offset:0 sc1
  v_mul_f32 v61, v61, abs(v61)
  v_mul_f32 v62, v62, abs(v62)
  v_mul_f32 v63, v63, abs(v63)
  v_mul_f32 v76, v76, abs(v76)
  v_mul_f32 v77, v77, abs(v77)
  v_mul_f32 v78, v78, abs(v78)
  v_mul_f32 v79, v79, abs(v79)
  v_cvt_pk_bf16_f32 v60, v60, v61
  v_cvt_pk_bf16_f32 v61, v62, v63
  v_cvt_pk_bf16_f32 v62, v76, v77
  v_cvt_pk_bf16_f32 v63, v78, v79
  v_pk_max_i16 v60, v60, 0
  v_pk_max_i16 v61, v61, 0
  v_pk_max_i16 v62, v62, 0
  v_pk_max_i16 v63, v63, 0
  v_mul_f32 v80, v80, abs(v80)
  v_mul_f32 v81, v81, abs(v81)
  v_mul_f32 v82, v82, abs(v82)
  v_mul_f32 v83, v83, abs(v83)
  v_mul_f32 v96, v96, abs(v96)
  v_mul_f32 v97, v97, abs(v97)
  v_mul_f32 v98, v98, abs(v98)
  v_mul_f32 v99, v99, abs(v99)
  v_cvt_pk_bf16_f32 v80, v80, v81
  buffer_store_dwordx4 v[60:63], v11, s[64:67], s74 offen offset:0 sc1
  v_cvt_pk_bf16_f32 v81, v82, v83
  v_cvt_pk_bf16_f32 v82, v96, v97
  v_cvt_pk_bf16_f32 v83, v98, v99
  v_pk_max_i16 v80, v80, 0
  v_pk_max_i16 v81, v81, 0
  v_pk_max_i16 v82, v82, 0
  v_pk_max_i16 v83, v83, 0
  v_mul_f32 v84, v84, abs(v84)
  v_mul_f32 v85, v85, abs(v85)
  v_mul_f32 v86, v86, abs(v86)
  v_mul_f32 v87, v87, abs(v87)
  v_mul_f32 v100, v100, abs(v100)
  buffer_store_dwordx4 v[80:83], v10, s[64:67], s73 offen offset:1024 sc1
  v_mul_f32 v101, v101, abs(v101)
  v_mul_f32 v102, v102, abs(v102)
  v_mul_f32 v103, v103, abs(v103)
  v_cvt_pk_bf16_f32 v84, v84, v85
  v_cvt_pk_bf16_f32 v85, v86, v87
  v_cvt_pk_bf16_f32 v86, v100, v101
  v_cvt_pk_bf16_f32 v87, v102, v103
  v_pk_max_i16 v84, v84, 0
  v_pk_max_i16 v85, v85, 0
  v_pk_max_i16 v86, v86, 0
  v_pk_max_i16 v87, v87, 0
  v_mul_f32 v88, v88, abs(v88)
  buffer_store_dwordx4 v[84:87], v11, s[64:67], s73 offen offset:1024 sc1
  v_mul_f32 v89, v89, abs(v89)
  v_mul_f32 v90, v90, abs(v90)
  v_mul_f32 v91, v91, abs(v91)
  v_mul_f32 v104, v104, abs(v104)
  v_mul_f32 v105, v105, abs(v105)
  v_mul_f32 v106, v106, abs(v106)
  v_mul_f32 v107, v107, abs(v107)
  v_cvt_pk_bf16_f32 v88, v88, v89
  v_cvt_pk_bf16_f32 v89, v90, v91
  v_cvt_pk_bf16_f32 v90, v104, v105
  v_cvt_pk_bf16_f32 v91, v106, v107
  v_pk_max_i16 v88, v88, 0
  v_pk_max_i16 v89, v89, 0
  v_pk_max_i16 v90, v90, 0
  v_pk_max_i16 v91, v91, 0
  v_mul_f32 v92, v92, abs(v92)
  v_mul_f32 v93, v93, abs(v93)
  v_mul_f32 v94, v94, abs(v94)
  v_mul_f32 v95, v95, abs(v95)
  v_mul_f32 v108, v108, abs(v108)
  v_mul_f32 v109, v109, abs(v109)
  v_mul_f32 v110, v110, abs(v110)
  v_mul_f32 v111, v111, abs(v111)
L_pad_969:
  s_cbranch_execz L_pad_1037
  v_cvt_pk_bf16_f32 v92, v92, v93
  buffer_store_dwordx4 v[88:91], v10, s[64:67], s74 offen offset:1024 sc1
  v_cvt_pk_bf16_f32 v93, v94, v95
  v_cvt_pk_bf16_f32 v94, v108, v109
  v_cvt_pk_bf16_f32 v95, v110, v111
  v_pk_max_i16 v92, v92, 0
  v_pk_max_i16 v93, v93, 0
  v_pk_max_i16 v94, v94, 0
  v_pk_max_i16 v95, v95, 0
  v_mul_f32 v112, v112, abs(v112)
  v_mul_f32 v113, v113, abs(v113)
  v_mul_f32 v114, v114, abs(v114)
  v_mul_f32 v115, v115, abs(v115)
  v_mul_f32 v128, v128, abs(v128)
  buffer_store_dwordx4 v[92:95], v11, s[64:67], s74 offen offset:1024 sc1
  v_mul_f32 v129, v129, abs(v129)
  v_mul_f32 v130, v130, abs(v130)
  v_mul_f32 v131, v131, abs(v131)
  v_cvt_pk_bf16_f32 v176, v112, v113
  v_cvt_pk_bf16_f32 v177, v114, v115
  v_cvt_pk_bf16_f32 v178, v128, v129
  v_cvt_pk_bf16_f32 v179, v130, v131
  v_pk_max_i16 v176, v176, 0
  v_pk_max_i16 v177, v177, 0
  v_pk_max_i16 v178, v178, 0
  v_pk_max_i16 v179, v179, 0
  v_mul_f32 v116, v116, abs(v116)
  v_mul_f32 v117, v117, abs(v117)
  v_mul_f32 v118, v118, abs(v118)
  v_mul_f32 v119, v119, abs(v119)
  v_mul_f32 v132, v132, abs(v132)
  v_mul_f32 v133, v133, abs(v133)
  v_mul_f32 v134, v134, abs(v134)
  v_mul_f32 v135, v135, abs(v135)
  v_cvt_pk_bf16_f32 v180, v116, v117
  v_cvt_pk_bf16_f32 v181, v118, v119
  v_cvt_pk_bf16_f32 v182, v132, v133
  v_cvt_pk_bf16_f32 v183, v134, v135
  v_pk_max_i16 v180, v180, 0
  v_pk_max_i16 v181, v181, 0
  v_pk_max_i16 v182, v182, 0
  v_pk_max_i16 v183, v183, 0
  v_mul_f32 v120, v120, abs(v120)
  v_mul_f32 v121, v121, abs(v121)
  v_mul_f32 v122, v122, abs(v122)
  v_mul_f32 v123, v123, abs(v123)
  v_mul_f32 v136, v136, abs(v136)
  v_mul_f32 v137, v137, abs(v137)
  v_mul_f32 v138, v138, abs(v138)
  v_mul_f32 v139, v139, abs(v139)
  v_cvt_pk_bf16_f32 v184, v120, v121
  v_cvt_pk_bf16_f32 v185, v122, v123
  v_cvt_pk_bf16_f32 v186, v136, v137
  v_cvt_pk_bf16_f32 v187, v138, v139
  v_pk_max_i16 v184, v184, 0
  v_pk_max_i16 v185, v185, 0
  v_pk_max_i16 v186, v186, 0
  v_pk_max_i16 v187, v187, 0
  v_mul_f32 v124, v124, abs(v124)
  v_mul_f32 v125, v125, abs(v125)
  v_mul_f32 v126, v126, abs(v126)
  v_mul_f32 v127, v127, abs(v127)
  v_mul_f32 v140, v140, abs(v140)
  v_mul_f32 v141, v141, abs(v141)
  v_mul_f32 v142, v142, abs(v142)
  v_mul_f32 v143, v143, abs(v143)
  v_cvt_pk_bf16_f32 v188, v124, v125
  v_cvt_pk_bf16_f32 v189, v126, v127
  v_cvt_pk_bf16_f32 v190, v140, v141
  v_cvt_pk_bf16_f32 v191, v142, v143
  v_pk_max_i16 v188, v188, 0
  v_pk_max_i16 v189, v189, 0
  v_pk_max_i16 v190, v190, 0
  v_pk_max_i16 v191, v191, 0
  v_bfe_u32 v4, v0, 1, 1
  v_add_u32 v4, -1, v4
  s_waitcnt lgkmcnt(0)
  v_mfma_f32_16x16x32_bf16 v[64:67], v[192:195], v[160:163], 0
  v_and_b32 v144, 0x3f803f80, v4
  v_mfma_f32_16x16x32_bf16 v[68:71], v[196:199], v[160:163], 0
  v_and_b32 v145, 0x3f803f80, v4
  v_mfma_f32_16x16x32_bf16 v[72:75], v[200:203], v[160:163], 0
  v_and_b32 v146, 0x3f803f80, v4
  v_mfma_f32_16x16x32_bf16 v[76:79], v[204:207], v[160:163], 0
  v_and_b32 v147, 0x3f803f80, v4
  v_and_b32 v4, 1, v0
  v_mul_u32_u24 v4, 0xaaaa, v4
  v_add_u32 v148, 0x4444, v4
  v_mov_b32 v149, v10
  v_mov_b64 v[48:49], 0
  v_mov_b64 v[50:51], 0
  v_mov_b64 v[52:53], 0
  v_mov_b64 v[54:55], 0
  v_mov_b64 v[56:57], 0
  v_mov_b64 v[58:59], 0
  v_mov_b64 v[60:61], 0
  v_mov_b64 v[62:63], 0
  s_mov_b32 s68, 2
  s_mov_b32 s26, 1
  v_mfma_f32_16x16x32_bf16 v[80:83], v[192:195], v[164:167], 0
  v_exp_f32 v64, v64
  v_mfma_f32_16x16x32_bf16 v[84:87], v[196:199], v[164:167], 0
  ds_read_b128 v[112:115], v149 offset:8192
  v_exp_f32 v65, v65
  v_exp_f32 v66, v66
  v_exp_f32 v67, v67
  v_cvt_pk_bf16_f32 v96, v64, v65
  v_mfma_f32_16x16x32_bf16 v[88:91], v[200:203], v[164:167], 0
  ds_read_b128 v[116:119], v149 offset:9216
  v_exp_f32 v68, v68
  v_mfma_f32_16x16x32_bf16 v[92:95], v[204:207], v[164:167], 0
  v_exp_f32 v69, v69
  v_exp_f32 v70, v70
  v_exp_f32 v71, v71
  v_exp_f32 v72, v72
  v_cvt_pk_bf16_f32 v97, v66, v67
  v_cvt_pk_bf16_f32 v98, v68, v69
  v_cvt_pk_bf16_f32 v99, v70, v71
  v_exp_f32 v73, v73
  v_exp_f32 v74, v74
  v_exp_f32 v75, v75
  buffer_store_dwordx4 v[176:179], v10, s[64:67], s73 offen offset:2048 sc1
  v_exp_f32 v76, v76
  v_exp_f32 v77, v77
  v_cvt_pk_bf16_f32 v100, v72, v73
  v_cvt_pk_bf16_f32 v101, v74, v75
  v_exp_f32 v78, v78
  v_exp_f32 v79, v79
  v_cvt_pk_bf16_f32 v102, v76, v77
  v_cvt_pk_bf16_f32 v103, v78, v79
  v_mfma_f32_16x16x32_bf16 v[64:67], v[192:195], v[168:171], 0
  v_exp_f32 v80, v80
  v_mfma_f32_16x16x32_bf16 v[68:71], v[196:199], v[168:171], 0
  ds_read_b128 v[120:123], v149 offset:10240
  v_exp_f32 v81, v81
  v_exp_f32 v82, v82
  v_exp_f32 v83, v83
  v_cvt_pk_bf16_f32 v104, v80, v81
  v_mfma_f32_16x16x32_bf16 v[72:75], v[200:203], v[168:171], 0
  ds_read_b128 v[124:127], v149 offset:11264
  v_exp_f32 v84, v84
  v_mfma_f32_16x16x32_bf16 v[76:79], v[204:207], v[168:171], 0
  v_exp_f32 v85, v85
  v_exp_f32 v86, v86
  v_exp_f32 v87, v87
  v_exp_f32 v88, v88
  v_cvt_pk_bf16_f32 v105, v82, v83
  v_cvt_pk_bf16_f32 v106, v84, v85
  v_cvt_pk_bf16_f32 v107, v86, v87
  v_mfma_f32_16x16x32_bf16 v[16:19], v[208:211], v[96:99], 0
  v_exp_f32 v89, v89
  v_mfma_f32_16x16x32_bf16 v[16:19], v[212:215], v[100:103], v[16:19]
  v_exp_f32 v90, v90
  v_mfma_f32_16x16x32_bf16 v[20:23], v[220:223], v[100:103], 0
  v_exp_f32 v91, v91
  v_mfma_f32_16x16x32_bf16 v[20:23], v[216:219], v[96:99], v[20:23]
L_pad_986:
  s_cbranch_execz L_pad_1054
  buffer_store_dwordx4 v[180:183], v11, s[64:67], s73 offen offset:2048 sc1
  v_exp_f32 v92, v92
  v_exp_f32 v93, v93
  v_cvt_pk_bf16_f32 v108, v88, v89
  v_cvt_pk_bf16_f32 v109, v90, v91
  v_smfmac_f32_16x16x64_bf16 v[48:51], v[144:147], v[96:103], v148
  v_exp_f32 v94, v94
  v_exp_f32 v95, v95
  v_cvt_pk_bf16_f32 v110, v92, v93
  v_cvt_pk_bf16_f32 v111, v94, v95
  v_mfma_f32_16x16x32_bf16 v[80:83], v[192:195], v[172:175], 0
  v_exp_f32 v64, v64
  v_mfma_f32_16x16x32_bf16 v[84:87], v[196:199], v[172:175], 0
  ds_read_b128 v[128:131], v149 offset:12288
  v_exp_f32 v65, v65
  v_exp_f32 v66, v66
  v_exp_f32 v67, v67
  v_cvt_pk_bf16_f32 v96, v64, v65
  v_mfma_f32_16x16x32_bf16 v[88:91], v[200:203], v[172:175], 0
  ds_read_b128 v[132:135], v149 offset:13312
  v_exp_f32 v68, v68
  v_mfma_f32_16x16x32_bf16 v[92:95], v[204:207], v[172:175], 0
  v_exp_f32 v69, v69
  v_exp_f32 v70, v70
  v_exp_f32 v71, v71
  v_exp_f32 v72, v72
  v_cvt_pk_bf16_f32 v97, v66, v67
  v_cvt_pk_bf16_f32 v98, v68, v69
  v_cvt_pk_bf16_f32 v99, v70, v71
  v_mfma_f32_16x16x32_bf16 v[24:27], v[208:211], v[104:107], 0
  v_exp_f32 v73, v73
  v_mfma_f32_16x16x32_bf16 v[24:27], v[212:215], v[108:111], v[24:27]
  v_exp_f32 v74, v74
  v_mfma_f32_16x16x32_bf16 v[28:31], v[220:223], v[108:111], 0
  v_exp_f32 v75, v75
  v_mfma_f32_16x16x32_bf16 v[28:31], v[216:219], v[104:107], v[28:31]
  buffer_store_dwordx4 v[184:187], v10, s[64:67], s74 offen offset:2048 sc1
  v_exp_f32 v76, v76
  v_exp_f32 v77, v77
  v_cvt_pk_bf16_f32 v100, v72, v73
  v_cvt_pk_bf16_f32 v101, v74, v75
  v_smfmac_f32_16x16x64_bf16 v[52:55], v[144:147], v[104:111], v148
  v_exp_f32 v78, v78
  v_exp_f32 v79, v79
  s_waitcnt lgkmcnt(0)
  v_cvt_pk_bf16_f32 v102, v76, v77
  v_cvt_pk_bf16_f32 v103, v78, v79
  v_mfma_f32_16x16x32_bf16 v[64:67], v[112:115], v[160:163], 0
  v_exp_f32 v80, v80
  v_mfma_f32_16x16x32_bf16 v[68:71], v[116:119], v[160:163], 0
  ds_read_b128 v[136:139], v149 offset:14336
  v_exp_f32 v81, v81
  v_exp_f32 v82, v82
  v_exp_f32 v83, v83
  v_cvt_pk_bf16_f32 v104, v80, v81
  v_mfma_f32_16x16x32_bf16 v[72:75], v[120:123], v[160:163], 0
  ds_read_b128 v[140:143], v149 offset:15360
  v_exp_f32 v84, v84
  v_mfma_f32_16x16x32_bf16 v[76:79], v[124:127], v[160:163], 0
  v_exp_f32 v85, v85
  v_exp_f32 v86, v86
  v_exp_f32 v87, v87
  v_exp_f32 v88, v88
  v_cvt_pk_bf16_f32 v105, v82, v83
  v_cvt_pk_bf16_f32 v106, v84, v85
  v_cvt_pk_bf16_f32 v107, v86, v87
  v_mfma_f32_16x16x32_bf16 v[32:35], v[208:211], v[96:99], 0
  v_exp_f32 v89, v89
  v_mfma_f32_16x16x32_bf16 v[32:35], v[212:215], v[100:103], v[32:35]
  v_exp_f32 v90, v90
  v_mfma_f32_16x16x32_bf16 v[36:39], v[220:223], v[100:103], 0
  v_exp_f32 v91, v91
  v_mfma_f32_16x16x32_bf16 v[36:39], v[216:219], v[96:99], v[36:39]
  buffer_store_dwordx4 v[188:191], v11, s[64:67], s74 offen offset:2048 sc1
  v_exp_f32 v92, v92
  v_exp_f32 v93, v93
  v_cvt_pk_bf16_f32 v108, v88, v89
  v_cvt_pk_bf16_f32 v109, v90, v91
  v_smfmac_f32_16x16x64_bf16 v[56:59], v[144:147], v[96:103], v148
  v_exp_f32 v94, v94
  v_exp_f32 v95, v95
  s_waitcnt lgkmcnt(0)
  v_cvt_pk_bf16_f32 v110, v92, v93
  v_cvt_pk_bf16_f32 v111, v94, v95
  v_mfma_f32_16x16x32_bf16 v[80:83], v[112:115], v[164:167], 0
  s_barrier
  v_add_u32 v149, 32768, v149
  v_exp_f32 v64, v64
  v_mfma_f32_16x16x32_bf16 v[84:87], v[116:119], v[164:167], 0
  ds_read_b128 v[192:195], v149 offset:0
  v_exp_f32 v65, v65
  v_exp_f32 v66, v66
  v_exp_f32 v67, v67
  v_cvt_pk_bf16_f32 v96, v64, v65
  v_mfma_f32_16x16x32_bf16 v[88:91], v[120:123], v[164:167], 0
  ds_read_b128 v[196:199], v149 offset:1024
  v_exp_f32 v68, v68
  v_mfma_f32_16x16x32_bf16 v[92:95], v[124:127], v[164:167], 0
  v_exp_f32 v69, v69
  v_exp_f32 v70, v70
  v_exp_f32 v71, v71
  v_exp_f32 v72, v72
  v_cvt_pk_bf16_f32 v97, v66, v67
  v_cvt_pk_bf16_f32 v98, v68, v69
  v_cvt_pk_bf16_f32 v99, v70, v71
  v_mfma_f32_16x16x32_bf16 v[40:43], v[208:211], v[104:107], 0
  v_exp_f32 v73, v73
  v_mfma_f32_16x16x32_bf16 v[40:43], v[212:215], v[108:111], v[40:43]
  v_exp_f32 v74, v74
  v_mfma_f32_16x16x32_bf16 v[44:47], v[220:223], v[108:111], 0
  v_exp_f32 v75, v75
  v_mfma_f32_16x16x32_bf16 v[44:47], v[216:219], v[104:107], v[44:47]
  v_exp_f32 v76, v76
  v_exp_f32 v77, v77
  v_cvt_pk_bf16_f32 v100, v72, v73
  v_cvt_pk_bf16_f32 v101, v74, v75
  v_smfmac_f32_16x16x64_bf16 v[60:63], v[144:147], v[104:111], v148
  v_exp_f32 v78, v78
  v_exp_f32 v79, v79
  v_cvt_pk_bf16_f32 v102, v76, v77
  v_cvt_pk_bf16_f32 v103, v78, v79
  v_mfma_f32_16x16x32_bf16 v[64:67], v[112:115], v[168:171], 0
  v_exp_f32 v80, v80
  v_mfma_f32_16x16x32_bf16 v[68:71], v[116:119], v[168:171], 0
  ds_read_b128 v[200:203], v149 offset:2048
  v_exp_f32 v81, v81
  v_exp_f32 v82, v82
  v_exp_f32 v83, v83
  v_cvt_pk_bf16_f32 v104, v80, v81
  v_mfma_f32_16x16x32_bf16 v[72:75], v[120:123], v[168:171], 0
  ds_read_b128 v[204:207], v149 offset:3072
  v_exp_f32 v84, v84
  v_mfma_f32_16x16x32_bf16 v[76:79], v[124:127], v[168:171], 0
  v_exp_f32 v85, v85
  v_exp_f32 v86, v86
  v_exp_f32 v87, v87
  v_exp_f32 v88, v88
  v_cvt_pk_bf16_f32 v105, v82, v83
  v_cvt_pk_bf16_f32 v106, v84, v85
  v_cvt_pk_bf16_f32 v107, v86, v87
  v_mfma_f32_16x16x32_bf16 v[16:19], v[128:131], v[96:99], v[16:19]
  v_exp_f32 v89, v89
  v_mfma_f32_16x16x32_bf16 v[16:19], v[132:135], v[100:103], v[16:19]
  v_exp_f32 v90, v90
  v_mfma_f32_16x16x32_bf16 v[20:23], v[140:143], v[100:103], v[20:23]
  v_exp_f32 v91, v91
  v_mfma_f32_16x16x32_bf16 v[20:23], v[136:139], v[96:99], v[20:23]
  v_exp_f32 v92, v92
  v_exp_f32 v93, v93
  v_cvt_pk_bf16_f32 v108, v88, v89
  v_cvt_pk_bf16_f32 v109, v90, v91
  v_smfmac_f32_16x16x64_bf16 v[48:51], v[144:147], v[96:103], v148
  v_exp_f32 v94, v94
  v_exp_f32 v95, v95
  v_cvt_pk_bf16_f32 v110, v92, v93
  v_cvt_pk_bf16_f32 v111, v94, v95
  v_mfma_f32_16x16x32_bf16 v[80:83], v[112:115], v[172:175], 0
  v_exp_f32 v64, v64
  v_mfma_f32_16x16x32_bf16 v[84:87], v[116:119], v[172:175], 0
  ds_read_b128 v[208:211], v149 offset:4096
  v_exp_f32 v65, v65
  v_exp_f32 v66, v66
  v_exp_f32 v67, v67
  v_cvt_pk_bf16_f32 v96, v64, v65
  v_mfma_f32_16x16x32_bf16 v[88:91], v[120:123], v[172:175], 0
  ds_read_b128 v[212:215], v149 offset:5120
  v_exp_f32 v68, v68
  v_mfma_f32_16x16x32_bf16 v[92:95], v[124:127], v[172:175], 0
  v_exp_f32 v69, v69
  v_exp_f32 v70, v70
  v_exp_f32 v71, v71
  v_exp_f32 v72, v72
  v_cvt_pk_bf16_f32 v97, v66, v67
  v_cvt_pk_bf16_f32 v98, v68, v69
  v_cvt_pk_bf16_f32 v99, v70, v71
  v_mfma_f32_16x16x32_bf16 v[24:27], v[128:131], v[104:107], v[24:27]
L_pad_1003:
  s_cbranch_execz L_ret_s2
  v_exp_f32 v73, v73
  v_mfma_f32_16x16x32_bf16 v[24:27], v[132:135], v[108:111], v[24:27]
  v_exp_f32 v74, v74
  v_mfma_f32_16x16x32_bf16 v[28:31], v[140:143], v[108:111], v[28:31]
  v_exp_f32 v75, v75
  v_mfma_f32_16x16x32_bf16 v[28:31], v[136:139], v[104:107], v[28:31]
  v_exp_f32 v76, v76
  v_exp_f32 v77, v77
  v_cvt_pk_bf16_f32 v100, v72, v73
  v_cvt_pk_bf16_f32 v101, v74, v75
  v_smfmac_f32_16x16x64_bf16 v[52:55], v[144:147], v[104:111], v148
  v_exp_f32 v78, v78
  v_exp_f32 v79, v79
  s_waitcnt lgkmcnt(0)
  v_cvt_pk_bf16_f32 v102, v76, v77
  v_cvt_pk_bf16_f32 v103, v78, v79
  v_mfma_f32_16x16x32_bf16 v[64:67], v[192:195], v[160:163], 0
  v_exp_f32 v80, v80
  v_mfma_f32_16x16x32_bf16 v[68:71], v[196:199], v[160:163], 0
  ds_read_b128 v[216:219], v149 offset:6144
  v_exp_f32 v81, v81
  v_exp_f32 v82, v82
  v_exp_f32 v83, v83
  v_cvt_pk_bf16_f32 v104, v80, v81
  v_mfma_f32_16x16x32_bf16 v[72:75], v[200:203], v[160:163], 0
  ds_read_b128 v[220:223], v149 offset:7168
  v_exp_f32 v84, v84
  v_mfma_f32_16x16x32_bf16 v[76:79], v[204:207], v[160:163], 0
  v_exp_f32 v85, v85
  v_exp_f32 v86, v86
  v_exp_f32 v87, v87
  v_exp_f32 v88, v88
  v_cvt_pk_bf16_f32 v105, v82, v83
  v_cvt_pk_bf16_f32 v106, v84, v85
  v_cvt_pk_bf16_f32 v107, v86, v87
  v_mfma_f32_16x16x32_bf16 v[32:35], v[128:131], v[96:99], v[32:35]
  v_exp_f32 v89, v89
  v_mfma_f32_16x16x32_bf16 v[32:35], v[132:135], v[100:103], v[32:35]
  v_exp_f32 v90, v90
  v_mfma_f32_16x16x32_bf16 v[36:39], v[140:143], v[100:103], v[36:39]
  v_exp_f32 v91, v91
  v_mfma_f32_16x16x32_bf16 v[36:39], v[136:139], v[96:99], v[36:39]
  v_exp_f32 v92, v92
  v_exp_f32 v93, v93
  v_cvt_pk_bf16_f32 v108, v88, v89
  v_cvt_pk_bf16_f32 v109, v90, v91
  v_smfmac_f32_16x16x64_bf16 v[56:59], v[144:147], v[96:103], v148
  v_exp_f32 v94, v94
  v_exp_f32 v95, v95
  s_waitcnt lgkmcnt(0)
  v_cvt_pk_bf16_f32 v110, v92, v93
  v_cvt_pk_bf16_f32 v111, v94, v95
  v_mfma_f32_16x16x32_bf16 v[80:83], v[192:195], v[164:167], 0
  v_exp_f32 v64, v64
  v_mfma_f32_16x16x32_bf16 v[84:87], v[196:199], v[164:167], 0
  ds_read_b128 v[112:115], v149 offset:8192
  v_exp_f32 v65, v65
  v_exp_f32 v66, v66
  v_exp_f32 v67, v67
  v_cvt_pk_bf16_f32 v96, v64, v65
  v_mfma_f32_16x16x32_bf16 v[88:91], v[200:203], v[164:167], 0
  ds_read_b128 v[116:119], v149 offset:9216
  v_exp_f32 v68, v68
  v_mfma_f32_16x16x32_bf16 v[92:95], v[204:207], v[164:167], 0
  v_exp_f32 v69, v69
  v_exp_f32 v70, v70
  v_exp_f32 v71, v71
  v_exp_f32 v72, v72
  v_cvt_pk_bf16_f32 v97, v66, v67
  v_cvt_pk_bf16_f32 v98, v68, v69
  v_cvt_pk_bf16_f32 v99, v70, v71
  v_mfma_f32_16x16x32_bf16 v[40:43], v[128:131], v[104:107], v[40:43]
  v_exp_f32 v73, v73
  v_mfma_f32_16x16x32_bf16 v[40:43], v[132:135], v[108:111], v[40:43]
  v_exp_f32 v74, v74
  v_mfma_f32_16x16x32_bf16 v[44:47], v[140:143], v[108:111], v[44:47]
  v_exp_f32 v75, v75
  v_mfma_f32_16x16x32_bf16 v[44:47], v[136:139], v[104:107], v[44:47]
  v_exp_f32 v76, v76
  v_exp_f32 v77, v77
  v_cvt_pk_bf16_f32 v100, v72, v73
  v_cvt_pk_bf16_f32 v101, v74, v75
  v_smfmac_f32_16x16x64_bf16 v[60:63], v[144:147], v[104:111], v148
  v_exp_f32 v78, v78
  v_exp_f32 v79, v79
  v_cvt_pk_bf16_f32 v102, v76, v77
  v_cvt_pk_bf16_f32 v103, v78, v79
  v_mfma_f32_16x16x32_bf16 v[64:67], v[192:195], v[168:171], 0
  v_exp_f32 v80, v80
  v_mfma_f32_16x16x32_bf16 v[68:71], v[196:199], v[168:171], 0
  ds_read_b128 v[120:123], v149 offset:10240
  v_exp_f32 v81, v81
  v_exp_f32 v82, v82
  v_exp_f32 v83, v83
  v_cvt_pk_bf16_f32 v104, v80, v81
  v_mfma_f32_16x16x32_bf16 v[72:75], v[200:203], v[168:171], 0
  ds_read_b128 v[124:127], v149 offset:11264
  v_exp_f32 v84, v84
  v_mfma_f32_16x16x32_bf16 v[76:79], v[204:207], v[168:171], 0
  v_exp_f32 v85, v85
  v_exp_f32 v86, v86
  v_exp_f32 v87, v87
  v_exp_f32 v88, v88
  v_cvt_pk_bf16_f32 v105, v82, v83
  v_cvt_pk_bf16_f32 v106, v84, v85
  v_cvt_pk_bf16_f32 v107, v86, v87
  v_mfma_f32_16x16x32_bf16 v[16:19], v[208:211], v[96:99], v[16:19]
  v_exp_f32 v89, v89
  v_mfma_f32_16x16x32_bf16 v[16:19], v[212:215], v[100:103], v[16:19]
  v_exp_f32 v90, v90
  v_mfma_f32_16x16x32_bf16 v[20:23], v[220:223], v[100:103], v[20:23]
  v_exp_f32 v91, v91
  v_mfma_f32_16x16x32_bf16 v[20:23], v[216:219], v[96:99], v[20:23]
  v_exp_f32 v92, v92
  v_exp_f32 v93, v93
  v_cvt_pk_bf16_f32 v108, v88, v89
  v_cvt_pk_bf16_f32 v109, v90, v91
  v_smfmac_f32_16x16x64_bf16 v[48:51], v[144:147], v[96:103], v148
  v_exp_f32 v94, v94
  v_exp_f32 v95, v95
  v_cvt_pk_bf16_f32 v110, v92, v93
  v_cvt_pk_bf16_f32 v111, v94, v95
  v_mfma_f32_16x16x32_bf16 v[80:83], v[192:195], v[172:175], 0
  v_exp_f32 v64, v64
  v_mfma_f32_16x16x32_bf16 v[84:87], v[196:199], v[172:175], 0
  ds_read_b128 v[128:131], v149 offset:12288
  v_exp_f32 v65, v65
  v_exp_f32 v66, v66
  v_exp_f32 v67, v67
  v_cvt_pk_bf16_f32 v96, v64, v65
  v_mfma_f32_16x16x32_bf16 v[88:91], v[200:203], v[172:175], 0
  ds_read_b128 v[132:135], v149 offset:13312
  v_exp_f32 v68, v68
  v_mfma_f32_16x16x32_bf16 v[92:95], v[204:207], v[172:175], 0
  v_exp_f32 v69, v69
  v_exp_f32 v70, v70
  v_exp_f32 v71, v71
  v_exp_f32 v72, v72
  v_cvt_pk_bf16_f32 v97, v66, v67
  v_cvt_pk_bf16_f32 v98, v68, v69
  v_cvt_pk_bf16_f32 v99, v70, v71
  v_mfma_f32_16x16x32_bf16 v[24:27], v[208:211], v[104:107], v[24:27]
  v_exp_f32 v73, v73
  v_mfma_f32_16x16x32_bf16 v[24:27], v[212:215], v[108:111], v[24:27]
  v_exp_f32 v74, v74
  v_mfma_f32_16x16x32_bf16 v[28:31], v[220:223], v[108:111], v[28:31]
  v_exp_f32 v75, v75
  v_mfma_f32_16x16x32_bf16 v[28:31], v[216:219], v[104:107], v[28:31]
  v_exp_f32 v76, v76
  v_exp_f32 v77, v77
  v_cvt_pk_bf16_f32 v100, v72, v73
  v_cvt_pk_bf16_f32 v101, v74, v75
  v_smfmac_f32_16x16x64_bf16 v[52:55], v[144:147], v[104:111], v148
  v_exp_f32 v78, v78
  v_exp_f32 v79, v79
  s_waitcnt lgkmcnt(0)
  v_cvt_pk_bf16_f32 v102, v76, v77
  v_cvt_pk_bf16_f32 v103, v78, v79
  v_mfma_f32_16x16x32_bf16 v[64:67], v[112:115], v[160:163], 0
  v_exp_f32 v80, v80
  v_mfma_f32_16x16x32_bf16 v[68:71], v[116:119], v[160:163], 0
  ds_read_b128 v[136:139], v149 offset:14336
  v_exp_f32 v81, v81
  v_exp_f32 v82, v82
  v_exp_f32 v83, v83
  v_cvt_pk_bf16_f32 v104, v80, v81
  v_mfma_f32_16x16x32_bf16 v[72:75], v[120:123], v[160:163], 0
  ds_read_b128 v[140:143], v149 offset:15360
  v_exp_f32 v84, v84
  v_mfma_f32_16x16x32_bf16 v[76:79], v[124:127], v[160:163], 0
  v_exp_f32 v85, v85
  v_exp_f32 v86, v86
  v_exp_f32 v87, v87
  v_exp_f32 v88, v88
  v_cvt_pk_bf16_f32 v105, v82, v83
  v_cvt_pk_bf16_f32 v106, v84, v85
  v_cvt_pk_bf16_f32 v107, v86, v87
L_pad_1020:
  s_cbranch_execz L_ret_s2
  v_mfma_f32_16x16x32_bf16 v[32:35], v[208:211], v[96:99], v[32:35]
  v_exp_f32 v89, v89
  v_mfma_f32_16x16x32_bf16 v[32:35], v[212:215], v[100:103], v[32:35]
  v_exp_f32 v90, v90
  v_mfma_f32_16x16x32_bf16 v[36:39], v[220:223], v[100:103], v[36:39]
  v_exp_f32 v91, v91
  v_mfma_f32_16x16x32_bf16 v[36:39], v[216:219], v[96:99], v[36:39]
  v_exp_f32 v92, v92
  v_exp_f32 v93, v93
  v_cvt_pk_bf16_f32 v108, v88, v89
  v_cvt_pk_bf16_f32 v109, v90, v91
  v_smfmac_f32_16x16x64_bf16 v[56:59], v[144:147], v[96:103], v148
  v_exp_f32 v94, v94
  v_exp_f32 v95, v95
  s_waitcnt lgkmcnt(0)
  v_cvt_pk_bf16_f32 v110, v92, v93
  v_cvt_pk_bf16_f32 v111, v94, v95
  v_mfma_f32_16x16x32_bf16 v[80:83], v[112:115], v[164:167], 0
  s_barrier
  v_add_u32 v149, 4294950912, v149
  v_exp_f32 v64, v64
  v_mfma_f32_16x16x32_bf16 v[84:87], v[116:119], v[164:167], 0
  ds_read_b128 v[192:195], v149 offset:0
  v_exp_f32 v65, v65
  v_exp_f32 v66, v66
  v_exp_f32 v67, v67
  v_cvt_pk_bf16_f32 v96, v64, v65
  v_mfma_f32_16x16x32_bf16 v[88:91], v[120:123], v[164:167], 0
  ds_read_b128 v[196:199], v149 offset:1024
  v_exp_f32 v68, v68
  v_mfma_f32_16x16x32_bf16 v[92:95], v[124:127], v[164:167], 0
  v_exp_f32 v69, v69
  v_exp_f32 v70, v70
  v_exp_f32 v71, v71
  v_exp_f32 v72, v72
  v_cvt_pk_bf16_f32 v97, v66, v67
  v_cvt_pk_bf16_f32 v98, v68, v69
  v_cvt_pk_bf16_f32 v99, v70, v71
  v_mfma_f32_16x16x32_bf16 v[40:43], v[208:211], v[104:107], v[40:43]
  v_exp_f32 v73, v73
  v_mfma_f32_16x16x32_bf16 v[40:43], v[212:215], v[108:111], v[40:43]
  v_exp_f32 v74, v74
  v_mfma_f32_16x16x32_bf16 v[44:47], v[220:223], v[108:111], v[44:47]
  v_exp_f32 v75, v75
  v_mfma_f32_16x16x32_bf16 v[44:47], v[216:219], v[104:107], v[44:47]
  v_exp_f32 v76, v76
  v_exp_f32 v77, v77
  v_cvt_pk_bf16_f32 v100, v72, v73
  v_cvt_pk_bf16_f32 v101, v74, v75
  v_smfmac_f32_16x16x64_bf16 v[60:63], v[144:147], v[104:111], v148
  v_exp_f32 v78, v78
  v_exp_f32 v79, v79
  v_cvt_pk_bf16_f32 v102, v76, v77
  v_cvt_pk_bf16_f32 v103, v78, v79
  v_mfma_f32_16x16x32_bf16 v[64:67], v[112:115], v[168:171], 0
  v_exp_f32 v80, v80
  v_mfma_f32_16x16x32_bf16 v[68:71], v[116:119], v[168:171], 0
  ds_read_b128 v[200:203], v149 offset:2048
  v_exp_f32 v81, v81
  v_exp_f32 v82, v82
  v_exp_f32 v83, v83
  v_cvt_pk_bf16_f32 v104, v80, v81
  v_mfma_f32_16x16x32_bf16 v[72:75], v[120:123], v[168:171], 0
  ds_read_b128 v[204:207], v149 offset:3072
  v_exp_f32 v84, v84
  v_mfma_f32_16x16x32_bf16 v[76:79], v[124:127], v[168:171], 0
  v_exp_f32 v85, v85
  v_exp_f32 v86, v86
  v_exp_f32 v87, v87
  v_exp_f32 v88, v88
  v_cvt_pk_bf16_f32 v105, v82, v83
  v_cvt_pk_bf16_f32 v106, v84, v85
  v_cvt_pk_bf16_f32 v107, v86, v87
  v_mfma_f32_16x16x32_bf16 v[16:19], v[128:131], v[96:99], v[16:19]
  v_exp_f32 v89, v89
  v_mfma_f32_16x16x32_bf16 v[16:19], v[132:135], v[100:103], v[16:19]
  v_exp_f32 v90, v90
  v_mfma_f32_16x16x32_bf16 v[20:23], v[140:143], v[100:103], v[20:23]
  v_exp_f32 v91, v91
  v_mfma_f32_16x16x32_bf16 v[20:23], v[136:139], v[96:99], v[20:23]
  v_exp_f32 v92, v92
  v_exp_f32 v93, v93
  v_cvt_pk_bf16_f32 v108, v88, v89
  v_cvt_pk_bf16_f32 v109, v90, v91
  v_smfmac_f32_16x16x64_bf16 v[48:51], v[144:147], v[96:103], v148
  v_exp_f32 v94, v94
  v_exp_f32 v95, v95
  v_cvt_pk_bf16_f32 v110, v92, v93
  v_cvt_pk_bf16_f32 v111, v94, v95
  v_mfma_f32_16x16x32_bf16 v[80:83], v[112:115], v[172:175], 0
  v_exp_f32 v64, v64
  v_mfma_f32_16x16x32_bf16 v[84:87], v[116:119], v[172:175], 0
  ds_read_b128 v[208:211], v149 offset:4096
  v_exp_f32 v65, v65
  v_exp_f32 v66, v66
  v_exp_f32 v67, v67
  v_cvt_pk_bf16_f32 v96, v64, v65
  v_mfma_f32_16x16x32_bf16 v[88:91], v[120:123], v[172:175], 0
  ds_read_b128 v[212:215], v149 offset:5120
  v_exp_f32 v68, v68
  v_mfma_f32_16x16x32_bf16 v[92:95], v[124:127], v[172:175], 0
  v_exp_f32 v69, v69
  v_exp_f32 v70, v70
  v_exp_f32 v71, v71
  v_exp_f32 v72, v72
  v_cvt_pk_bf16_f32 v97, v66, v67
  v_cvt_pk_bf16_f32 v98, v68, v69
  v_cvt_pk_bf16_f32 v99, v70, v71
  v_mfma_f32_16x16x32_bf16 v[24:27], v[128:131], v[104:107], v[24:27]
  v_exp_f32 v73, v73
  v_mfma_f32_16x16x32_bf16 v[24:27], v[132:135], v[108:111], v[24:27]
  v_exp_f32 v74, v74
  v_mfma_f32_16x16x32_bf16 v[28:31], v[140:143], v[108:111], v[28:31]
  v_exp_f32 v75, v75
  v_mfma_f32_16x16x32_bf16 v[28:31], v[136:139], v[104:107], v[28:31]
  v_and_b32 v2, 15, v0
  v_lshlrev_b32 v1, 2, v2
  v_bfe_u32 v4, v0, 4, 1
  v_add_u32 v255, 1, v4
  v_xor_b32 v3, s4, v4
  v_xor_b32 v5, s36, v2
  v_lshl_add_u32 v3, v5, 2, v3
  v_lshlrev_b32 v3, 7, v3
  v_add_u32 v249, s19, v3
  v_lshrrev_b32 v5, 5, v0
  v_add_u32 v248, 0x8000, v10
  v_add_u32 v251, s33, v10
  v_and_b32 v7, 7, v0
  v_xor_b32 v6, v5, v7
  v_lshl_add_u32 v6, v6, 4, s33
  v_lshl_add_u32 v6, v2, 7, v6
  v_lshl_add_u32 v252, v4, 3, v6
  v_lshrrev_b32 v4, 3, v0
  v_xor_b32 v6, v7, v4
  v_lshl_add_u32 v6, v6, 4, s33
  v_lshl_add_u32 v253, v4, 7, v6
  v_lshlrev_b32 v7, 4, v7
  v_lshl_add_u32 v254, v4, 11, v7
  v_and_b32 v6, 3, v0
  v_lshlrev_b32 v6, 3, v6
  v_and_b32 v4, 3, v4
  v_lshl_add_u32 v4, v4, 5, v6
  v_lshrrev_b32 v6, 2, v0
  v_lshl_add_u32 v244, v6, 7, v4
  v_xor_b32 v245, 32, v244
  v_xor_b32 v246, 64, v244
  v_xor_b32 v247, 96, v244
  v_add_u32 v12, s35, v244
  v_add_u32 v240, s23, v244
  v_add_u32 v13, s35, v245
  v_add_u32 v241, s23, v245
  v_add_u32 v14, s35, v246
  v_add_u32 v242, s23, v246
  v_add_u32 v15, s35, v247
  v_add_u32 v243, s23, v247
  s_waitcnt vmcnt(0)
  s_mov_b64 exec, 1
  v_mov_b32 v2, 0
  v_mov_b32 v3, 1
  buffer_store_dword v3, v2, s[64:67], s69 offen offset:0 sc1
  s_mov_b64 exec, -1
  v_exp_f32 v76, v76
  v_exp_f32 v77, v77
  v_cvt_pk_bf16_f32 v100, v72, v73
  v_cvt_pk_bf16_f32 v101, v74, v75
  v_smfmac_f32_16x16x64_bf16 v[52:55], v[144:147], v[104:111], v148
  v_exp_f32 v78, v78
  v_exp_f32 v79, v79
  s_waitcnt lgkmcnt(0)
  v_cvt_pk_bf16_f32 v102, v76, v77
  v_cvt_pk_bf16_f32 v103, v78, v79
  v_mfma_f32_16x16x32_bf16 v[64:67], v[192:195], v[160:163], 0
  v_exp_f32 v80, v80
  v_mfma_f32_16x16x32_bf16 v[68:71], v[196:199], v[160:163], 0
  ds_read_b128 v[216:219], v149 offset:6144
  v_exp_f32 v81, v81
  v_exp_f32 v82, v82
  v_exp_f32 v83, v83
  v_cvt_pk_bf16_f32 v104, v80, v81
  v_mfma_f32_16x16x32_bf16 v[72:75], v[200:203], v[160:163], 0
  ds_read_b128 v[220:223], v149 offset:7168
  v_exp_f32 v84, v84
  v_mfma_f32_16x16x32_bf16 v[76:79], v[204:207], v[160:163], 0
L_pad_1037:
  s_cbranch_execz L_ret_s2
  v_exp_f32 v85, v85
  v_exp_f32 v86, v86
  v_exp_f32 v87, v87
  v_exp_f32 v88, v88
  v_cvt_pk_bf16_f32 v105, v82, v83
  v_cvt_pk_bf16_f32 v106, v84, v85
  v_cvt_pk_bf16_f32 v107, v86, v87
  v_mfma_f32_16x16x32_bf16 v[32:35], v[128:131], v[96:99], v[32:35]
  v_exp_f32 v89, v89
  v_mfma_f32_16x16x32_bf16 v[32:35], v[132:135], v[100:103], v[32:35]
  v_exp_f32 v90, v90
  v_mfma_f32_16x16x32_bf16 v[36:39], v[140:143], v[100:103], v[36:39]
  v_exp_f32 v91, v91
  v_mfma_f32_16x16x32_bf16 v[36:39], v[136:139], v[96:99], v[36:39]
  v_exp_f32 v92, v92
  v_exp_f32 v93, v93
  v_cvt_pk_bf16_f32 v108, v88, v89
  v_cvt_pk_bf16_f32 v109, v90, v91
  v_smfmac_f32_16x16x64_bf16 v[56:59], v[144:147], v[96:103], v148
  v_exp_f32 v94, v94
  v_exp_f32 v95, v95
  s_waitcnt lgkmcnt(0)
  v_cvt_pk_bf16_f32 v110, v92, v93
  v_cvt_pk_bf16_f32 v111, v94, v95
  s_mov_b32 s14, 4294950912
.p2align 6
L_a_loop:
  v_mfma_f32_16x16x32_bf16 v[80:83], v[192:195], v[164:167], 0
  v_exp_f32 v64, v64
  v_mfma_f32_16x16x32_bf16 v[84:87], v[196:199], v[164:167], 0
  ds_read_b128 v[112:115], v149 offset:8192
  v_exp_f32 v65, v65
  v_exp_f32 v66, v66
  v_exp_f32 v67, v67
  v_cvt_pk_bf16_f32 v96, v64, v65
  v_mfma_f32_16x16x32_bf16 v[88:91], v[200:203], v[164:167], 0
  ds_read_b128 v[116:119], v149 offset:9216
  v_exp_f32 v68, v68
  v_mfma_f32_16x16x32_bf16 v[92:95], v[204:207], v[164:167], 0
  s_add_u32 s26, s26, 1
  v_exp_f32 v69, v69
  v_exp_f32 v70, v70
  v_exp_f32 v71, v71
  v_exp_f32 v72, v72
  v_cvt_pk_bf16_f32 v97, v66, v67
  v_cvt_pk_bf16_f32 v98, v68, v69
  v_cvt_pk_bf16_f32 v99, v70, v71
  v_mfma_f32_16x16x32_bf16 v[40:43], v[128:131], v[104:107], v[40:43]
  v_exp_f32 v73, v73
  v_mfma_f32_16x16x32_bf16 v[40:43], v[132:135], v[108:111], v[40:43]
  v_exp_f32 v74, v74
  v_mfma_f32_16x16x32_bf16 v[44:47], v[140:143], v[108:111], v[44:47]
  v_exp_f32 v75, v75
  v_mfma_f32_16x16x32_bf16 v[44:47], v[136:139], v[104:107], v[44:47]
  v_exp_f32 v76, v76
  v_exp_f32 v77, v77
  v_cvt_pk_bf16_f32 v100, v72, v73
  v_cvt_pk_bf16_f32 v101, v74, v75
  v_smfmac_f32_16x16x64_bf16 v[60:63], v[144:147], v[104:111], v148
  v_exp_f32 v78, v78
  v_exp_f32 v79, v79
  v_cvt_pk_bf16_f32 v102, v76, v77
  v_cvt_pk_bf16_f32 v103, v78, v79
  v_mfma_f32_16x16x32_bf16 v[64:67], v[192:195], v[168:171], 0
  v_exp_f32 v80, v80
  v_mfma_f32_16x16x32_bf16 v[68:71], v[196:199], v[168:171], 0
  ds_read_b128 v[120:123], v149 offset:10240
  v_exp_f32 v81, v81
  v_exp_f32 v82, v82
  v_exp_f32 v83, v83
  v_cvt_pk_bf16_f32 v104, v80, v81
  v_mfma_f32_16x16x32_bf16 v[72:75], v[200:203], v[168:171], 0
  ds_read_b128 v[124:127], v149 offset:11264
  v_exp_f32 v84, v84
  v_mfma_f32_16x16x32_bf16 v[76:79], v[204:207], v[168:171], 0
  s_cmp_eq_u32 s26, 3
  v_exp_f32 v85, v85
  v_exp_f32 v86, v86
  v_exp_f32 v87, v87
  v_exp_f32 v88, v88
  v_cvt_pk_bf16_f32 v105, v82, v83
  v_cvt_pk_bf16_f32 v106, v84, v85
  v_cvt_pk_bf16_f32 v107, v86, v87
  v_mfma_f32_16x16x32_bf16 v[16:19], v[208:211], v[96:99], v[16:19]
  v_exp_f32 v89, v89
  v_mfma_f32_16x16x32_bf16 v[16:19], v[212:215], v[100:103], v[16:19]
  v_exp_f32 v90, v90
  v_mfma_f32_16x16x32_bf16 v[20:23], v[220:223], v[100:103], v[20:23]
  v_exp_f32 v91, v91
  v_mfma_f32_16x16x32_bf16 v[20:23], v[216:219], v[96:99], v[20:23]
  v_exp_f32 v92, v92
  v_exp_f32 v93, v93
  v_cvt_pk_bf16_f32 v108, v88, v89
  v_cvt_pk_bf16_f32 v109, v90, v91
  v_smfmac_f32_16x16x64_bf16 v[48:51], v[144:147], v[96:103], v148
  v_exp_f32 v94, v94
  v_exp_f32 v95, v95
  v_cvt_pk_bf16_f32 v110, v92, v93
  v_cvt_pk_bf16_f32 v111, v94, v95
  v_mfma_f32_16x16x32_bf16 v[80:83], v[192:195], v[172:175], 0
  v_exp_f32 v64, v64
  v_mfma_f32_16x16x32_bf16 v[84:87], v[196:199], v[172:175], 0
  ds_read_b128 v[128:131], v149 offset:12288
  v_exp_f32 v65, v65
  v_exp_f32 v66, v66
  v_exp_f32 v67, v67
  v_cvt_pk_bf16_f32 v96, v64, v65
  v_mfma_f32_16x16x32_bf16 v[88:91], v[200:203], v[172:175], 0
  ds_read_b128 v[132:135], v149 offset:13312
  v_exp_f32 v68, v68
  v_mfma_f32_16x16x32_bf16 v[92:95], v[204:207], v[172:175], 0
  s_cselect_b32 s27, 0x8000, s14
  v_exp_f32 v69, v69
  v_exp_f32 v70, v70
  v_exp_f32 v71, v71
  v_exp_f32 v72, v72
  v_cvt_pk_bf16_f32 v97, v66, v67
  v_cvt_pk_bf16_f32 v98, v68, v69
  v_cvt_pk_bf16_f32 v99, v70, v71
  v_mfma_f32_16x16x32_bf16 v[24:27], v[208:211], v[104:107], v[24:27]
  v_exp_f32 v73, v73
  v_mfma_f32_16x16x32_bf16 v[24:27], v[212:215], v[108:111], v[24:27]
  v_exp_f32 v74, v74
  v_mfma_f32_16x16x32_bf16 v[28:31], v[220:223], v[108:111], v[28:31]
  v_exp_f32 v75, v75
  v_mfma_f32_16x16x32_bf16 v[28:31], v[216:219], v[104:107], v[28:31]
  v_exp_f32 v76, v76
  v_exp_f32 v77, v77
  v_cvt_pk_bf16_f32 v100, v72, v73
  v_cvt_pk_bf16_f32 v101, v74, v75
  v_smfmac_f32_16x16x64_bf16 v[52:55], v[144:147], v[104:111], v148
  v_exp_f32 v78, v78
  v_exp_f32 v79, v79
  s_waitcnt lgkmcnt(0)
  v_cvt_pk_bf16_f32 v102, v76, v77
  v_cvt_pk_bf16_f32 v103, v78, v79
  v_mfma_f32_16x16x32_bf16 v[64:67], v[112:115], v[160:163], 0
  v_exp_f32 v80, v80
  v_mfma_f32_16x16x32_bf16 v[68:71], v[116:119], v[160:163], 0
  ds_read_b128 v[136:139], v149 offset:14336
  v_exp_f32 v81, v81
  v_exp_f32 v82, v82
  v_exp_f32 v83, v83
  v_cvt_pk_bf16_f32 v104, v80, v81
  v_mfma_f32_16x16x32_bf16 v[72:75], v[120:123], v[160:163], 0
  ds_read_b128 v[140:143], v149 offset:15360
  v_exp_f32 v84, v84
  v_mfma_f32_16x16x32_bf16 v[76:79], v[124:127], v[160:163], 0
  s_cselect_b32 s26, 0, s26
  v_exp_f32 v85, v85
  v_exp_f32 v86, v86
  v_exp_f32 v87, v87
  v_exp_f32 v88, v88
  v_cvt_pk_bf16_f32 v105, v82, v83
  v_cvt_pk_bf16_f32 v106, v84, v85
  v_cvt_pk_bf16_f32 v107, v86, v87
  v_mfma_f32_16x16x32_bf16 v[32:35], v[208:211], v[96:99], v[32:35]
  v_exp_f32 v89, v89
  v_mfma_f32_16x16x32_bf16 v[32:35], v[212:215], v[100:103], v[32:35]
  v_exp_f32 v90, v90
  v_mfma_f32_16x16x32_bf16 v[36:39], v[220:223], v[100:103], v[36:39]
  v_exp_f32 v91, v91
  v_mfma_f32_16x16x32_bf16 v[36:39], v[216:219], v[96:99], v[36:39]
  v_exp_f32 v92, v92
  v_exp_f32 v93, v93
  v_cvt_pk_bf16_f32 v108, v88, v89
  v_cvt_pk_bf16_f32 v109, v90, v91
  v_smfmac_f32_16x16x64_bf16 v[56:59], v[144:147], v[96:103], v148
  v_exp_f32 v94, v94
  v_exp_f32 v95, v95
  s_waitcnt lgkmcnt(0)
  v_cvt_pk_bf16_f32 v110, v92, v93
  v_cvt_pk_bf16_f32 v111, v94, v95
  v_mfma_f32_16x16x32_bf16 v[80:83], v[112:115], v[164:167], 0
L_pad_1054:
  s_cbranch_execz L_ret_s2
  s_barrier
  v_add_u32 v149, s27, v149
  v_exp_f32 v64, v64
  v_mfma_f32_16x16x32_bf16 v[84:87], v[116:119], v[164:167], 0
  ds_read_b128 v[192:195], v149 offset:0
  v_exp_f32 v65, v65
  v_exp_f32 v66, v66
  v_exp_f32 v67, v67
  v_cvt_pk_bf16_f32 v96, v64, v65
  v_mfma_f32_16x16x32_bf16 v[88:91], v[120:123], v[164:167], 0
  ds_read_b128 v[196:199], v149 offset:1024
  v_exp_f32 v68, v68
  v_mfma_f32_16x16x32_bf16 v[92:95], v[124:127], v[164:167], 0
  v_exp_f32 v69, v69
  v_exp_f32 v70, v70
  v_exp_f32 v71, v71
  v_exp_f32 v72, v72
  v_cvt_pk_bf16_f32 v97, v66, v67
  v_cvt_pk_bf16_f32 v98, v68, v69
  v_cvt_pk_bf16_f32 v99, v70, v71
  v_mfma_f32_16x16x32_bf16 v[40:43], v[208:211], v[104:107], v[40:43]
  v_exp_f32 v73, v73
  v_mfma_f32_16x16x32_bf16 v[40:43], v[212:215], v[108:111], v[40:43]
  v_exp_f32 v74, v74
  v_mfma_f32_16x16x32_bf16 v[44:47], v[220:223], v[108:111], v[44:47]
  v_exp_f32 v75, v75
  v_mfma_f32_16x16x32_bf16 v[44:47], v[216:219], v[104:107], v[44:47]
  v_exp_f32 v76, v76
  v_exp_f32 v77, v77
  v_cvt_pk_bf16_f32 v100, v72, v73
  v_cvt_pk_bf16_f32 v101, v74, v75
  v_smfmac_f32_16x16x64_bf16 v[60:63], v[144:147], v[104:111], v148
  v_exp_f32 v78, v78
  v_exp_f32 v79, v79
  v_cvt_pk_bf16_f32 v102, v76, v77
  v_cvt_pk_bf16_f32 v103, v78, v79
  v_mfma_f32_16x16x32_bf16 v[64:67], v[112:115], v[168:171], 0
  v_exp_f32 v80, v80
  v_mfma_f32_16x16x32_bf16 v[68:71], v[116:119], v[168:171], 0
  ds_read_b128 v[200:203], v149 offset:2048
  v_exp_f32 v81, v81
  v_exp_f32 v82, v82
  v_exp_f32 v83, v83
  v_cvt_pk_bf16_f32 v104, v80, v81
  v_mfma_f32_16x16x32_bf16 v[72:75], v[120:123], v[168:171], 0
  ds_read_b128 v[204:207], v149 offset:3072
  v_exp_f32 v84, v84
  v_mfma_f32_16x16x32_bf16 v[76:79], v[124:127], v[168:171], 0
  v_exp_f32 v85, v85
  v_exp_f32 v86, v86
  v_exp_f32 v87, v87
  v_exp_f32 v88, v88
  v_cvt_pk_bf16_f32 v105, v82, v83
  v_cvt_pk_bf16_f32 v106, v84, v85
  v_cvt_pk_bf16_f32 v107, v86, v87
  v_mfma_f32_16x16x32_bf16 v[16:19], v[128:131], v[96:99], v[16:19]
  v_exp_f32 v89, v89
  v_mfma_f32_16x16x32_bf16 v[16:19], v[132:135], v[100:103], v[16:19]
  v_exp_f32 v90, v90
  v_mfma_f32_16x16x32_bf16 v[20:23], v[140:143], v[100:103], v[20:23]
  v_exp_f32 v91, v91
  v_mfma_f32_16x16x32_bf16 v[20:23], v[136:139], v[96:99], v[20:23]
  v_exp_f32 v92, v92
  v_exp_f32 v93, v93
  v_cvt_pk_bf16_f32 v108, v88, v89
  v_cvt_pk_bf16_f32 v109, v90, v91
  v_smfmac_f32_16x16x64_bf16 v[48:51], v[144:147], v[96:103], v148
  v_exp_f32 v94, v94
  v_exp_f32 v95, v95
  v_cvt_pk_bf16_f32 v110, v92, v93
  v_cvt_pk_bf16_f32 v111, v94, v95
  v_mfma_f32_16x16x32_bf16 v[80:83], v[112:115], v[172:175], 0
  v_exp_f32 v64, v64
  v_mfma_f32_16x16x32_bf16 v[84:87], v[116:119], v[172:175], 0
  ds_read_b128 v[208:211], v149 offset:4096
  v_exp_f32 v65, v65
  v_exp_f32 v66, v66
  v_exp_f32 v67, v67
  v_cvt_pk_bf16_f32 v96, v64, v65
  v_mfma_f32_16x16x32_bf16 v[88:91], v[120:123], v[172:175], 0
  ds_read_b128 v[212:215], v149 offset:5120
  v_exp_f32 v68, v68
  v_mfma_f32_16x16x32_bf16 v[92:95], v[124:127], v[172:175], 0
  s_add_u32 s68, s68, 1
  v_exp_f32 v69, v69
  v_exp_f32 v70, v70
  v_exp_f32 v71, v71
  v_exp_f32 v72, v72
  v_cvt_pk_bf16_f32 v97, v66, v67
  v_cvt_pk_bf16_f32 v98, v68, v69
  v_cvt_pk_bf16_f32 v99, v70, v71
  v_mfma_f32_16x16x32_bf16 v[24:27], v[128:131], v[104:107], v[24:27]
  v_exp_f32 v73, v73
  v_mfma_f32_16x16x32_bf16 v[24:27], v[132:135], v[108:111], v[24:27]
  v_exp_f32 v74, v74
  v_mfma_f32_16x16x32_bf16 v[28:31], v[140:143], v[108:111], v[28:31]
  v_exp_f32 v75, v75
  v_mfma_f32_16x16x32_bf16 v[28:31], v[136:139], v[104:107], v[28:31]
  v_exp_f32 v76, v76
  v_exp_f32 v77, v77
  v_cvt_pk_bf16_f32 v100, v72, v73
  v_cvt_pk_bf16_f32 v101, v74, v75
  v_smfmac_f32_16x16x64_bf16 v[52:55], v[144:147], v[104:111], v148
  v_exp_f32 v78, v78
  v_exp_f32 v79, v79
  s_waitcnt lgkmcnt(0)
  v_cvt_pk_bf16_f32 v102, v76, v77
  v_cvt_pk_bf16_f32 v103, v78, v79
  v_mfma_f32_16x16x32_bf16 v[64:67], v[192:195], v[160:163], 0
  v_exp_f32 v80, v80
  v_mfma_f32_16x16x32_bf16 v[68:71], v[196:199], v[160:163], 0
  ds_read_b128 v[216:219], v149 offset:6144
  v_exp_f32 v81, v81
  v_exp_f32 v82, v82
  v_exp_f32 v83, v83
  v_cvt_pk_bf16_f32 v104, v80, v81
  v_mfma_f32_16x16x32_bf16 v[72:75], v[200:203], v[160:163], 0
  ds_read_b128 v[220:223], v149 offset:7168
  v_exp_f32 v84, v84
  v_mfma_f32_16x16x32_bf16 v[76:79], v[204:207], v[160:163], 0
  s_cmp_lg_u32 s68, 13
  v_exp_f32 v85, v85
  v_exp_f32 v86, v86
  v_exp_f32 v87, v87
  v_exp_f32 v88, v88
  v_cvt_pk_bf16_f32 v105, v82, v83
  v_cvt_pk_bf16_f32 v106, v84, v85
  v_cvt_pk_bf16_f32 v107, v86, v87
  v_mfma_f32_16x16x32_bf16 v[32:35], v[128:131], v[96:99], v[32:35]
  v_exp_f32 v89, v89
  v_mfma_f32_16x16x32_bf16 v[32:35], v[132:135], v[100:103], v[32:35]
  v_exp_f32 v90, v90
  v_mfma_f32_16x16x32_bf16 v[36:39], v[140:143], v[100:103], v[36:39]
  v_exp_f32 v91, v91
  v_mfma_f32_16x16x32_bf16 v[36:39], v[136:139], v[96:99], v[36:39]
  v_exp_f32 v92, v92
  v_exp_f32 v93, v93
  v_cvt_pk_bf16_f32 v108, v88, v89
  v_cvt_pk_bf16_f32 v109, v90, v91
  v_smfmac_f32_16x16x64_bf16 v[56:59], v[144:147], v[96:103], v148
  v_exp_f32 v94, v94
  v_exp_f32 v95, v95
  s_waitcnt lgkmcnt(0)
  v_cvt_pk_bf16_f32 v110, v92, v93
  v_cvt_pk_bf16_f32 v111, v94, v95
  s_cbranch_scc1 L_a_loop
  v_mfma_f32_16x16x32_bf16 v[80:83], v[192:195], v[164:167], 0
  v_exp_f32 v64, v64
  v_mfma_f32_16x16x32_bf16 v[84:87], v[196:199], v[164:167], 0
  ds_read_b128 v[112:115], v10 offset:40960
  ds_read_b128 v[116:119], v10 offset:41984
  v_exp_f32 v65, v65
  v_exp_f32 v66, v66
  v_exp_f32 v67, v67
  v_cvt_pk_bf16_f32 v96, v64, v65
  v_mfma_f32_16x16x32_bf16 v[88:91], v[200:203], v[164:167], 0
  ds_read_b128 v[120:123], v10 offset:43008
  ds_read_b128 v[124:127], v10 offset:44032
  v_exp_f32 v68, v68
  v_mfma_f32_16x16x32_bf16 v[92:95], v[204:207], v[164:167], 0
  v_exp_f32 v69, v69
  v_exp_f32 v70, v70
  v_exp_f32 v71, v71
  v_exp_f32 v72, v72
  v_cvt_pk_bf16_f32 v97, v66, v67
  v_cvt_pk_bf16_f32 v98, v68, v69
  v_cvt_pk_bf16_f32 v99, v70, v71
  v_mfma_f32_16x16x32_bf16 v[40:43], v[128:131], v[104:107], v[40:43]
  v_exp_f32 v73, v73
  v_mfma_f32_16x16x32_bf16 v[40:43], v[132:135], v[108:111], v[40:43]
  v_exp_f32 v74, v74
  v_mfma_f32_16x16x32_bf16 v[44:47], v[140:143], v[108:111], v[44:47]
  v_exp_f32 v75, v75
  v_mfma_f32_16x16x32_bf16 v[44:47], v[136:139], v[104:107], v[44:47]
  v_exp_f32 v76, v76
  v_exp_f32 v77, v77
  v_cvt_pk_bf16_f32 v100, v72, v73
  v_cvt_pk_bf16_f32 v101, v74, v75
L_pad_1071:
  s_cbranch_execz L_pad_1139
  v_smfmac_f32_16x16x64_bf16 v[60:63], v[144:147], v[104:111], v148
  v_exp_f32 v78, v78
  v_exp_f32 v79, v79
  s_waitcnt lgkmcnt(0)
  v_cvt_pk_bf16_f32 v102, v76, v77
  v_cvt_pk_bf16_f32 v103, v78, v79
  v_mfma_f32_16x16x32_bf16 v[64:67], v[112:115], v[160:163], 0
  v_exp_f32 v80, v80
  v_mfma_f32_16x16x32_bf16 v[68:71], v[116:119], v[160:163], 0
  ds_read_b128 v[128:131], v10 offset:45056
  ds_read_b128 v[132:135], v10 offset:46080
  v_exp_f32 v81, v81
  v_exp_f32 v82, v82
  v_exp_f32 v83, v83
  v_cvt_pk_bf16_f32 v104, v80, v81
  v_mfma_f32_16x16x32_bf16 v[72:75], v[120:123], v[160:163], 0
  ds_read_b128 v[136:139], v10 offset:47104
  ds_read_b128 v[140:143], v10 offset:48128
  v_exp_f32 v84, v84
  v_mfma_f32_16x16x32_bf16 v[76:79], v[124:127], v[160:163], 0
  v_exp_f32 v85, v85
  v_exp_f32 v86, v86
  v_exp_f32 v87, v87
  v_exp_f32 v88, v88
  v_cvt_pk_bf16_f32 v105, v82, v83
  v_cvt_pk_bf16_f32 v106, v84, v85
  v_cvt_pk_bf16_f32 v107, v86, v87
  v_mfma_f32_16x16x32_bf16 v[16:19], v[208:211], v[96:99], v[16:19]
  v_exp_f32 v89, v89
  v_mfma_f32_16x16x32_bf16 v[16:19], v[212:215], v[100:103], v[16:19]
  v_exp_f32 v90, v90
  v_mfma_f32_16x16x32_bf16 v[20:23], v[220:223], v[100:103], v[20:23]
  v_exp_f32 v91, v91
  v_mfma_f32_16x16x32_bf16 v[20:23], v[216:219], v[96:99], v[20:23]
  buffer_load_dword v8, v1, s[64:67], s32 offen sc1
  buffer_load_dword v9, v1, s[64:67], s32 offen offset:64 sc1
  v_exp_f32 v92, v92
  v_exp_f32 v93, v93
  v_cvt_pk_bf16_f32 v108, v88, v89
  v_cvt_pk_bf16_f32 v109, v90, v91
  v_smfmac_f32_16x16x64_bf16 v[48:51], v[144:147], v[96:103], v148
  v_exp_f32 v94, v94
  v_exp_f32 v95, v95
  s_waitcnt lgkmcnt(0)
  v_cvt_pk_bf16_f32 v110, v92, v93
  v_cvt_pk_bf16_f32 v111, v94, v95
  v_mfma_f32_16x16x32_bf16 v[80:83], v[112:115], v[164:167], 0
  s_barrier
  v_exp_f32 v64, v64
  v_mfma_f32_16x16x32_bf16 v[84:87], v[116:119], v[164:167], 0
  ds_read_b128 v[192:195], v10 offset:16384
  ds_read_b128 v[196:199], v10 offset:17408
  v_exp_f32 v65, v65
  v_exp_f32 v66, v66
  v_exp_f32 v67, v67
  v_cvt_pk_bf16_f32 v96, v64, v65
  v_mfma_f32_16x16x32_bf16 v[88:91], v[120:123], v[164:167], 0
  ds_read_b128 v[200:203], v10 offset:18432
  ds_read_b128 v[204:207], v10 offset:19456
  v_exp_f32 v68, v68
  v_mfma_f32_16x16x32_bf16 v[92:95], v[124:127], v[164:167], 0
  v_exp_f32 v69, v69
  v_exp_f32 v70, v70
  v_exp_f32 v71, v71
  v_exp_f32 v72, v72
  v_cvt_pk_bf16_f32 v97, v66, v67
  v_cvt_pk_bf16_f32 v98, v68, v69
  v_cvt_pk_bf16_f32 v99, v70, v71
  v_mfma_f32_16x16x32_bf16 v[24:27], v[208:211], v[104:107], v[24:27]
  v_exp_f32 v73, v73
  v_mfma_f32_16x16x32_bf16 v[24:27], v[212:215], v[108:111], v[24:27]
  v_exp_f32 v74, v74
  v_mfma_f32_16x16x32_bf16 v[28:31], v[220:223], v[108:111], v[28:31]
  v_exp_f32 v75, v75
  v_mfma_f32_16x16x32_bf16 v[28:31], v[216:219], v[104:107], v[28:31]
  v_exp_f32 v76, v76
  v_exp_f32 v77, v77
  v_cvt_pk_bf16_f32 v100, v72, v73
  v_cvt_pk_bf16_f32 v101, v74, v75
  v_smfmac_f32_16x16x64_bf16 v[52:55], v[144:147], v[104:111], v148
  v_exp_f32 v78, v78
  v_exp_f32 v79, v79
  s_waitcnt lgkmcnt(0)
  v_cvt_pk_bf16_f32 v102, v76, v77
  v_cvt_pk_bf16_f32 v103, v78, v79
  v_mfma_f32_16x16x32_bf16 v[64:67], v[192:195], v[160:163], 0
  v_exp_f32 v80, v80
  v_mfma_f32_16x16x32_bf16 v[68:71], v[196:199], v[160:163], 0
  ds_read_b128 v[208:211], v10 offset:20480
  ds_read_b128 v[212:215], v10 offset:21504
  v_exp_f32 v81, v81
  v_exp_f32 v82, v82
  v_exp_f32 v83, v83
  v_cvt_pk_bf16_f32 v104, v80, v81
  v_mfma_f32_16x16x32_bf16 v[72:75], v[200:203], v[160:163], 0
  ds_read_b128 v[216:219], v10 offset:22528
  ds_read_b128 v[220:223], v10 offset:23552
  v_exp_f32 v84, v84
  v_mfma_f32_16x16x32_bf16 v[76:79], v[204:207], v[160:163], 0
  v_exp_f32 v85, v85
  v_exp_f32 v86, v86
  v_exp_f32 v87, v87
  v_exp_f32 v88, v88
  v_cvt_pk_bf16_f32 v105, v82, v83
  v_cvt_pk_bf16_f32 v106, v84, v85
  v_cvt_pk_bf16_f32 v107, v86, v87
  v_mfma_f32_16x16x32_bf16 v[16:19], v[128:131], v[96:99], v[16:19]
  v_exp_f32 v89, v89
  v_mfma_f32_16x16x32_bf16 v[16:19], v[132:135], v[100:103], v[16:19]
  v_exp_f32 v90, v90
  v_mfma_f32_16x16x32_bf16 v[20:23], v[140:143], v[100:103], v[20:23]
  v_exp_f32 v91, v91
  v_mfma_f32_16x16x32_bf16 v[20:23], v[136:139], v[96:99], v[20:23]
  v_exp_f32 v92, v92
  v_exp_f32 v93, v93
  v_cvt_pk_bf16_f32 v108, v88, v89
  v_cvt_pk_bf16_f32 v109, v90, v91
  v_smfmac_f32_16x16x64_bf16 v[48:51], v[144:147], v[96:103], v148
  v_exp_f32 v94, v94
  v_exp_f32 v95, v95
  s_waitcnt lgkmcnt(0)
  v_cvt_pk_bf16_f32 v110, v92, v93
  v_cvt_pk_bf16_f32 v111, v94, v95
  v_mfma_f32_16x16x32_bf16 v[80:83], v[192:195], v[164:167], 0
  v_exp_f32 v64, v64
  v_mfma_f32_16x16x32_bf16 v[84:87], v[196:199], v[164:167], 0
  ds_read_b128 v[112:115], v10 offset:24576
  ds_read_b128 v[116:119], v10 offset:25600
  v_exp_f32 v65, v65
  v_exp_f32 v66, v66
  v_exp_f32 v67, v67
  v_cvt_pk_bf16_f32 v96, v64, v65
  v_mfma_f32_16x16x32_bf16 v[88:91], v[200:203], v[164:167], 0
  ds_read_b128 v[120:123], v10 offset:26624
  ds_read_b128 v[124:127], v10 offset:27648
  v_exp_f32 v68, v68
  v_mfma_f32_16x16x32_bf16 v[92:95], v[204:207], v[164:167], 0
  v_exp_f32 v69, v69
  v_exp_f32 v70, v70
  v_exp_f32 v71, v71
  v_exp_f32 v72, v72
  v_cvt_pk_bf16_f32 v97, v66, v67
  v_cvt_pk_bf16_f32 v98, v68, v69
  v_cvt_pk_bf16_f32 v99, v70, v71
  v_mfma_f32_16x16x32_bf16 v[24:27], v[128:131], v[104:107], v[24:27]
  v_exp_f32 v73, v73
  v_mfma_f32_16x16x32_bf16 v[24:27], v[132:135], v[108:111], v[24:27]
  v_exp_f32 v74, v74
  v_mfma_f32_16x16x32_bf16 v[28:31], v[140:143], v[108:111], v[28:31]
  v_exp_f32 v75, v75
  v_mfma_f32_16x16x32_bf16 v[28:31], v[136:139], v[104:107], v[28:31]
  v_exp_f32 v76, v76
  v_exp_f32 v77, v77
  v_cvt_pk_bf16_f32 v100, v72, v73
  v_cvt_pk_bf16_f32 v101, v74, v75
  v_smfmac_f32_16x16x64_bf16 v[52:55], v[144:147], v[104:111], v148
  v_exp_f32 v78, v78
  v_exp_f32 v79, v79
  s_waitcnt lgkmcnt(0)
  v_cvt_pk_bf16_f32 v102, v76, v77
  v_cvt_pk_bf16_f32 v103, v78, v79
  v_mfma_f32_16x16x32_bf16 v[64:67], v[112:115], v[160:163], 0
  v_exp_f32 v80, v80
  v_mfma_f32_16x16x32_bf16 v[68:71], v[116:119], v[160:163], 0
  ds_read_b128 v[128:131], v10 offset:28672
  ds_read_b128 v[132:135], v10 offset:29696
  v_exp_f32 v81, v81
  v_exp_f32 v82, v82
  v_exp_f32 v83, v83
  v_cvt_pk_bf16_f32 v104, v80, v81
  v_mfma_f32_16x16x32_bf16 v[72:75], v[120:123], v[160:163], 0
  ds_read_b128 v[136:139], v10 offset:30720
  ds_read_b128 v[140:143], v10 offset:31744
L_pad_1088:
  s_cbranch_execz L_pad_1156
  v_exp_f32 v84, v84
  v_mfma_f32_16x16x32_bf16 v[76:79], v[124:127], v[160:163], 0
  v_exp_f32 v85, v85
  v_exp_f32 v86, v86
  v_exp_f32 v87, v87
  v_exp_f32 v88, v88
  v_cvt_pk_bf16_f32 v105, v82, v83
  v_cvt_pk_bf16_f32 v106, v84, v85
  v_cvt_pk_bf16_f32 v107, v86, v87
  v_mfma_f32_16x16x32_bf16 v[16:19], v[208:211], v[96:99], v[16:19]
  v_exp_f32 v89, v89
  v_mfma_f32_16x16x32_bf16 v[16:19], v[212:215], v[100:103], v[16:19]
  v_exp_f32 v90, v90
  v_mfma_f32_16x16x32_bf16 v[20:23], v[220:223], v[100:103], v[20:23]
  v_exp_f32 v91, v91
  v_mfma_f32_16x16x32_bf16 v[20:23], v[216:219], v[96:99], v[20:23]
  v_exp_f32 v92, v92
  v_exp_f32 v93, v93
  v_cvt_pk_bf16_f32 v108, v88, v89
  v_cvt_pk_bf16_f32 v109, v90, v91
  v_smfmac_f32_16x16x64_bf16 v[48:51], v[144:147], v[96:103], v148
  v_exp_f32 v94, v94
  v_exp_f32 v95, v95
  s_waitcnt lgkmcnt(0)
  v_cvt_pk_bf16_f32 v110, v92, v93
  v_cvt_pk_bf16_f32 v111, v94, v95
  v_mfma_f32_16x16x32_bf16 v[80:83], v[112:115], v[164:167], 0
  s_barrier
  v_exp_f32 v64, v64
  v_mfma_f32_16x16x32_bf16 v[84:87], v[116:119], v[164:167], 0
  ds_read_b128 v[192:195], v10 offset:0
  ds_read_b128 v[196:199], v10 offset:1024
  v_exp_f32 v65, v65
  v_exp_f32 v66, v66
  v_exp_f32 v67, v67
  v_cvt_pk_bf16_f32 v96, v64, v65
  v_mfma_f32_16x16x32_bf16 v[88:91], v[120:123], v[164:167], 0
  ds_read_b128 v[200:203], v10 offset:2048
  ds_read_b128 v[204:207], v10 offset:3072
  v_exp_f32 v68, v68
  v_mfma_f32_16x16x32_bf16 v[92:95], v[124:127], v[164:167], 0
  v_exp_f32 v69, v69
  v_exp_f32 v70, v70
  v_exp_f32 v71, v71
  v_exp_f32 v72, v72
  v_cvt_pk_bf16_f32 v97, v66, v67
  v_cvt_pk_bf16_f32 v98, v68, v69
  v_cvt_pk_bf16_f32 v99, v70, v71
  v_mfma_f32_16x16x32_bf16 v[24:27], v[208:211], v[104:107], v[24:27]
  v_exp_f32 v73, v73
  v_mfma_f32_16x16x32_bf16 v[24:27], v[212:215], v[108:111], v[24:27]
  v_exp_f32 v74, v74
  v_mfma_f32_16x16x32_bf16 v[28:31], v[220:223], v[108:111], v[28:31]
  v_exp_f32 v75, v75
  v_mfma_f32_16x16x32_bf16 v[28:31], v[216:219], v[104:107], v[28:31]
  v_exp_f32 v76, v76
  v_exp_f32 v77, v77
  v_cvt_pk_bf16_f32 v100, v72, v73
  v_cvt_pk_bf16_f32 v101, v74, v75
  v_smfmac_f32_16x16x64_bf16 v[52:55], v[144:147], v[104:111], v148
  v_exp_f32 v78, v78
  v_exp_f32 v79, v79
  s_waitcnt lgkmcnt(0)
  v_cvt_pk_bf16_f32 v102, v76, v77
  v_cvt_pk_bf16_f32 v103, v78, v79
  v_mfma_f32_16x16x32_bf16 v[64:67], v[192:195], v[160:163], 0
  v_exp_f32 v80, v80
  v_mfma_f32_16x16x32_bf16 v[68:71], v[196:199], v[160:163], 0
  ds_read_b128 v[208:211], v10 offset:4096
  ds_read_b128 v[212:215], v10 offset:5120
  v_exp_f32 v81, v81
  v_exp_f32 v82, v82
  v_exp_f32 v83, v83
  v_cvt_pk_bf16_f32 v104, v80, v81
  v_mfma_f32_16x16x32_bf16 v[72:75], v[200:203], v[160:163], 0
  ds_read_b128 v[216:219], v10 offset:6144
  ds_read_b128 v[220:223], v10 offset:7168
  v_exp_f32 v84, v84
  v_mfma_f32_16x16x32_bf16 v[76:79], v[204:207], v[160:163], 0
  v_exp_f32 v85, v85
  v_exp_f32 v86, v86
  v_exp_f32 v87, v87
  v_exp_f32 v88, v88
  v_cvt_pk_bf16_f32 v105, v82, v83
  v_cvt_pk_bf16_f32 v106, v84, v85
  v_cvt_pk_bf16_f32 v107, v86, v87
  v_mfma_f32_16x16x32_bf16 v[16:19], v[128:131], v[96:99], v[16:19]
  v_exp_f32 v89, v89
  v_mfma_f32_16x16x32_bf16 v[16:19], v[132:135], v[100:103], v[16:19]
  v_exp_f32 v90, v90
  v_mfma_f32_16x16x32_bf16 v[20:23], v[140:143], v[100:103], v[20:23]
  v_exp_f32 v91, v91
  v_mfma_f32_16x16x32_bf16 v[20:23], v[136:139], v[96:99], v[20:23]
  v_exp_f32 v92, v92
  v_exp_f32 v93, v93
  v_cvt_pk_bf16_f32 v108, v88, v89
  v_cvt_pk_bf16_f32 v109, v90, v91
  v_smfmac_f32_16x16x64_bf16 v[48:51], v[144:147], v[96:103], v148
  v_exp_f32 v94, v94
  v_exp_f32 v95, v95
  s_waitcnt lgkmcnt(0)
  v_cvt_pk_bf16_f32 v110, v92, v93
  v_cvt_pk_bf16_f32 v111, v94, v95
  v_mfma_f32_16x16x32_bf16 v[80:83], v[192:195], v[164:167], 0
  v_exp_f32 v64, v64
  v_mfma_f32_16x16x32_bf16 v[84:87], v[196:199], v[164:167], 0
  ds_read_b128 v[112:115], v10 offset:8192
  ds_read_b128 v[116:119], v10 offset:9216
  v_exp_f32 v65, v65
  v_exp_f32 v66, v66
  v_exp_f32 v67, v67
  v_cvt_pk_bf16_f32 v96, v64, v65
  v_mfma_f32_16x16x32_bf16 v[88:91], v[200:203], v[164:167], 0
  ds_read_b128 v[120:123], v10 offset:10240
  ds_read_b128 v[124:127], v10 offset:11264
  v_exp_f32 v68, v68
  v_mfma_f32_16x16x32_bf16 v[92:95], v[204:207], v[164:167], 0
  v_exp_f32 v69, v69
  v_exp_f32 v70, v70
  v_exp_f32 v71, v71
  v_exp_f32 v72, v72
  v_cvt_pk_bf16_f32 v97, v66, v67
  v_cvt_pk_bf16_f32 v98, v68, v69
  v_cvt_pk_bf16_f32 v99, v70, v71
  v_mfma_f32_16x16x32_bf16 v[24:27], v[128:131], v[104:107], v[24:27]
  v_exp_f32 v73, v73
  v_mfma_f32_16x16x32_bf16 v[24:27], v[132:135], v[108:111], v[24:27]
  v_exp_f32 v74, v74
  v_mfma_f32_16x16x32_bf16 v[28:31], v[140:143], v[108:111], v[28:31]
  v_exp_f32 v75, v75
  v_mfma_f32_16x16x32_bf16 v[28:31], v[136:139], v[104:107], v[28:31]
  v_exp_f32 v76, v76
  v_exp_f32 v77, v77
  v_cvt_pk_bf16_f32 v100, v72, v73
  v_cvt_pk_bf16_f32 v101, v74, v75
  v_smfmac_f32_16x16x64_bf16 v[52:55], v[144:147], v[104:111], v148
  v_exp_f32 v78, v78
  v_exp_f32 v79, v79
  s_waitcnt lgkmcnt(0)
  v_cvt_pk_bf16_f32 v102, v76, v77
  v_cvt_pk_bf16_f32 v103, v78, v79
  v_mfma_f32_16x16x32_bf16 v[64:67], v[112:115], v[160:163], 0
  v_exp_f32 v80, v80
  v_mfma_f32_16x16x32_bf16 v[68:71], v[116:119], v[160:163], 0
  ds_read_b128 v[128:131], v10 offset:12288
  ds_read_b128 v[132:135], v10 offset:13312
  v_exp_f32 v81, v81
  v_exp_f32 v82, v82
  v_exp_f32 v83, v83
  v_cvt_pk_bf16_f32 v104, v80, v81
  v_mfma_f32_16x16x32_bf16 v[72:75], v[120:123], v[160:163], 0
  ds_read_b128 v[136:139], v10 offset:14336
  ds_read_b128 v[140:143], v10 offset:15360
  v_exp_f32 v84, v84
  v_mfma_f32_16x16x32_bf16 v[76:79], v[124:127], v[160:163], 0
  v_exp_f32 v85, v85
  v_exp_f32 v86, v86
  v_exp_f32 v87, v87
  v_exp_f32 v88, v88
  v_cvt_pk_bf16_f32 v105, v82, v83
  v_cvt_pk_bf16_f32 v106, v84, v85
  v_cvt_pk_bf16_f32 v107, v86, v87
  v_mfma_f32_16x16x32_bf16 v[16:19], v[208:211], v[96:99], v[16:19]
  v_exp_f32 v89, v89
  v_mfma_f32_16x16x32_bf16 v[16:19], v[212:215], v[100:103], v[16:19]
  v_exp_f32 v90, v90
  v_mfma_f32_16x16x32_bf16 v[20:23], v[220:223], v[100:103], v[20:23]
  v_exp_f32 v91, v91
  v_mfma_f32_16x16x32_bf16 v[20:23], v[216:219], v[96:99], v[20:23]
  v_exp_f32 v92, v92
  v_exp_f32 v93, v93
  v_cvt_pk_bf16_f32 v108, v88, v89
  v_cvt_pk_bf16_f32 v109, v90, v91
  v_smfmac_f32_16x16x64_bf16 v[48:51], v[144:147], v[96:103], v148
  v_exp_f32 v94, v94
  v_exp_f32 v95, v95
L_pad_1105:
  s_cbranch_execz L_pad_1173
  s_waitcnt lgkmcnt(0)
  v_cvt_pk_bf16_f32 v110, v92, v93
  v_cvt_pk_bf16_f32 v111, v94, v95
  v_mfma_f32_16x16x32_bf16 v[80:83], v[112:115], v[164:167], 0
  v_exp_f32 v64, v64
  v_mfma_f32_16x16x32_bf16 v[84:87], v[116:119], v[164:167], 0
  ds_read_b128 v[192:195], v10 offset:32768
  ds_read_b128 v[196:199], v10 offset:33792
  v_exp_f32 v65, v65
  v_exp_f32 v66, v66
  v_exp_f32 v67, v67
  v_cvt_pk_bf16_f32 v96, v64, v65
  v_mfma_f32_16x16x32_bf16 v[88:91], v[120:123], v[164:167], 0
  ds_read_b128 v[200:203], v10 offset:34816
  ds_read_b128 v[204:207], v10 offset:35840
  v_exp_f32 v68, v68
  v_mfma_f32_16x16x32_bf16 v[92:95], v[124:127], v[164:167], 0
  v_exp_f32 v69, v69
  v_exp_f32 v70, v70
  v_exp_f32 v71, v71
  v_exp_f32 v72, v72
  v_cvt_pk_bf16_f32 v97, v66, v67
  v_cvt_pk_bf16_f32 v98, v68, v69
  v_cvt_pk_bf16_f32 v99, v70, v71
  v_mfma_f32_16x16x32_bf16 v[24:27], v[208:211], v[104:107], v[24:27]
  v_exp_f32 v73, v73
  v_mfma_f32_16x16x32_bf16 v[24:27], v[212:215], v[108:111], v[24:27]
  v_exp_f32 v74, v74
  v_mfma_f32_16x16x32_bf16 v[28:31], v[220:223], v[108:111], v[28:31]
  v_exp_f32 v75, v75
  v_mfma_f32_16x16x32_bf16 v[28:31], v[216:219], v[104:107], v[28:31]
  v_exp_f32 v76, v76
  v_exp_f32 v77, v77
  v_cvt_pk_bf16_f32 v100, v72, v73
  v_cvt_pk_bf16_f32 v101, v74, v75
  v_smfmac_f32_16x16x64_bf16 v[52:55], v[144:147], v[104:111], v148
  v_exp_f32 v78, v78
  v_exp_f32 v79, v79
  s_waitcnt lgkmcnt(0)
  v_cvt_pk_bf16_f32 v102, v76, v77
  v_cvt_pk_bf16_f32 v103, v78, v79
  v_mfma_f32_16x16x32_bf16 v[64:67], v[192:195], v[168:171], 0
  v_exp_f32 v80, v80
  v_mfma_f32_16x16x32_bf16 v[68:71], v[196:199], v[168:171], 0
  ds_read_b128 v[208:211], v10 offset:36864
  ds_read_b128 v[212:215], v10 offset:37888
  v_exp_f32 v81, v81
  v_exp_f32 v82, v82
  v_exp_f32 v83, v83
  v_cvt_pk_bf16_f32 v104, v80, v81
  v_mfma_f32_16x16x32_bf16 v[72:75], v[200:203], v[168:171], 0
  ds_read_b128 v[216:219], v10 offset:38912
  ds_read_b128 v[220:223], v10 offset:39936
  v_exp_f32 v84, v84
  v_mfma_f32_16x16x32_bf16 v[76:79], v[204:207], v[168:171], 0
  v_exp_f32 v85, v85
  v_exp_f32 v86, v86
  v_exp_f32 v87, v87
  v_exp_f32 v88, v88
  v_cvt_pk_bf16_f32 v105, v82, v83
  v_cvt_pk_bf16_f32 v106, v84, v85
  v_cvt_pk_bf16_f32 v107, v86, v87
  v_mfma_f32_16x16x32_bf16 v[16:19], v[128:131], v[96:99], v[16:19]
  v_exp_f32 v89, v89
  v_mfma_f32_16x16x32_bf16 v[16:19], v[132:135], v[100:103], v[16:19]
  v_exp_f32 v90, v90
  v_mfma_f32_16x16x32_bf16 v[20:23], v[140:143], v[100:103], v[20:23]
  v_exp_f32 v91, v91
  v_mfma_f32_16x16x32_bf16 v[20:23], v[136:139], v[96:99], v[20:23]
  v_exp_f32 v92, v92
  v_exp_f32 v93, v93
  v_cvt_pk_bf16_f32 v108, v88, v89
  v_cvt_pk_bf16_f32 v109, v90, v91
  v_smfmac_f32_16x16x64_bf16 v[48:51], v[144:147], v[96:103], v148
  v_exp_f32 v94, v94
  v_exp_f32 v95, v95
  s_waitcnt lgkmcnt(0)
  v_cvt_pk_bf16_f32 v110, v92, v93
  v_cvt_pk_bf16_f32 v111, v94, v95
  v_mfma_f32_16x16x32_bf16 v[80:83], v[192:195], v[172:175], 0
  v_exp_f32 v64, v64
  v_mfma_f32_16x16x32_bf16 v[84:87], v[196:199], v[172:175], 0
  ds_read_b128 v[112:115], v10 offset:40960
  ds_read_b128 v[116:119], v10 offset:41984
  v_exp_f32 v65, v65
  v_exp_f32 v66, v66
  v_exp_f32 v67, v67
  v_cvt_pk_bf16_f32 v96, v64, v65
  v_mfma_f32_16x16x32_bf16 v[88:91], v[200:203], v[172:175], 0
  ds_read_b128 v[120:123], v10 offset:43008
  ds_read_b128 v[124:127], v10 offset:44032
  v_exp_f32 v68, v68
  v_mfma_f32_16x16x32_bf16 v[92:95], v[204:207], v[172:175], 0
  v_exp_f32 v69, v69
  v_exp_f32 v70, v70
  v_exp_f32 v71, v71
  v_exp_f32 v72, v72
  v_cvt_pk_bf16_f32 v97, v66, v67
  v_cvt_pk_bf16_f32 v98, v68, v69
  v_cvt_pk_bf16_f32 v99, v70, v71
  v_mfma_f32_16x16x32_bf16 v[24:27], v[128:131], v[104:107], v[24:27]
  v_exp_f32 v73, v73
  v_mfma_f32_16x16x32_bf16 v[24:27], v[132:135], v[108:111], v[24:27]
  v_exp_f32 v74, v74
  v_mfma_f32_16x16x32_bf16 v[28:31], v[140:143], v[108:111], v[28:31]
  v_exp_f32 v75, v75
  v_mfma_f32_16x16x32_bf16 v[28:31], v[136:139], v[104:107], v[28:31]
  v_exp_f32 v76, v76
  v_exp_f32 v77, v77
  v_cvt_pk_bf16_f32 v100, v72, v73
  v_cvt_pk_bf16_f32 v101, v74, v75
  v_smfmac_f32_16x16x64_bf16 v[52:55], v[144:147], v[104:111], v148
  v_exp_f32 v78, v78
  v_exp_f32 v79, v79
  s_waitcnt lgkmcnt(0)
  v_cvt_pk_bf16_f32 v102, v76, v77
  v_cvt_pk_bf16_f32 v103, v78, v79
  v_mfma_f32_16x16x32_bf16 v[64:67], v[112:115], v[168:171], 0
  v_exp_f32 v80, v80
  v_mfma_f32_16x16x32_bf16 v[68:71], v[116:119], v[168:171], 0
  ds_read_b128 v[128:131], v10 offset:45056
  ds_read_b128 v[132:135], v10 offset:46080
  v_exp_f32 v81, v81
  v_exp_f32 v82, v82
  v_exp_f32 v83, v83
  v_cvt_pk_bf16_f32 v104, v80, v81
  v_mfma_f32_16x16x32_bf16 v[72:75], v[120:123], v[168:171], 0
  ds_read_b128 v[136:139], v10 offset:47104
  ds_read_b128 v[140:143], v10 offset:48128
  v_exp_f32 v84, v84
  v_mfma_f32_16x16x32_bf16 v[76:79], v[124:127], v[168:171], 0
  v_exp_f32 v85, v85
  v_exp_f32 v86, v86
  v_exp_f32 v87, v87
  v_exp_f32 v88, v88
  v_cvt_pk_bf16_f32 v105, v82, v83
  v_cvt_pk_bf16_f32 v106, v84, v85
  v_cvt_pk_bf16_f32 v107, v86, v87
  v_mfma_f32_16x16x32_bf16 v[32:35], v[208:211], v[96:99], v[32:35]
  v_exp_f32 v89, v89
  v_mfma_f32_16x16x32_bf16 v[32:35], v[212:215], v[100:103], v[32:35]
  v_exp_f32 v90, v90
  v_mfma_f32_16x16x32_bf16 v[36:39], v[220:223], v[100:103], v[36:39]
  v_exp_f32 v91, v91
  v_mfma_f32_16x16x32_bf16 v[36:39], v[216:219], v[96:99], v[36:39]
  v_add_f32 v4, v48, v49
  v_add_f32 v5, v52, v53
  v_min_f32 v2, v4, v5
  v_add_f32 v3, v4, v5
  v_cmp_le_f32 vcc, s28, v2
  v_cmp_ge_f32 s[14:15], s29, v3
  s_mov_b32 s68, 0
  s_and_b64 vcc, vcc, s[14:15]
  s_cmp_eq_u64 vcc, exec
  s_cbranch_scc0 L_a_slow
  v_rcp_f32 v4, v4
  v_rcp_f32 v5, v5
  v_mul_f32 v16, v4, v16
  v_mul_f32 v17, v4, v17
  v_mul_f32 v18, v4, v18
  v_mul_f32 v19, v4, v19
  v_mul_f32 v20, v4, v20
  v_mul_f32 v21, v4, v21
  v_mul_f32 v22, v4, v22
  v_mul_f32 v23, v4, v23
  v_cvt_pk_bf16_f32 v16, v16, v17
  v_cvt_pk_bf16_f32 v17, v18, v19
  v_cvt_pk_bf16_f32 v18, v20, v21
  v_cvt_pk_bf16_f32 v19, v22, v23
  buffer_store_dwordx4 v[16:19], v10, s[64:67], s16 offen sc1
  v_mul_f32 v24, v5, v24
  v_mul_f32 v25, v5, v25
  v_mul_f32 v26, v5, v26
  v_mul_f32 v27, v5, v27
  v_mul_f32 v28, v5, v28
  v_mul_f32 v29, v5, v29
  v_mul_f32 v30, v5, v30
  v_mul_f32 v31, v5, v31
  v_cvt_pk_bf16_f32 v24, v24, v25
  v_cvt_pk_bf16_f32 v25, v26, v27
  v_cvt_pk_bf16_f32 v26, v28, v29
L_pad_1122:
  s_cbranch_execz L_pad_1190
  v_cvt_pk_bf16_f32 v27, v30, v31
  buffer_store_dwordx4 v[24:27], v248, s[64:67], s16 offen sc1
  v_exp_f32 v92, v92
  v_exp_f32 v93, v93
  v_cvt_pk_bf16_f32 v108, v88, v89
  v_cvt_pk_bf16_f32 v109, v90, v91
  v_smfmac_f32_16x16x64_bf16 v[56:59], v[144:147], v[96:103], v148
  v_exp_f32 v94, v94
  v_exp_f32 v95, v95
  s_waitcnt lgkmcnt(0)
  v_cvt_pk_bf16_f32 v110, v92, v93
  v_cvt_pk_bf16_f32 v111, v94, v95
  v_mfma_f32_16x16x32_bf16 v[80:83], v[112:115], v[172:175], 0
  s_barrier
  v_exp_f32 v64, v64
  v_mfma_f32_16x16x32_bf16 v[84:87], v[116:119], v[172:175], 0
  ds_read_b128 v[192:195], v10 offset:16384
  ds_read_b128 v[196:199], v10 offset:17408
  v_exp_f32 v65, v65
  v_exp_f32 v66, v66
  v_exp_f32 v67, v67
  v_cvt_pk_bf16_f32 v96, v64, v65
  v_mfma_f32_16x16x32_bf16 v[88:91], v[120:123], v[172:175], 0
  ds_read_b128 v[200:203], v10 offset:18432
  ds_read_b128 v[204:207], v10 offset:19456
  v_exp_f32 v68, v68
  v_mfma_f32_16x16x32_bf16 v[92:95], v[124:127], v[172:175], 0
  v_exp_f32 v69, v69
  v_exp_f32 v70, v70
  v_exp_f32 v71, v71
  v_exp_f32 v72, v72
  v_cvt_pk_bf16_f32 v97, v66, v67
  v_cvt_pk_bf16_f32 v98, v68, v69
  v_cvt_pk_bf16_f32 v99, v70, v71
  v_mfma_f32_16x16x32_bf16 v[40:43], v[208:211], v[104:107], v[40:43]
  v_exp_f32 v73, v73
  v_mfma_f32_16x16x32_bf16 v[40:43], v[212:215], v[108:111], v[40:43]
  v_exp_f32 v74, v74
  v_mfma_f32_16x16x32_bf16 v[44:47], v[220:223], v[108:111], v[44:47]
  v_exp_f32 v75, v75
  v_mfma_f32_16x16x32_bf16 v[44:47], v[216:219], v[104:107], v[44:47]
  v_exp_f32 v76, v76
  v_exp_f32 v77, v77
  v_cvt_pk_bf16_f32 v100, v72, v73
  v_cvt_pk_bf16_f32 v101, v74, v75
  v_smfmac_f32_16x16x64_bf16 v[60:63], v[144:147], v[104:111], v148
  v_exp_f32 v78, v78
  v_exp_f32 v79, v79
  s_waitcnt lgkmcnt(0)
  v_cvt_pk_bf16_f32 v102, v76, v77
  v_cvt_pk_bf16_f32 v103, v78, v79
  v_mfma_f32_16x16x32_bf16 v[64:67], v[192:195], v[168:171], 0
  v_exp_f32 v80, v80
  v_mfma_f32_16x16x32_bf16 v[68:71], v[196:199], v[168:171], 0
  ds_read_b128 v[208:211], v10 offset:20480
  ds_read_b128 v[212:215], v10 offset:21504
  v_exp_f32 v81, v81
  v_exp_f32 v82, v82
  v_exp_f32 v83, v83
  v_cvt_pk_bf16_f32 v104, v80, v81
  v_mfma_f32_16x16x32_bf16 v[72:75], v[200:203], v[168:171], 0
  ds_read_b128 v[216:219], v10 offset:22528
  ds_read_b128 v[220:223], v10 offset:23552
  v_exp_f32 v84, v84
  v_mfma_f32_16x16x32_bf16 v[76:79], v[204:207], v[168:171], 0
  v_exp_f32 v85, v85
  v_exp_f32 v86, v86
  v_exp_f32 v87, v87
  v_exp_f32 v88, v88
  v_cvt_pk_bf16_f32 v105, v82, v83
  v_cvt_pk_bf16_f32 v106, v84, v85
  v_cvt_pk_bf16_f32 v107, v86, v87
  v_mfma_f32_16x16x32_bf16 v[32:35], v[128:131], v[96:99], v[32:35]
  v_exp_f32 v89, v89
  v_mfma_f32_16x16x32_bf16 v[32:35], v[132:135], v[100:103], v[32:35]
  v_exp_f32 v90, v90
  v_mfma_f32_16x16x32_bf16 v[36:39], v[140:143], v[100:103], v[36:39]
  v_exp_f32 v91, v91
  v_mfma_f32_16x16x32_bf16 v[36:39], v[136:139], v[96:99], v[36:39]
  v_exp_f32 v92, v92
  v_exp_f32 v93, v93
  v_cvt_pk_bf16_f32 v108, v88, v89
  v_cvt_pk_bf16_f32 v109, v90, v91
  v_smfmac_f32_16x16x64_bf16 v[56:59], v[144:147], v[96:103], v148
  v_exp_f32 v94, v94
  v_exp_f32 v95, v95
  s_waitcnt lgkmcnt(0)
  v_cvt_pk_bf16_f32 v110, v92, v93
  v_cvt_pk_bf16_f32 v111, v94, v95
  v_mfma_f32_16x16x32_bf16 v[80:83], v[192:195], v[172:175], 0
  v_exp_f32 v64, v64
  v_mfma_f32_16x16x32_bf16 v[84:87], v[196:199], v[172:175], 0
  ds_read_b128 v[112:115], v10 offset:24576
  ds_read_b128 v[116:119], v10 offset:25600
  v_exp_f32 v65, v65
  v_exp_f32 v66, v66
  v_exp_f32 v67, v67
  v_cvt_pk_bf16_f32 v96, v64, v65
  v_mfma_f32_16x16x32_bf16 v[88:91], v[200:203], v[172:175], 0
  ds_read_b128 v[120:123], v10 offset:26624
  ds_read_b128 v[124:127], v10 offset:27648
  v_exp_f32 v68, v68
  v_mfma_f32_16x16x32_bf16 v[92:95], v[204:207], v[172:175], 0
  v_exp_f32 v69, v69
  v_exp_f32 v70, v70
  v_exp_f32 v71, v71
  v_exp_f32 v72, v72
  v_cvt_pk_bf16_f32 v97, v66, v67
  v_cvt_pk_bf16_f32 v98, v68, v69
  v_cvt_pk_bf16_f32 v99, v70, v71
  v_mfma_f32_16x16x32_bf16 v[40:43], v[128:131], v[104:107], v[40:43]
  v_exp_f32 v73, v73
  v_mfma_f32_16x16x32_bf16 v[40:43], v[132:135], v[108:111], v[40:43]
  v_exp_f32 v74, v74
  v_mfma_f32_16x16x32_bf16 v[44:47], v[140:143], v[108:111], v[44:47]
  v_exp_f32 v75, v75
  v_mfma_f32_16x16x32_bf16 v[44:47], v[136:139], v[104:107], v[44:47]
  v_exp_f32 v76, v76
  v_exp_f32 v77, v77
  v_cvt_pk_bf16_f32 v100, v72, v73
  v_cvt_pk_bf16_f32 v101, v74, v75
  v_smfmac_f32_16x16x64_bf16 v[60:63], v[144:147], v[104:111], v148
  v_exp_f32 v78, v78
  v_exp_f32 v79, v79
  s_waitcnt lgkmcnt(0)
  v_cvt_pk_bf16_f32 v102, v76, v77
  v_cvt_pk_bf16_f32 v103, v78, v79
  v_mfma_f32_16x16x32_bf16 v[64:67], v[112:115], v[168:171], 0
  v_exp_f32 v80, v80
  v_mfma_f32_16x16x32_bf16 v[68:71], v[116:119], v[168:171], 0
  ds_read_b128 v[128:131], v10 offset:28672
  ds_read_b128 v[132:135], v10 offset:29696
  v_exp_f32 v81, v81
  v_exp_f32 v82, v82
  v_exp_f32 v83, v83
  v_cvt_pk_bf16_f32 v104, v80, v81
  v_mfma_f32_16x16x32_bf16 v[72:75], v[120:123], v[168:171], 0
  ds_read_b128 v[136:139], v10 offset:30720
  ds_read_b128 v[140:143], v10 offset:31744
  v_exp_f32 v84, v84
  v_mfma_f32_16x16x32_bf16 v[76:79], v[124:127], v[168:171], 0
  v_exp_f32 v85, v85
  v_exp_f32 v86, v86
  v_exp_f32 v87, v87
  v_exp_f32 v88, v88
  v_cvt_pk_bf16_f32 v105, v82, v83
  v_cvt_pk_bf16_f32 v106, v84, v85
  v_cvt_pk_bf16_f32 v107, v86, v87
  v_mfma_f32_16x16x32_bf16 v[32:35], v[208:211], v[96:99], v[32:35]
  v_exp_f32 v89, v89
  v_mfma_f32_16x16x32_bf16 v[32:35], v[212:215], v[100:103], v[32:35]
  v_exp_f32 v90, v90
  v_mfma_f32_16x16x32_bf16 v[36:39], v[220:223], v[100:103], v[36:39]
  v_exp_f32 v91, v91
  v_mfma_f32_16x16x32_bf16 v[36:39], v[216:219], v[96:99], v[36:39]
  s_waitcnt vmcnt(0)
  s_mov_b64 exec, 1
  v_mov_b32 v2, 0
  v_mov_b32 v3, 1
  buffer_store_dword v3, v2, s[64:67], s69 offen offset:4 sc1
  s_mov_b64 exec, -1
  v_exp_f32 v92, v92
  v_exp_f32 v93, v93
  v_cvt_pk_bf16_f32 v108, v88, v89
  v_cvt_pk_bf16_f32 v109, v90, v91
  v_smfmac_f32_16x16x64_bf16 v[56:59], v[144:147], v[96:103], v148
  v_exp_f32 v94, v94
  v_exp_f32 v95, v95
  s_waitcnt lgkmcnt(0)
  v_cvt_pk_bf16_f32 v110, v92, v93
  v_cvt_pk_bf16_f32 v111, v94, v95
  v_mfma_f32_16x16x32_bf16 v[80:83], v[112:115], v[172:175], 0
  s_barrier
  v_exp_f32 v64, v64
  v_mfma_f32_16x16x32_bf16 v[84:87], v[116:119], v[172:175], 0
  ds_read_b128 v[192:195], v10 offset:0
L_pad_1139:
  s_cbranch_execz L_pad_1207
  ds_read_b128 v[196:199], v10 offset:1024
  v_exp_f32 v65, v65
  v_exp_f32 v66, v66
  v_exp_f32 v67, v67
  v_cvt_pk_bf16_f32 v96, v64, v65
  v_mfma_f32_16x16x32_bf16 v[88:91], v[120:123], v[172:175], 0
  ds_read_b128 v[200:203], v10 offset:2048
  ds_read_b128 v[204:207], v10 offset:3072
  v_exp_f32 v68, v68
  v_mfma_f32_16x16x32_bf16 v[92:95], v[124:127], v[172:175], 0
  v_exp_f32 v69, v69
  v_exp_f32 v70, v70
  v_exp_f32 v71, v71
  v_exp_f32 v72, v72
  v_cvt_pk_bf16_f32 v97, v66, v67
  v_cvt_pk_bf16_f32 v98, v68, v69
  v_cvt_pk_bf16_f32 v99, v70, v71
  v_mfma_f32_16x16x32_bf16 v[40:43], v[208:211], v[104:107], v[40:43]
  v_exp_f32 v73, v73
  v_mfma_f32_16x16x32_bf16 v[40:43], v[212:215], v[108:111], v[40:43]
  v_exp_f32 v74, v74
  v_mfma_f32_16x16x32_bf16 v[44:47], v[220:223], v[108:111], v[44:47]
  v_exp_f32 v75, v75
  v_mfma_f32_16x16x32_bf16 v[44:47], v[216:219], v[104:107], v[44:47]
  v_exp_f32 v76, v76
  v_exp_f32 v77, v77
  v_cvt_pk_bf16_f32 v100, v72, v73
  v_cvt_pk_bf16_f32 v101, v74, v75
  v_smfmac_f32_16x16x64_bf16 v[60:63], v[144:147], v[104:111], v148
  v_exp_f32 v78, v78
  v_exp_f32 v79, v79
  s_waitcnt lgkmcnt(0)
  v_cvt_pk_bf16_f32 v102, v76, v77
  v_cvt_pk_bf16_f32 v103, v78, v79
  v_mfma_f32_16x16x32_bf16 v[64:67], v[192:195], v[168:171], 0
  v_exp_f32 v80, v80
  v_mfma_f32_16x16x32_bf16 v[68:71], v[196:199], v[168:171], 0
  ds_read_b128 v[208:211], v10 offset:4096
  ds_read_b128 v[212:215], v10 offset:5120
  v_exp_f32 v81, v81
  v_exp_f32 v82, v82
  v_exp_f32 v83, v83
  v_cvt_pk_bf16_f32 v104, v80, v81
  v_mfma_f32_16x16x32_bf16 v[72:75], v[200:203], v[168:171], 0
  ds_read_b128 v[216:219], v10 offset:6144
  ds_read_b128 v[220:223], v10 offset:7168
  v_exp_f32 v84, v84
  v_mfma_f32_16x16x32_bf16 v[76:79], v[204:207], v[168:171], 0
  v_exp_f32 v85, v85
  v_exp_f32 v86, v86
  v_exp_f32 v87, v87
  v_exp_f32 v88, v88
  v_cvt_pk_bf16_f32 v105, v82, v83
  v_cvt_pk_bf16_f32 v106, v84, v85
  v_cvt_pk_bf16_f32 v107, v86, v87
  v_mfma_f32_16x16x32_bf16 v[32:35], v[128:131], v[96:99], v[32:35]
  v_exp_f32 v89, v89
  v_mfma_f32_16x16x32_bf16 v[32:35], v[132:135], v[100:103], v[32:35]
  v_exp_f32 v90, v90
  v_mfma_f32_16x16x32_bf16 v[36:39], v[140:143], v[100:103], v[36:39]
  v_exp_f32 v91, v91
  v_mfma_f32_16x16x32_bf16 v[36:39], v[136:139], v[96:99], v[36:39]
  v_exp_f32 v92, v92
  v_exp_f32 v93, v93
  v_cvt_pk_bf16_f32 v108, v88, v89
  v_cvt_pk_bf16_f32 v109, v90, v91
  v_smfmac_f32_16x16x64_bf16 v[56:59], v[144:147], v[96:103], v148
  v_exp_f32 v94, v94
  v_exp_f32 v95, v95
  s_waitcnt lgkmcnt(0)
  v_cvt_pk_bf16_f32 v110, v92, v93
  v_cvt_pk_bf16_f32 v111, v94, v95
  v_mfma_f32_16x16x32_bf16 v[80:83], v[192:195], v[172:175], 0
  v_exp_f32 v64, v64
  v_mfma_f32_16x16x32_bf16 v[84:87], v[196:199], v[172:175], 0
  ds_read_b128 v[112:115], v10 offset:8192
  ds_read_b128 v[116:119], v10 offset:9216
  v_exp_f32 v65, v65
  v_exp_f32 v66, v66
  v_exp_f32 v67, v67
  v_cvt_pk_bf16_f32 v96, v64, v65
  v_mfma_f32_16x16x32_bf16 v[88:91], v[200:203], v[172:175], 0
  ds_read_b128 v[120:123], v10 offset:10240
  ds_read_b128 v[124:127], v10 offset:11264
  v_exp_f32 v68, v68
  v_mfma_f32_16x16x32_bf16 v[92:95], v[204:207], v[172:175], 0
  v_exp_f32 v69, v69
  v_exp_f32 v70, v70
  v_exp_f32 v71, v71
  v_exp_f32 v72, v72
  v_cvt_pk_bf16_f32 v97, v66, v67
  v_cvt_pk_bf16_f32 v98, v68, v69
  v_cvt_pk_bf16_f32 v99, v70, v71
  v_mfma_f32_16x16x32_bf16 v[40:43], v[128:131], v[104:107], v[40:43]
  v_exp_f32 v73, v73
  v_mfma_f32_16x16x32_bf16 v[40:43], v[132:135], v[108:111], v[40:43]
  v_exp_f32 v74, v74
  v_mfma_f32_16x16x32_bf16 v[44:47], v[140:143], v[108:111], v[44:47]
  v_exp_f32 v75, v75
  v_mfma_f32_16x16x32_bf16 v[44:47], v[136:139], v[104:107], v[44:47]
  v_exp_f32 v76, v76
  v_exp_f32 v77, v77
  v_cvt_pk_bf16_f32 v100, v72, v73
  v_cvt_pk_bf16_f32 v101, v74, v75
  v_smfmac_f32_16x16x64_bf16 v[60:63], v[144:147], v[104:111], v148
  v_exp_f32 v78, v78
  v_exp_f32 v79, v79
  s_waitcnt lgkmcnt(0)
  v_cvt_pk_bf16_f32 v102, v76, v77
  v_cvt_pk_bf16_f32 v103, v78, v79
  v_mfma_f32_16x16x32_bf16 v[64:67], v[112:115], v[168:171], 0
  v_exp_f32 v80, v80
  v_mfma_f32_16x16x32_bf16 v[68:71], v[116:119], v[168:171], 0
  ds_read_b128 v[128:131], v10 offset:12288
  ds_read_b128 v[132:135], v10 offset:13312
  v_exp_f32 v81, v81
  v_exp_f32 v82, v82
  v_exp_f32 v83, v83
  v_cvt_pk_bf16_f32 v104, v80, v81
  v_mfma_f32_16x16x32_bf16 v[72:75], v[120:123], v[168:171], 0
  ds_read_b128 v[136:139], v10 offset:14336
  ds_read_b128 v[140:143], v10 offset:15360
  v_exp_f32 v84, v84
  v_mfma_f32_16x16x32_bf16 v[76:79], v[124:127], v[168:171], 0
  v_exp_f32 v85, v85
  v_exp_f32 v86, v86
  v_exp_f32 v87, v87
  v_exp_f32 v88, v88
  v_cvt_pk_bf16_f32 v105, v82, v83
  v_cvt_pk_bf16_f32 v106, v84, v85
  v_cvt_pk_bf16_f32 v107, v86, v87
  v_mfma_f32_16x16x32_bf16 v[32:35], v[208:211], v[96:99], v[32:35]
  v_exp_f32 v89, v89
  v_mfma_f32_16x16x32_bf16 v[32:35], v[212:215], v[100:103], v[32:35]
  v_exp_f32 v90, v90
  v_mfma_f32_16x16x32_bf16 v[36:39], v[220:223], v[100:103], v[36:39]
  v_exp_f32 v91, v91
  v_mfma_f32_16x16x32_bf16 v[36:39], v[216:219], v[96:99], v[36:39]
  v_exp_f32 v92, v92
  v_exp_f32 v93, v93
  v_cvt_pk_bf16_f32 v108, v88, v89
  v_cvt_pk_bf16_f32 v109, v90, v91
  v_smfmac_f32_16x16x64_bf16 v[56:59], v[144:147], v[96:103], v148
  v_exp_f32 v94, v94
  v_exp_f32 v95, v95
  s_waitcnt lgkmcnt(0)
  v_cvt_pk_bf16_f32 v110, v92, v93
  v_cvt_pk_bf16_f32 v111, v94, v95
  v_mfma_f32_16x16x32_bf16 v[80:83], v[112:115], v[172:175], 0
  s_barrier
  v_exp_f32 v64, v64
  v_mfma_f32_16x16x32_bf16 v[84:87], v[116:119], v[172:175], 0
  v_exp_f32 v65, v65
  v_exp_f32 v66, v66
  v_exp_f32 v67, v67
  v_cvt_pk_bf16_f32 v96, v64, v65
  v_mfma_f32_16x16x32_bf16 v[88:91], v[120:123], v[172:175], 0
  v_exp_f32 v68, v68
  v_mfma_f32_16x16x32_bf16 v[92:95], v[124:127], v[172:175], 0
  v_exp_f32 v69, v69
  v_exp_f32 v70, v70
  v_exp_f32 v71, v71
  v_exp_f32 v72, v72
  v_cvt_pk_bf16_f32 v97, v66, v67
  v_cvt_pk_bf16_f32 v98, v68, v69
  v_cvt_pk_bf16_f32 v99, v70, v71
  v_mfma_f32_16x16x32_bf16 v[40:43], v[208:211], v[104:107], v[40:43]
  v_exp_f32 v73, v73
  v_mfma_f32_16x16x32_bf16 v[40:43], v[212:215], v[108:111], v[40:43]
  v_exp_f32 v74, v74
  v_mfma_f32_16x16x32_bf16 v[44:47], v[220:223], v[108:111], v[44:47]
  v_exp_f32 v75, v75
  v_mfma_f32_16x16x32_bf16 v[44:47], v[216:219], v[104:107], v[44:47]
  s_mov_b32 exec_lo, 0xffff
  s_mov_b32 exec_hi, 0
  buffer_load_dword v250, v249, s[64:67], 0 offen offset:4 sc1
  s_mov_b64 exec, -1
L_pad_1156:
  s_cbranch_execz L_pad_1224
  v_exp_f32 v76, v76
  v_exp_f32 v77, v77
  v_cvt_pk_bf16_f32 v100, v72, v73
  v_cvt_pk_bf16_f32 v101, v74, v75
  v_smfmac_f32_16x16x64_bf16 v[60:63], v[144:147], v[104:111], v148
  v_exp_f32 v78, v78
  v_exp_f32 v79, v79
  v_cvt_pk_bf16_f32 v102, v76, v77
  v_cvt_pk_bf16_f32 v103, v78, v79
  v_exp_f32 v80, v80
  v_exp_f32 v81, v81
  v_exp_f32 v82, v82
  v_exp_f32 v83, v83
  v_cvt_pk_bf16_f32 v104, v80, v81
  v_exp_f32 v84, v84
  v_exp_f32 v85, v85
  v_exp_f32 v86, v86
  v_exp_f32 v87, v87
  v_exp_f32 v88, v88
  v_cvt_pk_bf16_f32 v105, v82, v83
  v_cvt_pk_bf16_f32 v106, v84, v85
  v_cvt_pk_bf16_f32 v107, v86, v87
  v_mfma_f32_16x16x32_bf16 v[32:35], v[128:131], v[96:99], v[32:35]
  v_exp_f32 v89, v89
  v_mfma_f32_16x16x32_bf16 v[32:35], v[132:135], v[100:103], v[32:35]
  v_exp_f32 v90, v90
  v_mfma_f32_16x16x32_bf16 v[36:39], v[140:143], v[100:103], v[36:39]
  v_exp_f32 v91, v91
  v_mfma_f32_16x16x32_bf16 v[36:39], v[136:139], v[96:99], v[36:39]
  v_exp_f32 v92, v92
  v_exp_f32 v93, v93
  v_cvt_pk_bf16_f32 v108, v88, v89
  v_cvt_pk_bf16_f32 v109, v90, v91
  v_smfmac_f32_16x16x64_bf16 v[56:59], v[144:147], v[96:103], v148
  v_exp_f32 v94, v94
  v_exp_f32 v95, v95
  v_cvt_pk_bf16_f32 v110, v92, v93
  v_cvt_pk_bf16_f32 v111, v94, v95
  s_nop 1
  v_mfma_f32_16x16x32_bf16 v[40:43], v[128:131], v[104:107], v[40:43]
  v_mfma_f32_16x16x32_bf16 v[40:43], v[132:135], v[108:111], v[40:43]
  v_mfma_f32_16x16x32_bf16 v[44:47], v[140:143], v[108:111], v[44:47]
  v_mfma_f32_16x16x32_bf16 v[44:47], v[136:139], v[104:107], v[44:47]
  v_smfmac_f32_16x16x64_bf16 v[60:63], v[144:147], v[104:111], v148
  s_waitcnt vmcnt(0)
  v_cmp_le_u32 vcc, v255, v250
  s_nop 1
  s_lshr_b32 s12, vcc_lo, 2
  s_and_b32 s12, s12, vcc_lo
  s_lshr_b32 s13, s12, 1
  s_and_b32 s19, s12, s13
  s_andn2_b32 s24, 0x110, s19
  s_cselect_b32 s56, 0x7f000000, s22
  s_add_u32 s57, s56, 4096
  s_add_u32 s58, s56, s37
  s_add_u32 s59, s57, s37
  v_add_f32 v4, v56, v57
  v_add_f32 v5, v60, v61
  v_min_f32 v2, v4, v5
  v_add_f32 v3, v4, v5
  v_cmp_le_f32 vcc, s28, v2
  v_cmp_ge_f32 s[14:15], s29, v3
  s_mov_b32 s68, 1
  s_and_b64 vcc, vcc, s[14:15]
  s_cmp_eq_u64 vcc, exec
  s_cbranch_scc0 L_a_slow
L_a_norm1:
  ds_read_b64_tr_b16 v[144:145], v12 offset:0
  ds_read_b64_tr_b16 v[146:147], v12 offset:2048
  ds_read_b64_tr_b16 v[148:149], v12 offset:8192
  ds_read_b64_tr_b16 v[150:151], v12 offset:10240
  ds_read_b64_tr_b16 v[152:153], v13 offset:0
  ds_read_b64_tr_b16 v[154:155], v13 offset:2048
  ds_read_b64_tr_b16 v[156:157], v13 offset:8192
  ds_read_b64_tr_b16 v[158:159], v13 offset:10240
  ds_read_b64_tr_b16 v[160:161], v14 offset:0
  ds_read_b64_tr_b16 v[162:163], v14 offset:2048
  ds_read_b64_tr_b16 v[164:165], v14 offset:8192
  ds_read_b64_tr_b16 v[166:167], v14 offset:10240
  v_rcp_f32 v4, v4
  v_rcp_f32 v5, v5
  v_mul_f32 v32, v4, v32
  v_mul_f32 v33, v4, v33
  v_mul_f32 v34, v4, v34
  v_mul_f32 v35, v4, v35
  v_mul_f32 v36, v4, v36
  v_mul_f32 v37, v4, v37
  v_mul_f32 v38, v4, v38
  v_mul_f32 v39, v4, v39
  v_cvt_pk_bf16_f32 v32, v32, v33
  v_cvt_pk_bf16_f32 v33, v34, v35
  v_cvt_pk_bf16_f32 v34, v36, v37
  v_cvt_pk_bf16_f32 v35, v38, v39
  buffer_store_dwordx4 v[32:35], v10, s[64:67], s17 offen sc1
  v_mul_f32 v40, v5, v40
  v_mul_f32 v41, v5, v41
  v_mul_f32 v42, v5, v42
  v_mul_f32 v43, v5, v43
  v_mul_f32 v44, v5, v44
  v_mul_f32 v45, v5, v45
  v_mul_f32 v46, v5, v46
  v_mul_f32 v47, v5, v47
  v_cvt_pk_bf16_f32 v40, v40, v41
  v_cvt_pk_bf16_f32 v41, v42, v43
  v_cvt_pk_bf16_f32 v42, v44, v45
  v_cvt_pk_bf16_f32 v43, v46, v47
  buffer_store_dwordx4 v[40:43], v248, s[64:67], s17 offen sc1
  buffer_load_dwordx4 v[176:179], v10, s[64:67], s56 offen offset:0 sc1
  buffer_load_dwordx4 v[180:183], v10, s[64:67], s56 offen offset:2048 sc1
  buffer_load_dwordx4 v[184:187], v248, s[64:67], s56 offen offset:0 sc1
  buffer_load_dwordx4 v[188:191], v248, s[64:67], s56 offen offset:2048 sc1
  buffer_load_dwordx4 v[192:195], v10, s[64:67], s57 offen offset:0 sc1
  buffer_load_dwordx4 v[196:199], v10, s[64:67], s57 offen offset:2048 sc1
  buffer_load_dwordx4 v[200:203], v248, s[64:67], s57 offen offset:0 sc1
  buffer_load_dwordx4 v[204:207], v248, s[64:67], s57 offen offset:2048 sc1
  s_barrier
  s_waitcnt vmcnt(8)
  s_barrier
  s_cmp_lg_u32 s24, 0
  s_cbranch_scc1 L_of_3_s
L_of_3:
  buffer_load_dwordx4 v[208:211], v10, s[64:67], s58 offen offset:0 sc1
  buffer_load_dwordx4 v[212:215], v10, s[64:67], s58 offen offset:2048 sc1
  s_waitcnt vmcnt(6)
  s_waitcnt lgkmcnt(8)
  v_mfma_f32_16x16x32_bf16 v[16:19], v[144:147], v[176:179], 0
  ds_read_b64_tr_b16 v[168:169], v15 offset:0
  v_mfma_f32_16x16x32_bf16 v[16:19], v[148:151], v[180:183], v[16:19]
  ds_read_b64_tr_b16 v[170:171], v15 offset:2048
  buffer_load_dwordx4 v[216:219], v248, s[64:67], s58 offen offset:0 sc1
  v_mfma_f32_16x16x32_bf16 v[20:23], v[148:151], v[188:191], 0
  ds_read_b64_tr_b16 v[172:173], v15 offset:8192
  v_mfma_f32_16x16x32_bf16 v[20:23], v[144:147], v[184:187], v[20:23]
  ds_read_b64_tr_b16 v[174:175], v15 offset:10240
  s_waitcnt lgkmcnt(8)
  v_mfma_f32_16x16x32_bf16 v[28:31], v[152:155], v[184:187], 0
  ds_read_b64_tr_b16 v[144:145], v12 offset:16384
  v_mfma_f32_16x16x32_bf16 v[28:31], v[156:159], v[188:191], v[28:31]
  ds_read_b64_tr_b16 v[146:147], v12 offset:18432
  buffer_load_dwordx4 v[220:223], v248, s[64:67], s58 offen offset:2048 sc1
  v_mfma_f32_16x16x32_bf16 v[24:27], v[156:159], v[180:183], 0
  ds_read_b64_tr_b16 v[148:149], v12 offset:24576
  v_mfma_f32_16x16x32_bf16 v[24:27], v[152:155], v[176:179], v[24:27]
  ds_read_b64_tr_b16 v[150:151], v12 offset:26624
  s_waitcnt lgkmcnt(8)
  v_mfma_f32_16x16x32_bf16 v[32:35], v[160:163], v[176:179], 0
  ds_read_b64_tr_b16 v[152:153], v13 offset:16384
  v_mfma_f32_16x16x32_bf16 v[32:35], v[164:167], v[180:183], v[32:35]
  ds_read_b64_tr_b16 v[154:155], v13 offset:18432
  buffer_load_dwordx4 v[224:227], v10, s[64:67], s59 offen offset:0 sc1
  v_mfma_f32_16x16x32_bf16 v[36:39], v[164:167], v[188:191], 0
  ds_read_b64_tr_b16 v[156:157], v13 offset:24576
  v_mfma_f32_16x16x32_bf16 v[36:39], v[160:163], v[184:187], v[36:39]
  ds_read_b64_tr_b16 v[158:159], v13 offset:26624
  s_waitcnt lgkmcnt(8)
  v_mfma_f32_16x16x32_bf16 v[44:47], v[168:171], v[184:187], 0
  ds_read_b64_tr_b16 v[160:161], v14 offset:16384
  v_mfma_f32_16x16x32_bf16 v[44:47], v[172:175], v[188:191], v[44:47]
  ds_read_b64_tr_b16 v[162:163], v14 offset:18432
  buffer_load_dwordx4 v[228:231], v10, s[64:67], s59 offen offset:2048 sc1
  v_mfma_f32_16x16x32_bf16 v[40:43], v[172:175], v[180:183], 0
  ds_read_b64_tr_b16 v[164:165], v14 offset:24576
  v_mfma_f32_16x16x32_bf16 v[40:43], v[168:171], v[176:179], v[40:43]
  ds_read_b64_tr_b16 v[166:167], v14 offset:26624
L_pick_4:
  s_and_b32 s12, s19, s21
  s_cbranch_scc0 L_spin_5
L_pick_4_go:
  s_waitcnt vmcnt(6)
  s_waitcnt lgkmcnt(8)
  v_mfma_f32_16x16x32_bf16 v[16:19], v[144:147], v[192:195], v[16:19]
  ds_read_b64_tr_b16 v[168:169], v15 offset:16384
  s_ff1_i32_b32 s12, s12
  v_mfma_f32_16x16x32_bf16 v[16:19], v[148:151], v[196:199], v[16:19]
  ds_read_b64_tr_b16 v[170:171], v15 offset:18432
L_pad_1173:
  s_cbranch_execz L_pad_1241
  buffer_load_dwordx4 v[232:235], v248, s[64:67], s59 offen offset:0 sc1
  v_mfma_f32_16x16x32_bf16 v[20:23], v[148:151], v[204:207], v[20:23]
  ds_read_b64_tr_b16 v[172:173], v15 offset:24576
  s_bitset0_b32 s21, s12
  v_mfma_f32_16x16x32_bf16 v[20:23], v[144:147], v[200:203], v[20:23]
  ds_read_b64_tr_b16 v[174:175], v15 offset:26624
  s_lshl_b32 s54, 0xf0000, s12
  s_waitcnt lgkmcnt(8)
  v_mfma_f32_16x16x32_bf16 v[28:31], v[152:155], v[200:203], v[28:31]
  ds_read_b64_tr_b16 v[144:145], v240 offset:0
  s_xor_b32 s12, s12, s36
  v_mfma_f32_16x16x32_bf16 v[28:31], v[156:159], v[204:207], v[28:31]
  ds_read_b64_tr_b16 v[146:147], v240 offset:2048
  buffer_load_dwordx4 v[236:239], v248, s[64:67], s59 offen offset:2048 sc1
  v_mfma_f32_16x16x32_bf16 v[24:27], v[156:159], v[196:199], v[24:27]
  ds_read_b64_tr_b16 v[148:149], v240 offset:8192
  s_lshl1_add_u32 s50, s12, s70
  v_mfma_f32_16x16x32_bf16 v[24:27], v[152:155], v[192:195], v[24:27]
  ds_read_b64_tr_b16 v[150:151], v240 offset:10240
  s_lshl_b32 s22, s50, 10
  s_waitcnt lgkmcnt(8)
  v_mfma_f32_16x16x32_bf16 v[32:35], v[160:163], v[192:195], v[32:35]
  ds_read_b64_tr_b16 v[152:153], v241 offset:0
  s_add_u32 s22, s22, s18
  v_mfma_f32_16x16x32_bf16 v[32:35], v[164:167], v[196:199], v[32:35]
  ds_read_b64_tr_b16 v[154:155], v241 offset:2048
  buffer_load_dwordx4 v[176:179], v10, s[64:67], s22 offen offset:0 sc1
  v_mfma_f32_16x16x32_bf16 v[36:39], v[164:167], v[204:207], v[36:39]
  ds_read_b64_tr_b16 v[156:157], v241 offset:8192
  s_lshl_b32 s30, s50, 12
  v_mfma_f32_16x16x32_bf16 v[36:39], v[160:163], v[200:203], v[36:39]
  ds_read_b64_tr_b16 v[158:159], v241 offset:10240
  v_add_u32 v12, s30, v244
  v_add_u32 v13, s30, v245
  v_add_u32 v14, s30, v246
  v_add_u32 v15, s30, v247
  s_waitcnt lgkmcnt(8)
  v_mfma_f32_16x16x32_bf16 v[44:47], v[168:171], v[200:203], v[44:47]
  ds_read_b64_tr_b16 v[160:161], v242 offset:0
  v_mfma_f32_16x16x32_bf16 v[44:47], v[172:175], v[204:207], v[44:47]
  ds_read_b64_tr_b16 v[162:163], v242 offset:2048
  buffer_load_dwordx4 v[180:183], v10, s[64:67], s22 offen offset:2048 sc1
  v_mfma_f32_16x16x32_bf16 v[40:43], v[172:175], v[196:199], v[40:43]
  ds_read_b64_tr_b16 v[164:165], v242 offset:8192
  v_mfma_f32_16x16x32_bf16 v[40:43], v[168:171], v[192:195], v[40:43]
  ds_read_b64_tr_b16 v[166:167], v242 offset:10240
  s_waitcnt vmcnt(6)
  s_waitcnt lgkmcnt(8)
  v_mfma_f32_16x16x32_bf16 v[16:19], v[144:147], v[208:211], v[16:19]
  ds_read_b64_tr_b16 v[168:169], v243 offset:0
  v_mfma_f32_16x16x32_bf16 v[16:19], v[148:151], v[212:215], v[16:19]
  ds_read_b64_tr_b16 v[170:171], v243 offset:2048
  buffer_load_dwordx4 v[184:187], v248, s[64:67], s22 offen offset:0 sc1
  v_mfma_f32_16x16x32_bf16 v[20:23], v[148:151], v[220:223], v[20:23]
  ds_read_b64_tr_b16 v[172:173], v243 offset:8192
  v_mfma_f32_16x16x32_bf16 v[20:23], v[144:147], v[216:219], v[20:23]
  ds_read_b64_tr_b16 v[174:175], v243 offset:10240
  s_waitcnt lgkmcnt(8)
  v_mfma_f32_16x16x32_bf16 v[28:31], v[152:155], v[216:219], v[28:31]
  ds_read_b64_tr_b16 v[144:145], v240 offset:16384
  v_mfma_f32_16x16x32_bf16 v[28:31], v[156:159], v[220:223], v[28:31]
  ds_read_b64_tr_b16 v[146:147], v240 offset:18432
  buffer_load_dwordx4 v[188:191], v248, s[64:67], s22 offen offset:2048 sc1
  v_mfma_f32_16x16x32_bf16 v[24:27], v[156:159], v[212:215], v[24:27]
  ds_read_b64_tr_b16 v[148:149], v240 offset:24576
  v_mfma_f32_16x16x32_bf16 v[24:27], v[152:155], v[208:211], v[24:27]
  ds_read_b64_tr_b16 v[150:151], v240 offset:26624
  s_waitcnt lgkmcnt(8)
  v_mfma_f32_16x16x32_bf16 v[32:35], v[160:163], v[208:211], v[32:35]
  ds_read_b64_tr_b16 v[152:153], v241 offset:16384
  v_mfma_f32_16x16x32_bf16 v[32:35], v[164:167], v[212:215], v[32:35]
  ds_read_b64_tr_b16 v[154:155], v241 offset:18432
  s_add_u32 s22, s22, 4096
  buffer_load_dwordx4 v[192:195], v10, s[64:67], s22 offen offset:0 sc1
  v_mfma_f32_16x16x32_bf16 v[36:39], v[164:167], v[220:223], v[36:39]
  ds_read_b64_tr_b16 v[156:157], v241 offset:24576
  v_mfma_f32_16x16x32_bf16 v[36:39], v[160:163], v[216:219], v[36:39]
  ds_read_b64_tr_b16 v[158:159], v241 offset:26624
  s_waitcnt lgkmcnt(8)
  v_mfma_f32_16x16x32_bf16 v[44:47], v[168:171], v[216:219], v[44:47]
  ds_read_b64_tr_b16 v[160:161], v242 offset:16384
  v_mfma_f32_16x16x32_bf16 v[44:47], v[172:175], v[220:223], v[44:47]
  ds_read_b64_tr_b16 v[162:163], v242 offset:18432
  buffer_load_dwordx4 v[196:199], v10, s[64:67], s22 offen offset:2048 sc1
  v_mfma_f32_16x16x32_bf16 v[40:43], v[172:175], v[212:215], v[40:43]
  ds_read_b64_tr_b16 v[164:165], v242 offset:24576
  v_mfma_f32_16x16x32_bf16 v[40:43], v[168:171], v[208:211], v[40:43]
  ds_read_b64_tr_b16 v[166:167], v242 offset:26624
L_pick_6:
  s_and_b32 s12, s19, s21
  s_cbranch_scc0 L_spin_7
L_pick_6_go:
  s_waitcnt vmcnt(6)
  s_waitcnt lgkmcnt(8)
  v_mfma_f32_16x16x32_bf16 v[16:19], v[144:147], v[224:227], v[16:19]
  ds_read_b64_tr_b16 v[168:169], v243 offset:16384
  s_ff1_i32_b32 s12, s12
  v_mfma_f32_16x16x32_bf16 v[16:19], v[148:151], v[228:231], v[16:19]
  ds_read_b64_tr_b16 v[170:171], v243 offset:18432
  buffer_load_dwordx4 v[200:203], v248, s[64:67], s22 offen offset:0 sc1
  v_mfma_f32_16x16x32_bf16 v[20:23], v[148:151], v[236:239], v[20:23]
  ds_read_b64_tr_b16 v[172:173], v243 offset:24576
  s_bitset0_b32 s21, s12
  v_mfma_f32_16x16x32_bf16 v[20:23], v[144:147], v[232:235], v[20:23]
  ds_read_b64_tr_b16 v[174:175], v243 offset:26624
  s_lshl_b32 s55, 0xf0000, s12
  s_waitcnt lgkmcnt(8)
  v_mfma_f32_16x16x32_bf16 v[28:31], v[152:155], v[232:235], v[28:31]
  ds_read_b64_tr_b16 v[144:145], v12 offset:0
  s_xor_b32 s12, s12, s36
  v_mfma_f32_16x16x32_bf16 v[28:31], v[156:159], v[236:239], v[28:31]
  ds_read_b64_tr_b16 v[146:147], v12 offset:2048
  buffer_load_dwordx4 v[204:207], v248, s[64:67], s22 offen offset:2048 sc1
  v_mfma_f32_16x16x32_bf16 v[24:27], v[156:159], v[228:231], v[24:27]
  ds_read_b64_tr_b16 v[148:149], v12 offset:8192
  s_lshl1_add_u32 s51, s12, s70
  v_mfma_f32_16x16x32_bf16 v[24:27], v[152:155], v[224:227], v[24:27]
  ds_read_b64_tr_b16 v[150:151], v12 offset:10240
  s_lshl_b32 s34, s51, 10
  s_waitcnt lgkmcnt(8)
  v_mfma_f32_16x16x32_bf16 v[32:35], v[160:163], v[224:227], v[32:35]
  ds_read_b64_tr_b16 v[152:153], v13 offset:0
  s_add_u32 s34, s34, s18
  v_mfma_f32_16x16x32_bf16 v[32:35], v[164:167], v[228:231], v[32:35]
  ds_read_b64_tr_b16 v[154:155], v13 offset:2048
  buffer_load_dwordx4 v[208:211], v10, s[64:67], s34 offen offset:0 sc1
  v_mfma_f32_16x16x32_bf16 v[36:39], v[164:167], v[236:239], v[36:39]
  ds_read_b64_tr_b16 v[156:157], v13 offset:8192
  s_lshl_b32 s30, s51, 12
  v_mfma_f32_16x16x32_bf16 v[36:39], v[160:163], v[232:235], v[36:39]
  ds_read_b64_tr_b16 v[158:159], v13 offset:10240
  v_add_u32 v240, s30, v244
  v_add_u32 v241, s30, v245
  v_add_u32 v242, s30, v246
  v_add_u32 v243, s30, v247
  s_waitcnt lgkmcnt(8)
  v_mfma_f32_16x16x32_bf16 v[44:47], v[168:171], v[232:235], v[44:47]
  ds_read_b64_tr_b16 v[160:161], v14 offset:0
  v_mfma_f32_16x16x32_bf16 v[44:47], v[172:175], v[236:239], v[44:47]
  ds_read_b64_tr_b16 v[162:163], v14 offset:2048
  buffer_load_dwordx4 v[212:215], v10, s[64:67], s34 offen offset:2048 sc1
  v_mfma_f32_16x16x32_bf16 v[40:43], v[172:175], v[228:231], v[40:43]
  ds_read_b64_tr_b16 v[164:165], v14 offset:8192
  v_mfma_f32_16x16x32_bf16 v[40:43], v[168:171], v[224:227], v[40:43]
  ds_read_b64_tr_b16 v[166:167], v14 offset:10240
  s_waitcnt vmcnt(6)
  s_waitcnt lgkmcnt(8)
  v_mfma_f32_16x16x32_bf16 v[16:19], v[144:147], v[176:179], v[16:19]
  ds_read_b64_tr_b16 v[168:169], v15 offset:0
  v_mfma_f32_16x16x32_bf16 v[16:19], v[148:151], v[180:183], v[16:19]
  ds_read_b64_tr_b16 v[170:171], v15 offset:2048
  buffer_load_dwordx4 v[216:219], v248, s[64:67], s34 offen offset:0 sc1
  s_mov_b32 exec_lo, s52
  s_mov_b32 exec_hi, 0
  buffer_load_dword v250, v249, s[64:67], 0 offen offset:4 sc1
  s_mov_b64 exec, -1
  v_mfma_f32_16x16x32_bf16 v[20:23], v[148:151], v[188:191], v[20:23]
  ds_read_b64_tr_b16 v[172:173], v15 offset:8192
L_pad_1190:
  s_cbranch_execz L_pad_1258
  v_mfma_f32_16x16x32_bf16 v[20:23], v[144:147], v[184:187], v[20:23]
  ds_read_b64_tr_b16 v[174:175], v15 offset:10240
  s_waitcnt lgkmcnt(8)
  v_mfma_f32_16x16x32_bf16 v[28:31], v[152:155], v[184:187], v[28:31]
  ds_read_b64_tr_b16 v[144:145], v12 offset:16384
  v_mfma_f32_16x16x32_bf16 v[28:31], v[156:159], v[188:191], v[28:31]
  ds_read_b64_tr_b16 v[146:147], v12 offset:18432
  buffer_load_dwordx4 v[220:223], v248, s[64:67], s34 offen offset:2048 sc1
  v_mfma_f32_16x16x32_bf16 v[24:27], v[156:159], v[180:183], v[24:27]
  ds_read_b64_tr_b16 v[148:149], v12 offset:24576
  v_mfma_f32_16x16x32_bf16 v[24:27], v[152:155], v[176:179], v[24:27]
  ds_read_b64_tr_b16 v[150:151], v12 offset:26624
  s_waitcnt lgkmcnt(8)
  v_mfma_f32_16x16x32_bf16 v[32:35], v[160:163], v[176:179], v[32:35]
  ds_read_b64_tr_b16 v[152:153], v13 offset:16384
  v_mfma_f32_16x16x32_bf16 v[32:35], v[164:167], v[180:183], v[32:35]
  ds_read_b64_tr_b16 v[154:155], v13 offset:18432
  s_add_u32 s34, s34, 4096
  buffer_load_dwordx4 v[224:227], v10, s[64:67], s34 offen offset:0 sc1
  v_mfma_f32_16x16x32_bf16 v[36:39], v[164:167], v[188:191], v[36:39]
  ds_read_b64_tr_b16 v[156:157], v13 offset:24576
  v_mfma_f32_16x16x32_bf16 v[36:39], v[160:163], v[184:187], v[36:39]
  ds_read_b64_tr_b16 v[158:159], v13 offset:26624
  s_waitcnt lgkmcnt(8)
  v_mfma_f32_16x16x32_bf16 v[44:47], v[168:171], v[184:187], v[44:47]
  ds_read_b64_tr_b16 v[160:161], v14 offset:16384
  v_mfma_f32_16x16x32_bf16 v[44:47], v[172:175], v[188:191], v[44:47]
  ds_read_b64_tr_b16 v[162:163], v14 offset:18432
  buffer_load_dwordx4 v[228:231], v10, s[64:67], s34 offen offset:2048 sc1
  v_mfma_f32_16x16x32_bf16 v[40:43], v[172:175], v[180:183], v[40:43]
  ds_read_b64_tr_b16 v[164:165], v14 offset:24576
  v_mfma_f32_16x16x32_bf16 v[40:43], v[168:171], v[176:179], v[40:43]
  ds_read_b64_tr_b16 v[166:167], v14 offset:26624
  s_waitcnt vmcnt(7)
  s_waitcnt lgkmcnt(8)
  v_mfma_f32_16x16x32_bf16 v[16:19], v[144:147], v[192:195], v[16:19]
  ds_read_b64_tr_b16 v[168:169], v15 offset:16384
  v_mfma_f32_16x16x32_bf16 v[16:19], v[148:151], v[196:199], v[16:19]
  ds_read_b64_tr_b16 v[170:171], v15 offset:18432
  buffer_load_dwordx4 v[232:235], v248, s[64:67], s34 offen offset:0 sc1
  v_mfma_f32_16x16x32_bf16 v[20:23], v[148:151], v[204:207], v[20:23]
  ds_read_b64_tr_b16 v[172:173], v15 offset:24576
  s_xor_b32 s48, s48, 1
  v_mfma_f32_16x16x32_bf16 v[20:23], v[144:147], v[200:203], v[20:23]
  ds_read_b64_tr_b16 v[174:175], v15 offset:26624
  s_lshl_b32 s22, s48, 10
  s_waitcnt lgkmcnt(8)
  v_mfma_f32_16x16x32_bf16 v[28:31], v[152:155], v[200:203], v[28:31]
  ds_read_b64_tr_b16 v[144:145], v240 offset:0
  s_add_u32 s22, s22, s18
  v_mfma_f32_16x16x32_bf16 v[28:31], v[156:159], v[204:207], v[28:31]
  ds_read_b64_tr_b16 v[146:147], v240 offset:2048
  buffer_load_dwordx4 v[236:239], v248, s[64:67], s34 offen offset:2048 sc1
  v_mfma_f32_16x16x32_bf16 v[24:27], v[156:159], v[196:199], v[24:27]
  ds_read_b64_tr_b16 v[148:149], v240 offset:8192
  s_waitcnt vmcnt(5)
  v_cmp_le_u32 vcc, v255, v250
  v_mfma_f32_16x16x32_bf16 v[24:27], v[152:155], v[192:195], v[24:27]
  ds_read_b64_tr_b16 v[150:151], v240 offset:10240
L_pick_8:
  s_andn2_b32 s12, s52, vcc_lo
  s_cbranch_scc1 L_spin_9
L_pick_8_go:
  s_waitcnt lgkmcnt(8)
  v_mfma_f32_16x16x32_bf16 v[32:35], v[160:163], v[192:195], v[32:35]
  ds_read_b64_tr_b16 v[152:153], v241 offset:0
  v_mfma_f32_16x16x32_bf16 v[32:35], v[164:167], v[196:199], v[32:35]
  ds_read_b64_tr_b16 v[154:155], v241 offset:2048
  buffer_load_dwordx4 v[176:179], v10, s[64:67], s22 offen offset:0 sc1
  v_mfma_f32_16x16x32_bf16 v[36:39], v[164:167], v[204:207], v[36:39]
  ds_read_b64_tr_b16 v[156:157], v241 offset:8192
  s_lshl_b32 s30, s48, 12
  v_mfma_f32_16x16x32_bf16 v[36:39], v[160:163], v[200:203], v[36:39]
  ds_read_b64_tr_b16 v[158:159], v241 offset:10240
  v_add_u32 v12, s30, v244
  v_add_u32 v13, s30, v245
  v_add_u32 v14, s30, v246
  v_add_u32 v15, s30, v247
  s_waitcnt lgkmcnt(8)
  v_mfma_f32_16x16x32_bf16 v[44:47], v[168:171], v[200:203], v[44:47]
  ds_read_b64_tr_b16 v[160:161], v242 offset:0
  v_mfma_f32_16x16x32_bf16 v[44:47], v[172:175], v[204:207], v[44:47]
  ds_read_b64_tr_b16 v[162:163], v242 offset:2048
  buffer_load_dwordx4 v[180:183], v10, s[64:67], s22 offen offset:2048 sc1
  v_mfma_f32_16x16x32_bf16 v[40:43], v[172:175], v[196:199], v[40:43]
  ds_read_b64_tr_b16 v[164:165], v242 offset:8192
  v_mfma_f32_16x16x32_bf16 v[40:43], v[168:171], v[192:195], v[40:43]
  ds_read_b64_tr_b16 v[166:167], v242 offset:10240
  s_waitcnt vmcnt(6)
  s_waitcnt lgkmcnt(8)
  v_mfma_f32_16x16x32_bf16 v[16:19], v[144:147], v[208:211], v[16:19]
  ds_read_b64_tr_b16 v[168:169], v243 offset:0
  v_mfma_f32_16x16x32_bf16 v[16:19], v[148:151], v[212:215], v[16:19]
  ds_read_b64_tr_b16 v[170:171], v243 offset:2048
  buffer_load_dwordx4 v[184:187], v248, s[64:67], s22 offen offset:0 sc1
  s_mov_b32 exec_lo, s53
  s_mov_b32 exec_hi, 0
  buffer_load_dword v250, v249, s[64:67], 0 offen offset:4 sc1
  s_mov_b64 exec, -1
  v_mfma_f32_16x16x32_bf16 v[20:23], v[148:151], v[220:223], v[20:23]
  ds_read_b64_tr_b16 v[172:173], v243 offset:8192
  v_mfma_f32_16x16x32_bf16 v[20:23], v[144:147], v[216:219], v[20:23]
  ds_read_b64_tr_b16 v[174:175], v243 offset:10240
  s_waitcnt lgkmcnt(8)
  v_mfma_f32_16x16x32_bf16 v[28:31], v[152:155], v[216:219], v[28:31]
  ds_read_b64_tr_b16 v[144:145], v240 offset:16384
  v_mfma_f32_16x16x32_bf16 v[28:31], v[156:159], v[220:223], v[28:31]
  ds_read_b64_tr_b16 v[146:147], v240 offset:18432
  buffer_load_dwordx4 v[188:191], v248, s[64:67], s22 offen offset:2048 sc1
  v_mfma_f32_16x16x32_bf16 v[24:27], v[156:159], v[212:215], v[24:27]
  ds_read_b64_tr_b16 v[148:149], v240 offset:24576
  v_mfma_f32_16x16x32_bf16 v[24:27], v[152:155], v[208:211], v[24:27]
  ds_read_b64_tr_b16 v[150:151], v240 offset:26624
  s_waitcnt lgkmcnt(8)
  v_mfma_f32_16x16x32_bf16 v[32:35], v[160:163], v[208:211], v[32:35]
  ds_read_b64_tr_b16 v[152:153], v241 offset:16384
  v_mfma_f32_16x16x32_bf16 v[32:35], v[164:167], v[212:215], v[32:35]
  ds_read_b64_tr_b16 v[154:155], v241 offset:18432
  s_add_u32 s22, s22, 4096
  buffer_load_dwordx4 v[192:195], v10, s[64:67], s22 offen offset:0 sc1
  v_mfma_f32_16x16x32_bf16 v[36:39], v[164:167], v[220:223], v[36:39]
  ds_read_b64_tr_b16 v[156:157], v241 offset:24576
  v_mfma_f32_16x16x32_bf16 v[36:39], v[160:163], v[216:219], v[36:39]
  ds_read_b64_tr_b16 v[158:159], v241 offset:26624
  s_waitcnt lgkmcnt(8)
  v_mfma_f32_16x16x32_bf16 v[44:47], v[168:171], v[216:219], v[44:47]
  ds_read_b64_tr_b16 v[160:161], v242 offset:16384
  v_mfma_f32_16x16x32_bf16 v[44:47], v[172:175], v[220:223], v[44:47]
  ds_read_b64_tr_b16 v[162:163], v242 offset:18432
  buffer_load_dwordx4 v[196:199], v10, s[64:67], s22 offen offset:2048 sc1
  v_mfma_f32_16x16x32_bf16 v[40:43], v[172:175], v[212:215], v[40:43]
  ds_read_b64_tr_b16 v[164:165], v242 offset:24576
  v_mfma_f32_16x16x32_bf16 v[40:43], v[168:171], v[208:211], v[40:43]
  ds_read_b64_tr_b16 v[166:167], v242 offset:26624
  s_waitcnt vmcnt(7)
  s_waitcnt lgkmcnt(8)
  v_mfma_f32_16x16x32_bf16 v[16:19], v[144:147], v[224:227], v[16:19]
  ds_read_b64_tr_b16 v[168:169], v243 offset:16384
  v_mfma_f32_16x16x32_bf16 v[16:19], v[148:151], v[228:231], v[16:19]
  ds_read_b64_tr_b16 v[170:171], v243 offset:18432
  buffer_load_dwordx4 v[200:203], v248, s[64:67], s22 offen offset:0 sc1
  v_mfma_f32_16x16x32_bf16 v[20:23], v[148:151], v[236:239], v[20:23]
  ds_read_b64_tr_b16 v[172:173], v243 offset:24576
  s_xor_b32 s49, s49, 1
  v_mfma_f32_16x16x32_bf16 v[20:23], v[144:147], v[232:235], v[20:23]
  ds_read_b64_tr_b16 v[174:175], v243 offset:26624
  s_lshl_b32 s34, s49, 10
  s_waitcnt lgkmcnt(8)
  v_mfma_f32_16x16x32_bf16 v[28:31], v[152:155], v[232:235], v[28:31]
  ds_read_b64_tr_b16 v[144:145], v12 offset:0
  s_add_u32 s34, s34, s18
  v_mfma_f32_16x16x32_bf16 v[28:31], v[156:159], v[236:239], v[28:31]
  ds_read_b64_tr_b16 v[146:147], v12 offset:2048
  buffer_load_dwordx4 v[204:207], v248, s[64:67], s22 offen offset:2048 sc1
  v_mfma_f32_16x16x32_bf16 v[24:27], v[156:159], v[228:231], v[24:27]
L_pad_1207:
  s_cbranch_execz L_ret_s3
  ds_read_b64_tr_b16 v[148:149], v12 offset:8192
  s_waitcnt vmcnt(5)
  v_cmp_le_u32 vcc, v255, v250
  v_mfma_f32_16x16x32_bf16 v[24:27], v[152:155], v[224:227], v[24:27]
  ds_read_b64_tr_b16 v[150:151], v12 offset:10240
L_pick_10:
  s_andn2_b32 s12, s53, vcc_lo
  s_cbranch_scc1 L_spin_11
L_pick_10_go:
  s_waitcnt lgkmcnt(8)
  v_mfma_f32_16x16x32_bf16 v[32:35], v[160:163], v[224:227], v[32:35]
  ds_read_b64_tr_b16 v[152:153], v13 offset:0
  v_mfma_f32_16x16x32_bf16 v[32:35], v[164:167], v[228:231], v[32:35]
  ds_read_b64_tr_b16 v[154:155], v13 offset:2048
  buffer_load_dwordx4 v[208:211], v10, s[64:67], s34 offen offset:0 sc1
  v_mfma_f32_16x16x32_bf16 v[36:39], v[164:167], v[236:239], v[36:39]
  ds_read_b64_tr_b16 v[156:157], v13 offset:8192
  s_lshl_b32 s30, s49, 12
  v_mfma_f32_16x16x32_bf16 v[36:39], v[160:163], v[232:235], v[36:39]
  ds_read_b64_tr_b16 v[158:159], v13 offset:10240
  v_add_u32 v240, s30, v244
  v_add_u32 v241, s30, v245
  v_add_u32 v242, s30, v246
  v_add_u32 v243, s30, v247
  s_waitcnt lgkmcnt(8)
  v_mfma_f32_16x16x32_bf16 v[44:47], v[168:171], v[232:235], v[44:47]
  ds_read_b64_tr_b16 v[160:161], v14 offset:0
  v_mfma_f32_16x16x32_bf16 v[44:47], v[172:175], v[236:239], v[44:47]
  ds_read_b64_tr_b16 v[162:163], v14 offset:2048
  buffer_load_dwordx4 v[212:215], v10, s[64:67], s34 offen offset:2048 sc1
  v_mfma_f32_16x16x32_bf16 v[40:43], v[172:175], v[228:231], v[40:43]
  ds_read_b64_tr_b16 v[164:165], v14 offset:8192
  v_mfma_f32_16x16x32_bf16 v[40:43], v[168:171], v[224:227], v[40:43]
  ds_read_b64_tr_b16 v[166:167], v14 offset:10240
  s_waitcnt vmcnt(6)
  s_waitcnt lgkmcnt(8)
  v_mfma_f32_16x16x32_bf16 v[16:19], v[144:147], v[176:179], v[16:19]
  ds_read_b64_tr_b16 v[168:169], v15 offset:0
  v_mfma_f32_16x16x32_bf16 v[16:19], v[148:151], v[180:183], v[16:19]
  ds_read_b64_tr_b16 v[170:171], v15 offset:2048
  buffer_load_dwordx4 v[216:219], v248, s[64:67], s34 offen offset:0 sc1
  s_mov_b32 exec_lo, s54
  s_mov_b32 exec_hi, 0
  buffer_load_dword v250, v249, s[64:67], 0 offen offset:4 sc1
  s_mov_b64 exec, -1
  v_mfma_f32_16x16x32_bf16 v[20:23], v[148:151], v[188:191], v[20:23]
  ds_read_b64_tr_b16 v[172:173], v15 offset:8192
  v_mfma_f32_16x16x32_bf16 v[20:23], v[144:147], v[184:187], v[20:23]
  ds_read_b64_tr_b16 v[174:175], v15 offset:10240
  s_waitcnt lgkmcnt(8)
  v_mfma_f32_16x16x32_bf16 v[28:31], v[152:155], v[184:187], v[28:31]
  ds_read_b64_tr_b16 v[144:145], v12 offset:16384
  v_mfma_f32_16x16x32_bf16 v[28:31], v[156:159], v[188:191], v[28:31]
  ds_read_b64_tr_b16 v[146:147], v12 offset:18432
  buffer_load_dwordx4 v[220:223], v248, s[64:67], s34 offen offset:2048 sc1
  v_mfma_f32_16x16x32_bf16 v[24:27], v[156:159], v[180:183], v[24:27]
  ds_read_b64_tr_b16 v[148:149], v12 offset:24576
  v_mfma_f32_16x16x32_bf16 v[24:27], v[152:155], v[176:179], v[24:27]
  ds_read_b64_tr_b16 v[150:151], v12 offset:26624
  s_waitcnt lgkmcnt(8)
  v_mfma_f32_16x16x32_bf16 v[32:35], v[160:163], v[176:179], v[32:35]
  ds_read_b64_tr_b16 v[152:153], v13 offset:16384
  v_mfma_f32_16x16x32_bf16 v[32:35], v[164:167], v[180:183], v[32:35]
  ds_read_b64_tr_b16 v[154:155], v13 offset:18432
  s_add_u32 s34, s34, 4096
  buffer_load_dwordx4 v[224:227], v10, s[64:67], s34 offen offset:0 sc1
  v_mfma_f32_16x16x32_bf16 v[36:39], v[164:167], v[188:191], v[36:39]
  ds_read_b64_tr_b16 v[156:157], v13 offset:24576
  v_mfma_f32_16x16x32_bf16 v[36:39], v[160:163], v[184:187], v[36:39]
  ds_read_b64_tr_b16 v[158:159], v13 offset:26624
  s_waitcnt lgkmcnt(8)
  v_mfma_f32_16x16x32_bf16 v[44:47], v[168:171], v[184:187], v[44:47]
  ds_read_b64_tr_b16 v[160:161], v14 offset:16384
  v_mfma_f32_16x16x32_bf16 v[44:47], v[172:175], v[188:191], v[44:47]
  ds_read_b64_tr_b16 v[162:163], v14 offset:18432
  buffer_load_dwordx4 v[228:231], v10, s[64:67], s34 offen offset:2048 sc1
  v_mfma_f32_16x16x32_bf16 v[40:43], v[172:175], v[180:183], v[40:43]
  ds_read_b64_tr_b16 v[164:165], v14 offset:24576
  v_mfma_f32_16x16x32_bf16 v[40:43], v[168:171], v[176:179], v[40:43]
  ds_read_b64_tr_b16 v[166:167], v14 offset:26624
  s_waitcnt vmcnt(7)
  s_waitcnt lgkmcnt(8)
  v_mfma_f32_16x16x32_bf16 v[16:19], v[144:147], v[192:195], v[16:19]
  ds_read_b64_tr_b16 v[168:169], v15 offset:16384
  v_mfma_f32_16x16x32_bf16 v[16:19], v[148:151], v[196:199], v[16:19]
  ds_read_b64_tr_b16 v[170:171], v15 offset:18432
  buffer_load_dwordx4 v[232:235], v248, s[64:67], s34 offen offset:0 sc1
  v_mfma_f32_16x16x32_bf16 v[20:23], v[148:151], v[204:207], v[20:23]
  ds_read_b64_tr_b16 v[172:173], v15 offset:24576
  s_xor_b32 s50, s50, 1
  v_mfma_f32_16x16x32_bf16 v[20:23], v[144:147], v[200:203], v[20:23]
  ds_read_b64_tr_b16 v[174:175], v15 offset:26624
  s_lshl_b32 s22, s50, 10
  s_waitcnt lgkmcnt(8)
  v_mfma_f32_16x16x32_bf16 v[28:31], v[152:155], v[200:203], v[28:31]
  ds_read_b64_tr_b16 v[144:145], v240 offset:0
  s_add_u32 s22, s22, s18
  v_mfma_f32_16x16x32_bf16 v[28:31], v[156:159], v[204:207], v[28:31]
  ds_read_b64_tr_b16 v[146:147], v240 offset:2048
  buffer_load_dwordx4 v[236:239], v248, s[64:67], s34 offen offset:2048 sc1
  v_mfma_f32_16x16x32_bf16 v[24:27], v[156:159], v[196:199], v[24:27]
  ds_read_b64_tr_b16 v[148:149], v240 offset:8192
  s_waitcnt vmcnt(5)
  v_cmp_le_u32 vcc, v255, v250
  v_mfma_f32_16x16x32_bf16 v[24:27], v[152:155], v[192:195], v[24:27]
  ds_read_b64_tr_b16 v[150:151], v240 offset:10240
L_pick_12:
  s_andn2_b32 s12, s54, vcc_lo
  s_cbranch_scc1 L_spin_13
L_pick_12_go:
  s_waitcnt lgkmcnt(8)
  v_mfma_f32_16x16x32_bf16 v[32:35], v[160:163], v[192:195], v[32:35]
  ds_read_b64_tr_b16 v[152:153], v241 offset:0
  v_mfma_f32_16x16x32_bf16 v[32:35], v[164:167], v[196:199], v[32:35]
  ds_read_b64_tr_b16 v[154:155], v241 offset:2048
  buffer_load_dwordx4 v[176:179], v10, s[64:67], s22 offen offset:0 sc1
  v_mfma_f32_16x16x32_bf16 v[36:39], v[164:167], v[204:207], v[36:39]
  ds_read_b64_tr_b16 v[156:157], v241 offset:8192
  s_lshl_b32 s30, s50, 12
  v_mfma_f32_16x16x32_bf16 v[36:39], v[160:163], v[200:203], v[36:39]
  ds_read_b64_tr_b16 v[158:159], v241 offset:10240
  v_add_u32 v12, s30, v244
  v_add_u32 v13, s30, v245
  v_add_u32 v14, s30, v246
  v_add_u32 v15, s30, v247
  s_waitcnt lgkmcnt(8)
  v_mfma_f32_16x16x32_bf16 v[44:47], v[168:171], v[200:203], v[44:47]
  ds_read_b64_tr_b16 v[160:161], v242 offset:0
  v_mfma_f32_16x16x32_bf16 v[44:47], v[172:175], v[204:207], v[44:47]
  ds_read_b64_tr_b16 v[162:163], v242 offset:2048
  buffer_load_dwordx4 v[180:183], v10, s[64:67], s22 offen offset:2048 sc1
  v_mfma_f32_16x16x32_bf16 v[40:43], v[172:175], v[196:199], v[40:43]
  ds_read_b64_tr_b16 v[164:165], v242 offset:8192
  v_mfma_f32_16x16x32_bf16 v[40:43], v[168:171], v[192:195], v[40:43]
  ds_read_b64_tr_b16 v[166:167], v242 offset:10240
  s_waitcnt vmcnt(6)
  s_waitcnt lgkmcnt(8)
  v_mfma_f32_16x16x32_bf16 v[16:19], v[144:147], v[208:211], v[16:19]
  ds_read_b64_tr_b16 v[168:169], v243 offset:0
  v_mfma_f32_16x16x32_bf16 v[16:19], v[148:151], v[212:215], v[16:19]
  ds_read_b64_tr_b16 v[170:171], v243 offset:2048
  buffer_load_dwordx4 v[184:187], v248, s[64:67], s22 offen offset:0 sc1
  s_mov_b32 exec_lo, s55
  s_mov_b32 exec_hi, 0
  buffer_load_dword v250, v249, s[64:67], 0 offen offset:4 sc1
  s_mov_b64 exec, -1
  v_mfma_f32_16x16x32_bf16 v[20:23], v[148:151], v[220:223], v[20:23]
  ds_read_b64_tr_b16 v[172:173], v243 offset:8192
  v_mfma_f32_16x16x32_bf16 v[20:23], v[144:147], v[216:219], v[20:23]
  ds_read_b64_tr_b16 v[174:175], v243 offset:10240
  s_waitcnt lgkmcnt(8)
  v_mfma_f32_16x16x32_bf16 v[28:31], v[152:155], v[216:219], v[28:31]
  ds_read_b64_tr_b16 v[144:145], v240 offset:16384
  v_mfma_f32_16x16x32_bf16 v[28:31], v[156:159], v[220:223], v[28:31]
  ds_read_b64_tr_b16 v[146:147], v240 offset:18432
  buffer_load_dwordx4 v[188:191], v248, s[64:67], s22 offen offset:2048 sc1
  v_mfma_f32_16x16x32_bf16 v[24:27], v[156:159], v[212:215], v[24:27]
  ds_read_b64_tr_b16 v[148:149], v240 offset:24576
  v_mfma_f32_16x16x32_bf16 v[24:27], v[152:155], v[208:211], v[24:27]
  ds_read_b64_tr_b16 v[150:151], v240 offset:26624
L_pad_1224:
  s_cbranch_execz L_ret_s3
  s_waitcnt lgkmcnt(8)
  v_mfma_f32_16x16x32_bf16 v[32:35], v[160:163], v[208:211], v[32:35]
  ds_read_b64_tr_b16 v[152:153], v241 offset:16384
  v_mfma_f32_16x16x32_bf16 v[32:35], v[164:167], v[212:215], v[32:35]
  ds_read_b64_tr_b16 v[154:155], v241 offset:18432
  s_add_u32 s22, s22, 4096
  buffer_load_dwordx4 v[192:195], v10, s[64:67], s22 offen offset:0 sc1
  v_mfma_f32_16x16x32_bf16 v[36:39], v[164:167], v[220:223], v[36:39]
  ds_read_b64_tr_b16 v[156:157], v241 offset:24576
  v_mfma_f32_16x16x32_bf16 v[36:39], v[160:163], v[216:219], v[36:39]
  ds_read_b64_tr_b16 v[158:159], v241 offset:26624
  s_waitcnt lgkmcnt(8)
  v_mfma_f32_16x16x32_bf16 v[44:47], v[168:171], v[216:219], v[44:47]
  ds_read_b64_tr_b16 v[160:161], v242 offset:16384
  v_mfma_f32_16x16x32_bf16 v[44:47], v[172:175], v[220:223], v[44:47]
  ds_read_b64_tr_b16 v[162:163], v242 offset:18432
  buffer_load_dwordx4 v[196:199], v10, s[64:67], s22 offen offset:2048 sc1
  v_mfma_f32_16x16x32_bf16 v[40:43], v[172:175], v[212:215], v[40:43]
  ds_read_b64_tr_b16 v[164:165], v242 offset:24576
  v_mfma_f32_16x16x32_bf16 v[40:43], v[168:171], v[208:211], v[40:43]
  ds_read_b64_tr_b16 v[166:167], v242 offset:26624
  s_waitcnt vmcnt(7)
  s_waitcnt lgkmcnt(8)
  v_mfma_f32_16x16x32_bf16 v[16:19], v[144:147], v[224:227], v[16:19]
  ds_read_b64_tr_b16 v[168:169], v243 offset:16384
  v_mfma_f32_16x16x32_bf16 v[16:19], v[148:151], v[228:231], v[16:19]
  ds_read_b64_tr_b16 v[170:171], v243 offset:18432
  buffer_load_dwordx4 v[200:203], v248, s[64:67], s22 offen offset:0 sc1
  v_mfma_f32_16x16x32_bf16 v[20:23], v[148:151], v[236:239], v[20:23]
  ds_read_b64_tr_b16 v[172:173], v243 offset:24576
  s_xor_b32 s51, s51, 1
  v_mfma_f32_16x16x32_bf16 v[20:23], v[144:147], v[232:235], v[20:23]
  ds_read_b64_tr_b16 v[174:175], v243 offset:26624
  s_lshl_b32 s34, s51, 10
  s_waitcnt lgkmcnt(8)
  v_mfma_f32_16x16x32_bf16 v[28:31], v[152:155], v[232:235], v[28:31]
  ds_read_b64_tr_b16 v[144:145], v12 offset:0
  s_add_u32 s34, s34, s18
  v_mfma_f32_16x16x32_bf16 v[28:31], v[156:159], v[236:239], v[28:31]
  ds_read_b64_tr_b16 v[146:147], v12 offset:2048
  buffer_load_dwordx4 v[204:207], v248, s[64:67], s22 offen offset:2048 sc1
  v_mfma_f32_16x16x32_bf16 v[24:27], v[156:159], v[228:231], v[24:27]
  ds_read_b64_tr_b16 v[148:149], v12 offset:8192
  s_waitcnt vmcnt(5)
  v_cmp_le_u32 vcc, v255, v250
  v_mfma_f32_16x16x32_bf16 v[24:27], v[152:155], v[224:227], v[24:27]
  ds_read_b64_tr_b16 v[150:151], v12 offset:10240
L_pick_14:
  s_andn2_b32 s12, s55, vcc_lo
  s_cbranch_scc1 L_spin_15
L_pick_14_go:
  s_waitcnt lgkmcnt(8)
  v_mfma_f32_16x16x32_bf16 v[32:35], v[160:163], v[224:227], v[32:35]
  ds_read_b64_tr_b16 v[152:153], v13 offset:0
  v_mfma_f32_16x16x32_bf16 v[32:35], v[164:167], v[228:231], v[32:35]
  ds_read_b64_tr_b16 v[154:155], v13 offset:2048
  buffer_load_dwordx4 v[208:211], v10, s[64:67], s34 offen offset:0 sc1
  v_mfma_f32_16x16x32_bf16 v[36:39], v[164:167], v[236:239], v[36:39]
  ds_read_b64_tr_b16 v[156:157], v13 offset:8192
  s_lshl_b32 s30, s51, 12
  v_mfma_f32_16x16x32_bf16 v[36:39], v[160:163], v[232:235], v[36:39]
  ds_read_b64_tr_b16 v[158:159], v13 offset:10240
  v_add_u32 v240, s30, v244
  v_add_u32 v241, s30, v245
  v_add_u32 v242, s30, v246
  v_add_u32 v243, s30, v247
  s_waitcnt lgkmcnt(8)
  v_mfma_f32_16x16x32_bf16 v[44:47], v[168:171], v[232:235], v[44:47]
  ds_read_b64_tr_b16 v[160:161], v14 offset:0
  v_mfma_f32_16x16x32_bf16 v[44:47], v[172:175], v[236:239], v[44:47]
  ds_read_b64_tr_b16 v[162:163], v14 offset:2048
  buffer_load_dwordx4 v[212:215], v10, s[64:67], s34 offen offset:2048 sc1
  v_mfma_f32_16x16x32_bf16 v[40:43], v[172:175], v[228:231], v[40:43]
  ds_read_b64_tr_b16 v[164:165], v14 offset:8192
  v_mfma_f32_16x16x32_bf16 v[40:43], v[168:171], v[224:227], v[40:43]
  ds_read_b64_tr_b16 v[166:167], v14 offset:10240
  s_waitcnt vmcnt(6)
  s_waitcnt lgkmcnt(8)
  v_mfma_f32_16x16x32_bf16 v[16:19], v[144:147], v[176:179], v[16:19]
  ds_read_b64_tr_b16 v[168:169], v15 offset:0
  v_mfma_f32_16x16x32_bf16 v[16:19], v[148:151], v[180:183], v[16:19]
  ds_read_b64_tr_b16 v[170:171], v15 offset:2048
  buffer_load_dwordx4 v[216:219], v248, s[64:67], s34 offen offset:0 sc1
  v_mfma_f32_16x16x32_bf16 v[20:23], v[148:151], v[188:191], v[20:23]
  ds_read_b64_tr_b16 v[172:173], v15 offset:8192
  v_mfma_f32_16x16x32_bf16 v[20:23], v[144:147], v[184:187], v[20:23]
  ds_read_b64_tr_b16 v[174:175], v15 offset:10240
  s_waitcnt lgkmcnt(8)
  v_mfma_f32_16x16x32_bf16 v[28:31], v[152:155], v[184:187], v[28:31]
  ds_read_b64_tr_b16 v[144:145], v12 offset:16384
  v_mfma_f32_16x16x32_bf16 v[28:31], v[156:159], v[188:191], v[28:31]
  ds_read_b64_tr_b16 v[146:147], v12 offset:18432
  buffer_load_dwordx4 v[220:223], v248, s[64:67], s34 offen offset:2048 sc1
  v_mfma_f32_16x16x32_bf16 v[24:27], v[156:159], v[180:183], v[24:27]
  ds_read_b64_tr_b16 v[148:149], v12 offset:24576
  v_mfma_f32_16x16x32_bf16 v[24:27], v[152:155], v[176:179], v[24:27]
  ds_read_b64_tr_b16 v[150:151], v12 offset:26624
  s_waitcnt lgkmcnt(8)
  v_mfma_f32_16x16x32_bf16 v[32:35], v[160:163], v[176:179], v[32:35]
  ds_read_b64_tr_b16 v[152:153], v13 offset:16384
  v_mfma_f32_16x16x32_bf16 v[32:35], v[164:167], v[180:183], v[32:35]
  ds_read_b64_tr_b16 v[154:155], v13 offset:18432
  s_add_u32 s34, s34, 4096
  buffer_load_dwordx4 v[224:227], v10, s[64:67], s34 offen offset:0 sc1
  v_mfma_f32_16x16x32_bf16 v[36:39], v[164:167], v[188:191], v[36:39]
  ds_read_b64_tr_b16 v[156:157], v13 offset:24576
  v_mfma_f32_16x16x32_bf16 v[36:39], v[160:163], v[184:187], v[36:39]
  ds_read_b64_tr_b16 v[158:159], v13 offset:26624
  s_waitcnt lgkmcnt(8)
  v_mfma_f32_16x16x32_bf16 v[44:47], v[168:171], v[184:187], v[44:47]
  ds_read_b64_tr_b16 v[160:161], v14 offset:16384
  v_mfma_f32_16x16x32_bf16 v[44:47], v[172:175], v[188:191], v[44:47]
  ds_read_b64_tr_b16 v[162:163], v14 offset:18432
  buffer_load_dwordx4 v[228:231], v10, s[64:67], s34 offen offset:2048 sc1
  v_mfma_f32_16x16x32_bf16 v[40:43], v[172:175], v[180:183], v[40:43]
  ds_read_b64_tr_b16 v[164:165], v14 offset:24576
  v_mfma_f32_16x16x32_bf16 v[40:43], v[168:171], v[176:179], v[40:43]
  ds_read_b64_tr_b16 v[166:167], v14 offset:26624
  s_waitcnt vmcnt(6)
  s_waitcnt lgkmcnt(8)
  v_mfma_f32_16x16x32_bf16 v[16:19], v[144:147], v[192:195], v[16:19]
  ds_read_b64_tr_b16 v[168:169], v15 offset:16384
  v_mfma_f32_16x16x32_bf16 v[16:19], v[148:151], v[196:199], v[16:19]
  ds_read_b64_tr_b16 v[170:171], v15 offset:18432
  buffer_load_dwordx4 v[232:235], v248, s[64:67], s34 offen offset:0 sc1
  v_mfma_f32_16x16x32_bf16 v[20:23], v[148:151], v[204:207], v[20:23]
  ds_read_b64_tr_b16 v[172:173], v15 offset:24576
  v_mfma_f32_16x16x32_bf16 v[20:23], v[144:147], v[200:203], v[20:23]
  ds_read_b64_tr_b16 v[174:175], v15 offset:26624
  s_waitcnt lgkmcnt(8)
  v_mfma_f32_16x16x32_bf16 v[28:31], v[152:155], v[200:203], v[28:31]
  ds_read_b64_tr_b16 v[144:145], v240 offset:0
  v_mfma_f32_16x16x32_bf16 v[28:31], v[156:159], v[204:207], v[28:31]
  ds_read_b64_tr_b16 v[146:147], v240 offset:2048
  buffer_load_dwordx4 v[236:239], v248, s[64:67], s34 offen offset:2048 sc1
  v_mfma_f32_16x16x32_bf16 v[24:27], v[156:159], v[196:199], v[24:27]
  ds_read_b64_tr_b16 v[148:149], v240 offset:8192
  v_mfma_f32_16x16x32_bf16 v[24:27], v[152:155], v[192:195], v[24:27]
  ds_read_b64_tr_b16 v[150:151], v240 offset:10240
  s_waitcnt lgkmcnt(8)
  v_mfma_f32_16x16x32_bf16 v[32:35], v[160:163], v[192:195], v[32:35]
  ds_read_b64_tr_b16 v[152:153], v241 offset:0
  v_mfma_f32_16x16x32_bf16 v[32:35], v[164:167], v[196:199], v[32:35]
  ds_read_b64_tr_b16 v[154:155], v241 offset:2048
  v_mfma_f32_16x16x32_bf16 v[36:39], v[164:167], v[204:207], v[36:39]
  ds_read_b64_tr_b16 v[156:157], v241 offset:8192
  v_mfma_f32_16x16x32_bf16 v[36:39], v[160:163], v[200:203], v[36:39]
  ds_read_b64_tr_b16 v[158:159], v241 offset:10240
  ds_read_b128 v[80:83], v251 offset:0
  s_waitcnt lgkmcnt(8)
  v_mfma_f32_16x16x32_bf16 v[44:47], v[168:171], v[200:203], v[44:47]
  ds_read_b64_tr_b16 v[160:161], v242 offset:0
L_pad_1241:
  s_cbranch_execz L_ret_s3
  v_mfma_f32_16x16x32_bf16 v[44:47], v[172:175], v[204:207], v[44:47]
  ds_read_b64_tr_b16 v[162:163], v242 offset:2048
  v_mfma_f32_16x16x32_bf16 v[40:43], v[172:175], v[196:199], v[40:43]
  ds_read_b64_tr_b16 v[164:165], v242 offset:8192
  v_mfma_f32_16x16x32_bf16 v[40:43], v[168:171], v[192:195], v[40:43]
  ds_read_b64_tr_b16 v[166:167], v242 offset:10240
  ds_read_b128 v[84:87], v251 offset:1024
  s_waitcnt vmcnt(4)
  s_waitcnt lgkmcnt(8)
  v_mfma_f32_16x16x32_bf16 v[16:19], v[144:147], v[208:211], v[16:19]
  ds_read_b64_tr_b16 v[168:169], v243 offset:0
  v_mfma_f32_16x16x32_bf16 v[16:19], v[148:151], v[212:215], v[16:19]
  ds_read_b64_tr_b16 v[170:171], v243 offset:2048
  v_mfma_f32_16x16x32_bf16 v[20:23], v[148:151], v[220:223], v[20:23]
  ds_read_b64_tr_b16 v[172:173], v243 offset:8192
  v_mfma_f32_16x16x32_bf16 v[20:23], v[144:147], v[216:219], v[20:23]
  ds_read_b64_tr_b16 v[174:175], v243 offset:10240
  ds_read_b128 v[88:91], v251 offset:2048
  v_mfma_f32_16x16x32_bf16 v[28:31], v[152:155], v[216:219], v[28:31]
  ds_read_b64_tr_b16 v[144:145], v240 offset:16384
  s_waitcnt lgkmcnt(8)
  v_mfma_f32_16x16x32_bf16 v[28:31], v[156:159], v[220:223], v[28:31]
  ds_read_b64_tr_b16 v[146:147], v240 offset:18432
  v_mfma_f32_16x16x32_bf16 v[24:27], v[156:159], v[212:215], v[24:27]
  ds_read_b64_tr_b16 v[148:149], v240 offset:24576
  v_mfma_f32_16x16x32_bf16 v[24:27], v[152:155], v[208:211], v[24:27]
  ds_read_b64_tr_b16 v[150:151], v240 offset:26624
  ds_read_b128 v[92:95], v251 offset:3072
  v_mfma_f32_16x16x32_bf16 v[32:35], v[160:163], v[208:211], v[32:35]
  ds_read_b64_tr_b16 v[152:153], v241 offset:16384
  s_waitcnt lgkmcnt(8)
  v_mfma_f32_16x16x32_bf16 v[32:35], v[164:167], v[212:215], v[32:35]
  ds_read_b64_tr_b16 v[154:155], v241 offset:18432
  v_mfma_f32_16x16x32_bf16 v[36:39], v[164:167], v[220:223], v[36:39]
  ds_read_b64_tr_b16 v[156:157], v241 offset:24576
  v_mfma_f32_16x16x32_bf16 v[36:39], v[160:163], v[216:219], v[36:39]
  ds_read_b64_tr_b16 v[158:159], v241 offset:26624
  ds_read_b128 v[96:99], v251 offset:4096
  v_mfma_f32_16x16x32_bf16 v[44:47], v[168:171], v[216:219], v[44:47]
  ds_read_b64_tr_b16 v[160:161], v242 offset:16384
  s_waitcnt lgkmcnt(8)
  v_mfma_f32_16x16x32_bf16 v[44:47], v[172:175], v[220:223], v[44:47]
  ds_read_b64_tr_b16 v[162:163], v242 offset:18432
  v_mfma_f32_16x16x32_bf16 v[40:43], v[172:175], v[212:215], v[40:43]
  ds_read_b64_tr_b16 v[164:165], v242 offset:24576
  v_mfma_f32_16x16x32_bf16 v[40:43], v[168:171], v[208:211], v[40:43]
  ds_read_b64_tr_b16 v[166:167], v242 offset:26624
  ds_read_b128 v[100:103], v251 offset:5120
  s_waitcnt vmcnt(0)
  v_mfma_f32_16x16x32_bf16 v[16:19], v[144:147], v[224:227], v[16:19]
  ds_read_b64_tr_b16 v[168:169], v243 offset:16384
  s_waitcnt lgkmcnt(8)
  v_mfma_f32_16x16x32_bf16 v[16:19], v[148:151], v[228:231], v[16:19]
  ds_read_b64_tr_b16 v[170:171], v243 offset:18432
  v_mfma_f32_16x16x32_bf16 v[20:23], v[148:151], v[236:239], v[20:23]
  ds_read_b64_tr_b16 v[172:173], v243 offset:24576
  v_mfma_f32_16x16x32_bf16 v[20:23], v[144:147], v[232:235], v[20:23]
  ds_read_b64_tr_b16 v[174:175], v243 offset:26624
  ds_read_b128 v[104:107], v251 offset:6144
  v_mfma_f32_16x16x32_bf16 v[28:31], v[152:155], v[232:235], v[28:31]
  s_waitcnt lgkmcnt(8)
  v_mfma_f32_16x16x32_bf16 v[28:31], v[156:159], v[236:239], v[28:31]
  v_mfma_f32_16x16x32_bf16 v[24:27], v[156:159], v[228:231], v[24:27]
  v_mfma_f32_16x16x32_bf16 v[24:27], v[152:155], v[224:227], v[24:27]
  ds_read_b128 v[108:111], v251 offset:7168
  v_mfma_f32_16x16x32_bf16 v[32:35], v[160:163], v[224:227], v[32:35]
  s_waitcnt lgkmcnt(7)
  v_mfma_f32_16x16x32_bf16 v[32:35], v[164:167], v[228:231], v[32:35]
  v_mfma_f32_16x16x32_bf16 v[36:39], v[164:167], v[236:239], v[36:39]
  v_mfma_f32_16x16x32_bf16 v[36:39], v[160:163], v[232:235], v[36:39]
  s_waitcnt lgkmcnt(4)
  v_mfma_f32_16x16x32_bf16 v[44:47], v[168:171], v[232:235], v[44:47]
  s_waitcnt lgkmcnt(2)
  v_mfma_f32_16x16x32_bf16 v[44:47], v[172:175], v[236:239], v[44:47]
  v_mfma_f32_16x16x32_bf16 v[40:43], v[172:175], v[228:231], v[40:43]
  v_mfma_f32_16x16x32_bf16 v[40:43], v[168:171], v[224:227], v[40:43]
  s_waitcnt lgkmcnt(0)
  v_xor_b32 v7, 0, v252
  v_fma_f32 v16, v8, v16, v80
  v_fma_f32 v17, v8, v17, v81
  v_fma_f32 v18, v8, v18, v82
  v_fma_f32 v19, v8, v19, v83
  v_cvt_pk_bf16_f32 v80, v16, v17
  v_cvt_pk_bf16_f32 v81, v18, v19
  ds_write_b64 v7, v[80:81] offset:0
  v_fma_f32 v20, v9, v20, v84
  v_fma_f32 v21, v9, v21, v85
  v_fma_f32 v22, v9, v22, v86
  v_fma_f32 v23, v9, v23, v87
  v_cvt_pk_bf16_f32 v84, v20, v21
  v_cvt_pk_bf16_f32 v85, v22, v23
  ds_write_b64 v7, v[84:85] offset:2048
  v_xor_b32 v7, 32, v252
  v_fma_f32 v24, v8, v24, v88
  v_fma_f32 v25, v8, v25, v89
  v_fma_f32 v26, v8, v26, v90
  v_fma_f32 v27, v8, v27, v91
  v_cvt_pk_bf16_f32 v88, v24, v25
  v_cvt_pk_bf16_f32 v89, v26, v27
  ds_write_b64 v7, v[88:89] offset:0
  v_fma_f32 v28, v9, v28, v92
  v_fma_f32 v29, v9, v29, v93
  v_fma_f32 v30, v9, v30, v94
  v_fma_f32 v31, v9, v31, v95
  v_cvt_pk_bf16_f32 v92, v28, v29
  v_cvt_pk_bf16_f32 v93, v30, v31
  ds_write_b64 v7, v[92:93] offset:2048
  v_xor_b32 v7, 64, v252
  v_fma_f32 v32, v8, v32, v96
  v_fma_f32 v33, v8, v33, v97
  v_fma_f32 v34, v8, v34, v98
  v_fma_f32 v35, v8, v35, v99
  v_cvt_pk_bf16_f32 v96, v32, v33
  v_cvt_pk_bf16_f32 v97, v34, v35
  ds_write_b64 v7, v[96:97] offset:0
  v_fma_f32 v36, v9, v36, v100
  v_fma_f32 v37, v9, v37, v101
  v_fma_f32 v38, v9, v38, v102
  v_fma_f32 v39, v9, v39, v103
  v_cvt_pk_bf16_f32 v100, v36, v37
  v_cvt_pk_bf16_f32 v101, v38, v39
  ds_write_b64 v7, v[100:101] offset:2048
  v_xor_b32 v7, 96, v252
  v_fma_f32 v40, v8, v40, v104
  v_fma_f32 v41, v8, v41, v105
  v_fma_f32 v42, v8, v42, v106
  v_fma_f32 v43, v8, v43, v107
  v_cvt_pk_bf16_f32 v104, v40, v41
  v_cvt_pk_bf16_f32 v105, v42, v43
  ds_write_b64 v7, v[104:105] offset:0
  v_fma_f32 v44, v9, v44, v108
  v_fma_f32 v45, v9, v45, v109
  v_fma_f32 v46, v9, v46, v110
  v_fma_f32 v47, v9, v47, v111
  v_cvt_pk_bf16_f32 v108, v44, v45
  v_cvt_pk_bf16_f32 v109, v46, v47
  ds_write_b64 v7, v[108:109] offset:2048
  ds_read_b128 v[144:147], v253 offset:0
  ds_read_b128 v[148:151], v253 offset:1024
  ds_read_b128 v[152:155], v253 offset:2048
  ds_read_b128 v[156:159], v253 offset:3072
  s_waitcnt lgkmcnt(3)
  buffer_store_dwordx4 v[144:147], v254, s[44:47], s20 offen sc1
  s_add_u32 s20, s20, 16384
L_pad_1258:
  s_cbranch_execz L_ret_s3
  s_waitcnt lgkmcnt(2)
  buffer_store_dwordx4 v[148:151], v254, s[44:47], s20 offen sc1
  s_add_u32 s20, s20, 16384
  s_waitcnt lgkmcnt(1)
  buffer_store_dwordx4 v[152:155], v254, s[44:47], s20 offen sc1
  s_add_u32 s20, s20, 16384
  s_waitcnt lgkmcnt(0)
  buffer_store_dwordx4 v[156:159], v254, s[44:47], s20 offen sc1
  s_endpgm
L_of_3_s:
  s_mov_b32 exec_lo, 0xffff
  s_mov_b32 exec_hi, 0
  buffer_load_dword v250, v249, s[64:67], 0 offen offset:4 sc1
  s_mov_b64 exec, -1
  s_waitcnt vmcnt(0)
  v_cmp_le_u32 vcc, v255, v250
  s_nop 1
  s_lshr_b32 s12, vcc_lo, 2
  s_and_b32 s12, s12, vcc_lo
  s_lshr_b32 s13, s12, 1
  s_and_b32 s19, s12, s13
  s_sub_u32 s31, s31, 1
  s_cmp_eq_u32 s31, 0
  s_cbranch_scc1 L_of_3_t
  s_andn2_b32 s12, 0x110, s19
  s_cbranch_scc1 L_of_3_s
L_of_3_g:
  s_or_b32 s19, s19, 0x110
  s_andn2_b32 s24, 0x110, s19
  s_cselect_b32 s56, 0x7f000000, s22
  s_add_u32 s57, s56, 4096
  s_add_u32 s58, s56, s37
  s_add_u32 s59, s57, s37
  buffer_load_dwordx4 v[176:179], v10, s[64:67], s56 offen offset:0 sc1
  buffer_load_dwordx4 v[180:183], v10, s[64:67], s56 offen offset:2048 sc1
  buffer_load_dwordx4 v[184:187], v248, s[64:67], s56 offen offset:0 sc1
  buffer_load_dwordx4 v[188:191], v248, s[64:67], s56 offen offset:2048 sc1
  buffer_load_dwordx4 v[192:195], v10, s[64:67], s57 offen offset:0 sc1
  buffer_load_dwordx4 v[196:199], v10, s[64:67], s57 offen offset:2048 sc1
  buffer_load_dwordx4 v[200:203], v248, s[64:67], s57 offen offset:0 sc1
  buffer_load_dwordx4 v[204:207], v248, s[64:67], s57 offen offset:2048 sc1
  s_branch L_of_3
L_of_3_t:
  s_mov_b32 s31, 1
  s_branch L_of_3_g
L_spin_5:
  s_mov_b32 exec_lo, 0xffff
  s_mov_b32 exec_hi, 0
  buffer_load_dword v250, v249, s[64:67], 0 offen offset:4 sc1
  s_mov_b64 exec, -1
  s_waitcnt vmcnt(0)
  v_cmp_le_u32 vcc, v255, v250
  s_nop 1
  s_lshr_b32 s12, vcc_lo, 2
  s_and_b32 s12, s12, vcc_lo
  s_lshr_b32 s13, s12, 1
  s_and_b32 s19, s12, s13
  s_sub_u32 s31, s31, 1
  s_cmp_lg_u32 s31, 0
  s_cbranch_scc1 L_pick_4
  s_mov_b32 s31, 1
  s_mov_b32 s12, s21
  s_branch L_pick_4_go
L_spin_7:
  s_mov_b32 exec_lo, 0xffff
  s_mov_b32 exec_hi, 0
  buffer_load_dword v250, v249, s[64:67], 0 offen offset:4 sc1
  s_mov_b64 exec, -1
  s_waitcnt vmcnt(0)
  v_cmp_le_u32 vcc, v255, v250
  s_nop 1
  s_lshr_b32 s12, vcc_lo, 2
  s_and_b32 s12, s12, vcc_lo
  s_lshr_b32 s13, s12, 1
  s_and_b32 s19, s12, s13
  s_sub_u32 s31, s31, 1
  s_cmp_lg_u32 s31, 0
  s_cbranch_scc1 L_pick_6
  s_mov_b32 s31, 1
  s_mov_b32 s12, s21
  s_branch L_pick_6_go
L_spin_9:
  s_mov_b32 exec_lo, s52
  s_mov_b32 exec_hi, 0
  buffer_load_dword v250, v249, s[64:67], 0 offen offset:4 sc1
  s_mov_b64 exec, -1
  s_waitcnt vmcnt(0)
  v_cmp_le_u32 vcc, v255, v250
  s_nop 1
  s_sub_u32 s31, s31, 1
  s_cmp_lg_u32 s31, 0
  s_cbranch_scc1 L_pick_8
  s_mov_b32 s31, 1
  s_branch L_pick_8_go
L_spin_11:
  s_mov_b32 exec_lo, s53
  s_mov_b32 exec_hi, 0
  buffer_load_dword v250, v249, s[64:67], 0 offen offset:4 sc1
  s_mov_b64 exec, -1
  s_waitcnt vmcnt(0)
  v_cmp_le_u32 vcc, v255, v250
  s_nop 1
  s_sub_u32 s31, s31, 1
  s_cmp_lg_u32 s31, 0
  s_cbranch_scc1 L_pick_10
  s_mov_b32 s31, 1
  s_branch L_pick_10_go
L_spin_13:
  s_mov_b32 exec_lo, s54
  s_mov_b32 exec_hi, 0
  buffer_load_dword v250, v249, s[64:67], 0 offen offset:4 sc1
  s_mov_b64 exec, -1
  s_waitcnt vmcnt(0)
  v_cmp_le_u32 vcc, v255, v250
  s_nop 1
  s_sub_u32 s31, s31, 1
  s_cmp_lg_u32 s31, 0
  s_cbranch_scc1 L_pick_12
  s_mov_b32 s31, 1
  s_branch L_pick_12_go
L_spin_15:
  s_mov_b32 exec_lo, s55
  s_mov_b32 exec_hi, 0
  buffer_load_dword v250, v249, s[64:67], 0 offen offset:4 sc1
  s_mov_b64 exec, -1
  s_waitcnt vmcnt(0)
  v_cmp_le_u32 vcc, v255, v250
  s_nop 1
  s_sub_u32 s31, s31, 1
  s_cmp_lg_u32 s31, 0
  s_cbranch_scc1 L_pick_14
  s_mov_b32 s31, 1
  s_branch L_pick_14_go
L_a_slow:
  s_nop 11
  s_mov_b32 s12, 27262976
  s_waitcnt lgkmcnt(0)
  v_mov_b32 v224, 0xff800000
  v_mov_b32 v228, 0xff800000
  v_mov_b32 v232, 0xff800000
  v_mov_b32 v236, 0xff800000
L_s_loop1:
  buffer_load_dwordx4 v[192:195], v10, s[64:67], s12 offen offset:0 sc1
  buffer_load_dwordx4 v[196:199], v10, s[64:67], s12 offen offset:1024 sc1
  buffer_load_dwordx4 v[200:203], v10, s[64:67], s12 offen offset:2048 sc1
  buffer_load_dwordx4 v[204:207], v10, s[64:67], s12 offen offset:3072 sc1
  s_waitcnt vmcnt(0)
  v_mfma_f32_16x16x32_bf16 v[64:67], v[192:195], v[160:163], 0
  v_mfma_f32_16x16x32_bf16 v[68:71], v[196:199], v[160:163], 0
  v_mfma_f32_16x16x32_bf16 v[72:75], v[200:203], v[160:163], 0
  v_mfma_f32_16x16x32_bf16 v[76:79], v[204:207], v[160:163], 0
  s_nop 7
  v_max3_f32 v224, v64, v65, v224
  v_max3_f32 v224, v66, v67, v224
  v_max3_f32 v224, v68, v69, v224
  v_max3_f32 v224, v70, v71, v224
  v_max3_f32 v224, v72, v73, v224
  v_max3_f32 v224, v74, v75, v224
  v_max3_f32 v224, v76, v77, v224
  v_max3_f32 v224, v78, v79, v224
  v_mfma_f32_16x16x32_bf16 v[64:67], v[192:195], v[164:167], 0
  v_mfma_f32_16x16x32_bf16 v[68:71], v[196:199], v[164:167], 0
  v_mfma_f32_16x16x32_bf16 v[72:75], v[200:203], v[164:167], 0
  v_mfma_f32_16x16x32_bf16 v[76:79], v[204:207], v[164:167], 0
  s_nop 7
  v_max3_f32 v228, v64, v65, v228
  v_max3_f32 v228, v66, v67, v228
  v_max3_f32 v228, v68, v69, v228
  v_max3_f32 v228, v70, v71, v228
  v_max3_f32 v228, v72, v73, v228
  v_max3_f32 v228, v74, v75, v228
  v_max3_f32 v228, v76, v77, v228
  v_max3_f32 v228, v78, v79, v228
  v_mfma_f32_16x16x32_bf16 v[64:67], v[192:195], v[168:171], 0
  v_mfma_f32_16x16x32_bf16 v[68:71], v[196:199], v[168:171], 0
  v_mfma_f32_16x16x32_bf16 v[72:75], v[200:203], v[168:171], 0
  v_mfma_f32_16x16x32_bf16 v[76:79], v[204:207], v[168:171], 0
  s_nop 7
  v_max3_f32 v232, v64, v65, v232
  v_max3_f32 v232, v66, v67, v232
  v_max3_f32 v232, v68, v69, v232
  v_max3_f32 v232, v70, v71, v232
  v_max3_f32 v232, v72, v73, v232
  v_max3_f32 v232, v74, v75, v232
  v_max3_f32 v232, v76, v77, v232
  v_max3_f32 v232, v78, v79, v232
  v_mfma_f32_16x16x32_bf16 v[64:67], v[192:195], v[172:175], 0
  v_mfma_f32_16x16x32_bf16 v[68:71], v[196:199], v[172:175], 0
  v_mfma_f32_16x16x32_bf16 v[72:75], v[200:203], v[172:175], 0
  v_mfma_f32_16x16x32_bf16 v[76:79], v[204:207], v[172:175], 0
  s_nop 7
  v_max3_f32 v236, v64, v65, v236
  v_max3_f32 v236, v66, v67, v236
  v_max3_f32 v236, v68, v69, v236
  v_max3_f32 v236, v70, v71, v236
  v_max3_f32 v236, v72, v73, v236
  v_max3_f32 v236, v74, v75, v236
  v_max3_f32 v236, v76, v77, v236
  v_max3_f32 v236, v78, v79, v236
  s_add_u32 s12, s12, 8192
  s_cmp_lg_u32 s12, 27525120
  s_cbranch_scc1 L_s_loop1
  v_mov_b32 v225, v224
  s_nop 1
  v_permlane16_swap_b32 v224, v225
  s_nop 1
  v_max_f32 v224, v224, v225
  v_mov_b32 v225, v224
  s_nop 1
  v_permlane32_swap_b32 v224, v225
  s_nop 1
  v_max_f32 v224, v224, v225
  v_sub_f32 v227, 0, v224
  v_sub_f32 v226, 0, v224
  v_sub_f32 v225, 0, v224
  v_sub_f32 v224, 0, v224
  v_mov_b32 v229, v228
  s_nop 1
  v_permlane16_swap_b32 v228, v229
  s_nop 1
  v_max_f32 v228, v228, v229
  v_mov_b32 v229, v228
  s_nop 1
  v_permlane32_swap_b32 v228, v229
  s_nop 1
  v_max_f32 v228, v228, v229
  v_sub_f32 v231, 0, v228
  v_sub_f32 v230, 0, v228
  v_sub_f32 v229, 0, v228
  v_sub_f32 v228, 0, v228
  v_mov_b32 v233, v232
  s_nop 1
  v_permlane16_swap_b32 v232, v233
  s_nop 1
  v_max_f32 v232, v232, v233
  v_mov_b32 v233, v232
  s_nop 1
  v_permlane32_swap_b32 v232, v233
  s_nop 1
  v_max_f32 v232, v232, v233
  v_sub_f32 v235, 0, v232
  v_sub_f32 v234, 0, v232
  v_sub_f32 v233, 0, v232
  v_sub_f32 v232, 0, v232
  v_mov_b32 v237, v236
  s_nop 1
  v_permlane16_swap_b32 v236, v237
  s_nop 1
  v_max_f32 v236, v236, v237
  v_mov_b32 v237, v236
  s_nop 1
  v_permlane32_swap_b32 v236, v237
  s_nop 1
  v_max_f32 v236, v236, v237
  v_sub_f32 v239, 0, v236
  v_sub_f32 v238, 0, v236
  v_sub_f32 v237, 0, v236
  v_sub_f32 v236, 0, v236
  v_mov_b32 v16, 0
  v_mov_b32 v17, 0
  v_mov_b32 v18, 0
  v_mov_b32 v19, 0
  v_mov_b32 v20, 0
  v_mov_b32 v21, 0
  v_mov_b32 v22, 0
  v_mov_b32 v23, 0
  v_mov_b32 v24, 0
  v_mov_b32 v25, 0
  v_mov_b32 v26, 0
  v_mov_b32 v27, 0
  v_mov_b32 v28, 0
  v_mov_b32 v29, 0
  v_mov_b32 v30, 0
  v_mov_b32 v31, 0
  v_mov_b32 v32, 0
  v_mov_b32 v33, 0
  v_mov_b32 v34, 0
  v_mov_b32 v35, 0
  v_mov_b32 v36, 0
  v_mov_b32 v37, 0
  v_mov_b32 v38, 0
  v_mov_b32 v39, 0
  v_mov_b32 v40, 0
  v_mov_b32 v41, 0
  v_mov_b32 v42, 0
  v_mov_b32 v43, 0
  v_mov_b32 v44, 0
  v_mov_b32 v45, 0
  v_mov_b32 v46, 0
  v_mov_b32 v47, 0
  v_mov_b32 v48, 0
  v_mov_b32 v49, 0
  v_mov_b32 v50, 0
  v_mov_b32 v51, 0
  v_mov_b32 v52, 0
  v_mov_b32 v53, 0
  v_mov_b32 v54, 0
  v_mov_b32 v55, 0
  v_mov_b32 v56, 0
  v_mov_b32 v57, 0
  v_mov_b32 v58, 0
  v_mov_b32 v59, 0
  v_mov_b32 v60, 0
  v_mov_b32 v61, 0
  v_mov_b32 v62, 0
  v_mov_b32 v63, 0
  s_mov_b32 s12, 27262976
L_s_loop2:
  s_add_u32 s13, s12, 4096
  buffer_load_dwordx4 v[192:195], v10, s[64:67], s12 offen offset:0 sc1
  buffer_load_dwordx4 v[196:199], v10, s[64:67], s12 offen offset:1024 sc1
  buffer_load_dwordx4 v[200:203], v10, s[64:67], s12 offen offset:2048 sc1
  buffer_load_dwordx4 v[204:207], v10, s[64:67], s12 offen offset:3072 sc1
  buffer_load_dwordx4 v[208:211], v10, s[64:67], s13 offen offset:0 sc1
  buffer_load_dwordx4 v[212:215], v10, s[64:67], s13 offen offset:1024 sc1
  buffer_load_dwordx4 v[216:219], v10, s[64:67], s13 offen offset:2048 sc1
  buffer_load_dwordx4 v[220:223], v10, s[64:67], s13 offen offset:3072 sc1
  s_waitcnt vmcnt(0)
  v_mfma_f32_16x16x32_bf16 v[64:67], v[192:195], v[160:163], v[224:227]
  v_mfma_f32_16x16x32_bf16 v[68:71], v[196:199], v[160:163], v[224:227]
  v_mfma_f32_16x16x32_bf16 v[72:75], v[200:203], v[160:163], v[224:227]
  v_mfma_f32_16x16x32_bf16 v[76:79], v[204:207], v[160:163], v[224:227]
  s_nop 7
  v_exp_f32 v64, v64
  v_exp_f32 v65, v65
  v_exp_f32 v66, v66
  v_exp_f32 v67, v67
  v_exp_f32 v68, v68
  v_exp_f32 v69, v69
  v_exp_f32 v70, v70
  v_exp_f32 v71, v71
  v_exp_f32 v72, v72
  v_exp_f32 v73, v73
  v_exp_f32 v74, v74
  v_exp_f32 v75, v75
  v_exp_f32 v76, v76
  v_exp_f32 v77, v77
  v_exp_f32 v78, v78
  v_exp_f32 v79, v79
  v_cvt_pk_bf16_f32 v96, v64, v65
  v_cvt_pk_bf16_f32 v97, v66, v67
  v_cvt_pk_bf16_f32 v98, v68, v69
  v_cvt_pk_bf16_f32 v99, v70, v71
  v_cvt_pk_bf16_f32 v100, v72, v73
  v_cvt_pk_bf16_f32 v101, v74, v75
  v_cvt_pk_bf16_f32 v102, v76, v77
  v_cvt_pk_bf16_f32 v103, v78, v79
  s_nop 1
  v_mfma_f32_16x16x32_bf16 v[16:19], v[208:211], v[96:99], v[16:19]
  v_mfma_f32_16x16x32_bf16 v[16:19], v[212:215], v[100:103], v[16:19]
  v_mfma_f32_16x16x32_bf16 v[20:23], v[220:223], v[100:103], v[20:23]
  v_mfma_f32_16x16x32_bf16 v[20:23], v[216:219], v[96:99], v[20:23]
  v_smfmac_f32_16x16x64_bf16 v[48:51], v[144:147], v[96:103], v148
  v_mfma_f32_16x16x32_bf16 v[64:67], v[192:195], v[164:167], v[228:231]
  v_mfma_f32_16x16x32_bf16 v[68:71], v[196:199], v[164:167], v[228:231]
  v_mfma_f32_16x16x32_bf16 v[72:75], v[200:203], v[164:167], v[228:231]
  v_mfma_f32_16x16x32_bf16 v[76:79], v[204:207], v[164:167], v[228:231]
  s_nop 7
  v_exp_f32 v64, v64
  v_exp_f32 v65, v65
  v_exp_f32 v66, v66
  v_exp_f32 v67, v67
  v_exp_f32 v68, v68
  v_exp_f32 v69, v69
  v_exp_f32 v70, v70
  v_exp_f32 v71, v71
  v_exp_f32 v72, v72
  v_exp_f32 v73, v73
  v_exp_f32 v74, v74
  v_exp_f32 v75, v75
  v_exp_f32 v76, v76
  v_exp_f32 v77, v77
  v_exp_f32 v78, v78
  v_exp_f32 v79, v79
  v_cvt_pk_bf16_f32 v96, v64, v65
  v_cvt_pk_bf16_f32 v97, v66, v67
  v_cvt_pk_bf16_f32 v98, v68, v69
  v_cvt_pk_bf16_f32 v99, v70, v71
  v_cvt_pk_bf16_f32 v100, v72, v73
  v_cvt_pk_bf16_f32 v101, v74, v75
  v_cvt_pk_bf16_f32 v102, v76, v77
  v_cvt_pk_bf16_f32 v103, v78, v79
  s_nop 1
  v_mfma_f32_16x16x32_bf16 v[24:27], v[208:211], v[96:99], v[24:27]
  v_mfma_f32_16x16x32_bf16 v[24:27], v[212:215], v[100:103], v[24:27]
  v_mfma_f32_16x16x32_bf16 v[28:31], v[220:223], v[100:103], v[28:31]
  v_mfma_f32_16x16x32_bf16 v[28:31], v[216:219], v[96:99], v[28:31]
  v_smfmac_f32_16x16x64_bf16 v[52:55], v[144:147], v[96:103], v148
  v_mfma_f32_16x16x32_bf16 v[64:67], v[192:195], v[168:171], v[232:235]
  v_mfma_f32_16x16x32_bf16 v[68:71], v[196:199], v[168:171], v[232:235]
  v_mfma_f32_16x16x32_bf16 v[72:75], v[200:203], v[168:171], v[232:235]
  v_mfma_f32_16x16x32_bf16 v[76:79], v[204:207], v[168:171], v[232:235]
  s_nop 7
  v_exp_f32 v64, v64
  v_exp_f32 v65, v65
  v_exp_f32 v66, v66
  v_exp_f32 v67, v67
  v_exp_f32 v68, v68
  v_exp_f32 v69, v69
  v_exp_f32 v70, v70
  v_exp_f32 v71, v71
  v_exp_f32 v72, v72
  v_exp_f32 v73, v73
  v_exp_f32 v74, v74
  v_exp_f32 v75, v75
  v_exp_f32 v76, v76
  v_exp_f32 v77, v77
  v_exp_f32 v78, v78
  v_exp_f32 v79, v79
  v_cvt_pk_bf16_f32 v96, v64, v65
  v_cvt_pk_bf16_f32 v97, v66, v67
  v_cvt_pk_bf16_f32 v98, v68, v69
  v_cvt_pk_bf16_f32 v99, v70, v71
  v_cvt_pk_bf16_f32 v100, v72, v73
  v_cvt_pk_bf16_f32 v101, v74, v75
  v_cvt_pk_bf16_f32 v102, v76, v77
  v_cvt_pk_bf16_f32 v103, v78, v79
  s_nop 1
  v_mfma_f32_16x16x32_bf16 v[32:35], v[208:211], v[96:99], v[32:35]
  v_mfma_f32_16x16x32_bf16 v[32:35], v[212:215], v[100:103], v[32:35]
  v_mfma_f32_16x16x32_bf16 v[36:39], v[220:223], v[100:103], v[36:39]
  v_mfma_f32_16x16x32_bf16 v[36:39], v[216:219], v[96:99], v[36:39]
  v_smfmac_f32_16x16x64_bf16 v[56:59], v[144:147], v[96:103], v148
  v_mfma_f32_16x16x32_bf16 v[64:67], v[192:195], v[172:175], v[236:239]
  v_mfma_f32_16x16x32_bf16 v[68:71], v[196:199], v[172:175], v[236:239]
  v_mfma_f32_16x16x32_bf16 v[72:75], v[200:203], v[172:175], v[236:239]
  v_mfma_f32_16x16x32_bf16 v[76:79], v[204:207], v[172:175], v[236:239]
  s_nop 7
  v_exp_f32 v64, v64
  v_exp_f32 v65, v65
  v_exp_f32 v66, v66
  v_exp_f32 v67, v67
  v_exp_f32 v68, v68
  v_exp_f32 v69, v69
  v_exp_f32 v70, v70
  v_exp_f32 v71, v71
  v_exp_f32 v72, v72
  v_exp_f32 v73, v73
  v_exp_f32 v74, v74
  v_exp_f32 v75, v75
  v_exp_f32 v76, v76
  v_exp_f32 v77, v77
  v_exp_f32 v78, v78
  v_exp_f32 v79, v79
  v_cvt_pk_bf16_f32 v96, v64, v65
  v_cvt_pk_bf16_f32 v97, v66, v67
  v_cvt_pk_bf16_f32 v98, v68, v69
  v_cvt_pk_bf16_f32 v99, v70, v71
  v_cvt_pk_bf16_f32 v100, v72, v73
  v_cvt_pk_bf16_f32 v101, v74, v75
  v_cvt_pk_bf16_f32 v102, v76, v77
  v_cvt_pk_bf16_f32 v103, v78, v79
  s_nop 1
  v_mfma_f32_16x16x32_bf16 v[40:43], v[208:211], v[96:99], v[40:43]
  v_mfma_f32_16x16x32_bf16 v[40:43], v[212:215], v[100:103], v[40:43]
  v_mfma_f32_16x16x32_bf16 v[44:47], v[220:223], v[100:103], v[44:47]
  v_mfma_f32_16x16x32_bf16 v[44:47], v[216:219], v[96:99], v[44:47]
  v_smfmac_f32_16x16x64_bf16 v[60:63], v[144:147], v[96:103], v148
  s_add_u32 s12, s12, 8192
  s_cmp_lg_u32 s12, 27525120
  s_cbranch_scc1 L_s_loop2
  s_nop 11
  s_cmp_eq_u32 s68, 1
  s_cbranch_scc1 L_s_q1
  v_add_f32 v4, v48, v49
  v_add_f32 v5, v52, v53
  v_rcp_f32 v4, v4
  v_rcp_f32 v5, v5
  v_mul_f32 v16, v4, v16
  v_mul_f32 v17, v4, v17
  v_mul_f32 v18, v4, v18
  v_mul_f32 v19, v4, v19
  v_mul_f32 v20, v4, v20
  v_mul_f32 v21, v4, v21
  v_mul_f32 v22, v4, v22
  v_mul_f32 v23, v4, v23
  v_cvt_pk_bf16_f32 v16, v16, v17
  v_cvt_pk_bf16_f32 v17, v18, v19
  v_cvt_pk_bf16_f32 v18, v20, v21
  v_cvt_pk_bf16_f32 v19, v22, v23
  buffer_store_dwordx4 v[16:19], v10, s[64:67], s16 offen sc1
  v_mul_f32 v24, v5, v24
  v_mul_f32 v25, v5, v25
  v_mul_f32 v26, v5, v26
  v_mul_f32 v27, v5, v27
  v_mul_f32 v28, v5, v28
  v_mul_f32 v29, v5, v29
  v_mul_f32 v30, v5, v30
  v_mul_f32 v31, v5, v31
  v_cvt_pk_bf16_f32 v24, v24, v25
  v_cvt_pk_bf16_f32 v25, v26, v27
  v_cvt_pk_bf16_f32 v26, v28, v29
  v_cvt_pk_bf16_f32 v27, v30, v31
  buffer_store_dwordx4 v[24:27], v248, s[64:67], s16 offen sc1
  s_waitcnt vmcnt(0)
  s_mov_b64 exec, 1
  v_mov_b32 v2, 0
  v_mov_b32 v3, 1
  buffer_store_dword v3, v2, s[64:67], s69 offen offset:4 sc1
  s_mov_b64 exec, -1
  s_barrier
  s_barrier
  s_barrier
  s_mov_b32 s19, 0
  s_andn2_b32 s24, 0x110, s19
  s_cselect_b32 s56, 0x7f000000, s22
  s_add_u32 s57, s56, 4096
  s_add_u32 s58, s56, s37
  s_add_u32 s59, s57, s37
L_s_q1:
  v_add_f32 v4, v56, v57
  v_add_f32 v5, v60, v61
  s_branch L_a_norm1
L_exit:
  s_endpgm
.section .rodata,"a"
.p2align 6
.amdhsa_kernel gated_mix__grouped_kv_mqa__dense_activation_squared_relu__prompt_kernel
  .amdhsa_next_free_vgpr 256
  .amdhsa_next_free_sgpr 102
  .amdhsa_accum_offset 256
  .amdhsa_group_segment_fixed_size 0
  .amdhsa_kernarg_size 112
  .amdhsa_user_sgpr_count 2
  .amdhsa_user_sgpr_kernarg_segment_ptr 1
  .amdhsa_system_sgpr_workgroup_id_x 1
.end_amdhsa_kernel
```
